```python
import torch

def _softmax(x, axis=-1):
    return torch.softmax(x, dim=axis)
def _gelu(x):
    return torch.nn.functional.gelu(x, approximate="tanh")
def _silu(x):
    return torch.nn.functional.silu(x)
def _sigmoid(x):
    return torch.sigmoid(x)
def _layernorm(x, axis=-1, eps=1e-5):
    m = x.mean(dim=axis, keepdim=True)
    v = x.var(dim=axis, keepdim=True, unbiased=False)
    return (x - m) / torch.sqrt(v + eps)
def _scatter_add(tgt, idx, src, axis=0):
    return tgt.clone().index_add_(axis, idx, src)
def _segment_sum(src, seg, n):
    out = torch.zeros((n,) + src.shape[1:], dtype=src.dtype)
    return out.index_add_(0, seg, src)
def _pad(x, pw):
    flat = tuple(v for pair in reversed(pw) for v in pair)
    return torch.nn.functional.pad(x, flat)

kernel_name = 'standalone__gqa_block_cached__near_ridge'

def setup_inputs():

    _w = (lambda a: (lambda t: t.to(torch.bfloat16) if t.is_floating_point() else t)(torch.as_tensor(a)))
    B, Sq, D = 32, 144, 640
    Hq, Hkv, Sk, Dh = 32, 32, 512, 128
    assert Hq % Hkv == 0, (Hq, Hkv)
    return {
        "x": _w((lambda *s: torch.randn(*s, dtype=torch.bfloat16) * 0.8)(B, Sq, D)),
        "k_cache": _w((lambda *s: torch.randn(*s, dtype=torch.bfloat16) * 0.8)(B, Hkv, Sk, Dh)),
        "v_cache": _w((lambda *s: torch.randn(*s, dtype=torch.bfloat16) * 0.05)(B, Hkv, Sk, Dh)),
        "wq": _w((lambda *s: torch.randn(*s, dtype=torch.bfloat16) * 0.8)(D, Hq * Dh) * (D ** -0.5)),
        "wo": _w((lambda *s: torch.randn(*s, dtype=torch.bfloat16) * 0.05)(Hq * Dh, D) * ((Hq * Dh) ** -0.5)),
    }

def reference(x, k_cache, v_cache, wq, wo):
    B, Sq, D = x.shape
    Hq, Dh = 32, 128
    Hkv = k_cache.shape[1]
    rep = Hq // Hkv
    q = (lambda x, *d: x.permute(*d))((x @ wq).reshape(B, Sq, Hq, Dh), 0, 2, 1, 3)
    k = (lambda x, n, axis: torch.repeat_interleave(x, n, dim=axis))(k_cache, rep, axis=1)
    v = (lambda x, n, axis: torch.repeat_interleave(x, n, dim=axis))(v_cache, rep, axis=1)
    scores = torch.einsum("bhqd,bhkd->bhqk", q, k) * (Dh ** -0.5)
    p = _softmax(scores, axis=-1)
    o = torch.einsum("bhqk,bhkd->bhqd", p, v)
    return (lambda x, *d: x.permute(*d))(o, 0, 2, 1, 3).reshape(B, Sq, Hq * Dh) @ wo
```

```asm
; @launch grid=(256,1,1) block=(256,1,1) lds=163840
.amdgcn_target "amdgcn-amd-amdhsa--gfx950"
.text
.globl standalone__gqa_block_cached__near_ridge_kernel
.p2align 8
.type standalone__gqa_block_cached__near_ridge_kernel,@function
standalone__gqa_block_cached__near_ridge_kernel:
s_cmp_ge_u32 s2,256
s_cbranch_scc1 L_early
s_load_dwordx16 s[4:19],s[0:1],0
s_getpc_b64 s[76:77]
L_cpf:
s_mov_b32 s78,L_code_end-L_cpf
s_mov_b32 s79,0x20000
v_lshlrev_b32 v9,3,v0
s_lshr_b32 s3,s2,3
s_lshl_b32 s3,s3,12
buffer_load_dwordx2 a[252:253],v9,s[76:79],0 offen offset:0
v_lshl_add_u32 v8,v9,1,s3
buffer_load_dwordx4 a[248:251],v8,s[76:79],0 offen offset:2048
s_branch L_go
L_early:
s_endpgm
L_go:
v_lshrrev_b32 v4,6,v0
v_and_b32 v1,63,v0
v_bfe_u32 v2,v0,4,2
v_and_b32 v3,15,v0
v_readfirstlane_b32 s48,v4
v_lshlrev_b32 v10,4,v1
s_nop 1
s_and_b32 s83,s48,1
s_lshr_b32 s82,s48,1
s_lshl_b32 s84,s82,14
s_and_b32 s3,s2,7
s_lshr_b32 s57,s2,3
s_and_b32 s51,s57,7
s_lshr_b32 s57,s57,3
s_lshl_b32 s49,s3,2
s_add_u32 s49,s49,s57
s_lshl_b32 s50,s51,1
s_add_u32 s50,s50,s82
s_mov_b32 s93,0
s_and_b32 s59,s57,2
s_and_b32 s57,s51,3
s_mul_i32 s57,s57,5
s_add_u32 s57,s57,1
s_lshr_b32 s57,s57,1
s_add_u32 s59,s59,s57
s_add_u32 s59,s59,s3
s_cmp_ge_u32 s59,10
s_cselect_b32 s57,10,0
s_sub_u32 s59,s59,s57
s_cmp_ge_u32 s59,10
s_cselect_b32 s57,10,0
s_sub_u32 s59,s59,s57
s_lshl_b32 s91,s59,7
s_lshl_b32 s92,s59,19
s_lshl_b32 s85,s83,11
s_add_u32 s85,s85,s84
s_lshl_b32 s87,s48,12
s_lshl_b32 s88,s48,9
v_lshrrev_b32 v4,3,v1
v_and_b32 v5,7,v1
v_xor_b32 v7,v5,v2
s_lshl_b32 s59,s48,5
v_add_u32 v6,s59,v4
v_mul_u32_u24 v6,1280,v6
v_lshl_add_u32 v16,v7,4,v6
v_xor_b32 v17,64,v16
s_lshl_b32 s59,s48,2
s_add_u32 s59,s59,128
v_add_u32 v6,s59,v4
v_mul_u32_u24 v6,1280,v6
s_lshl_b32 s59,s48,1
v_xor_b32 v7,s59,v7
v_lshl_add_u32 v18,v7,4,v6
s_lshl_b32 s59,s83,3
v_add_u32 v4,s59,v2
v_lshlrev_b32 v5,2,v2
s_lshl_b32 s59,s83,1
v_add_u32 v5,s59,v5
v_xor_b32 v5,v5,v3
v_lshlrev_b32 v5,4,v5
v_and_b32 v6,1,v2
v_add_u32 v6,s59,v6
v_lshlrev_b32 v6,1,v6
v_and_b32 v7,7,v1
v_xor_b32 v6,v6,v7
v_lshlrev_b32 v6,4,v6
v_lshrrev_b32 v7,3,v1
v_lshl_add_u32 v6,v7,13,v6
s_lshl_b32 s57,s83,16
v_add_u32 v15,s57,v6
s_lshl_b32 s101,s83,10
s_add_u32 s101,s101,s84
v_lshl_add_u32 v14,v4,8,v5
s_lshl_b32 s59,s83,2
v_xor_b32 v5,v2,v3
v_xor_b32 v5,s59,v5
v_lshlrev_b32 v5,4,v5
v_lshl_add_u32 v12,v4,8,v5
v_xor_b32 v13,128,v12
s_mul_i32 s59,s49,184320
s_lshl_b32 s57,s50,8
s_mov_b32 s22,184320
s_mov_b32 s23,0x20000
s_sub_u32 s26,5242880,s57
s_mov_b32 s27,0x20000
s_waitcnt lgkmcnt(0)
s_add_u32 s20,s4,s59
s_addc_u32 s21,s5,0
s_add_u32 s24,s10,s57
s_addc_u32 s25,s11,0
s_add_u32 m0,s87,32768
s_add_u32 s58,s91,0
buffer_load_dwordx4 v16,s[20:23],s58 offen lds
s_add_u32 m0,s87,33792
s_add_u32 s58,s91,10240
buffer_load_dwordx4 v17,s[20:23],s58 offen lds
s_add_u32 m0,s87,34816
s_add_u32 s58,s91,20480
buffer_load_dwordx4 v16,s[20:23],s58 offen lds
s_add_u32 m0,s87,35840
s_add_u32 s58,s91,30720
buffer_load_dwordx4 v17,s[20:23],s58 offen lds
s_add_u32 m0,s88,131072
s_mov_b64 exec,0xffffffff
buffer_load_dwordx4 v18,s[20:23],s91 offen lds
s_mov_b64 exec,-1
s_add_u32 s91,s91,128
s_cmp_eq_u32 s91,1280
s_cselect_b32 s91,0,s91
s_add_u32 m0,s101,65536
s_add_u32 s58,s92,0
buffer_load_dwordx4 v15,s[24:27],s58 offen lds
s_add_u32 m0,s101,67584
s_add_u32 s58,s92,131072
buffer_load_dwordx4 v15,s[24:27],s58 offen lds
s_add_u32 m0,s101,69632
s_add_u32 s58,s92,262144
buffer_load_dwordx4 v15,s[24:27],s58 offen lds
s_add_u32 m0,s101,71680
s_add_u32 s58,s92,393216
buffer_load_dwordx4 v15,s[24:27],s58 offen lds
s_add_u32 m0,s101,73728
s_add_u32 s58,s92,128
buffer_load_dwordx4 v15,s[24:27],s58 offen lds
s_add_u32 m0,s101,75776
s_add_u32 s58,s92,131200
buffer_load_dwordx4 v15,s[24:27],s58 offen lds
s_add_u32 m0,s101,77824
s_add_u32 s58,s92,262272
buffer_load_dwordx4 v15,s[24:27],s58 offen lds
s_add_u32 m0,s101,79872
s_add_u32 s58,s92,393344
buffer_load_dwordx4 v15,s[24:27],s58 offen lds
s_add_u32 s92,s92,524288
s_cmp_eq_u32 s92,5242880
s_cselect_b32 s92,0,s92
s_add_u32 m0,s87,49152
s_add_u32 s58,s91,0
buffer_load_dwordx4 v16,s[20:23],s58 offen lds
s_add_u32 m0,s87,50176
s_add_u32 s58,s91,10240
buffer_load_dwordx4 v17,s[20:23],s58 offen lds
s_add_u32 m0,s87,51200
s_add_u32 s58,s91,20480
buffer_load_dwordx4 v16,s[20:23],s58 offen lds
s_add_u32 m0,s87,52224
s_add_u32 s58,s91,30720
buffer_load_dwordx4 v17,s[20:23],s58 offen lds
s_add_u32 m0,s88,133120
s_mov_b64 exec,0xffffffff
buffer_load_dwordx4 v18,s[20:23],s91 offen lds
s_mov_b64 exec,-1
s_add_u32 s91,s91,128
s_cmp_eq_u32 s91,1280
s_cselect_b32 s91,0,s91
s_lshl_b32 s57,s49,5
s_add_u32 s57,s57,s50
s_lshl_b32 s59,s57,17
s_add_u32 s28,s6,s59
s_addc_u32 s29,s7,0
s_mov_b32 s30,2228224
s_mov_b32 s31,0x20000
s_add_u32 s32,s8,s59
s_addc_u32 s33,s9,0
s_mov_b32 s34,2228224
s_mov_b32 s35,0x20000
s_mul_i32 s59,s57,36864
s_add_u32 s36,s18,s59
s_addc_u32 s37,s19,0
s_mov_b32 s38,626688
s_mov_b32 s39,0x20000
s_mov_b32 s11,0
s_lshl_b32 s59,s82,12
s_or_b32 s11,s11,s59
s_bfe_u32 s59,s2,0x10005
s_lshl_b32 s59,s59,13
s_or_b32 s11,s11,s59
s_lshl_b32 s8,s83,13
s_mov_b32 s74,0x3e0293ee
s_mov_b32 s75,s74
s_mul_i32 s90,s83,22528
s_mul_i32 s86,s83,14336
s_sub_u32 s86,18432,s86
s_mul_i32 s89,s83,18432
s_add_u32 s89,s89,8192
s_mov_b32 s40,s12
s_mov_b32 s41,s13
s_mov_b32 s42,5242880
s_mov_b32 s43,0x20000
s_add_u32 s44,s18,37748736
s_addc_u32 s45,s19,0
s_mov_b32 s46,5242880
s_mov_b32 s47,0x20000
s_mov_b32 s96,s16
s_mov_b32 s97,s17
s_mov_b32 s98,256
s_mov_b32 s99,0x20000
s_getreg_b32 s53,hwreg(HW_REG_XCC_ID)
s_and_b32 s100,s53,1
s_and_b32 s53,s53,7
s_or_b32 s53,s53,0x80
s_mul_i32 s53,s53,0x01010101
s_lshl_b32 s55,s49,3
s_add_u32 s55,s55,s51
s_lshl_b32 s56,s51,2
s_lshr_b32 s54,s2,3
s_mul_i32 s54,s54,7
s_lshr_b32 s54,s54,5
s_cmp_eq_u32 s48,0
s_cselect_b32 s54,s54,99
v_bfe_u32 v4,v0,2,2
v_and_b32 v5,1,v2
v_lshl_add_u32 v5,v4,1,v5
s_lshl_b32 s59,s83,2
v_xor_b32 v5,s59,v5
v_lshlrev_b32 v5,5,v5
v_lshl_add_u32 v6,v2,3,v4
v_lshl_add_u32 v5,v6,8,v5
v_and_b32 v6,3,v0
v_lshl_add_u32 v5,v6,3,v5
s_lshl_b32 s57,s83,13
s_add_u32 s57,s57,s84
s_add_u32 s59,s57,65536
v_add_u32 v24,s59,v5
v_xor_b32 v25,32,v24
v_xor_b32 v26,64,v24
v_xor_b32 v27,96,v24
v_xor_b32 v28,128,v24
v_xor_b32 v29,160,v24
v_xor_b32 v30,192,v24
v_xor_b32 v31,224,v24
v_xor_b32 v32,8192,v24
v_xor_b32 v33,8224,v24
v_xor_b32 v34,8256,v24
v_xor_b32 v35,8288,v24
v_xor_b32 v36,8320,v24
v_xor_b32 v37,8352,v24
v_xor_b32 v38,8384,v24
v_xor_b32 v39,8416,v24
v_xor_b32 v5,s83,v2
v_and_b32 v5,1,v5
v_lshrrev_b32 v7,1,v4
v_lshl_add_u32 v5,v5,1,v7
v_lshlrev_b32 v5,5,v5
v_lshlrev_b32 v7,4,v6
v_xor_b32 v5,v7,v5
v_lshl_add_u32 v7,v2,3,v4
v_lshl_add_u32 v5,v7,7,v5
s_add_u32 s59,s84,65536
v_add_u32 v5,s59,v5
v_xor_b32 v19,v5,v24
v_xor_b32 v24,v19,v24
v_xor_b32 v26,v19,v26
v_lshl_add_u32 v5,v4,3,v6
v_xor_b32 v7,v2,v3
s_lshl_b32 s59,s83,2
v_xor_b32 v7,s59,v7
v_lshlrev_b32 v7,4,v7
v_lshl_add_u32 v7,v5,8,v7
v_add_u32 v40,s57,v7
v_xor_b32 v41,64,v40
v_xor_b32 v42,128,v40
v_xor_b32 v43,192,v40
v_xor_b32 v44,8192,v40
v_xor_b32 v45,8256,v40
v_xor_b32 v46,8320,v40
v_xor_b32 v47,8384,v40
v_mov_b32 v176,0x3f803f80
v_mov_b32 v177,0x3f803f80
v_mov_b32 v178,0x3f803f80
v_mov_b32 v179,0x3f803f80
s_getpc_b64 s[60:61]
L_pcA0:
s_add_u32 s60,s60,L_rsA0-L_pcA0
s_addc_u32 s61,s61,0
s_getpc_b64 s[64:65]
L_pcA1:
s_add_u32 s64,s64,L_rsA1-L_pcA1
s_addc_u32 s65,s65,0
s_getpc_b64 s[66:67]
L_pc9:
s_add_u32 s66,s66,L_rs9-L_pc9
s_addc_u32 s67,s67,0
s_getpc_b64 s[80:81]
L_pcP2:
s_add_u32 s80,s80,L_rsP2-L_pcP2
s_addc_u32 s81,s81,0
s_lshr_b32 s68,s2,1
s_and_b32 s69,s2,1
s_mul_i32 s70,s68,40960
s_mul_i32 s71,s69,640
s_add_u32 s70,s70,s71
s_mul_i32 s71,s48,10240
s_add_u32 s70,s70,s71
s_lshl_b32 s69,s69,2
s_add_u32 s69,s69,s48
s_lshl_b32 s69,s69,7
s_add_u32 s69,s69,s68
s_mul_i32 s69,s69,5120
s_add_u32 s68,s69,4096
v_add_u32 v4,0,v1
v_mul_u32_u24 v5,1639,v4
v_lshrrev_b32 v5,16,v5
v_mul_u32_u24 v5,640,v5
v_lshl_add_u32 v180,v4,4,v5
v_add_u32 v4,64,v1
v_mul_u32_u24 v5,1639,v4
v_lshrrev_b32 v5,16,v5
v_mul_u32_u24 v5,640,v5
v_lshl_add_u32 v181,v4,4,v5
v_add_u32 v4,128,v1
v_mul_u32_u24 v5,1639,v4
v_lshrrev_b32 v5,16,v5
v_mul_u32_u24 v5,640,v5
v_lshl_add_u32 v182,v4,4,v5
v_add_u32 v4,192,v1
v_mul_u32_u24 v5,1639,v4
v_lshrrev_b32 v5,16,v5
v_mul_u32_u24 v5,640,v5
v_lshl_add_u32 v183,v4,4,v5
v_add_u32 v4,256,v1
v_mul_u32_u24 v5,1639,v4
v_lshrrev_b32 v5,16,v5
v_mul_u32_u24 v5,640,v5
v_lshl_add_u32 v184,v4,4,v5
v_lshrrev_b32 v4,2,v1
v_mul_u32_u24 v4,640,v4
v_and_b32 v5,3,v0
v_lshl_add_u32 v4,v5,3,v4
s_mul_i32 s71,s48,160
s_add_u32 s71,s71,143360
v_add_u32 v8,s71,v4
s_mul_i32 s71,s48,5120
v_bfe_u32 v4,v0,1,3
v_xor_b32 v4,v4,v2
v_lshlrev_b32 v4,4,v4
v_lshl_add_u32 v4,v3,7,v4
s_lshl_b32 s59,s83,13
v_add_u32 v252,s59,v4
v_add_u32 v254,131072,v4
v_xor_b32 v253,64,v252
v_xor_b32 v255,64,v254
s_add_u32 m0,s101,98304
s_add_u32 s58,s92,0
buffer_load_dwordx4 v15,s[24:27],s58 offen lds
s_add_u32 m0,s101,100352
s_add_u32 s58,s92,131072
buffer_load_dwordx4 v15,s[24:27],s58 offen lds
s_add_u32 m0,s101,102400
s_add_u32 s58,s92,262144
buffer_load_dwordx4 v15,s[24:27],s58 offen lds
s_add_u32 m0,s101,104448
s_add_u32 s58,s92,393216
buffer_load_dwordx4 v15,s[24:27],s58 offen lds
s_waitcnt vmcnt(17)
s_barrier
ds_read_b128 a[0:3],v252 offset:32768
ds_read_b128 a[4:7],v252 offset:34816
ds_read_b128 a[8:11],v252 offset:36864
ds_read_b128 a[12:15],v252 offset:38912
ds_read_b128 a[16:19],v254 offset:0
ds_read_b128 a[20:23],v253 offset:32768
ds_read_b128 a[24:27],v253 offset:34816
ds_read_b128 a[28:31],v253 offset:36864
ds_read_b128 a[32:35],v253 offset:38912
ds_read_b128 a[36:39],v255 offset:0
s_waitcnt vmcnt(13) lgkmcnt(0)
s_barrier
ds_read_b64_tr_b16 a[160:161],v24 offset:0
ds_read_b64_tr_b16 a[162:163],v24 offset:512
ds_read_b64_tr_b16 a[164:165],v24 offset:4096
ds_read_b64_tr_b16 a[166:167],v24 offset:4608
ds_read_b64_tr_b16 a[168:169],v24 offset:8
ds_read_b64_tr_b16 a[170:171],v24 offset:520
ds_read_b64_tr_b16 a[172:173],v24 offset:4104
ds_read_b64_tr_b16 a[174:175],v24 offset:4616
ds_read_b64_tr_b16 a[176:177],v26 offset:0
ds_read_b64_tr_b16 a[178:179],v26 offset:512
s_waitcnt lgkmcnt(8)
v_mfma_f32_16x16x32_bf16 a[128:131],a[160:163],a[16:19],0
s_add_u32 m0,s87,32768
s_add_u32 s58,s91,0
s_waitcnt lgkmcnt(6)
v_mfma_f32_16x16x32_bf16 a[128:131],a[164:167],a[36:39],a[128:131]
buffer_load_dwordx4 v16,s[20:23],s58 offen lds
v_mfma_f32_16x16x32_bf16 v[128:131],a[164:167],a[20:23],0
ds_read_b64_tr_b16 a[180:181],v26 offset:4096
ds_read_b64_tr_b16 a[182:183],v26 offset:4608
v_mfma_f32_16x16x32_bf16 v[128:131],a[160:163],a[0:3],v[128:131]
s_add_u32 m0,s87,33792
s_add_u32 s58,s91,10240
v_mfma_f32_16x16x32_bf16 v[132:135],a[160:163],a[4:7],0
ds_read_b64_tr_b16 a[184:185],v26 offset:8
ds_read_b64_tr_b16 a[186:187],v26 offset:520
v_mfma_f32_16x16x32_bf16 v[132:135],a[164:167],a[24:27],v[132:135]
buffer_load_dwordx4 v17,s[20:23],s58 offen lds
v_mfma_f32_16x16x32_bf16 v[48:51],a[164:167],a[28:31],0
ds_read_b64_tr_b16 a[188:189],v26 offset:4104
ds_read_b64_tr_b16 a[190:191],v26 offset:4616
v_mfma_f32_16x16x32_bf16 v[48:51],a[160:163],a[8:11],v[48:51]
s_add_u32 m0,s87,34816
s_add_u32 s58,s91,20480
v_mfma_f32_16x16x32_bf16 v[52:55],a[160:163],a[12:15],0
v_mfma_f32_16x16x32_bf16 v[52:55],a[164:167],a[32:35],v[52:55]
buffer_load_dwordx4 v16,s[20:23],s58 offen lds
s_waitcnt lgkmcnt(2)
v_mfma_f32_16x16x32_bf16 v[68:71],a[172:175],a[32:35],0
s_add_u32 m0,s87,35840
s_add_u32 s58,s91,30720
v_mfma_f32_16x16x32_bf16 v[68:71],a[168:171],a[12:15],v[68:71]
v_mfma_f32_16x16x32_bf16 v[64:67],a[168:171],a[8:11],0
s_waitcnt vmcnt(7) lgkmcnt(0)
s_barrier
v_mfma_f32_16x16x32_bf16 v[64:67],a[172:175],a[28:31],v[64:67]
buffer_load_dwordx4 v17,s[20:23],s58 offen lds
v_mfma_f32_16x16x32_bf16 v[60:63],a[172:175],a[24:27],0
ds_read_b128 a[40:43],v252 offset:49152
v_mfma_f32_16x16x32_bf16 v[60:63],a[168:171],a[4:7],v[60:63]
ds_read_b64_tr_b16 a[192:193],v24 offset:8192
ds_read_b64_tr_b16 a[194:195],v24 offset:8704
v_mfma_f32_16x16x32_bf16 v[56:59],a[168:171],a[0:3],0
s_add_u32 m0,s88,131072
v_mfma_f32_16x16x32_bf16 v[56:59],a[172:175],a[20:23],v[56:59]
s_mov_b64 exec,0xffffffff
buffer_load_dwordx4 v18,s[20:23],s91 offen lds
s_mov_b64 exec,-1
v_mfma_f32_16x16x32_bf16 a[132:135],a[172:175],a[36:39],0
ds_read_b128 a[44:47],v252 offset:51200
v_mfma_f32_16x16x32_bf16 a[132:135],a[168:171],a[16:19],a[132:135]
ds_read_b64_tr_b16 a[196:197],v24 offset:12288
ds_read_b64_tr_b16 a[198:199],v24 offset:12800
v_mfma_f32_16x16x32_bf16 v[72:75],a[176:179],a[0:3],0
s_add_u32 s91,s91,128
v_mfma_f32_16x16x32_bf16 v[72:75],a[180:183],a[20:23],v[72:75]
s_cmp_eq_u32 s91,1280
s_cselect_b32 s91,0,s91
v_mfma_f32_16x16x32_bf16 v[76:79],a[180:183],a[24:27],0
s_add_u32 m0,s101,106496
s_add_u32 s58,s92,128
v_mfma_f32_16x16x32_bf16 v[76:79],a[176:179],a[4:7],v[76:79]
buffer_load_dwordx4 v15,s[24:27],s58 offen lds
v_mfma_f32_16x16x32_bf16 v[136:139],a[176:179],a[8:11],0
ds_read_b128 a[48:51],v252 offset:53248
v_mfma_f32_16x16x32_bf16 v[136:139],a[180:183],a[28:31],v[136:139]
ds_read_b64_tr_b16 a[160:161],v24 offset:8200
ds_read_b64_tr_b16 a[162:163],v24 offset:8712
v_mfma_f32_16x16x32_bf16 v[140:143],a[180:183],a[32:35],0
s_add_u32 m0,s101,108544
s_add_u32 s58,s92,131200
v_mfma_f32_16x16x32_bf16 v[140:143],a[176:179],a[12:15],v[140:143]
buffer_load_dwordx4 v15,s[24:27],s58 offen lds
v_mfma_f32_16x16x32_bf16 v[124:127],a[184:187],a[12:15],0
ds_read_b128 a[52:55],v252 offset:55296
v_mfma_f32_16x16x32_bf16 v[124:127],a[188:191],a[32:35],v[124:127]
ds_read_b64_tr_b16 a[164:165],v24 offset:12296
ds_read_b64_tr_b16 a[166:167],v24 offset:12808
v_mfma_f32_16x16x32_bf16 v[120:123],a[188:191],a[28:31],0
s_add_u32 m0,s101,110592
s_add_u32 s58,s92,262272
v_mfma_f32_16x16x32_bf16 v[120:123],a[184:187],a[8:11],v[120:123]
buffer_load_dwordx4 v15,s[24:27],s58 offen lds
v_mfma_f32_16x16x32_bf16 v[116:119],a[184:187],a[4:7],0
ds_read_b128 a[56:59],v254 offset:2048
v_mfma_f32_16x16x32_bf16 v[116:119],a[188:191],a[24:27],v[116:119]
s_add_u32 m0,s101,112640
s_add_u32 s58,s92,393344
v_mfma_f32_16x16x32_bf16 v[112:115],a[188:191],a[20:23],0
v_mfma_f32_16x16x32_bf16 v[112:115],a[184:187],a[0:3],v[112:115]
buffer_load_dwordx4 v15,s[24:27],s58 offen lds
s_waitcnt lgkmcnt(1)
v_mfma_f32_16x16x32_bf16 a[136:139],a[192:195],a[16:19],0
ds_read_b64_tr_b16 a[172:173],v26 offset:8192
ds_read_b64_tr_b16 a[174:175],v26 offset:8704
v_mfma_f32_16x16x32_bf16 a[136:139],a[196:199],a[36:39],a[136:139]
s_add_u32 s92,s92,524288
v_mfma_f32_16x16x32_bf16 v[80:83],a[196:199],a[20:23],0
s_cmp_eq_u32 s92,5242880
s_cselect_b32 s92,0,s92
v_mfma_f32_16x16x32_bf16 v[80:83],a[192:195],a[0:3],v[80:83]
s_add_u32 m0,s85,0
s_xor_b32 s58,s11,0
v_mfma_f32_16x16x32_bf16 v[84:87],a[192:195],a[4:7],0
buffer_load_dwordx4 v12,s[28:31],s58 offen nt lds
v_mfma_f32_16x16x32_bf16 v[84:87],a[196:199],a[24:27],v[84:87]
ds_read_b128 a[60:63],v253 offset:49152
ds_read_b128 a[64:67],v253 offset:51200
v_mfma_f32_16x16x32_bf16 v[88:91],a[196:199],a[28:31],0
v_mfma_f32_16x16x32_bf16 v[88:91],a[192:195],a[8:11],v[88:91]
ds_read_b64_tr_b16 a[168:169],v26 offset:12288
ds_read_b64_tr_b16 a[170:171],v26 offset:12800
v_mfma_f32_16x16x32_bf16 v[92:95],a[192:195],a[12:15],0
buffer_load_dwordx4 v12,s[28:31],s58 offen offset:1024 nt lds
v_mfma_f32_16x16x32_bf16 v[92:95],a[196:199],a[32:35],v[92:95]
ds_read_b128 a[68:71],v253 offset:53248
ds_read_b128 a[72:75],v253 offset:55296
v_mfma_f32_16x16x32_bf16 v[108:111],a[164:167],a[32:35],0
s_add_u32 m0,s85,4096
s_xor_b32 s58,s11,32768
v_mfma_f32_16x16x32_bf16 v[108:111],a[160:163],a[12:15],v[108:111]
ds_read_b64_tr_b16 a[180:181],v26 offset:8200
ds_read_b64_tr_b16 a[182:183],v26 offset:8712
v_mfma_f32_16x16x32_bf16 v[104:107],a[160:163],a[8:11],0
buffer_load_dwordx4 v13,s[28:31],s58 offen nt lds
v_mfma_f32_16x16x32_bf16 v[104:107],a[164:167],a[28:31],v[104:107]
ds_read_b128 a[76:79],v255 offset:2048
v_mfma_f32_16x16x32_bf16 v[100:103],a[164:167],a[24:27],0
ds_read_b64_tr_b16 a[176:177],v26 offset:12296
ds_read_b64_tr_b16 a[178:179],v26 offset:12808
v_mfma_f32_16x16x32_bf16 v[100:103],a[160:163],a[4:7],v[100:103]
v_mfma_f32_16x16x32_bf16 v[96:99],a[160:163],a[0:3],0
buffer_load_dwordx4 v13,s[28:31],s58 offen offset:1024 nt lds
v_mfma_f32_16x16x32_bf16 v[96:99],a[164:167],a[20:23],v[96:99]
s_add_u32 m0,s85,8192
s_xor_b32 s58,s11,8192
v_mfma_f32_16x16x32_bf16 a[140:143],a[164:167],a[36:39],0
v_mfma_f32_16x16x32_bf16 a[140:143],a[160:163],a[16:19],a[140:143]
s_waitcnt lgkmcnt(0)
v_mfma_f32_16x16x32_bf16 v[144:147],a[172:175],a[0:3],0
buffer_load_dwordx4 v12,s[28:31],s58 offen nt lds
v_mfma_f32_16x16x32_bf16 v[144:147],a[168:171],a[20:23],v[144:147]
buffer_load_dwordx4 v12,s[28:31],s58 offen offset:1024 nt lds
s_add_u32 m0,s85,12288
s_xor_b32 s58,s11,40960
buffer_load_dwordx4 v13,s[28:31],s58 offen nt lds
buffer_load_dwordx4 v13,s[28:31],s58 offen offset:1024 nt lds
s_waitcnt vmcnt(17)
s_barrier
v_mfma_f32_16x16x32_bf16 v[148:151],a[168:171],a[24:27],0
ds_read_b64_tr_b16 a[188:189],v24 offset:32768
ds_read_b64_tr_b16 a[190:191],v24 offset:33280
v_mfma_f32_16x16x32_bf16 v[148:151],a[172:175],a[4:7],v[148:151]
s_add_u32 m0,s101,65536
s_add_u32 s58,s92,0
v_mfma_f32_16x16x32_bf16 v[152:155],a[172:175],a[8:11],0
buffer_load_dwordx4 v15,s[24:27],s58 offen lds
v_mfma_f32_16x16x32_bf16 v[152:155],a[168:171],a[28:31],v[152:155]
ds_read_b64_tr_b16 a[184:185],v24 offset:36864
ds_read_b64_tr_b16 a[186:187],v24 offset:37376
v_mfma_f32_16x16x32_bf16 v[156:159],a[168:171],a[32:35],0
s_add_u32 m0,s101,67584
s_add_u32 s58,s92,131072
v_mfma_f32_16x16x32_bf16 v[156:159],a[172:175],a[12:15],v[156:159]
ds_read_b64_tr_b16 a[192:193],v24 offset:32776
ds_read_b64_tr_b16 a[194:195],v24 offset:33288
v_mfma_f32_16x16x32_bf16 v[172:175],a[180:183],a[12:15],0
buffer_load_dwordx4 v15,s[24:27],s58 offen lds
v_mfma_f32_16x16x32_bf16 v[172:175],a[176:179],a[32:35],v[172:175]
ds_read_b64_tr_b16 a[196:197],v24 offset:36872
ds_read_b64_tr_b16 a[198:199],v24 offset:37384
v_mfma_f32_16x16x32_bf16 v[168:171],a[176:179],a[28:31],0
s_add_u32 m0,s101,69632
s_add_u32 s58,s92,262144
v_mfma_f32_16x16x32_bf16 v[168:171],a[180:183],a[8:11],v[168:171]
ds_read_b64_tr_b16 a[164:165],v26 offset:32768
ds_read_b64_tr_b16 a[166:167],v26 offset:33280
v_mfma_f32_16x16x32_bf16 v[164:167],a[180:183],a[4:7],0
buffer_load_dwordx4 v15,s[24:27],s58 offen lds
v_mfma_f32_16x16x32_bf16 v[164:167],a[176:179],a[24:27],v[164:167]
ds_read_b64_tr_b16 a[160:161],v26 offset:36864
ds_read_b64_tr_b16 a[162:163],v26 offset:37376
v_mfma_f32_16x16x32_bf16 v[160:163],a[176:179],a[20:23],0
s_add_u32 m0,s101,71680
s_add_u32 s58,s92,393216
v_mfma_f32_16x16x32_bf16 v[160:163],a[180:183],a[0:3],v[160:163]
ds_read_b64_tr_b16 a[168:169],v26 offset:32776
ds_read_b64_tr_b16 a[170:171],v26 offset:33288
s_waitcnt lgkmcnt(4)
v_mfma_f32_16x16x32_bf16 a[128:131],a[188:191],a[56:59],a[128:131]
buffer_load_dwordx4 v15,s[24:27],s58 offen lds
v_mfma_f32_16x16x32_bf16 a[128:131],a[184:187],a[76:79],a[128:131]
ds_read_b64_tr_b16 a[172:173],v26 offset:36872
ds_read_b64_tr_b16 a[174:175],v26 offset:37384
v_mfma_f32_16x16x32_bf16 v[128:131],a[184:187],a[60:63],v[128:131]
s_add_u32 m0,s87,49152
s_add_u32 s58,s91,0
v_mfma_f32_16x16x32_bf16 v[128:131],a[188:191],a[40:43],v[128:131]
v_mfma_f32_16x16x32_bf16 v[132:135],a[188:191],a[44:47],v[132:135]
buffer_load_dwordx4 v16,s[20:23],s58 offen lds
v_mfma_f32_16x16x32_bf16 v[132:135],a[184:187],a[64:67],v[132:135]
s_add_u32 m0,s87,50176
s_add_u32 s58,s91,10240
v_mfma_f32_16x16x32_bf16 v[48:51],a[184:187],a[68:71],v[48:51]
v_mfma_f32_16x16x32_bf16 v[48:51],a[188:191],a[48:51],v[48:51]
s_waitcnt vmcnt(13) lgkmcnt(0)
s_barrier
v_mfma_f32_16x16x32_bf16 v[52:55],a[188:191],a[52:55],v[52:55]
buffer_load_dwordx4 v17,s[20:23],s58 offen lds
v_mfma_f32_16x16x32_bf16 v[52:55],a[184:187],a[72:75],v[52:55]
ds_read_b128 a[0:3],v252 offset:32768
v_mfma_f32_16x16x32_bf16 v[68:71],a[196:199],a[72:75],v[68:71]
ds_read_b64_tr_b16 a[176:177],v24 offset:40960
ds_read_b64_tr_b16 a[178:179],v24 offset:41472
v_mfma_f32_16x16x32_bf16 v[68:71],a[192:195],a[52:55],v[68:71]
s_add_u32 m0,s87,51200
s_add_u32 s58,s91,20480
v_mfma_f32_16x16x32_bf16 v[64:67],a[192:195],a[48:51],v[64:67]
buffer_load_dwordx4 v16,s[20:23],s58 offen lds
v_mfma_f32_16x16x32_bf16 v[64:67],a[196:199],a[68:71],v[64:67]
ds_read_b128 a[4:7],v252 offset:34816
v_mfma_f32_16x16x32_bf16 v[60:63],a[196:199],a[64:67],v[60:63]
ds_read_b64_tr_b16 a[180:181],v24 offset:45056
ds_read_b64_tr_b16 a[182:183],v24 offset:45568
v_mfma_f32_16x16x32_bf16 v[60:63],a[192:195],a[44:47],v[60:63]
s_add_u32 m0,s87,52224
s_add_u32 s58,s91,30720
v_mfma_f32_16x16x32_bf16 v[56:59],a[192:195],a[40:43],v[56:59]
buffer_load_dwordx4 v17,s[20:23],s58 offen lds
v_mfma_f32_16x16x32_bf16 v[56:59],a[196:199],a[60:63],v[56:59]
ds_read_b128 a[8:11],v252 offset:36864
v_mfma_f32_16x16x32_bf16 a[132:135],a[196:199],a[76:79],a[132:135]
ds_read_b64_tr_b16 a[188:189],v24 offset:40968
ds_read_b64_tr_b16 a[190:191],v24 offset:41480
v_mfma_f32_16x16x32_bf16 a[132:135],a[192:195],a[56:59],a[132:135]
s_add_u32 m0,s88,133120
v_mfma_f32_16x16x32_bf16 v[72:75],a[164:167],a[40:43],v[72:75]
s_mov_b64 exec,0xffffffff
buffer_load_dwordx4 v18,s[20:23],s91 offen lds
s_mov_b64 exec,-1
v_mfma_f32_16x16x32_bf16 v[72:75],a[160:163],a[60:63],v[72:75]
ds_read_b128 a[12:15],v252 offset:38912
v_mfma_f32_16x16x32_bf16 v[76:79],a[160:163],a[64:67],v[76:79]
ds_read_b64_tr_b16 a[184:185],v24 offset:45064
ds_read_b64_tr_b16 a[186:187],v24 offset:45576
v_mfma_f32_16x16x32_bf16 v[76:79],a[164:167],a[44:47],v[76:79]
s_add_u32 s91,s91,128
v_mfma_f32_16x16x32_bf16 v[136:139],a[164:167],a[48:51],v[136:139]
s_cmp_eq_u32 s91,1280
s_cselect_b32 s91,0,s91
v_mfma_f32_16x16x32_bf16 v[136:139],a[160:163],a[68:71],v[136:139]
s_add_u32 m0,s101,73728
s_add_u32 s58,s92,128
v_mfma_f32_16x16x32_bf16 v[140:143],a[160:163],a[72:75],v[140:143]
buffer_load_dwordx4 v15,s[24:27],s58 offen lds
v_mfma_f32_16x16x32_bf16 v[140:143],a[164:167],a[52:55],v[140:143]
ds_read_b128 a[16:19],v254 offset:0
v_mfma_f32_16x16x32_bf16 v[124:127],a[168:171],a[52:55],v[124:127]
s_add_u32 m0,s101,75776
s_add_u32 s58,s92,131200
v_mfma_f32_16x16x32_bf16 v[124:127],a[172:175],a[72:75],v[124:127]
v_mfma_f32_16x16x32_bf16 v[120:123],a[172:175],a[68:71],v[120:123]
buffer_load_dwordx4 v15,s[24:27],s58 offen lds
v_mfma_f32_16x16x32_bf16 v[120:123],a[168:171],a[48:51],v[120:123]
s_add_u32 m0,s101,77824
s_add_u32 s58,s92,262272
v_mfma_f32_16x16x32_bf16 v[116:119],a[168:171],a[44:47],v[116:119]
v_mfma_f32_16x16x32_bf16 v[116:119],a[172:175],a[64:67],v[116:119]
v_mfma_f32_16x16x32_bf16 v[112:115],a[172:175],a[60:63],v[112:115]
buffer_load_dwordx4 v15,s[24:27],s58 offen lds
v_mfma_f32_16x16x32_bf16 v[112:115],a[168:171],a[40:43],v[112:115]
s_add_u32 m0,s101,79872
s_add_u32 s58,s92,393344
s_waitcnt lgkmcnt(0)
v_mfma_f32_16x16x32_bf16 a[136:139],a[176:179],a[56:59],a[136:139]
ds_read_b64_tr_b16 a[196:197],v26 offset:40960
ds_read_b64_tr_b16 a[198:199],v26 offset:41472
v_mfma_f32_16x16x32_bf16 a[136:139],a[180:183],a[76:79],a[136:139]
v_mfma_f32_16x16x32_bf16 v[80:83],a[180:183],a[60:63],v[80:83]
buffer_load_dwordx4 v15,s[24:27],s58 offen lds
v_mfma_f32_16x16x32_bf16 v[80:83],a[176:179],a[40:43],v[80:83]
ds_read_b128 a[20:23],v253 offset:32768
ds_read_b128 a[24:27],v253 offset:34816
v_mfma_f32_16x16x32_bf16 v[84:87],a[176:179],a[44:47],v[84:87]
s_add_u32 s92,s92,524288
v_mfma_f32_16x16x32_bf16 v[84:87],a[180:183],a[64:67],v[84:87]
s_cmp_eq_u32 s92,5242880
s_cselect_b32 s92,0,s92
v_mfma_f32_16x16x32_bf16 v[88:91],a[180:183],a[68:71],v[88:91]
s_add_u32 m0,s101,98304
s_add_u32 s58,s92,0
v_mfma_f32_16x16x32_bf16 v[88:91],a[176:179],a[48:51],v[88:91]
buffer_load_dwordx4 v15,s[24:27],s58 offen lds
v_mfma_f32_16x16x32_bf16 v[92:95],a[176:179],a[52:55],v[92:95]
ds_read_b64_tr_b16 a[192:193],v26 offset:45056
ds_read_b64_tr_b16 a[194:195],v26 offset:45568
v_mfma_f32_16x16x32_bf16 v[92:95],a[180:183],a[72:75],v[92:95]
s_add_u32 m0,s101,100352
s_add_u32 s58,s92,131072
v_mfma_f32_16x16x32_bf16 v[108:111],a[184:187],a[72:75],v[108:111]
ds_read_b128 a[28:31],v253 offset:36864
ds_read_b128 a[32:35],v253 offset:38912
v_mfma_f32_16x16x32_bf16 v[108:111],a[188:191],a[52:55],v[108:111]
buffer_load_dwordx4 v15,s[24:27],s58 offen lds
v_mfma_f32_16x16x32_bf16 v[104:107],a[188:191],a[48:51],v[104:107]
ds_read_b64_tr_b16 a[160:161],v26 offset:40968
ds_read_b64_tr_b16 a[162:163],v26 offset:41480
v_mfma_f32_16x16x32_bf16 v[104:107],a[184:187],a[68:71],v[104:107]
s_add_u32 m0,s101,102400
s_add_u32 s58,s92,262144
v_mfma_f32_16x16x32_bf16 v[100:103],a[184:187],a[64:67],v[100:103]
ds_read_b128 a[36:39],v255 offset:0
v_mfma_f32_16x16x32_bf16 v[100:103],a[188:191],a[44:47],v[100:103]
buffer_load_dwordx4 v15,s[24:27],s58 offen lds
v_mfma_f32_16x16x32_bf16 v[96:99],a[188:191],a[40:43],v[96:99]
ds_read_b64_tr_b16 a[164:165],v26 offset:45064
ds_read_b64_tr_b16 a[166:167],v26 offset:45576
v_mfma_f32_16x16x32_bf16 v[96:99],a[184:187],a[60:63],v[96:99]
s_add_u32 m0,s101,104448
s_add_u32 s58,s92,393216
v_mfma_f32_16x16x32_bf16 a[140:143],a[184:187],a[76:79],a[140:143]
v_mfma_f32_16x16x32_bf16 a[140:143],a[188:191],a[56:59],a[140:143]
buffer_load_dwordx4 v15,s[24:27],s58 offen lds
s_waitcnt lgkmcnt(2)
v_mfma_f32_16x16x32_bf16 v[144:147],a[196:199],a[40:43],v[144:147]
v_mfma_f32_16x16x32_bf16 v[144:147],a[192:195],a[60:63],v[144:147]
v_mfma_f32_16x16x32_bf16 v[148:151],a[192:195],a[64:67],v[148:151]
s_waitcnt vmcnt(13) lgkmcnt(0)
s_barrier
v_mfma_f32_16x16x32_bf16 v[148:151],a[196:199],a[44:47],v[148:151]
s_add_u32 m0,s87,32768
s_add_u32 s58,s91,0
v_mfma_f32_16x16x32_bf16 v[152:155],a[196:199],a[48:51],v[152:155]
buffer_load_dwordx4 v16,s[20:23],s58 offen lds
v_mfma_f32_16x16x32_bf16 v[152:155],a[192:195],a[68:71],v[152:155]
ds_read_b64_tr_b16 a[172:173],v24 offset:0
ds_read_b64_tr_b16 a[174:175],v24 offset:512
v_mfma_f32_16x16x32_bf16 v[156:159],a[192:195],a[72:75],v[156:159]
s_add_u32 m0,s87,33792
s_add_u32 s58,s91,10240
v_mfma_f32_16x16x32_bf16 v[156:159],a[196:199],a[52:55],v[156:159]
ds_read_b64_tr_b16 a[168:169],v24 offset:4096
ds_read_b64_tr_b16 a[170:171],v24 offset:4608
v_mfma_f32_16x16x32_bf16 v[172:175],a[160:163],a[52:55],v[172:175]
buffer_load_dwordx4 v17,s[20:23],s58 offen lds
v_mfma_f32_16x16x32_bf16 v[172:175],a[164:167],a[72:75],v[172:175]
ds_read_b64_tr_b16 a[176:177],v24 offset:8
ds_read_b64_tr_b16 a[178:179],v24 offset:520
v_mfma_f32_16x16x32_bf16 v[168:171],a[164:167],a[68:71],v[168:171]
s_add_u32 m0,s87,34816
s_add_u32 s58,s91,20480
v_mfma_f32_16x16x32_bf16 v[168:171],a[160:163],a[48:51],v[168:171]
ds_read_b64_tr_b16 a[180:181],v24 offset:4104
ds_read_b64_tr_b16 a[182:183],v24 offset:4616
v_mfma_f32_16x16x32_bf16 v[164:167],a[160:163],a[44:47],v[164:167]
buffer_load_dwordx4 v16,s[20:23],s58 offen lds
v_mfma_f32_16x16x32_bf16 v[164:167],a[164:167],a[64:67],v[164:167]
ds_read_b64_tr_b16 a[184:185],v26 offset:0
ds_read_b64_tr_b16 a[186:187],v26 offset:512
v_mfma_f32_16x16x32_bf16 v[160:163],a[164:167],a[60:63],v[160:163]
s_add_u32 m0,s87,35840
s_add_u32 s58,s91,30720
v_mfma_f32_16x16x32_bf16 v[160:163],a[160:163],a[40:43],v[160:163]
ds_read_b64_tr_b16 a[188:189],v26 offset:4096
ds_read_b64_tr_b16 a[190:191],v26 offset:4608
s_waitcnt lgkmcnt(4)
v_mfma_f32_16x16x32_bf16 a[128:131],a[172:175],a[16:19],a[128:131]
buffer_load_dwordx4 v17,s[20:23],s58 offen lds
v_mfma_f32_16x16x32_bf16 a[128:131],a[168:171],a[36:39],a[128:131]
ds_read_b64_tr_b16 a[192:193],v26 offset:8
ds_read_b64_tr_b16 a[194:195],v26 offset:520
v_mfma_f32_16x16x32_bf16 v[128:131],a[168:171],a[20:23],v[128:131]
s_add_u32 m0,s88,131072
v_mfma_f32_16x16x32_bf16 v[128:131],a[172:175],a[0:3],v[128:131]
ds_read_b64_tr_b16 a[196:197],v26 offset:4104
ds_read_b64_tr_b16 a[198:199],v26 offset:4616
v_mfma_f32_16x16x32_bf16 v[132:135],a[172:175],a[4:7],v[132:135]
s_mov_b64 exec,0xffffffff
buffer_load_dwordx4 v18,s[20:23],s91 offen lds
s_mov_b64 exec,-1
v_mfma_f32_16x16x32_bf16 v[132:135],a[168:171],a[24:27],v[132:135]
s_add_u32 s91,s91,128
v_mfma_f32_16x16x32_bf16 v[48:51],a[168:171],a[28:31],v[48:51]
s_cmp_eq_u32 s91,1280
s_cselect_b32 s91,0,s91
v_mfma_f32_16x16x32_bf16 v[48:51],a[172:175],a[8:11],v[48:51]
s_add_u32 m0,s101,106496
s_add_u32 s58,s92,128
v_mfma_f32_16x16x32_bf16 v[52:55],a[172:175],a[12:15],v[52:55]
buffer_load_dwordx4 v15,s[24:27],s58 offen lds
v_mfma_f32_16x16x32_bf16 v[52:55],a[168:171],a[32:35],v[52:55]
s_waitcnt vmcnt(10) lgkmcnt(0)
s_barrier
v_mfma_f32_16x16x32_bf16 v[68:71],a[180:183],a[32:35],v[68:71]
ds_read_b128 a[40:43],v252 offset:49152
v_mfma_f32_16x16x32_bf16 v[68:71],a[176:179],a[12:15],v[68:71]
s_add_u32 m0,s101,108544
s_add_u32 s58,s92,131200
v_mfma_f32_16x16x32_bf16 v[64:67],a[176:179],a[8:11],v[64:67]
buffer_load_dwordx4 v15,s[24:27],s58 offen lds
v_mfma_f32_16x16x32_bf16 v[64:67],a[180:183],a[28:31],v[64:67]
ds_read_b64_tr_b16 a[164:165],v24 offset:8192
ds_read_b64_tr_b16 a[166:167],v24 offset:8704
v_mfma_f32_16x16x32_bf16 v[60:63],a[180:183],a[24:27],v[60:63]
s_add_u32 m0,s101,110592
s_add_u32 s58,s92,262272
v_mfma_f32_16x16x32_bf16 v[60:63],a[176:179],a[4:7],v[60:63]
ds_read_b128 a[44:47],v252 offset:51200
v_mfma_f32_16x16x32_bf16 v[56:59],a[176:179],a[0:3],v[56:59]
buffer_load_dwordx4 v15,s[24:27],s58 offen lds
v_mfma_f32_16x16x32_bf16 v[56:59],a[180:183],a[20:23],v[56:59]
ds_read_b64_tr_b16 a[160:161],v24 offset:12288
ds_read_b64_tr_b16 a[162:163],v24 offset:12800
v_mfma_f32_16x16x32_bf16 a[132:135],a[180:183],a[36:39],a[132:135]
s_add_u32 m0,s101,112640
s_add_u32 s58,s92,393344
v_mfma_f32_16x16x32_bf16 a[132:135],a[176:179],a[16:19],a[132:135]
ds_read_b128 a[48:51],v252 offset:53248
v_mfma_f32_16x16x32_bf16 v[72:75],a[184:187],a[0:3],v[72:75]
buffer_load_dwordx4 v15,s[24:27],s58 offen lds
v_mfma_f32_16x16x32_bf16 v[72:75],a[188:191],a[20:23],v[72:75]
ds_read_b64_tr_b16 a[172:173],v24 offset:8200
ds_read_b64_tr_b16 a[174:175],v24 offset:8712
v_mfma_f32_16x16x32_bf16 v[76:79],a[188:191],a[24:27],v[76:79]
s_add_u32 s92,s92,524288
v_mfma_f32_16x16x32_bf16 v[76:79],a[184:187],a[4:7],v[76:79]
s_cmp_eq_u32 s92,5242880
s_cselect_b32 s92,0,s92
v_mfma_f32_16x16x32_bf16 v[136:139],a[184:187],a[8:11],v[136:139]
s_add_u32 m0,s71,143360
ds_read_b128 a[52:55],v252 offset:55296
v_mfma_f32_16x16x32_bf16 v[136:139],a[188:191],a[28:31],v[136:139]
buffer_load_dwordx4 v180,s[40:43],s70 offen nt lds
v_mfma_f32_16x16x32_bf16 v[140:143],a[188:191],a[32:35],v[140:143]
ds_read_b64_tr_b16 a[168:169],v24 offset:12296
ds_read_b64_tr_b16 a[170:171],v24 offset:12808
v_mfma_f32_16x16x32_bf16 v[140:143],a[184:187],a[12:15],v[140:143]
s_add_u32 m0,s71,144384
v_mfma_f32_16x16x32_bf16 v[124:127],a[192:195],a[12:15],v[124:127]
ds_read_b128 a[56:59],v254 offset:2048
v_mfma_f32_16x16x32_bf16 v[124:127],a[196:199],a[32:35],v[124:127]
buffer_load_dwordx4 v181,s[40:43],s70 offen nt lds
v_mfma_f32_16x16x32_bf16 v[120:123],a[196:199],a[28:31],v[120:123]
s_add_u32 m0,s71,145408
v_mfma_f32_16x16x32_bf16 v[120:123],a[192:195],a[8:11],v[120:123]
v_mfma_f32_16x16x32_bf16 v[116:119],a[192:195],a[4:7],v[116:119]
v_mfma_f32_16x16x32_bf16 v[116:119],a[196:199],a[24:27],v[116:119]
buffer_load_dwordx4 v182,s[40:43],s70 offen nt lds
v_mfma_f32_16x16x32_bf16 v[112:115],a[196:199],a[20:23],v[112:115]
s_add_u32 m0,s71,146432
v_mfma_f32_16x16x32_bf16 v[112:115],a[192:195],a[0:3],v[112:115]
s_waitcnt lgkmcnt(0)
v_mfma_f32_16x16x32_bf16 a[136:139],a[164:167],a[16:19],a[136:139]
ds_read_b64_tr_b16 a[180:181],v26 offset:8192
ds_read_b64_tr_b16 a[182:183],v26 offset:8704
v_mfma_f32_16x16x32_bf16 a[136:139],a[160:163],a[36:39],a[136:139]
buffer_load_dwordx4 v183,s[40:43],s70 offen nt lds
v_mfma_f32_16x16x32_bf16 v[80:83],a[160:163],a[20:23],v[80:83]
ds_read_b128 a[60:63],v253 offset:49152
ds_read_b128 a[64:67],v253 offset:51200
v_mfma_f32_16x16x32_bf16 v[80:83],a[164:167],a[0:3],v[80:83]
s_add_u32 m0,s71,147456
v_mfma_f32_16x16x32_bf16 v[84:87],a[164:167],a[4:7],v[84:87]
ds_read_b64_tr_b16 a[176:177],v26 offset:12288
ds_read_b64_tr_b16 a[178:179],v26 offset:12800
v_mfma_f32_16x16x32_bf16 v[84:87],a[160:163],a[24:27],v[84:87]
buffer_load_dwordx4 v184,s[40:43],s70 offen nt lds
v_mfma_f32_16x16x32_bf16 v[88:91],a[160:163],a[28:31],v[88:91]
ds_read_b128 a[68:71],v253 offset:53248
ds_read_b128 a[72:75],v253 offset:55296
v_mfma_f32_16x16x32_bf16 v[88:91],a[164:167],a[8:11],v[88:91]
s_lshl_b32 s59,s49,7
s_add_u32 s59,s59,49283072
s_add_u32 s40,s18,s59
s_addc_u32 s41,s19,0
s_mov_b32 s42,128
v_mfma_f32_16x16x32_bf16 v[92:95],a[164:167],a[12:15],v[92:95]
ds_read_b64_tr_b16 a[188:189],v26 offset:8200
ds_read_b64_tr_b16 a[190:191],v26 offset:8712
v_mfma_f32_16x16x32_bf16 v[92:95],a[160:163],a[32:35],v[92:95]
v_mov_b32 v9,0
s_cmp_eq_u32 s48,0
s_cbranch_scc0 L_clr
s_mov_b64 exec,1
buffer_store_dword v9,off,s[40:43],s56 sc1
buffer_store_dword v9,off,s[40:43],s56 offset:32 sc1
s_mov_b64 exec,-1
L_clr:
v_mfma_f32_16x16x32_bf16 v[108:111],a[168:171],a[32:35],v[108:111]
ds_read_b128 a[76:79],v255 offset:2048
v_mfma_f32_16x16x32_bf16 v[108:111],a[172:175],a[12:15],v[108:111]
ds_read_b64_tr_b16 a[184:185],v26 offset:12296
ds_read_b64_tr_b16 a[186:187],v26 offset:12808
v_mfma_f32_16x16x32_bf16 v[104:107],a[172:175],a[8:11],v[104:107]
s_add_u32 m0,s101,65536
s_add_u32 s58,s92,0
v_mfma_f32_16x16x32_bf16 v[104:107],a[168:171],a[28:31],v[104:107]
buffer_load_dwordx4 v15,s[24:27],s58 offen lds
v_mfma_f32_16x16x32_bf16 v[100:103],a[168:171],a[24:27],v[100:103]
s_add_u32 m0,s101,67584
s_add_u32 s58,s92,131072
v_mfma_f32_16x16x32_bf16 v[100:103],a[172:175],a[4:7],v[100:103]
v_mfma_f32_16x16x32_bf16 v[96:99],a[172:175],a[0:3],v[96:99]
v_mfma_f32_16x16x32_bf16 v[96:99],a[168:171],a[20:23],v[96:99]
buffer_load_dwordx4 v15,s[24:27],s58 offen lds
v_mfma_f32_16x16x32_bf16 a[140:143],a[168:171],a[36:39],a[140:143]
s_waitcnt vmcnt(16) lgkmcnt(0)
s_barrier
v_mfma_f32_16x16x32_bf16 a[140:143],a[172:175],a[16:19],a[140:143]
ds_read_b64_tr_b16 a[196:197],v24 offset:32768
ds_read_b64_tr_b16 a[198:199],v24 offset:33280
v_mfma_f32_16x16x32_bf16 v[144:147],a[180:183],a[0:3],v[144:147]
s_add_u32 m0,s101,69632
s_add_u32 s58,s92,262144
v_mfma_f32_16x16x32_bf16 v[144:147],a[176:179],a[20:23],v[144:147]
buffer_load_dwordx4 v15,s[24:27],s58 offen lds
v_mfma_f32_16x16x32_bf16 v[148:151],a[176:179],a[24:27],v[148:151]
ds_read_b64_tr_b16 a[192:193],v24 offset:36864
ds_read_b64_tr_b16 a[194:195],v24 offset:37376
v_mfma_f32_16x16x32_bf16 v[148:151],a[180:183],a[4:7],v[148:151]
s_add_u32 m0,s101,71680
s_add_u32 s58,s92,393216
v_mfma_f32_16x16x32_bf16 v[152:155],a[180:183],a[8:11],v[152:155]
ds_read_b64_tr_b16 a[164:165],v24 offset:32776
ds_read_b64_tr_b16 a[166:167],v24 offset:33288
v_mfma_f32_16x16x32_bf16 v[152:155],a[176:179],a[28:31],v[152:155]
buffer_load_dwordx4 v15,s[24:27],s58 offen lds
v_mfma_f32_16x16x32_bf16 v[156:159],a[176:179],a[32:35],v[156:159]
ds_read_b64_tr_b16 a[160:161],v24 offset:36872
ds_read_b64_tr_b16 a[162:163],v24 offset:37384
v_mfma_f32_16x16x32_bf16 v[156:159],a[180:183],a[12:15],v[156:159]
s_add_u32 m0,s87,49152
s_add_u32 s58,s91,0
v_mfma_f32_16x16x32_bf16 v[172:175],a[188:191],a[12:15],v[172:175]
ds_read_b64_tr_b16 a[168:169],v26 offset:32768
ds_read_b64_tr_b16 a[170:171],v26 offset:33280
v_mfma_f32_16x16x32_bf16 v[172:175],a[184:187],a[32:35],v[172:175]
buffer_load_dwordx4 v16,s[20:23],s58 offen lds
v_mfma_f32_16x16x32_bf16 v[168:171],a[184:187],a[28:31],v[168:171]
ds_read_b64_tr_b16 a[172:173],v26 offset:36864
ds_read_b64_tr_b16 a[174:175],v26 offset:37376
v_mfma_f32_16x16x32_bf16 v[168:171],a[188:191],a[8:11],v[168:171]
s_add_u32 m0,s87,50176
s_add_u32 s58,s91,10240
v_mfma_f32_16x16x32_bf16 v[164:167],a[188:191],a[4:7],v[164:167]
ds_read_b64_tr_b16 a[176:177],v26 offset:32776
ds_read_b64_tr_b16 a[178:179],v26 offset:33288
v_mfma_f32_16x16x32_bf16 v[164:167],a[184:187],a[24:27],v[164:167]
buffer_load_dwordx4 v17,s[20:23],s58 offen lds
v_mfma_f32_16x16x32_bf16 v[160:163],a[184:187],a[20:23],v[160:163]
s_add_u32 m0,s87,51200
s_add_u32 s58,s91,20480
v_mfma_f32_16x16x32_bf16 v[160:163],a[188:191],a[0:3],v[160:163]
s_waitcnt lgkmcnt(2)
v_mfma_f32_16x16x32_bf16 a[128:131],a[196:199],a[56:59],a[128:131]
ds_read_b64_tr_b16 a[180:181],v26 offset:36872
ds_read_b64_tr_b16 a[182:183],v26 offset:37384
v_mfma_f32_16x16x32_bf16 a[128:131],a[192:195],a[76:79],a[128:131]
buffer_load_dwordx4 v16,s[20:23],s58 offen lds
v_mfma_f32_16x16x32_bf16 v[128:131],a[192:195],a[60:63],v[128:131]
s_add_u32 m0,s87,52224
s_add_u32 s58,s91,30720
v_mfma_f32_16x16x32_bf16 v[128:131],a[196:199],a[40:43],v[128:131]
v_mfma_f32_16x16x32_bf16 v[132:135],a[196:199],a[44:47],v[132:135]
v_mfma_f32_16x16x32_bf16 v[132:135],a[192:195],a[64:67],v[132:135]
buffer_load_dwordx4 v17,s[20:23],s58 offen lds
v_mfma_f32_16x16x32_bf16 v[48:51],a[192:195],a[68:71],v[48:51]
s_waitcnt vmcnt(13) lgkmcnt(0)
s_barrier
v_mfma_f32_16x16x32_bf16 v[48:51],a[196:199],a[48:51],v[48:51]
ds_read_b128 a[0:3],v252 offset:32768
v_mfma_f32_16x16x32_bf16 v[52:55],a[196:199],a[52:55],v[52:55]
s_add_u32 m0,s88,133120
v_mfma_f32_16x16x32_bf16 v[52:55],a[192:195],a[72:75],v[52:55]
s_mov_b64 exec,0xffffffff
buffer_load_dwordx4 v18,s[20:23],s91 offen lds
s_mov_b64 exec,-1
v_mfma_f32_16x16x32_bf16 v[68:71],a[160:163],a[72:75],v[68:71]
ds_read_b64_tr_b16 a[184:185],v24 offset:40960
ds_read_b64_tr_b16 a[186:187],v24 offset:41472
v_mfma_f32_16x16x32_bf16 v[68:71],a[164:167],a[52:55],v[68:71]
s_add_u32 s91,s91,128
v_mfma_f32_16x16x32_bf16 v[64:67],a[164:167],a[48:51],v[64:67]
s_cmp_eq_u32 s91,1280
s_cselect_b32 s91,0,s91
v_mfma_f32_16x16x32_bf16 v[64:67],a[160:163],a[68:71],v[64:67]
s_add_u32 m0,s101,73728
s_add_u32 s58,s92,128
v_mfma_f32_16x16x32_bf16 v[60:63],a[160:163],a[64:67],v[60:63]
buffer_load_dwordx4 v15,s[24:27],s58 offen lds
v_mfma_f32_16x16x32_bf16 v[60:63],a[164:167],a[44:47],v[60:63]
ds_read_b128 a[4:7],v252 offset:34816
v_mfma_f32_16x16x32_bf16 v[56:59],a[164:167],a[40:43],v[56:59]
ds_read_b64_tr_b16 a[188:189],v24 offset:45056
ds_read_b64_tr_b16 a[190:191],v24 offset:45568
v_mfma_f32_16x16x32_bf16 v[56:59],a[160:163],a[60:63],v[56:59]
s_add_u32 m0,s101,75776
s_add_u32 s58,s92,131200
v_mfma_f32_16x16x32_bf16 a[132:135],a[160:163],a[76:79],a[132:135]
buffer_load_dwordx4 v15,s[24:27],s58 offen lds
v_mfma_f32_16x16x32_bf16 a[132:135],a[164:167],a[56:59],a[132:135]
ds_read_b128 a[8:11],v252 offset:36864
v_mfma_f32_16x16x32_bf16 v[72:75],a[168:171],a[40:43],v[72:75]
ds_read_b64_tr_b16 a[196:197],v24 offset:40968
ds_read_b64_tr_b16 a[198:199],v24 offset:41480
v_mfma_f32_16x16x32_bf16 v[72:75],a[172:175],a[60:63],v[72:75]
s_add_u32 m0,s101,77824
s_add_u32 s58,s92,262272
v_mfma_f32_16x16x32_bf16 v[76:79],a[172:175],a[64:67],v[76:79]
buffer_load_dwordx4 v15,s[24:27],s58 offen lds
v_mfma_f32_16x16x32_bf16 v[76:79],a[168:171],a[44:47],v[76:79]
ds_read_b128 a[12:15],v252 offset:38912
v_mfma_f32_16x16x32_bf16 v[136:139],a[168:171],a[48:51],v[136:139]
ds_read_b64_tr_b16 a[192:193],v24 offset:45064
ds_read_b64_tr_b16 a[194:195],v24 offset:45576
v_mfma_f32_16x16x32_bf16 v[136:139],a[172:175],a[68:71],v[136:139]
s_add_u32 m0,s101,79872
s_add_u32 s58,s92,393344
v_mfma_f32_16x16x32_bf16 v[140:143],a[172:175],a[72:75],v[140:143]
buffer_load_dwordx4 v15,s[24:27],s58 offen lds
v_mfma_f32_16x16x32_bf16 v[140:143],a[168:171],a[52:55],v[140:143]
ds_read_b128 a[16:19],v254 offset:0
v_mfma_f32_16x16x32_bf16 v[124:127],a[176:179],a[52:55],v[124:127]
s_add_u32 s92,s92,524288
v_mfma_f32_16x16x32_bf16 v[124:127],a[180:183],a[72:75],v[124:127]
s_cmp_eq_u32 s92,5242880
s_cselect_b32 s92,0,s92
v_mfma_f32_16x16x32_bf16 v[120:123],a[180:183],a[68:71],v[120:123]
s_add_u32 m0,s101,98304
s_add_u32 s58,s92,0
v_mfma_f32_16x16x32_bf16 v[120:123],a[176:179],a[48:51],v[120:123]
buffer_load_dwordx4 v15,s[24:27],s58 offen lds
v_mfma_f32_16x16x32_bf16 v[116:119],a[176:179],a[44:47],v[116:119]
s_add_u32 m0,s101,100352
s_add_u32 s58,s92,131072
v_mfma_f32_16x16x32_bf16 v[116:119],a[180:183],a[64:67],v[116:119]
v_mfma_f32_16x16x32_bf16 v[112:115],a[180:183],a[60:63],v[112:115]
v_mfma_f32_16x16x32_bf16 v[112:115],a[176:179],a[40:43],v[112:115]
buffer_load_dwordx4 v15,s[24:27],s58 offen lds
s_waitcnt lgkmcnt(0)
v_mfma_f32_16x16x32_bf16 a[136:139],a[184:187],a[56:59],a[136:139]
ds_read_b64_tr_b16 a[160:161],v26 offset:40960
ds_read_b64_tr_b16 a[162:163],v26 offset:41472
v_mfma_f32_16x16x32_bf16 a[136:139],a[188:191],a[76:79],a[136:139]
s_add_u32 m0,s101,102400
s_add_u32 s58,s92,262144
v_mfma_f32_16x16x32_bf16 v[80:83],a[188:191],a[60:63],v[80:83]
ds_read_b128 a[20:23],v253 offset:32768
ds_read_b128 a[24:27],v253 offset:34816
v_mfma_f32_16x16x32_bf16 v[80:83],a[184:187],a[40:43],v[80:83]
buffer_load_dwordx4 v15,s[24:27],s58 offen lds
v_mfma_f32_16x16x32_bf16 v[84:87],a[184:187],a[44:47],v[84:87]
ds_read_b64_tr_b16 a[164:165],v26 offset:45056
ds_read_b64_tr_b16 a[166:167],v26 offset:45568
v_mfma_f32_16x16x32_bf16 v[84:87],a[188:191],a[64:67],v[84:87]
s_add_u32 m0,s101,104448
s_add_u32 s58,s92,393216
v_mfma_f32_16x16x32_bf16 v[88:91],a[188:191],a[68:71],v[88:91]
ds_read_b128 a[28:31],v253 offset:36864
ds_read_b128 a[32:35],v253 offset:38912
v_mfma_f32_16x16x32_bf16 v[88:91],a[184:187],a[48:51],v[88:91]
buffer_load_dwordx4 v15,s[24:27],s58 offen lds
v_mfma_f32_16x16x32_bf16 v[92:95],a[184:187],a[52:55],v[92:95]
ds_read_b64_tr_b16 a[172:173],v26 offset:40968
ds_read_b64_tr_b16 a[174:175],v26 offset:41480
v_mfma_f32_16x16x32_bf16 v[92:95],a[188:191],a[72:75],v[92:95]
v_mfma_f32_16x16x32_bf16 v[108:111],a[192:195],a[72:75],v[108:111]
ds_read_b128 a[36:39],v255 offset:0
v_mfma_f32_16x16x32_bf16 v[108:111],a[196:199],a[52:55],v[108:111]
ds_read_b64_tr_b16 a[168:169],v26 offset:45064
ds_read_b64_tr_b16 a[170:171],v26 offset:45576
v_mfma_f32_16x16x32_bf16 v[104:107],a[196:199],a[48:51],v[104:107]
v_mfma_f32_16x16x32_bf16 v[104:107],a[192:195],a[68:71],v[104:107]
v_mfma_f32_16x16x32_bf16 v[100:103],a[192:195],a[64:67],v[100:103]
v_mfma_f32_16x16x32_bf16 v[100:103],a[196:199],a[44:47],v[100:103]
v_mfma_f32_16x16x32_bf16 v[96:99],a[196:199],a[40:43],v[96:99]
v_mfma_f32_16x16x32_bf16 v[96:99],a[192:195],a[60:63],v[96:99]
s_waitcnt vmcnt(13) lgkmcnt(0)
s_barrier
v_mfma_f32_16x16x32_bf16 a[140:143],a[192:195],a[76:79],a[140:143]
s_add_u32 m0,s87,32768
s_add_u32 s58,s91,0
v_mfma_f32_16x16x32_bf16 a[140:143],a[196:199],a[56:59],a[140:143]
buffer_load_dwordx4 v16,s[20:23],s58 offen lds
v_mfma_f32_16x16x32_bf16 v[144:147],a[160:163],a[40:43],v[144:147]
ds_read_b64_tr_b16 a[180:181],v24 offset:0
ds_read_b64_tr_b16 a[182:183],v24 offset:512
v_mfma_f32_16x16x32_bf16 v[144:147],a[164:167],a[60:63],v[144:147]
s_add_u32 m0,s87,33792
s_add_u32 s58,s91,10240
v_mfma_f32_16x16x32_bf16 v[148:151],a[164:167],a[64:67],v[148:151]
ds_read_b64_tr_b16 a[176:177],v24 offset:4096
ds_read_b64_tr_b16 a[178:179],v24 offset:4608
v_mfma_f32_16x16x32_bf16 v[148:151],a[160:163],a[44:47],v[148:151]
buffer_load_dwordx4 v17,s[20:23],s58 offen lds
v_mfma_f32_16x16x32_bf16 v[152:155],a[160:163],a[48:51],v[152:155]
ds_read_b64_tr_b16 a[184:185],v24 offset:8
ds_read_b64_tr_b16 a[186:187],v24 offset:520
v_mfma_f32_16x16x32_bf16 v[152:155],a[164:167],a[68:71],v[152:155]
s_add_u32 m0,s87,34816
s_add_u32 s58,s91,20480
v_mfma_f32_16x16x32_bf16 v[156:159],a[164:167],a[72:75],v[156:159]
ds_read_b64_tr_b16 a[200:201],v8 offset:0
ds_read_b64_tr_b16 a[202:203],v8 offset:10240
v_mfma_f32_16x16x32_bf16 v[156:159],a[160:163],a[52:55],v[156:159]
buffer_load_dwordx4 v16,s[20:23],s58 offen lds
v_mfma_f32_16x16x32_bf16 v[172:175],a[172:175],a[52:55],v[172:175]
ds_read_b64_tr_b16 a[188:189],v24 offset:4104
ds_read_b64_tr_b16 a[190:191],v24 offset:4616
v_mfma_f32_16x16x32_bf16 v[172:175],a[168:171],a[72:75],v[172:175]
s_add_u32 m0,s87,35840
s_add_u32 s58,s91,30720
v_mfma_f32_16x16x32_bf16 v[168:171],a[168:171],a[68:71],v[168:171]
ds_read_b64_tr_b16 a[204:205],v8 offset:32
ds_read_b64_tr_b16 a[206:207],v8 offset:10272
v_mfma_f32_16x16x32_bf16 v[168:171],a[172:175],a[48:51],v[168:171]
buffer_load_dwordx4 v17,s[20:23],s58 offen lds
v_mfma_f32_16x16x32_bf16 v[164:167],a[172:175],a[44:47],v[164:167]
ds_read_b64_tr_b16 a[192:193],v26 offset:0
ds_read_b64_tr_b16 a[194:195],v26 offset:512
v_mfma_f32_16x16x32_bf16 v[164:167],a[168:171],a[64:67],v[164:167]
s_add_u32 m0,s88,131072
v_mfma_f32_16x16x32_bf16 v[160:163],a[168:171],a[60:63],v[160:163]
v_mfma_f32_16x16x32_bf16 v[160:163],a[172:175],a[40:43],v[160:163]
s_mov_b64 exec,0xffffffff
buffer_load_dwordx4 v18,s[20:23],s91 offen lds
s_mov_b64 exec,-1
s_waitcnt lgkmcnt(2)
v_mfma_f32_16x16x32_bf16 a[128:131],a[180:183],a[16:19],a[128:131]
ds_read_b64_tr_b16 a[208:209],v8 offset:64
ds_read_b64_tr_b16 a[210:211],v8 offset:10304
v_mfma_f32_16x16x32_bf16 a[128:131],a[176:179],a[36:39],a[128:131]
s_add_u32 s91,s91,128
v_mfma_f32_16x16x32_bf16 v[128:131],a[176:179],a[20:23],v[128:131]
s_cmp_eq_u32 s91,1280
s_cselect_b32 s91,0,s91
v_mfma_f32_16x16x32_bf16 v[128:131],a[180:183],a[0:3],v[128:131]
s_add_u32 m0,s101,106496
s_add_u32 s58,s92,128
v_mfma_f32_16x16x32_bf16 v[132:135],a[180:183],a[4:7],v[132:135]
buffer_load_dwordx4 v15,s[24:27],s58 offen lds
v_mfma_f32_16x16x32_bf16 v[132:135],a[176:179],a[24:27],v[132:135]
ds_read_b64_tr_b16 a[196:197],v26 offset:4096
ds_read_b64_tr_b16 a[198:199],v26 offset:4608
v_mfma_f32_16x16x32_bf16 v[48:51],a[176:179],a[28:31],v[48:51]
s_add_u32 m0,s101,108544
s_add_u32 s58,s92,131200
v_mfma_f32_16x16x32_bf16 v[48:51],a[180:183],a[8:11],v[48:51]
ds_read_b64_tr_b16 a[212:213],v8 offset:96
ds_read_b64_tr_b16 a[214:215],v8 offset:10336
v_mfma_f32_16x16x32_bf16 v[52:55],a[180:183],a[12:15],v[52:55]
buffer_load_dwordx4 v15,s[24:27],s58 offen lds
v_mfma_f32_16x16x32_bf16 v[52:55],a[176:179],a[32:35],v[52:55]
ds_read_b64_tr_b16 a[164:165],v26 offset:8
ds_read_b64_tr_b16 a[166:167],v26 offset:520
v_mfma_f32_16x16x32_bf16 v[68:71],a[188:191],a[32:35],v[68:71]
s_add_u32 m0,s101,110592
s_add_u32 s58,s92,262272
v_mfma_f32_16x16x32_bf16 v[68:71],a[184:187],a[12:15],v[68:71]
ds_read_b64_tr_b16 a[216:217],v8 offset:128
ds_read_b64_tr_b16 a[218:219],v8 offset:10368
v_mfma_f32_16x16x32_bf16 v[64:67],a[184:187],a[8:11],v[64:67]
buffer_load_dwordx4 v15,s[24:27],s58 offen lds
v_mfma_f32_16x16x32_bf16 v[64:67],a[188:191],a[28:31],v[64:67]
ds_read_b64_tr_b16 a[160:161],v26 offset:4104
ds_read_b64_tr_b16 a[162:163],v26 offset:4616
v_mfma_f32_16x16x32_bf16 v[60:63],a[188:191],a[24:27],v[60:63]
s_add_u32 m0,s101,112640
s_add_u32 s58,s92,393344
v_mfma_f32_16x16x32_bf16 v[60:63],a[184:187],a[4:7],v[60:63]
v_mfma_f32_16x16x32_bf16 v[56:59],a[184:187],a[0:3],v[56:59]
buffer_load_dwordx4 v15,s[24:27],s58 offen lds
v_mfma_f32_16x16x32_bf16 v[56:59],a[188:191],a[20:23],v[56:59]
s_add_u32 s92,s92,524288
v_mfma_f32_16x16x32_bf16 a[132:135],a[188:191],a[36:39],a[132:135]
s_cmp_eq_u32 s92,5242880
s_cselect_b32 s92,0,s92
v_mfma_f32_16x16x32_bf16 a[132:135],a[184:187],a[16:19],a[132:135]
s_waitcnt vmcnt(13) lgkmcnt(0)
s_barrier
v_mfma_f32_16x16x32_bf16 v[72:75],a[192:195],a[0:3],v[72:75]
s_add_u32 m0,s101,65536
s_add_u32 s58,s92,0
v_mfma_f32_16x16x32_bf16 v[72:75],a[196:199],a[20:23],v[72:75]
buffer_load_dwordx4 v15,s[24:27],s58 offen lds
v_mfma_f32_16x16x32_bf16 v[76:79],a[196:199],a[24:27],v[76:79]
ds_read_b128 a[40:43],v252 offset:49152
v_mfma_f32_16x16x32_bf16 v[76:79],a[192:195],a[4:7],v[76:79]
ds_read_b64_tr_b16 a[168:169],v24 offset:8192
ds_read_b64_tr_b16 a[170:171],v24 offset:8704
v_mfma_f32_16x16x32_bf16 v[136:139],a[192:195],a[8:11],v[136:139]
s_add_u32 m0,s101,67584
s_add_u32 s58,s92,131072
v_mfma_f32_16x16x32_bf16 v[136:139],a[196:199],a[28:31],v[136:139]
buffer_load_dwordx4 v15,s[24:27],s58 offen lds
v_mfma_f32_16x16x32_bf16 v[140:143],a[196:199],a[32:35],v[140:143]
ds_read_b128 a[44:47],v252 offset:51200
v_mfma_f32_16x16x32_bf16 v[140:143],a[192:195],a[12:15],v[140:143]
ds_read_b64_tr_b16 a[172:173],v24 offset:12288
ds_read_b64_tr_b16 a[174:175],v24 offset:12800
v_mfma_f32_16x16x32_bf16 v[124:127],a[164:167],a[12:15],v[124:127]
s_add_u32 m0,s101,69632
s_add_u32 s58,s92,262144
v_mfma_f32_16x16x32_bf16 v[124:127],a[160:163],a[32:35],v[124:127]
buffer_load_dwordx4 v15,s[24:27],s58 offen lds
v_mfma_f32_16x16x32_bf16 v[120:123],a[160:163],a[28:31],v[120:123]
ds_read_b128 a[48:51],v252 offset:53248
v_mfma_f32_16x16x32_bf16 v[120:123],a[164:167],a[8:11],v[120:123]
ds_read_b64_tr_b16 a[180:181],v24 offset:8200
ds_read_b64_tr_b16 a[182:183],v24 offset:8712
v_mfma_f32_16x16x32_bf16 v[116:119],a[164:167],a[4:7],v[116:119]
s_add_u32 m0,s101,71680
s_add_u32 s58,s92,393216
v_mfma_f32_16x16x32_bf16 v[116:119],a[160:163],a[24:27],v[116:119]
buffer_load_dwordx4 v15,s[24:27],s58 offen lds
v_mfma_f32_16x16x32_bf16 v[112:115],a[160:163],a[20:23],v[112:115]
ds_read_b128 a[52:55],v252 offset:55296
v_mfma_f32_16x16x32_bf16 v[112:115],a[164:167],a[0:3],v[112:115]
ds_read_b64_tr_b16 a[176:177],v24 offset:12296
ds_read_b64_tr_b16 a[178:179],v24 offset:12808
s_waitcnt lgkmcnt(3)
v_mfma_f32_16x16x32_bf16 a[136:139],a[168:171],a[16:19],a[136:139]
v_mfma_f32_16x16x32_bf16 a[136:139],a[172:175],a[36:39],a[136:139]
ds_read_b128 a[56:59],v254 offset:2048
v_mfma_f32_16x16x32_bf16 v[80:83],a[172:175],a[20:23],v[80:83]
ds_read_b64_tr_b16 a[188:189],v26 offset:8192
ds_read_b64_tr_b16 a[190:191],v26 offset:8704
v_mfma_f32_16x16x32_bf16 v[80:83],a[168:171],a[0:3],v[80:83]
v_mfma_f32_16x16x32_bf16 v[84:87],a[168:171],a[4:7],v[84:87]
ds_read_b128 a[60:63],v253 offset:49152
ds_read_b128 a[64:67],v253 offset:51200
v_mfma_f32_16x16x32_bf16 v[84:87],a[172:175],a[24:27],v[84:87]
v_mfma_f32_16x16x32_bf16 v[88:91],a[172:175],a[28:31],v[88:91]
ds_read_b64_tr_b16 a[184:185],v26 offset:12288
ds_read_b64_tr_b16 a[186:187],v26 offset:12800
v_mfma_f32_16x16x32_bf16 v[88:91],a[168:171],a[8:11],v[88:91]
v_mfma_f32_16x16x32_bf16 v[92:95],a[168:171],a[12:15],v[92:95]
ds_read_b128 a[68:71],v253 offset:53248
ds_read_b128 a[72:75],v253 offset:55296
v_mfma_f32_16x16x32_bf16 v[92:95],a[172:175],a[32:35],v[92:95]
s_waitcnt lgkmcnt(4)
v_mfma_f32_16x16x32_bf16 v[108:111],a[176:179],a[32:35],v[108:111]
ds_read_b64_tr_b16 a[196:197],v26 offset:8200
ds_read_b64_tr_b16 a[198:199],v26 offset:8712
v_mfma_f32_16x16x32_bf16 v[108:111],a[180:183],a[12:15],v[108:111]
v_mfma_f32_16x16x32_bf16 v[104:107],a[180:183],a[8:11],v[104:107]
ds_read_b128 a[76:79],v255 offset:2048
v_mfma_f32_16x16x32_bf16 v[104:107],a[176:179],a[28:31],v[104:107]
ds_read_b64_tr_b16 a[192:193],v26 offset:12296
ds_read_b64_tr_b16 a[194:195],v26 offset:12808
v_mfma_f32_16x16x32_bf16 v[100:103],a[176:179],a[24:27],v[100:103]
v_mfma_f32_16x16x32_bf16 v[100:103],a[180:183],a[4:7],v[100:103]
v_mfma_f32_16x16x32_bf16 v[96:99],a[180:183],a[0:3],v[96:99]
v_mfma_f32_16x16x32_bf16 v[96:99],a[176:179],a[20:23],v[96:99]
v_mfma_f32_16x16x32_bf16 a[140:143],a[176:179],a[36:39],a[140:143]
v_mfma_f32_16x16x32_bf16 a[140:143],a[180:183],a[16:19],a[140:143]
s_waitcnt vmcnt(13) lgkmcnt(0)
s_barrier
v_mfma_f32_16x16x32_bf16 v[144:147],a[188:191],a[0:3],v[144:147]
s_add_u32 m0,s87,49152
s_add_u32 s58,s91,0
v_mfma_f32_16x16x32_bf16 v[144:147],a[184:187],a[20:23],v[144:147]
buffer_load_dwordx4 v16,s[20:23],s58 offen lds
v_mfma_f32_16x16x32_bf16 v[148:151],a[184:187],a[24:27],v[148:151]
ds_read_b64_tr_b16 a[160:161],v24 offset:32768
ds_read_b64_tr_b16 a[162:163],v24 offset:33280
v_mfma_f32_16x16x32_bf16 v[148:151],a[188:191],a[4:7],v[148:151]
s_add_u32 m0,s87,50176
s_add_u32 s58,s91,10240
v_mfma_f32_16x16x32_bf16 v[152:155],a[188:191],a[8:11],v[152:155]
ds_read_b64_tr_b16 a[164:165],v24 offset:36864
ds_read_b64_tr_b16 a[166:167],v24 offset:37376
v_mfma_f32_16x16x32_bf16 v[152:155],a[184:187],a[28:31],v[152:155]
buffer_load_dwordx4 v17,s[20:23],s58 offen lds
v_mfma_f32_16x16x32_bf16 v[156:159],a[184:187],a[32:35],v[156:159]
ds_read_b64_tr_b16 a[168:169],v24 offset:32776
ds_read_b64_tr_b16 a[170:171],v24 offset:33288
v_mfma_f32_16x16x32_bf16 v[156:159],a[188:191],a[12:15],v[156:159]
s_add_u32 m0,s87,51200
s_add_u32 s58,s91,20480
v_mfma_f32_16x16x32_bf16 v[172:175],a[196:199],a[12:15],v[172:175]
ds_read_b64_tr_b16 a[172:173],v24 offset:36872
ds_read_b64_tr_b16 a[174:175],v24 offset:37384
v_mfma_f32_16x16x32_bf16 v[172:175],a[192:195],a[32:35],v[172:175]
buffer_load_dwordx4 v16,s[20:23],s58 offen lds
v_mfma_f32_16x16x32_bf16 v[168:171],a[192:195],a[28:31],v[168:171]
ds_read_b64_tr_b16 a[176:177],v26 offset:32768
ds_read_b64_tr_b16 a[178:179],v26 offset:33280
v_mfma_f32_16x16x32_bf16 v[168:171],a[196:199],a[8:11],v[168:171]
s_add_u32 m0,s87,52224
s_add_u32 s58,s91,30720
v_mfma_f32_16x16x32_bf16 v[164:167],a[196:199],a[4:7],v[164:167]
ds_read_b64_tr_b16 a[180:181],v26 offset:36864
ds_read_b64_tr_b16 a[182:183],v26 offset:37376
v_mfma_f32_16x16x32_bf16 v[164:167],a[192:195],a[24:27],v[164:167]
buffer_load_dwordx4 v17,s[20:23],s58 offen lds
v_mfma_f32_16x16x32_bf16 v[160:163],a[192:195],a[20:23],v[160:163]
ds_read_b64_tr_b16 a[184:185],v26 offset:32776
ds_read_b64_tr_b16 a[186:187],v26 offset:33288
v_mfma_f32_16x16x32_bf16 v[160:163],a[196:199],a[0:3],v[160:163]
s_add_u32 m0,s88,133120
s_waitcnt lgkmcnt(4)
v_mfma_f32_16x16x32_bf16 a[128:131],a[160:163],a[56:59],a[128:131]
ds_read_b64_tr_b16 a[188:189],v26 offset:36872
ds_read_b64_tr_b16 a[190:191],v26 offset:37384
v_mfma_f32_16x16x32_bf16 a[128:131],a[164:167],a[76:79],a[128:131]
s_mov_b64 exec,0xffffffff
buffer_load_dwordx4 v18,s[20:23],s91 offen lds
s_mov_b64 exec,-1
v_mfma_f32_16x16x32_bf16 v[128:131],a[164:167],a[60:63],v[128:131]
s_add_u32 s91,s91,128
v_mfma_f32_16x16x32_bf16 v[128:131],a[160:163],a[40:43],v[128:131]
s_cmp_eq_u32 s91,1280
s_cselect_b32 s91,0,s91
v_mfma_f32_16x16x32_bf16 v[132:135],a[160:163],a[44:47],v[132:135]
s_add_u32 m0,s101,73728
s_add_u32 s58,s92,128
v_mfma_f32_16x16x32_bf16 v[132:135],a[164:167],a[64:67],v[132:135]
buffer_load_dwordx4 v15,s[24:27],s58 offen lds
v_mfma_f32_16x16x32_bf16 v[48:51],a[164:167],a[68:71],v[48:51]
s_waitcnt vmcnt(10) lgkmcnt(0)
s_barrier
v_mfma_f32_16x16x32_bf16 v[48:51],a[160:163],a[48:51],v[48:51]
ds_read_b128 a[0:3],v252 offset:32768
v_mfma_f32_16x16x32_bf16 v[52:55],a[160:163],a[52:55],v[52:55]
s_add_u32 m0,s101,75776
s_add_u32 s58,s92,131200
v_mfma_f32_16x16x32_bf16 v[52:55],a[164:167],a[72:75],v[52:55]
buffer_load_dwordx4 v15,s[24:27],s58 offen lds
v_mfma_f32_16x16x32_bf16 v[68:71],a[172:175],a[72:75],v[68:71]
ds_read_b64_tr_b16 a[192:193],v24 offset:40960
ds_read_b64_tr_b16 a[194:195],v24 offset:41472
v_mfma_f32_16x16x32_bf16 v[68:71],a[168:171],a[52:55],v[68:71]
s_add_u32 m0,s101,77824
s_add_u32 s58,s92,262272
v_mfma_f32_16x16x32_bf16 v[64:67],a[168:171],a[48:51],v[64:67]
ds_read_b128 a[4:7],v252 offset:34816
v_mfma_f32_16x16x32_bf16 v[64:67],a[172:175],a[68:71],v[64:67]
buffer_load_dwordx4 v15,s[24:27],s58 offen lds
v_mfma_f32_16x16x32_bf16 v[60:63],a[172:175],a[64:67],v[60:63]
ds_read_b64_tr_b16 a[196:197],v24 offset:45056
ds_read_b64_tr_b16 a[198:199],v24 offset:45568
v_mfma_f32_16x16x32_bf16 v[60:63],a[168:171],a[44:47],v[60:63]
s_add_u32 m0,s101,79872
s_add_u32 s58,s92,393344
v_mfma_f32_16x16x32_bf16 v[56:59],a[168:171],a[40:43],v[56:59]
ds_read_b128 a[8:11],v252 offset:36864
v_mfma_f32_16x16x32_bf16 v[56:59],a[172:175],a[60:63],v[56:59]
buffer_load_dwordx4 v15,s[24:27],s58 offen lds
v_mfma_f32_16x16x32_bf16 a[132:135],a[172:175],a[76:79],a[132:135]
ds_read_b64_tr_b16 a[160:161],v24 offset:40968
ds_read_b64_tr_b16 a[162:163],v24 offset:41480
v_mfma_f32_16x16x32_bf16 a[132:135],a[168:171],a[56:59],a[132:135]
s_add_u32 s92,s92,524288
v_mfma_f32_16x16x32_bf16 v[72:75],a[176:179],a[40:43],v[72:75]
s_cmp_eq_u32 s92,5242880
s_cselect_b32 s92,0,s92
v_mfma_f32_16x16x32_bf16 v[72:75],a[180:183],a[60:63],v[72:75]
buffer_store_dwordx4 a[200:203],v10,s[44:47],s69 offen sc1
v_mfma_f32_16x16x32_bf16 v[76:79],a[180:183],a[64:67],v[76:79]
ds_read_b128 a[12:15],v252 offset:38912
v_mfma_f32_16x16x32_bf16 v[76:79],a[176:179],a[44:47],v[76:79]
ds_read_b64_tr_b16 a[164:165],v24 offset:45064
ds_read_b64_tr_b16 a[166:167],v24 offset:45576
v_mfma_f32_16x16x32_bf16 v[136:139],a[176:179],a[48:51],v[136:139]
v_mfma_f32_16x16x32_bf16 v[136:139],a[180:183],a[68:71],v[136:139]
buffer_store_dwordx4 a[204:207],v10,s[44:47],s69 offen offset:1024 sc1
v_mfma_f32_16x16x32_bf16 v[140:143],a[180:183],a[72:75],v[140:143]
ds_read_b128 a[16:19],v254 offset:0
v_mfma_f32_16x16x32_bf16 v[140:143],a[176:179],a[52:55],v[140:143]
v_mfma_f32_16x16x32_bf16 v[124:127],a[184:187],a[52:55],v[124:127]
v_mfma_f32_16x16x32_bf16 v[124:127],a[188:191],a[72:75],v[124:127]
buffer_store_dwordx4 a[208:211],v10,s[44:47],s69 offen offset:2048 sc1
v_mfma_f32_16x16x32_bf16 v[120:123],a[188:191],a[68:71],v[120:123]
v_mfma_f32_16x16x32_bf16 v[120:123],a[184:187],a[48:51],v[120:123]
v_mfma_f32_16x16x32_bf16 v[116:119],a[184:187],a[44:47],v[116:119]
v_mfma_f32_16x16x32_bf16 v[116:119],a[188:191],a[64:67],v[116:119]
buffer_store_dwordx4 a[212:215],v10,s[44:47],s69 offen offset:3072 sc1
v_mfma_f32_16x16x32_bf16 v[112:115],a[188:191],a[60:63],v[112:115]
v_mfma_f32_16x16x32_bf16 v[112:115],a[184:187],a[40:43],v[112:115]
s_waitcnt lgkmcnt(0)
v_mfma_f32_16x16x32_bf16 a[136:139],a[192:195],a[56:59],a[136:139]
ds_read_b64_tr_b16 a[172:173],v26 offset:40960
ds_read_b64_tr_b16 a[174:175],v26 offset:41472
v_mfma_f32_16x16x32_bf16 a[136:139],a[196:199],a[76:79],a[136:139]
buffer_store_dwordx4 a[216:219],v10,s[44:47],s68 offen sc1
v_mfma_f32_16x16x32_bf16 v[80:83],a[196:199],a[60:63],v[80:83]
ds_read_b128 a[20:23],v253 offset:32768
ds_read_b128 a[24:27],v253 offset:34816
v_mfma_f32_16x16x32_bf16 v[80:83],a[192:195],a[40:43],v[80:83]
s_add_u32 m0,s101,98304
s_add_u32 s58,s92,0
v_mfma_f32_16x16x32_bf16 v[84:87],a[192:195],a[44:47],v[84:87]
ds_read_b64_tr_b16 a[168:169],v26 offset:45056
ds_read_b64_tr_b16 a[170:171],v26 offset:45568
v_mfma_f32_16x16x32_bf16 v[84:87],a[196:199],a[64:67],v[84:87]
buffer_load_dwordx4 v15,s[24:27],s58 offen lds
v_mfma_f32_16x16x32_bf16 v[88:91],a[196:199],a[68:71],v[88:91]
ds_read_b128 a[28:31],v253 offset:36864
ds_read_b128 a[32:35],v253 offset:38912
v_mfma_f32_16x16x32_bf16 v[88:91],a[192:195],a[48:51],v[88:91]
s_add_u32 m0,s101,100352
s_add_u32 s58,s92,131072
v_mfma_f32_16x16x32_bf16 v[92:95],a[192:195],a[52:55],v[92:95]
ds_read_b64_tr_b16 a[180:181],v26 offset:40968
ds_read_b64_tr_b16 a[182:183],v26 offset:41480
v_mfma_f32_16x16x32_bf16 v[92:95],a[196:199],a[72:75],v[92:95]
buffer_load_dwordx4 v15,s[24:27],s58 offen lds
v_mfma_f32_16x16x32_bf16 v[108:111],a[164:167],a[72:75],v[108:111]
ds_read_b128 a[36:39],v255 offset:0
v_mfma_f32_16x16x32_bf16 v[108:111],a[160:163],a[52:55],v[108:111]
ds_read_b64_tr_b16 a[176:177],v26 offset:45064
ds_read_b64_tr_b16 a[178:179],v26 offset:45576
v_mfma_f32_16x16x32_bf16 v[104:107],a[160:163],a[48:51],v[104:107]
s_add_u32 m0,s101,102400
s_add_u32 s58,s92,262144
v_mfma_f32_16x16x32_bf16 v[104:107],a[164:167],a[68:71],v[104:107]
buffer_load_dwordx4 v15,s[24:27],s58 offen lds
v_mfma_f32_16x16x32_bf16 v[100:103],a[164:167],a[64:67],v[100:103]
s_add_u32 m0,s101,104448
s_add_u32 s58,s92,393216
v_mfma_f32_16x16x32_bf16 v[100:103],a[160:163],a[44:47],v[100:103]
v_mfma_f32_16x16x32_bf16 v[96:99],a[160:163],a[40:43],v[96:99]
v_mfma_f32_16x16x32_bf16 v[96:99],a[164:167],a[60:63],v[96:99]
buffer_load_dwordx4 v15,s[24:27],s58 offen lds
v_mfma_f32_16x16x32_bf16 a[140:143],a[164:167],a[76:79],a[140:143]
s_waitcnt vmcnt(18) lgkmcnt(0)
s_barrier
v_mfma_f32_16x16x32_bf16 a[140:143],a[160:163],a[56:59],a[140:143]
ds_read_b64_tr_b16 a[188:189],v24 offset:0
ds_read_b64_tr_b16 a[190:191],v24 offset:512
v_mfma_f32_16x16x32_bf16 v[144:147],a[172:175],a[40:43],v[144:147]
s_add_u32 m0,s87,32768
s_add_u32 s58,s91,0
v_mfma_f32_16x16x32_bf16 v[144:147],a[168:171],a[60:63],v[144:147]
buffer_load_dwordx4 v16,s[20:23],s58 offen lds
v_mfma_f32_16x16x32_bf16 v[148:151],a[168:171],a[64:67],v[148:151]
ds_read_b64_tr_b16 a[184:185],v24 offset:4096
ds_read_b64_tr_b16 a[186:187],v24 offset:4608
v_mfma_f32_16x16x32_bf16 v[148:151],a[172:175],a[44:47],v[148:151]
s_add_u32 m0,s87,33792
s_add_u32 s58,s91,10240
v_mfma_f32_16x16x32_bf16 v[152:155],a[172:175],a[48:51],v[152:155]
ds_read_b64_tr_b16 a[192:193],v24 offset:8
ds_read_b64_tr_b16 a[194:195],v24 offset:520
v_mfma_f32_16x16x32_bf16 v[152:155],a[168:171],a[68:71],v[152:155]
buffer_load_dwordx4 v17,s[20:23],s58 offen lds
v_mfma_f32_16x16x32_bf16 v[156:159],a[168:171],a[72:75],v[156:159]
ds_read_b64_tr_b16 a[196:197],v24 offset:4104
ds_read_b64_tr_b16 a[198:199],v24 offset:4616
v_mfma_f32_16x16x32_bf16 v[156:159],a[172:175],a[52:55],v[156:159]
s_add_u32 m0,s87,34816
s_add_u32 s58,s91,20480
v_mfma_f32_16x16x32_bf16 v[172:175],a[180:183],a[52:55],v[172:175]
ds_read_b64_tr_b16 a[164:165],v26 offset:0
ds_read_b64_tr_b16 a[166:167],v26 offset:512
v_mfma_f32_16x16x32_bf16 v[172:175],a[176:179],a[72:75],v[172:175]
buffer_load_dwordx4 v16,s[20:23],s58 offen lds
v_mfma_f32_16x16x32_bf16 v[168:171],a[176:179],a[68:71],v[168:171]
ds_read_b64_tr_b16 a[160:161],v26 offset:4096
ds_read_b64_tr_b16 a[162:163],v26 offset:4608
v_mfma_f32_16x16x32_bf16 v[168:171],a[180:183],a[48:51],v[168:171]
s_add_u32 m0,s87,35840
s_add_u32 s58,s91,30720
v_mfma_f32_16x16x32_bf16 v[164:167],a[180:183],a[44:47],v[164:167]
ds_read_b64_tr_b16 a[168:169],v26 offset:8
ds_read_b64_tr_b16 a[170:171],v26 offset:520
v_mfma_f32_16x16x32_bf16 v[164:167],a[176:179],a[64:67],v[164:167]
buffer_load_dwordx4 v17,s[20:23],s58 offen lds
v_mfma_f32_16x16x32_bf16 v[160:163],a[176:179],a[60:63],v[160:163]
s_add_u32 m0,s88,131072
v_mfma_f32_16x16x32_bf16 v[160:163],a[180:183],a[40:43],v[160:163]
s_waitcnt lgkmcnt(2)
v_mfma_f32_16x16x32_bf16 a[128:131],a[188:191],a[16:19],a[128:131]
ds_read_b64_tr_b16 a[172:173],v26 offset:4104
ds_read_b64_tr_b16 a[174:175],v26 offset:4616
v_mfma_f32_16x16x32_bf16 a[128:131],a[184:187],a[36:39],a[128:131]
s_mov_b64 exec,0xffffffff
buffer_load_dwordx4 v18,s[20:23],s91 offen lds
s_mov_b64 exec,-1
v_mfma_f32_16x16x32_bf16 v[128:131],a[184:187],a[20:23],v[128:131]
s_add_u32 s91,s91,128
v_mfma_f32_16x16x32_bf16 v[128:131],a[188:191],a[0:3],v[128:131]
s_cmp_eq_u32 s91,1280
s_cselect_b32 s91,0,s91
v_mfma_f32_16x16x32_bf16 v[132:135],a[188:191],a[4:7],v[132:135]
s_add_u32 m0,s101,106496
s_add_u32 s58,s92,128
v_mfma_f32_16x16x32_bf16 v[132:135],a[184:187],a[24:27],v[132:135]
buffer_load_dwordx4 v15,s[24:27],s58 offen lds
v_mfma_f32_16x16x32_bf16 v[48:51],a[184:187],a[28:31],v[48:51]
s_waitcnt vmcnt(15) lgkmcnt(0)
s_barrier
v_mfma_f32_16x16x32_bf16 v[48:51],a[188:191],a[8:11],v[48:51]
ds_read_b128 a[40:43],v252 offset:49152
v_mfma_f32_16x16x32_bf16 v[52:55],a[188:191],a[12:15],v[52:55]
s_add_u32 m0,s101,108544
s_add_u32 s58,s92,131200
v_mfma_f32_16x16x32_bf16 v[52:55],a[184:187],a[32:35],v[52:55]
buffer_load_dwordx4 v15,s[24:27],s58 offen lds
v_mfma_f32_16x16x32_bf16 v[68:71],a[196:199],a[32:35],v[68:71]
ds_read_b64_tr_b16 a[176:177],v24 offset:8192
ds_read_b64_tr_b16 a[178:179],v24 offset:8704
v_mfma_f32_16x16x32_bf16 v[68:71],a[192:195],a[12:15],v[68:71]
s_add_u32 m0,s101,110592
s_add_u32 s58,s92,262272
v_mfma_f32_16x16x32_bf16 v[64:67],a[192:195],a[8:11],v[64:67]
ds_read_b128 a[44:47],v252 offset:51200
v_mfma_f32_16x16x32_bf16 v[64:67],a[196:199],a[28:31],v[64:67]
buffer_load_dwordx4 v15,s[24:27],s58 offen lds
v_mfma_f32_16x16x32_bf16 v[60:63],a[196:199],a[24:27],v[60:63]
ds_read_b64_tr_b16 a[180:181],v24 offset:12288
ds_read_b64_tr_b16 a[182:183],v24 offset:12800
v_mfma_f32_16x16x32_bf16 v[60:63],a[192:195],a[4:7],v[60:63]
s_add_u32 m0,s101,112640
s_add_u32 s58,s92,393344
v_mfma_f32_16x16x32_bf16 v[56:59],a[192:195],a[0:3],v[56:59]
ds_read_b128 a[48:51],v252 offset:53248
v_mfma_f32_16x16x32_bf16 v[56:59],a[196:199],a[20:23],v[56:59]
buffer_load_dwordx4 v15,s[24:27],s58 offen lds
v_mfma_f32_16x16x32_bf16 a[132:135],a[196:199],a[36:39],a[132:135]
ds_read_b64_tr_b16 a[188:189],v24 offset:8200
ds_read_b64_tr_b16 a[190:191],v24 offset:8712
v_mfma_f32_16x16x32_bf16 a[132:135],a[192:195],a[16:19],a[132:135]
s_add_u32 s92,s92,524288
v_mfma_f32_16x16x32_bf16 v[72:75],a[164:167],a[0:3],v[72:75]
s_cmp_eq_u32 s92,5242880
s_cselect_b32 s92,0,s92
v_mfma_f32_16x16x32_bf16 v[72:75],a[160:163],a[20:23],v[72:75]
s_add_u32 m0,s101,65536
s_add_u32 s58,s92,0
v_mfma_f32_16x16x32_bf16 v[76:79],a[160:163],a[24:27],v[76:79]
buffer_load_dwordx4 v15,s[24:27],s58 offen lds
v_mfma_f32_16x16x32_bf16 v[76:79],a[164:167],a[4:7],v[76:79]
ds_read_b128 a[52:55],v252 offset:55296
v_mfma_f32_16x16x32_bf16 v[136:139],a[164:167],a[8:11],v[136:139]
ds_read_b64_tr_b16 a[184:185],v24 offset:12296
ds_read_b64_tr_b16 a[186:187],v24 offset:12808
v_mfma_f32_16x16x32_bf16 v[136:139],a[160:163],a[28:31],v[136:139]
s_add_u32 m0,s101,67584
s_add_u32 s58,s92,131072
v_mfma_f32_16x16x32_bf16 v[140:143],a[160:163],a[32:35],v[140:143]
buffer_load_dwordx4 v15,s[24:27],s58 offen lds
v_mfma_f32_16x16x32_bf16 v[140:143],a[164:167],a[12:15],v[140:143]
ds_read_b128 a[56:59],v254 offset:2048
v_mfma_f32_16x16x32_bf16 v[124:127],a[168:171],a[12:15],v[124:127]
s_add_u32 m0,s101,69632
s_add_u32 s58,s92,262144
v_mfma_f32_16x16x32_bf16 v[124:127],a[172:175],a[32:35],v[124:127]
v_mfma_f32_16x16x32_bf16 v[120:123],a[172:175],a[28:31],v[120:123]
buffer_load_dwordx4 v15,s[24:27],s58 offen lds
v_mfma_f32_16x16x32_bf16 v[120:123],a[168:171],a[8:11],v[120:123]
s_add_u32 m0,s101,71680
s_add_u32 s58,s92,393216
v_mfma_f32_16x16x32_bf16 v[116:119],a[168:171],a[4:7],v[116:119]
v_mfma_f32_16x16x32_bf16 v[116:119],a[172:175],a[24:27],v[116:119]
v_mfma_f32_16x16x32_bf16 v[112:115],a[172:175],a[20:23],v[112:115]
buffer_load_dwordx4 v15,s[24:27],s58 offen lds
v_mfma_f32_16x16x32_bf16 v[112:115],a[168:171],a[0:3],v[112:115]
s_waitcnt lgkmcnt(0)
v_mfma_f32_16x16x32_bf16 a[136:139],a[176:179],a[16:19],a[136:139]
ds_read_b64_tr_b16 a[196:197],v26 offset:8192
ds_read_b64_tr_b16 a[198:199],v26 offset:8704
v_mfma_f32_16x16x32_bf16 a[136:139],a[180:183],a[36:39],a[136:139]
v_mfma_f32_16x16x32_bf16 v[80:83],a[180:183],a[20:23],v[80:83]
ds_read_b128 a[60:63],v253 offset:49152
ds_read_b128 a[64:67],v253 offset:51200
v_mfma_f32_16x16x32_bf16 v[80:83],a[176:179],a[0:3],v[80:83]
v_mfma_f32_16x16x32_bf16 v[84:87],a[176:179],a[4:7],v[84:87]
ds_read_b64_tr_b16 a[192:193],v26 offset:12288
ds_read_b64_tr_b16 a[194:195],v26 offset:12800
v_mfma_f32_16x16x32_bf16 v[84:87],a[180:183],a[24:27],v[84:87]
v_mfma_f32_16x16x32_bf16 v[88:91],a[180:183],a[28:31],v[88:91]
ds_read_b128 a[68:71],v253 offset:53248
ds_read_b128 a[72:75],v253 offset:55296
v_mfma_f32_16x16x32_bf16 v[88:91],a[176:179],a[8:11],v[88:91]
v_mfma_f32_16x16x32_bf16 v[92:95],a[176:179],a[12:15],v[92:95]
ds_read_b64_tr_b16 a[160:161],v26 offset:8200
ds_read_b64_tr_b16 a[162:163],v26 offset:8712
v_mfma_f32_16x16x32_bf16 v[92:95],a[180:183],a[32:35],v[92:95]
v_mfma_f32_16x16x32_bf16 v[108:111],a[184:187],a[32:35],v[108:111]
ds_read_b128 a[76:79],v255 offset:2048
v_mfma_f32_16x16x32_bf16 v[108:111],a[188:191],a[12:15],v[108:111]
ds_read_b64_tr_b16 a[164:165],v26 offset:12296
ds_read_b64_tr_b16 a[166:167],v26 offset:12808
v_mfma_f32_16x16x32_bf16 v[104:107],a[188:191],a[8:11],v[104:107]
v_mfma_f32_16x16x32_bf16 v[104:107],a[184:187],a[28:31],v[104:107]
v_mfma_f32_16x16x32_bf16 v[100:103],a[184:187],a[24:27],v[100:103]
v_mfma_f32_16x16x32_bf16 v[100:103],a[188:191],a[4:7],v[100:103]
v_mfma_f32_16x16x32_bf16 v[96:99],a[188:191],a[0:3],v[96:99]
v_mfma_f32_16x16x32_bf16 v[96:99],a[184:187],a[20:23],v[96:99]
s_waitcnt vmcnt(13) lgkmcnt(0)
s_barrier
v_mfma_f32_16x16x32_bf16 a[140:143],a[184:187],a[36:39],a[140:143]
s_add_u32 m0,s87,143360
s_add_u32 s58,s91,0
v_mfma_f32_16x16x32_bf16 a[140:143],a[188:191],a[16:19],a[140:143]
buffer_load_dwordx4 v16,s[20:23],s58 offen lds
v_mfma_f32_16x16x32_bf16 v[144:147],a[196:199],a[0:3],v[144:147]
ds_read_b64_tr_b16 a[172:173],v24 offset:32768
ds_read_b64_tr_b16 a[174:175],v24 offset:33280
v_mfma_f32_16x16x32_bf16 v[144:147],a[192:195],a[20:23],v[144:147]
s_add_u32 m0,s87,144384
s_add_u32 s58,s91,10240
v_mfma_f32_16x16x32_bf16 v[148:151],a[192:195],a[24:27],v[148:151]
ds_read_b64_tr_b16 a[168:169],v24 offset:36864
ds_read_b64_tr_b16 a[170:171],v24 offset:37376
v_mfma_f32_16x16x32_bf16 v[148:151],a[196:199],a[4:7],v[148:151]
buffer_load_dwordx4 v17,s[20:23],s58 offen lds
v_mfma_f32_16x16x32_bf16 v[152:155],a[196:199],a[8:11],v[152:155]
ds_read_b64_tr_b16 a[176:177],v24 offset:32776
ds_read_b64_tr_b16 a[178:179],v24 offset:33288
v_mfma_f32_16x16x32_bf16 v[152:155],a[192:195],a[28:31],v[152:155]
s_add_u32 m0,s87,145408
s_add_u32 s58,s91,20480
v_mfma_f32_16x16x32_bf16 v[156:159],a[192:195],a[32:35],v[156:159]
ds_read_b64_tr_b16 a[180:181],v24 offset:36872
ds_read_b64_tr_b16 a[182:183],v24 offset:37384
v_mfma_f32_16x16x32_bf16 v[156:159],a[196:199],a[12:15],v[156:159]
buffer_load_dwordx4 v16,s[20:23],s58 offen lds
v_mfma_f32_16x16x32_bf16 v[172:175],a[160:163],a[12:15],v[172:175]
ds_read_b64_tr_b16 a[184:185],v26 offset:32768
ds_read_b64_tr_b16 a[186:187],v26 offset:33280
v_mfma_f32_16x16x32_bf16 v[172:175],a[164:167],a[32:35],v[172:175]
s_add_u32 m0,s87,146432
s_add_u32 s58,s91,30720
v_mfma_f32_16x16x32_bf16 v[168:171],a[164:167],a[28:31],v[168:171]
ds_read_b64_tr_b16 a[188:189],v26 offset:36864
ds_read_b64_tr_b16 a[190:191],v26 offset:37376
v_mfma_f32_16x16x32_bf16 v[168:171],a[160:163],a[8:11],v[168:171]
buffer_load_dwordx4 v17,s[20:23],s58 offen lds
v_mfma_f32_16x16x32_bf16 v[164:167],a[160:163],a[4:7],v[164:167]
ds_read_b64_tr_b16 a[192:193],v26 offset:32776
ds_read_b64_tr_b16 a[194:195],v26 offset:33288
v_mfma_f32_16x16x32_bf16 v[164:167],a[164:167],a[24:27],v[164:167]
s_add_u32 m0,s88,133120
v_mfma_f32_16x16x32_bf16 v[160:163],a[164:167],a[20:23],v[160:163]
v_mfma_f32_16x16x32_bf16 v[160:163],a[160:163],a[0:3],v[160:163]
s_mov_b64 exec,0xffffffff
buffer_load_dwordx4 v18,s[20:23],s91 offen lds
s_mov_b64 exec,-1
s_waitcnt lgkmcnt(2)
v_mfma_f32_16x16x32_bf16 a[128:131],a[172:175],a[56:59],a[128:131]
ds_read_b64_tr_b16 a[196:197],v26 offset:36872
ds_read_b64_tr_b16 a[198:199],v26 offset:37384
v_mfma_f32_16x16x32_bf16 a[128:131],a[168:171],a[76:79],a[128:131]
s_add_u32 s91,s91,128
v_mfma_f32_16x16x32_bf16 v[128:131],a[168:171],a[60:63],v[128:131]
s_cmp_eq_u32 s91,1280
s_cselect_b32 s91,0,s91
v_mfma_f32_16x16x32_bf16 v[128:131],a[172:175],a[40:43],v[128:131]
s_add_u32 m0,s101,73728
s_add_u32 s58,s92,128
v_mfma_f32_16x16x32_bf16 v[132:135],a[172:175],a[44:47],v[132:135]
buffer_load_dwordx4 v15,s[24:27],s58 offen lds
v_mfma_f32_16x16x32_bf16 v[132:135],a[168:171],a[64:67],v[132:135]
s_add_u32 m0,s101,75776
s_add_u32 s58,s92,131200
v_mfma_f32_16x16x32_bf16 v[48:51],a[168:171],a[68:71],v[48:51]
s_waitcnt vmcnt(10) lgkmcnt(0)
s_barrier
v_mfma_f32_16x16x32_bf16 v[48:51],a[172:175],a[48:51],v[48:51]
ds_read_b128 a[200:203],v252 offset:32768
v_mfma_f32_16x16x32_bf16 v[52:55],a[172:175],a[52:55],v[52:55]
buffer_load_dwordx4 v15,s[24:27],s58 offen lds
v_mfma_f32_16x16x32_bf16 v[52:55],a[168:171],a[72:75],v[52:55]
ds_read_b64_tr_b16 a[164:165],v24 offset:40960
ds_read_b64_tr_b16 a[166:167],v24 offset:41472
v_mfma_f32_16x16x32_bf16 v[68:71],a[180:183],a[72:75],v[68:71]
s_add_u32 m0,s101,77824
s_add_u32 s58,s92,262272
v_mfma_f32_16x16x32_bf16 v[68:71],a[176:179],a[52:55],v[68:71]
ds_read_b128 a[204:207],v252 offset:34816
v_mfma_f32_16x16x32_bf16 v[64:67],a[176:179],a[48:51],v[64:67]
buffer_load_dwordx4 v15,s[24:27],s58 offen lds
v_mfma_f32_16x16x32_bf16 v[64:67],a[180:183],a[68:71],v[64:67]
ds_read_b64_tr_b16 a[160:161],v24 offset:45056
ds_read_b64_tr_b16 a[162:163],v24 offset:45568
v_mfma_f32_16x16x32_bf16 v[60:63],a[180:183],a[64:67],v[60:63]
s_add_u32 m0,s101,79872
s_add_u32 s58,s92,393344
v_mfma_f32_16x16x32_bf16 v[60:63],a[176:179],a[44:47],v[60:63]
ds_read_b128 a[208:211],v252 offset:36864
v_mfma_f32_16x16x32_bf16 v[56:59],a[176:179],a[40:43],v[56:59]
buffer_load_dwordx4 v15,s[24:27],s58 offen lds
v_mfma_f32_16x16x32_bf16 v[56:59],a[180:183],a[60:63],v[56:59]
ds_read_b64_tr_b16 a[172:173],v24 offset:40968
ds_read_b64_tr_b16 a[174:175],v24 offset:41480
v_mfma_f32_16x16x32_bf16 a[132:135],a[180:183],a[76:79],a[132:135]
s_add_u32 s92,s92,524288
v_mfma_f32_16x16x32_bf16 a[132:135],a[176:179],a[56:59],a[132:135]
s_cmp_eq_u32 s92,5242880
s_cselect_b32 s92,0,s92
v_mfma_f32_16x16x32_bf16 v[72:75],a[184:187],a[40:43],v[72:75]
v_add_u32 v1,143360,v252
v_add_u32 v2,143360,v253
v_mfma_f32_16x16x32_bf16 v[72:75],a[188:191],a[60:63],v[72:75]
s_add_u32 m0,s101,98304
s_add_u32 s58,s92,0
v_mfma_f32_16x16x32_bf16 v[76:79],a[188:191],a[64:67],v[76:79]
buffer_load_dwordx4 v15,s[24:27],s58 offen lds
v_mfma_f32_16x16x32_bf16 v[76:79],a[184:187],a[44:47],v[76:79]
ds_read_b128 a[212:215],v252 offset:38912
v_mfma_f32_16x16x32_bf16 v[136:139],a[184:187],a[48:51],v[136:139]
ds_read_b64_tr_b16 a[168:169],v24 offset:45064
ds_read_b64_tr_b16 a[170:171],v24 offset:45576
v_mfma_f32_16x16x32_bf16 v[136:139],a[188:191],a[68:71],v[136:139]
s_add_u32 m0,s101,100352
s_add_u32 s58,s92,131072
v_mfma_f32_16x16x32_bf16 v[140:143],a[188:191],a[72:75],v[140:143]
buffer_load_dwordx4 v15,s[24:27],s58 offen lds
v_mfma_f32_16x16x32_bf16 v[140:143],a[184:187],a[52:55],v[140:143]
ds_read_b128 a[216:219],v254 offset:0
v_mfma_f32_16x16x32_bf16 v[124:127],a[192:195],a[52:55],v[124:127]
s_add_u32 m0,s101,102400
s_add_u32 s58,s92,262144
v_mfma_f32_16x16x32_bf16 v[124:127],a[196:199],a[72:75],v[124:127]
v_mfma_f32_16x16x32_bf16 v[120:123],a[196:199],a[68:71],v[120:123]
buffer_load_dwordx4 v15,s[24:27],s58 offen lds
v_mfma_f32_16x16x32_bf16 v[120:123],a[192:195],a[48:51],v[120:123]
s_add_u32 m0,s101,104448
s_add_u32 s58,s92,393216
v_mfma_f32_16x16x32_bf16 v[116:119],a[192:195],a[44:47],v[116:119]
v_mfma_f32_16x16x32_bf16 v[116:119],a[196:199],a[64:67],v[116:119]
v_mfma_f32_16x16x32_bf16 v[112:115],a[196:199],a[60:63],v[112:115]
buffer_load_dwordx4 v15,s[24:27],s58 offen lds
v_mfma_f32_16x16x32_bf16 v[112:115],a[192:195],a[40:43],v[112:115]
s_waitcnt lgkmcnt(0)
v_mfma_f32_16x16x32_bf16 a[136:139],a[164:167],a[56:59],a[136:139]
ds_read_b64_tr_b16 a[180:181],v26 offset:40960
ds_read_b64_tr_b16 a[182:183],v26 offset:41472
v_mfma_f32_16x16x32_bf16 a[136:139],a[160:163],a[76:79],a[136:139]
v_mfma_f32_16x16x32_bf16 v[80:83],a[160:163],a[60:63],v[80:83]
ds_read_b128 a[220:223],v253 offset:32768
ds_read_b128 a[224:227],v253 offset:34816
v_mfma_f32_16x16x32_bf16 v[80:83],a[164:167],a[40:43],v[80:83]
v_mfma_f32_16x16x32_bf16 v[84:87],a[164:167],a[44:47],v[84:87]
ds_read_b64_tr_b16 a[176:177],v26 offset:45056
ds_read_b64_tr_b16 a[178:179],v26 offset:45568
v_mfma_f32_16x16x32_bf16 v[84:87],a[160:163],a[64:67],v[84:87]
v_mfma_f32_16x16x32_bf16 v[88:91],a[160:163],a[68:71],v[88:91]
ds_read_b128 a[228:231],v253 offset:36864
ds_read_b128 a[232:235],v253 offset:38912
v_mfma_f32_16x16x32_bf16 v[88:91],a[164:167],a[48:51],v[88:91]
v_mfma_f32_16x16x32_bf16 v[92:95],a[164:167],a[52:55],v[92:95]
ds_read_b64_tr_b16 a[188:189],v26 offset:40968
ds_read_b64_tr_b16 a[190:191],v26 offset:41480
v_mfma_f32_16x16x32_bf16 v[92:95],a[160:163],a[72:75],v[92:95]
v_mfma_f32_16x16x32_bf16 v[108:111],a[168:171],a[72:75],v[108:111]
ds_read_b128 a[236:239],v255 offset:0
v_mfma_f32_16x16x32_bf16 v[108:111],a[172:175],a[52:55],v[108:111]
ds_read_b64_tr_b16 a[184:185],v26 offset:45064
ds_read_b64_tr_b16 a[186:187],v26 offset:45576
v_mfma_f32_16x16x32_bf16 v[104:107],a[172:175],a[48:51],v[104:107]
v_mfma_f32_16x16x32_bf16 v[104:107],a[168:171],a[68:71],v[104:107]
v_mfma_f32_16x16x32_bf16 v[100:103],a[168:171],a[64:67],v[100:103]
v_mfma_f32_16x16x32_bf16 v[100:103],a[172:175],a[44:47],v[100:103]
v_mfma_f32_16x16x32_bf16 v[96:99],a[172:175],a[40:43],v[96:99]
v_mfma_f32_16x16x32_bf16 v[96:99],a[168:171],a[60:63],v[96:99]
s_waitcnt vmcnt(13) lgkmcnt(0)
s_barrier
v_mfma_f32_16x16x32_bf16 a[140:143],a[168:171],a[76:79],a[140:143]
s_add_u32 m0,s101,106496
s_add_u32 s58,s92,128
v_mfma_f32_16x16x32_bf16 a[140:143],a[172:175],a[56:59],a[140:143]
buffer_load_dwordx4 v15,s[24:27],s58 offen lds
v_mfma_f32_16x16x32_bf16 v[144:147],a[180:183],a[40:43],v[144:147]
ds_read_b64_tr_b16 a[196:197],v24 offset:0
ds_read_b64_tr_b16 a[198:199],v24 offset:512
v_mfma_f32_16x16x32_bf16 v[144:147],a[176:179],a[60:63],v[144:147]
s_add_u32 m0,s101,108544
s_add_u32 s58,s92,131200
v_mfma_f32_16x16x32_bf16 v[148:151],a[176:179],a[64:67],v[148:151]
ds_read_b64_tr_b16 a[192:193],v24 offset:4096
ds_read_b64_tr_b16 a[194:195],v24 offset:4608
v_mfma_f32_16x16x32_bf16 v[148:151],a[180:183],a[44:47],v[148:151]
buffer_load_dwordx4 v15,s[24:27],s58 offen lds
v_mfma_f32_16x16x32_bf16 v[152:155],a[180:183],a[48:51],v[152:155]
ds_read_b64_tr_b16 a[164:165],v24 offset:8
ds_read_b64_tr_b16 a[166:167],v24 offset:520
v_mfma_f32_16x16x32_bf16 v[152:155],a[176:179],a[68:71],v[152:155]
s_add_u32 m0,s101,110592
s_add_u32 s58,s92,262272
v_mfma_f32_16x16x32_bf16 v[156:159],a[176:179],a[72:75],v[156:159]
ds_read_b64_tr_b16 a[160:161],v24 offset:4104
ds_read_b64_tr_b16 a[162:163],v24 offset:4616
v_mfma_f32_16x16x32_bf16 v[156:159],a[180:183],a[52:55],v[156:159]
buffer_load_dwordx4 v15,s[24:27],s58 offen lds
v_mfma_f32_16x16x32_bf16 v[172:175],a[188:191],a[52:55],v[172:175]
ds_read_b64_tr_b16 a[168:169],v26 offset:0
ds_read_b64_tr_b16 a[170:171],v26 offset:512
v_mfma_f32_16x16x32_bf16 v[172:175],a[184:187],a[72:75],v[172:175]
s_add_u32 m0,s101,112640
s_add_u32 s58,s92,393344
v_mfma_f32_16x16x32_bf16 v[168:171],a[184:187],a[68:71],v[168:171]
ds_read_b64_tr_b16 a[172:173],v26 offset:4096
ds_read_b64_tr_b16 a[174:175],v26 offset:4608
v_mfma_f32_16x16x32_bf16 v[168:171],a[188:191],a[48:51],v[168:171]
buffer_load_dwordx4 v15,s[24:27],s58 offen lds
v_mfma_f32_16x16x32_bf16 v[164:167],a[188:191],a[44:47],v[164:167]
ds_read_b64_tr_b16 a[176:177],v26 offset:8
ds_read_b64_tr_b16 a[178:179],v26 offset:520
v_mfma_f32_16x16x32_bf16 v[164:167],a[184:187],a[64:67],v[164:167]
s_add_u32 s92,s92,524288
v_mfma_f32_16x16x32_bf16 v[160:163],a[184:187],a[60:63],v[160:163]
s_cmp_eq_u32 s92,5242880
s_cselect_b32 s92,0,s92
v_mfma_f32_16x16x32_bf16 v[160:163],a[188:191],a[40:43],v[160:163]
s_add_u32 m0,s85,32768
s_xor_b32 s58,s11,4096
s_waitcnt lgkmcnt(2)
v_mfma_f32_16x16x32_bf16 a[128:131],a[196:199],a[216:219],a[128:131]
buffer_load_dwordx4 v12,s[28:31],s58 offen nt lds
v_mfma_f32_16x16x32_bf16 a[128:131],a[192:195],a[236:239],a[128:131]
ds_read_b64_tr_b16 a[180:181],v26 offset:4104
ds_read_b64_tr_b16 a[182:183],v26 offset:4616
v_mfma_f32_16x16x32_bf16 v[128:131],a[192:195],a[220:223],v[128:131]
v_mfma_f32_16x16x32_bf16 v[128:131],a[196:199],a[200:203],v[128:131]
v_mfma_f32_16x16x32_bf16 v[132:135],a[196:199],a[204:207],v[132:135]
buffer_load_dwordx4 v12,s[28:31],s58 offen offset:1024 nt lds
v_mfma_f32_16x16x32_bf16 v[132:135],a[192:195],a[224:227],v[132:135]
s_add_u32 m0,s85,36864
s_xor_b32 s58,s11,36864
v_mfma_f32_16x16x32_bf16 v[48:51],a[192:195],a[228:231],v[48:51]
v_mfma_f32_16x16x32_bf16 v[48:51],a[196:199],a[208:211],v[48:51]
s_waitcnt vmcnt(10) lgkmcnt(0)
s_barrier
v_mfma_f32_16x16x32_bf16 v[52:55],a[196:199],a[212:215],v[52:55]
buffer_load_dwordx4 v13,s[28:31],s58 offen nt lds
v_mfma_f32_16x16x32_bf16 v[52:55],a[192:195],a[232:235],v[52:55]
ds_read_b128 a[40:43],v1 offset:0
v_mfma_f32_16x16x32_bf16 v[68:71],a[160:163],a[232:235],v[68:71]
ds_read_b64_tr_b16 a[184:185],v24 offset:8192
ds_read_b64_tr_b16 a[186:187],v24 offset:8704
v_mfma_f32_16x16x32_bf16 v[68:71],a[164:167],a[212:215],v[68:71]
v_mfma_f32_16x16x32_bf16 v[64:67],a[164:167],a[208:211],v[64:67]
buffer_load_dwordx4 v13,s[28:31],s58 offen offset:1024 nt lds
v_mfma_f32_16x16x32_bf16 v[64:67],a[160:163],a[228:231],v[64:67]
ds_read_b128 a[44:47],v1 offset:2048
v_mfma_f32_16x16x32_bf16 v[60:63],a[160:163],a[224:227],v[60:63]
ds_read_b64_tr_b16 a[188:189],v24 offset:12288
ds_read_b64_tr_b16 a[190:191],v24 offset:12800
v_mfma_f32_16x16x32_bf16 v[60:63],a[164:167],a[204:207],v[60:63]
s_add_u32 m0,s85,40960
s_xor_b32 s58,s11,12288
v_mfma_f32_16x16x32_bf16 v[56:59],a[164:167],a[200:203],v[56:59]
buffer_load_dwordx4 v12,s[28:31],s58 offen nt lds
v_mfma_f32_16x16x32_bf16 v[56:59],a[160:163],a[220:223],v[56:59]
ds_read_b128 a[48:51],v1 offset:4096
v_mfma_f32_16x16x32_bf16 a[132:135],a[160:163],a[236:239],a[132:135]
ds_read_b64_tr_b16 a[196:197],v24 offset:8200
ds_read_b64_tr_b16 a[198:199],v24 offset:8712
v_mfma_f32_16x16x32_bf16 a[132:135],a[164:167],a[216:219],a[132:135]
v_mfma_f32_16x16x32_bf16 v[72:75],a[168:171],a[200:203],v[72:75]
buffer_load_dwordx4 v12,s[28:31],s58 offen offset:1024 nt lds
v_mfma_f32_16x16x32_bf16 v[72:75],a[172:175],a[220:223],v[72:75]
ds_read_b128 a[52:55],v1 offset:6144
v_mfma_f32_16x16x32_bf16 v[76:79],a[172:175],a[224:227],v[76:79]
ds_read_b64_tr_b16 a[192:193],v24 offset:12296
ds_read_b64_tr_b16 a[194:195],v24 offset:12808
v_mfma_f32_16x16x32_bf16 v[76:79],a[168:171],a[204:207],v[76:79]
s_add_u32 m0,s85,45056
s_xor_b32 s58,s11,45056
v_mfma_f32_16x16x32_bf16 v[136:139],a[168:171],a[208:211],v[136:139]
buffer_load_dwordx4 v13,s[28:31],s58 offen nt lds
v_mfma_f32_16x16x32_bf16 v[136:139],a[172:175],a[228:231],v[136:139]
ds_read_b128 a[56:59],v254 offset:2048
v_mfma_f32_16x16x32_bf16 v[140:143],a[172:175],a[232:235],v[140:143]
v_mfma_f32_16x16x32_bf16 v[140:143],a[168:171],a[212:215],v[140:143]
v_mfma_f32_16x16x32_bf16 v[124:127],a[176:179],a[212:215],v[124:127]
buffer_load_dwordx4 v13,s[28:31],s58 offen offset:1024 nt lds
v_mfma_f32_16x16x32_bf16 v[124:127],a[180:183],a[232:235],v[124:127]
s_add_u32 m0,s85,65536
s_xor_b32 s58,s11,0
v_mfma_f32_16x16x32_bf16 v[120:123],a[180:183],a[228:231],v[120:123]
v_mfma_f32_16x16x32_bf16 v[120:123],a[176:179],a[208:211],v[120:123]
v_mfma_f32_16x16x32_bf16 v[116:119],a[176:179],a[204:207],v[116:119]
buffer_load_dwordx4 v14,s[32:35],s58 offen nt lds
v_mfma_f32_16x16x32_bf16 v[116:119],a[180:183],a[224:227],v[116:119]
v_mfma_f32_16x16x32_bf16 v[112:115],a[180:183],a[220:223],v[112:115]
v_mfma_f32_16x16x32_bf16 v[112:115],a[176:179],a[200:203],v[112:115]
s_waitcnt lgkmcnt(0)
v_mfma_f32_16x16x32_bf16 a[136:139],a[184:187],a[216:219],a[136:139]
buffer_load_dwordx4 v14,s[32:35],s58 offen offset:1024 nt lds
v_mfma_f32_16x16x32_bf16 a[136:139],a[188:191],a[236:239],a[136:139]
ds_read_b64_tr_b16 a[160:161],v26 offset:8192
ds_read_b64_tr_b16 a[162:163],v26 offset:8704
v_mfma_f32_16x16x32_bf16 v[80:83],a[188:191],a[220:223],v[80:83]
s_add_u32 m0,s85,69632
s_xor_b32 s58,s11,32768
v_mfma_f32_16x16x32_bf16 v[80:83],a[184:187],a[200:203],v[80:83]
ds_read_b128 a[60:63],v2 offset:0
ds_read_b128 a[64:67],v2 offset:2048
v_mfma_f32_16x16x32_bf16 v[84:87],a[184:187],a[204:207],v[84:87]
buffer_load_dwordx4 v14,s[32:35],s58 offen nt lds
v_mfma_f32_16x16x32_bf16 v[84:87],a[188:191],a[224:227],v[84:87]
ds_read_b64_tr_b16 a[164:165],v26 offset:12288
ds_read_b64_tr_b16 a[166:167],v26 offset:12800
v_mfma_f32_16x16x32_bf16 v[88:91],a[188:191],a[228:231],v[88:91]
v_mfma_f32_16x16x32_bf16 v[88:91],a[184:187],a[208:211],v[88:91]
ds_read_b128 a[68:71],v2 offset:4096
ds_read_b128 a[72:75],v2 offset:6144
v_mfma_f32_16x16x32_bf16 v[92:95],a[184:187],a[212:215],v[92:95]
buffer_load_dwordx4 v14,s[32:35],s58 offen offset:1024 nt lds
v_mfma_f32_16x16x32_bf16 v[92:95],a[188:191],a[232:235],v[92:95]
ds_read_b64_tr_b16 a[172:173],v26 offset:8200
ds_read_b64_tr_b16 a[174:175],v26 offset:8712
v_mfma_f32_16x16x32_bf16 v[108:111],a[192:195],a[232:235],v[108:111]
v_mfma_f32_16x16x32_bf16 v[108:111],a[196:199],a[212:215],v[108:111]
ds_read_b128 a[76:79],v255 offset:2048
v_mfma_f32_16x16x32_bf16 v[104:107],a[196:199],a[208:211],v[104:107]
ds_read_b64_tr_b16 a[168:169],v26 offset:12296
ds_read_b64_tr_b16 a[170:171],v26 offset:12808
v_mfma_f32_16x16x32_bf16 v[104:107],a[192:195],a[228:231],v[104:107]
v_mfma_f32_16x16x32_bf16 v[100:103],a[192:195],a[224:227],v[100:103]
v_mfma_f32_16x16x32_bf16 v[100:103],a[196:199],a[204:207],v[100:103]
v_mfma_f32_16x16x32_bf16 v[96:99],a[196:199],a[200:203],v[96:99]
v_mfma_f32_16x16x32_bf16 v[96:99],a[192:195],a[220:223],v[96:99]
v_mfma_f32_16x16x32_bf16 a[140:143],a[192:195],a[236:239],a[140:143]
s_waitcnt vmcnt(12) lgkmcnt(0)
s_barrier
v_mfma_f32_16x16x32_bf16 a[140:143],a[196:199],a[216:219],a[140:143]
s_add_u32 m0,s85,73728
s_xor_b32 s58,s11,8192
v_mfma_f32_16x16x32_bf16 v[144:147],a[160:163],a[200:203],v[144:147]
buffer_load_dwordx4 v14,s[32:35],s58 offen nt lds
v_mfma_f32_16x16x32_bf16 v[144:147],a[164:167],a[220:223],v[144:147]
ds_read_b64_tr_b16 a[180:181],v24 offset:32768
ds_read_b64_tr_b16 a[182:183],v24 offset:33280
v_mfma_f32_16x16x32_bf16 v[148:151],a[164:167],a[224:227],v[148:151]
v_mfma_f32_16x16x32_bf16 v[148:151],a[160:163],a[204:207],v[148:151]
ds_read_b64_tr_b16 a[176:177],v24 offset:36864
ds_read_b64_tr_b16 a[178:179],v24 offset:37376
v_mfma_f32_16x16x32_bf16 v[152:155],a[160:163],a[208:211],v[152:155]
buffer_load_dwordx4 v14,s[32:35],s58 offen offset:1024 nt lds
v_mfma_f32_16x16x32_bf16 v[152:155],a[164:167],a[228:231],v[152:155]
ds_read_b64_tr_b16 a[184:185],v24 offset:32776
ds_read_b64_tr_b16 a[186:187],v24 offset:33288
v_mfma_f32_16x16x32_bf16 v[156:159],a[164:167],a[232:235],v[156:159]
s_add_u32 m0,s85,77824
s_xor_b32 s58,s11,40960
v_mfma_f32_16x16x32_bf16 v[156:159],a[160:163],a[212:215],v[156:159]
ds_read_b64_tr_b16 a[188:189],v24 offset:36872
ds_read_b64_tr_b16 a[190:191],v24 offset:37384
v_mfma_f32_16x16x32_bf16 v[172:175],a[172:175],a[212:215],v[172:175]
buffer_load_dwordx4 v14,s[32:35],s58 offen nt lds
v_mfma_f32_16x16x32_bf16 v[172:175],a[168:171],a[232:235],v[172:175]
ds_read_b64_tr_b16 a[192:193],v24 offset:40960
ds_read_b64_tr_b16 a[194:195],v24 offset:41472
v_mfma_f32_16x16x32_bf16 v[168:171],a[168:171],a[228:231],v[168:171]
v_mfma_f32_16x16x32_bf16 v[168:171],a[172:175],a[208:211],v[168:171]
ds_read_b64_tr_b16 a[196:197],v24 offset:45056
ds_read_b64_tr_b16 a[198:199],v24 offset:45568
v_mfma_f32_16x16x32_bf16 v[164:167],a[172:175],a[204:207],v[164:167]
buffer_load_dwordx4 v14,s[32:35],s58 offen offset:1024 nt lds
v_mfma_f32_16x16x32_bf16 v[164:167],a[168:171],a[224:227],v[164:167]
ds_read_b64_tr_b16 a[164:165],v24 offset:40968
ds_read_b64_tr_b16 a[166:167],v24 offset:41480
v_mfma_f32_16x16x32_bf16 v[160:163],a[168:171],a[220:223],v[160:163]
v_mfma_f32_16x16x32_bf16 v[160:163],a[172:175],a[200:203],v[160:163]
s_waitcnt lgkmcnt(2)
v_mfma_f32_16x16x32_bf16 a[128:131],a[180:183],a[56:59],a[128:131]
ds_read_b64_tr_b16 a[160:161],v24 offset:45064
ds_read_b64_tr_b16 a[162:163],v24 offset:45576
v_mfma_f32_16x16x32_bf16 a[128:131],a[176:179],a[76:79],a[128:131]
v_mfma_f32_16x16x32_bf16 v[128:131],a[176:179],a[60:63],v[128:131]
ds_read_b64_tr_b16 a[168:169],v26 offset:32768
ds_read_b64_tr_b16 a[170:171],v26 offset:33280
v_mfma_f32_16x16x32_bf16 v[128:131],a[180:183],a[40:43],v[128:131]
v_mfma_f32_16x16x32_bf16 v[132:135],a[180:183],a[44:47],v[132:135]
ds_read_b64_tr_b16 a[172:173],v26 offset:36864
ds_read_b64_tr_b16 a[174:175],v26 offset:37376
v_mfma_f32_16x16x32_bf16 v[132:135],a[176:179],a[64:67],v[132:135]
v_mfma_f32_16x16x32_bf16 v[48:51],a[176:179],a[68:71],v[48:51]
v_mfma_f32_16x16x32_bf16 v[48:51],a[180:183],a[48:51],v[48:51]
v_mfma_f32_16x16x32_bf16 v[52:55],a[180:183],a[52:55],v[52:55]
ds_read_b64_tr_b16 a[180:181],v26 offset:32776
ds_read_b64_tr_b16 a[182:183],v26 offset:33288
v_mfma_f32_16x16x32_bf16 v[52:55],a[176:179],a[72:75],v[52:55]
v_mul_f32 v128,s74,v128
v_mul_f32 v129,s74,v129
v_mfma_f32_16x16x32_bf16 a[132:135],a[188:191],a[76:79],a[132:135]
ds_read_b64_tr_b16 a[176:177],v26 offset:36872
ds_read_b64_tr_b16 a[178:179],v26 offset:37384
v_mfma_f32_16x16x32_bf16 a[132:135],a[184:187],a[56:59],a[132:135]
v_mul_f32 v130,s74,v130
v_mul_f32 v131,s74,v131
v_mfma_f32_16x16x32_bf16 v[56:59],a[184:187],a[40:43],v[56:59]
v_mul_f32 v132,s74,v132
v_mul_f32 v133,s74,v133
v_mfma_f32_16x16x32_bf16 v[56:59],a[188:191],a[60:63],v[56:59]
v_mul_f32 v134,s74,v134
v_mul_f32 v135,s74,v135
v_mfma_f32_16x16x32_bf16 v[60:63],a[188:191],a[64:67],v[60:63]
v_mul_f32 v48,s74,v48
v_mul_f32 v49,s74,v49
v_mfma_f32_16x16x32_bf16 v[60:63],a[184:187],a[44:47],v[60:63]
v_mul_f32 v50,s74,v50
v_mul_f32 v51,s74,v51
v_mfma_f32_16x16x32_bf16 v[64:67],a[184:187],a[48:51],v[64:67]
v_mul_f32 v52,s74,v52
v_mul_f32 v53,s74,v53
v_mfma_f32_16x16x32_bf16 v[64:67],a[188:191],a[68:71],v[64:67]
v_mul_f32 v54,s74,v54
v_mul_f32 v55,s74,v55
v_mfma_f32_16x16x32_bf16 v[68:71],a[188:191],a[72:75],v[68:71]
ds_read_b64_tr_b16 a[188:189],v26 offset:40960
ds_read_b64_tr_b16 a[190:191],v26 offset:41472
v_mfma_f32_16x16x32_bf16 v[68:71],a[184:187],a[52:55],v[68:71]
v_cvt_pk_bf16_f32 v180,v128,v129
v_cvt_pk_bf16_f32 v181,v130,v131
v_mfma_f32_16x16x32_bf16 a[136:139],a[192:195],a[56:59],a[136:139]
v_cvt_pk_bf16_f32 v196,v132,v133
v_cvt_pk_bf16_f32 v197,v134,v135
v_mfma_f32_16x16x32_bf16 a[136:139],a[196:199],a[76:79],a[136:139]
v_cvt_pk_bf16_f32 v212,v48,v49
v_cvt_pk_bf16_f32 v213,v50,v51
v_mfma_f32_16x16x32_bf16 v[80:83],a[196:199],a[60:63],v[80:83]
v_cvt_pk_bf16_f32 v228,v52,v53
v_cvt_pk_bf16_f32 v229,v54,v55
v_mfma_f32_16x16x32_bf16 v[80:83],a[192:195],a[40:43],v[80:83]
v_mul_f32 v56,s74,v56
v_mul_f32 v57,s74,v57
v_mfma_f32_16x16x32_bf16 v[84:87],a[192:195],a[44:47],v[84:87]
v_mul_f32 v58,s74,v58
v_mul_f32 v59,s74,v59
v_mfma_f32_16x16x32_bf16 v[84:87],a[196:199],a[64:67],v[84:87]
v_mul_f32 v60,s74,v60
v_mul_f32 v61,s74,v61
v_mfma_f32_16x16x32_bf16 v[88:91],a[196:199],a[68:71],v[88:91]
v_mul_f32 v62,s74,v62
v_mul_f32 v63,s74,v63
v_mfma_f32_16x16x32_bf16 v[88:91],a[192:195],a[48:51],v[88:91]
v_mul_f32 v64,s74,v64
v_mul_f32 v65,s74,v65
v_mfma_f32_16x16x32_bf16 v[92:95],a[192:195],a[52:55],v[92:95]
v_mul_f32 v66,s74,v66
v_mul_f32 v67,s74,v67
v_mfma_f32_16x16x32_bf16 v[92:95],a[196:199],a[72:75],v[92:95]
v_mul_f32 v68,s74,v68
v_mul_f32 v69,s74,v69
s_waitcnt lgkmcnt(0)
v_mfma_f32_16x16x32_bf16 a[140:143],a[160:163],a[76:79],a[140:143]
ds_read_b64_tr_b16 a[184:185],v26 offset:45056
ds_read_b64_tr_b16 a[186:187],v26 offset:45568
v_mfma_f32_16x16x32_bf16 a[140:143],a[164:167],a[56:59],a[140:143]
v_mul_f32 v70,s74,v70
v_mul_f32 v71,s74,v71
v_mfma_f32_16x16x32_bf16 v[96:99],a[164:167],a[40:43],v[96:99]
ds_read_b64_tr_b16 a[192:193],v26 offset:40968
ds_read_b64_tr_b16 a[194:195],v26 offset:41480
v_mfma_f32_16x16x32_bf16 v[96:99],a[160:163],a[60:63],v[96:99]
v_cvt_pk_bf16_f32 v182,v56,v57
v_cvt_pk_bf16_f32 v183,v58,v59
v_mfma_f32_16x16x32_bf16 v[100:103],a[160:163],a[64:67],v[100:103]
ds_read_b64_tr_b16 a[196:197],v26 offset:45064
ds_read_b64_tr_b16 a[198:199],v26 offset:45576
v_mfma_f32_16x16x32_bf16 v[100:103],a[164:167],a[44:47],v[100:103]
v_cvt_pk_bf16_f32 v198,v60,v61
v_cvt_pk_bf16_f32 v199,v62,v63
v_mfma_f32_16x16x32_bf16 v[104:107],a[164:167],a[48:51],v[104:107]
v_cvt_pk_bf16_f32 v214,v64,v65
v_cvt_pk_bf16_f32 v215,v66,v67
v_mfma_f32_16x16x32_bf16 v[104:107],a[160:163],a[68:71],v[104:107]
v_cvt_pk_bf16_f32 v230,v68,v69
v_cvt_pk_bf16_f32 v231,v70,v71
v_mfma_f32_16x16x32_bf16 v[108:111],a[160:163],a[72:75],v[108:111]
v_mul_f32 v80,s74,v80
v_mul_f32 v81,s74,v81
v_mfma_f32_16x16x32_bf16 v[108:111],a[164:167],a[52:55],v[108:111]
v_mul_f32 v82,s74,v82
v_mul_f32 v83,s74,v83
v_mfma_f32_16x16x32_bf16 v[72:75],a[168:171],a[40:43],v[72:75]
v_mul_f32 v84,s74,v84
v_mul_f32 v85,s74,v85
v_mfma_f32_16x16x32_bf16 v[72:75],a[172:175],a[60:63],v[72:75]
v_mul_f32 v86,s74,v86
v_mul_f32 v87,s74,v87
v_mfma_f32_16x16x32_bf16 v[76:79],a[172:175],a[64:67],v[76:79]
v_mul_f32 v88,s74,v88
v_mul_f32 v89,s74,v89
v_mfma_f32_16x16x32_bf16 v[76:79],a[168:171],a[44:47],v[76:79]
v_mul_f32 v90,s74,v90
v_mul_f32 v91,s74,v91
v_mfma_f32_16x16x32_bf16 v[136:139],a[168:171],a[48:51],v[136:139]
v_mul_f32 v92,s74,v92
v_mul_f32 v93,s74,v93
v_mfma_f32_16x16x32_bf16 v[136:139],a[172:175],a[68:71],v[136:139]
v_mul_f32 v94,s74,v94
v_mul_f32 v95,s74,v95
v_mfma_f32_16x16x32_bf16 v[140:143],a[172:175],a[72:75],v[140:143]
v_cvt_pk_bf16_f32 v188,v80,v81
v_cvt_pk_bf16_f32 v189,v82,v83
v_mfma_f32_16x16x32_bf16 v[140:143],a[168:171],a[52:55],v[140:143]
v_cvt_pk_bf16_f32 v204,v84,v85
v_cvt_pk_bf16_f32 v205,v86,v87
v_mfma_f32_16x16x32_bf16 v[112:115],a[180:183],a[40:43],v[112:115]
v_cvt_pk_bf16_f32 v220,v88,v89
v_cvt_pk_bf16_f32 v221,v90,v91
v_mfma_f32_16x16x32_bf16 v[112:115],a[176:179],a[60:63],v[112:115]
v_cvt_pk_bf16_f32 v236,v92,v93
v_cvt_pk_bf16_f32 v237,v94,v95
v_mfma_f32_16x16x32_bf16 v[116:119],a[176:179],a[64:67],v[116:119]
v_mul_f32 v96,s74,v96
v_mul_f32 v97,s74,v97
v_mfma_f32_16x16x32_bf16 v[116:119],a[180:183],a[44:47],v[116:119]
v_mul_f32 v98,s74,v98
v_mul_f32 v99,s74,v99
v_mfma_f32_16x16x32_bf16 v[120:123],a[180:183],a[48:51],v[120:123]
v_mul_f32 v100,s74,v100
v_mul_f32 v101,s74,v101
v_mfma_f32_16x16x32_bf16 v[120:123],a[176:179],a[68:71],v[120:123]
v_mul_f32 v102,s74,v102
v_mul_f32 v103,s74,v103
v_mfma_f32_16x16x32_bf16 v[124:127],a[176:179],a[72:75],v[124:127]
v_mul_f32 v104,s74,v104
v_mul_f32 v105,s74,v105
v_mfma_f32_16x16x32_bf16 v[124:127],a[180:183],a[52:55],v[124:127]
v_mul_f32 v106,s74,v106
v_mul_f32 v107,s74,v107
v_mfma_f32_16x16x32_bf16 v[144:147],a[188:191],a[40:43],v[144:147]
v_mul_f32 v108,s74,v108
v_mul_f32 v109,s74,v109
s_waitcnt lgkmcnt(0)
v_mfma_f32_16x16x32_bf16 v[144:147],a[184:187],a[60:63],v[144:147]
v_mul_f32 v110,s74,v110
v_mul_f32 v111,s74,v111
v_mfma_f32_16x16x32_bf16 v[148:151],a[184:187],a[64:67],v[148:151]
v_cvt_pk_bf16_f32 v190,v96,v97
v_cvt_pk_bf16_f32 v191,v98,v99
v_mfma_f32_16x16x32_bf16 v[148:151],a[188:191],a[44:47],v[148:151]
v_cvt_pk_bf16_f32 v206,v100,v101
v_cvt_pk_bf16_f32 v207,v102,v103
v_cvt_pk_bf16_f32 v222,v104,v105
v_cvt_pk_bf16_f32 v223,v106,v107
v_cvt_pk_bf16_f32 v238,v108,v109
v_cvt_pk_bf16_f32 v239,v110,v111
v_accvgpr_read_b32 v192,a128
v_accvgpr_read_b32 v193,a129
v_accvgpr_read_b32 v194,a130
v_accvgpr_read_b32 v195,a131
v_accvgpr_read_b32 v208,a132
v_accvgpr_read_b32 v209,a133
v_accvgpr_read_b32 v210,a134
v_accvgpr_read_b32 v211,a135
v_accvgpr_read_b32 v224,a136
v_accvgpr_read_b32 v225,a137
v_accvgpr_read_b32 v226,a138
v_accvgpr_read_b32 v227,a139
v_accvgpr_read_b32 v240,a140
v_accvgpr_read_b32 v241,a141
v_accvgpr_read_b32 v242,a142
v_accvgpr_read_b32 v243,a143
v_mul_f32 v192,s74,v192
v_mul_f32 v193,s74,v193
v_mul_f32 v194,s74,v194
v_mul_f32 v195,s74,v195
v_mul_f32 v208,s74,v208
v_mul_f32 v209,s74,v209
v_mul_f32 v210,s74,v210
v_mul_f32 v211,s74,v211
v_mul_f32 v224,s74,v224
v_mul_f32 v225,s74,v225
v_mul_f32 v226,s74,v226
v_mul_f32 v227,s74,v227
v_mul_f32 v240,s74,v240
v_mul_f32 v241,s74,v241
v_mul_f32 v242,s74,v242
v_mul_f32 v243,s74,v243
v_cvt_pk_bf16_f32 v128,v192,v193
v_cvt_pk_bf16_f32 v129,v194,v195
v_cvt_pk_bf16_f32 v130,v208,v209
v_cvt_pk_bf16_f32 v131,v210,v211
v_cvt_pk_bf16_f32 v132,v224,v225
v_cvt_pk_bf16_f32 v133,v226,v227
v_cvt_pk_bf16_f32 v134,v240,v241
v_cvt_pk_bf16_f32 v135,v242,v243
s_lshl_b32 s59,s48,11
s_add_u32 s59,s59,135168
v_add_u32 v6,s59,v10
v_xor_b32 v7,2048,v6
ds_write_b128 v6,v[128:131] offset:0
ds_write_b128 v6,v[132:135] offset:1024
s_waitcnt lgkmcnt(0)
s_barrier
v_mfma_f32_16x16x32_bf16 v[152:155],a[188:191],a[48:51],v[152:155]
s_add_u32 m0,s85,98304
s_xor_b32 s58,s11,4096
v_mfma_f32_16x16x32_bf16 v[152:155],a[184:187],a[68:71],v[152:155]
buffer_load_dwordx4 v14,s[32:35],s58 offen nt lds
v_mul_f32 v72,s74,v72
v_mfma_f32_16x16x32_bf16 v[156:159],a[184:187],a[72:75],v[156:159]
ds_read_b128 a[160:163],v40 offset:0
ds_read_b128 a[164:167],v40 offset:1024
v_mfma_f32_16x16x32_bf16 v[156:159],a[188:191],a[52:55],v[156:159]
v_mul_f32 v73,s74,v73
v_mul_f32 v74,s74,v74
v_mfma_f32_16x16x32_bf16 v[160:163],a[192:195],a[40:43],v[160:163]
ds_read_b128 a[172:175],v41 offset:0
ds_read_b128 a[168:171],v41 offset:1024
v_mfma_f32_16x16x32_bf16 v[160:163],a[196:199],a[60:63],v[160:163]
buffer_load_dwordx4 v14,s[32:35],s58 offen offset:1024 nt lds
v_mul_f32 v75,s74,v75
v_mfma_f32_16x16x32_bf16 v[164:167],a[196:199],a[64:67],v[164:167]
ds_read_b128 a[176:179],v42 offset:0
ds_read_b128 a[180:183],v42 offset:1024
v_mfma_f32_16x16x32_bf16 v[164:167],a[192:195],a[44:47],v[164:167]
s_add_u32 m0,s85,102400
s_xor_b32 s58,s11,36864
v_mfma_f32_16x16x32_bf16 v[168:171],a[192:195],a[48:51],v[168:171]
ds_read_b128 a[184:187],v43 offset:0
ds_read_b128 a[188:191],v43 offset:1024
v_mfma_f32_16x16x32_bf16 v[168:171],a[196:199],a[68:71],v[168:171]
buffer_load_dwordx4 v14,s[32:35],s58 offen nt lds
v_mul_f32 v76,s74,v76
v_mfma_f32_16x16x32_bf16 v[172:175],a[196:199],a[72:75],v[172:175]
ds_read_b128 a[196:199],v44 offset:0
v_mul_f32 v77,s74,v77
v_mfma_f32_16x16x32_bf16 v[172:175],a[192:195],a[52:55],v[172:175]
ds_read_b128 a[192:195],v45 offset:0
v_mul_f32 v78,s74,v78
v_mul_f32 v79,s74,v79
v_mul_f32 v136,s74,v136
v_mul_f32 v137,s74,v137
v_mul_f32 v138,s74,v138
v_mul_f32 v139,s74,v139
v_mul_f32 v140,s74,v140
v_mul_f32 v141,s74,v141
v_mul_f32 v142,s74,v142
v_mul_f32 v143,s74,v143
v_cvt_pk_bf16_f32 v184,v72,v73
v_cvt_pk_bf16_f32 v185,v74,v75
v_cvt_pk_bf16_f32 v200,v76,v77
v_cvt_pk_bf16_f32 v201,v78,v79
v_cvt_pk_bf16_f32 v216,v136,v137
v_cvt_pk_bf16_f32 v217,v138,v139
v_cvt_pk_bf16_f32 v232,v140,v141
v_cvt_pk_bf16_f32 v233,v142,v143
v_mul_f32 v112,s74,v112
v_mul_f32 v113,s74,v113
v_mul_f32 v114,s74,v114
v_mul_f32 v115,s74,v115
v_mul_f32 v116,s74,v116
v_mul_f32 v117,s74,v117
v_mul_f32 v118,s74,v118
v_mul_f32 v119,s74,v119
v_mul_f32 v120,s74,v120
v_mul_f32 v121,s74,v121
v_mul_f32 v122,s74,v122
v_mul_f32 v123,s74,v123
v_mul_f32 v124,s74,v124
v_mul_f32 v125,s74,v125
v_mul_f32 v126,s74,v126
v_mul_f32 v127,s74,v127
v_cvt_pk_bf16_f32 v186,v112,v113
v_cvt_pk_bf16_f32 v187,v114,v115
v_cvt_pk_bf16_f32 v202,v116,v117
v_cvt_pk_bf16_f32 v203,v118,v119
v_cvt_pk_bf16_f32 v218,v120,v121
v_cvt_pk_bf16_f32 v219,v122,v123
v_cvt_pk_bf16_f32 v234,v124,v125
v_cvt_pk_bf16_f32 v235,v126,v127
s_waitcnt lgkmcnt(4)
v_mfma_f32_16x16x32_bf16 v[48:51],a[160:163],v[180:183],0
v_mul_f32 v144,s74,v144
v_mul_f32 v145,s74,v145
v_mfma_f32_16x16x32_bf16 v[56:59],a[160:163],v[196:199],0
v_mul_f32 v146,s74,v146
v_mul_f32 v147,s74,v147
v_mfma_f32_16x16x32_bf16 v[64:67],a[160:163],v[212:215],0
v_mul_f32 v148,s74,v148
v_mul_f32 v149,s74,v149
v_mfma_f32_16x16x32_bf16 v[72:75],a[160:163],v[228:231],0
ds_read_b128 a[160:163],v45 offset:1024
v_mul_f32 v150,s74,v150
v_mfma_f32_16x16x32_bf16 v[52:55],a[164:167],v[180:183],0
buffer_load_dwordx4 v14,s[32:35],s58 offen offset:1024 nt lds
v_mul_f32 v151,s74,v151
v_mfma_f32_16x16x32_bf16 v[60:63],a[164:167],v[196:199],0
s_add_u32 m0,s85,106496
s_xor_b32 s58,s11,12288
v_mfma_f32_16x16x32_bf16 v[68:71],a[164:167],v[212:215],0
v_mul_f32 v152,s74,v152
v_mul_f32 v153,s74,v153
v_mfma_f32_16x16x32_bf16 v[76:79],a[164:167],v[228:231],0
ds_read_b128 a[164:167],v44 offset:1024
v_mul_f32 v154,s74,v154
v_mfma_f32_16x16x32_bf16 v[48:51],a[172:175],v[184:187],v[48:51]
v_mul_f32 v155,s74,v155
v_mul_f32 v156,s74,v156
v_mfma_f32_16x16x32_bf16 v[56:59],a[172:175],v[200:203],v[56:59]
v_mul_f32 v157,s74,v157
v_mul_f32 v158,s74,v158
v_mfma_f32_16x16x32_bf16 v[64:67],a[172:175],v[216:219],v[64:67]
v_mul_f32 v159,s74,v159
v_cvt_pk_bf16_f32 v192,v144,v145
v_mfma_f32_16x16x32_bf16 v[72:75],a[172:175],v[232:235],v[72:75]
buffer_load_dwordx4 v14,s[32:35],s58 offen nt lds
v_cvt_pk_bf16_f32 v193,v146,v147
v_mfma_f32_16x16x32_bf16 v[52:55],a[168:171],v[184:187],v[52:55]
ds_read_b128 a[172:175],v46 offset:0
v_cvt_pk_bf16_f32 v208,v148,v149
v_mfma_f32_16x16x32_bf16 v[60:63],a[168:171],v[200:203],v[60:63]
v_cvt_pk_bf16_f32 v209,v150,v151
v_cvt_pk_bf16_f32 v224,v152,v153
v_mfma_f32_16x16x32_bf16 v[68:71],a[168:171],v[216:219],v[68:71]
v_cvt_pk_bf16_f32 v225,v154,v155
v_cvt_pk_bf16_f32 v240,v156,v157
v_mfma_f32_16x16x32_bf16 v[76:79],a[168:171],v[232:235],v[76:79]
ds_read_b128 a[168:171],v47 offset:0
v_cvt_pk_bf16_f32 v241,v158,v159
ds_read_b128 v[136:139],v7 offset:0
ds_read_b128 v[140:143],v7 offset:1024
v_mfma_f32_16x16x32_bf16 v[48:51],a[176:179],v[188:191],v[48:51]
v_mul_f32 v160,s74,v160
v_mul_f32 v161,s74,v161
v_mfma_f32_16x16x32_bf16 v[56:59],a[176:179],v[204:207],v[56:59]
v_mul_f32 v162,s74,v162
v_mul_f32 v163,s74,v163
v_mfma_f32_16x16x32_bf16 v[64:67],a[176:179],v[220:223],v[64:67]
buffer_load_dwordx4 v14,s[32:35],s58 offen offset:1024 nt lds
v_mul_f32 v164,s74,v164
v_mfma_f32_16x16x32_bf16 v[72:75],a[176:179],v[236:239],v[72:75]
ds_read_b128 a[176:179],v47 offset:1024
v_mul_f32 v165,s74,v165
v_mfma_f32_16x16x32_bf16 v[52:55],a[180:183],v[188:191],v[52:55]
s_add_u32 m0,s85,110592
s_xor_b32 s58,s11,45056
v_mfma_f32_16x16x32_bf16 v[60:63],a[180:183],v[204:207],v[60:63]
v_mul_f32 v166,s74,v166
v_mul_f32 v167,s74,v167
v_mfma_f32_16x16x32_bf16 v[68:71],a[180:183],v[220:223],v[68:71]
v_mul_f32 v168,s74,v168
v_mul_f32 v169,s74,v169
v_mfma_f32_16x16x32_bf16 v[76:79],a[180:183],v[236:239],v[76:79]
ds_read_b128 a[180:183],v46 offset:1024
v_mul_f32 v170,s74,v170
v_mul_f32 v171,s74,v171
v_mul_f32 v172,s74,v172
v_mul_f32 v173,s74,v173
v_mul_f32 v174,s74,v174
v_mul_f32 v175,s74,v175
v_cvt_pk_bf16_f32 v194,v160,v161
v_cvt_pk_bf16_f32 v195,v162,v163
v_cvt_pk_bf16_f32 v210,v164,v165
v_cvt_pk_bf16_f32 v211,v166,v167
v_cvt_pk_bf16_f32 v226,v168,v169
v_cvt_pk_bf16_f32 v227,v170,v171
v_cvt_pk_bf16_f32 v242,v172,v173
v_cvt_pk_bf16_f32 v243,v174,v175
s_waitcnt lgkmcnt(1)
v_mfma_f32_16x16x32_bf16 v[48:51],a[184:187],v[192:195],v[48:51]
v_mfma_f32_16x16x32_bf16 v[56:59],a[184:187],v[208:211],v[56:59]
buffer_load_dwordx4 v14,s[32:35],s58 offen nt lds
v_mfma_f32_16x16x32_bf16 v[64:67],a[184:187],v[224:227],v[64:67]
v_mfma_f32_16x16x32_bf16 v[72:75],a[184:187],v[240:243],v[72:75]
v_mfma_f32_16x16x32_bf16 v[52:55],a[188:191],v[192:195],v[52:55]
v_mfma_f32_16x16x32_bf16 v[60:63],a[188:191],v[208:211],v[60:63]
buffer_load_dwordx4 v14,s[32:35],s58 offen offset:1024 nt lds
v_xor_b32 v24,v19,v24
v_xor_b32 v26,v19,v26
s_waitcnt vmcnt(8) lgkmcnt(0)
s_barrier
v_mfma_f32_16x16x32_bf16 v[68:71],a[188:191],v[224:227],v[68:71]
ds_read_b64_tr_b16 a[184:185],v24 offset:0
ds_read_b64_tr_b16 a[186:187],v24 offset:1024
v_mfma_f32_16x16x32_bf16 v[76:79],a[188:191],v[240:243],v[76:79]
v_max3_f32 v112,v48,v49,v50
v_max3_f32 v116,v56,v57,v58
v_max3_f32 v120,v64,v65,v66
v_max3_f32 v124,v72,v73,v74
v_max3_f32 v112,v112,v51,v52
v_max3_f32 v116,v116,v59,v60
v_max3_f32 v120,v120,v67,v68
s_nop 0
v_max3_f32 v124,v124,v75,v76
v_max3_f32 v112,v112,v53,v54
v_max3_f32 v116,v116,v61,v62
v_max3_f32 v120,v120,v69,v70
v_max3_f32 v124,v124,v77,v78
v_max_f32 v112,v112,v55
v_max_f32 v116,v116,v63
v_max_f32 v120,v120,v71
v_max_f32 v124,v124,v79
v_mov_b32 v113,v112
v_mov_b32 v117,v116
v_mov_b32 v121,v120
v_mov_b32 v125,v124
v_permlane32_swap_b32 v112,v113
v_permlane32_swap_b32 v116,v117
v_permlane32_swap_b32 v120,v121
v_permlane32_swap_b32 v124,v125
v_max_f32 v112,v112,v113
v_max_f32 v116,v116,v117
v_max_f32 v120,v120,v121
v_max_f32 v124,v124,v125
v_mov_b32 v113,v112
v_mov_b32 v117,v116
v_mov_b32 v121,v120
v_mov_b32 v125,v124
v_permlane16_swap_b32 v112,v113
v_permlane16_swap_b32 v116,v117
v_permlane16_swap_b32 v120,v121
v_permlane16_swap_b32 v124,v125
v_max_f32 v112,v112,v113
v_max_f32 v116,v116,v117
v_max_f32 v120,v120,v121
v_max_f32 v124,v124,v125
v_sub_f32 v113,0,v112
v_sub_f32 v117,0,v116
v_sub_f32 v121,0,v120
v_sub_f32 v125,0,v124
v_sub_f32 v114,0,v112
v_sub_f32 v118,0,v116
v_sub_f32 v122,0,v120
v_sub_f32 v126,0,v124
v_sub_f32 v115,0,v112
v_sub_f32 v119,0,v116
v_sub_f32 v123,0,v120
v_sub_f32 v127,0,v124
v_sub_f32 v112,0,v112
v_sub_f32 v116,0,v116
v_sub_f32 v120,0,v120
v_sub_f32 v124,0,v124
s_nop 1
v_mfma_f32_16x16x32_bf16 v[104:107],a[196:199],v[228:231],v[124:127]
ds_read_b64_tr_b16 a[188:189],v25 offset:0
ds_read_b64_tr_b16 a[190:191],v25 offset:1024
v_mfma_f32_16x16x32_bf16 v[104:107],a[192:195],v[232:235],v[104:107]
v_add_f32 v48,v48,v112
v_add_f32 v49,v49,v112
v_mfma_f32_16x16x32_bf16 v[96:99],a[192:195],v[216:219],v[120:123]
v_add_f32 v50,v50,v112
v_add_f32 v51,v51,v112
v_mfma_f32_16x16x32_bf16 v[96:99],a[196:199],v[212:215],v[96:99]
v_add_f32 v52,v52,v112
v_add_f32 v53,v53,v112
v_mfma_f32_16x16x32_bf16 v[88:91],a[196:199],v[196:199],v[116:119]
v_add_f32 v54,v54,v112
v_add_f32 v55,v55,v112
v_mfma_f32_16x16x32_bf16 v[88:91],a[192:195],v[200:203],v[88:91]
v_add_f32 v56,v56,v116
v_add_f32 v57,v57,v116
v_mfma_f32_16x16x32_bf16 v[80:83],a[192:195],v[184:187],v[112:115]
v_add_f32 v58,v58,v116
v_add_f32 v59,v59,v116
v_mfma_f32_16x16x32_bf16 v[80:83],a[196:199],v[180:183],v[80:83]
v_add_f32 v60,v60,v116
v_add_f32 v61,v61,v116
v_mfma_f32_16x16x32_bf16 v[144:147],a[196:199],v[128:131],0
ds_read_b64_tr_b16 a[196:197],v26 offset:0
ds_read_b64_tr_b16 a[198:199],v26 offset:1024
v_mfma_f32_16x16x32_bf16 v[144:147],a[192:195],v[136:139],v[144:147]
v_add_f32 v62,v62,v116
v_add_f32 v63,v63,v116
v_mfma_f32_16x16x32_bf16 v[148:151],a[160:163],v[136:139],0
ds_read_b64_tr_b16 a[192:193],v27 offset:0
ds_read_b64_tr_b16 a[194:195],v27 offset:1024
v_mfma_f32_16x16x32_bf16 v[148:151],a[164:167],v[128:131],v[148:151]
v_add_f32 v64,v64,v120
v_add_f32 v65,v65,v120
v_mfma_f32_16x16x32_bf16 v[84:87],a[164:167],v[180:183],v[112:115]
v_add_f32 v66,v66,v120
v_add_f32 v67,v67,v120
v_mfma_f32_16x16x32_bf16 v[84:87],a[160:163],v[184:187],v[84:87]
v_add_f32 v68,v68,v120
v_add_f32 v69,v69,v120
v_mfma_f32_16x16x32_bf16 v[92:95],a[160:163],v[200:203],v[116:119]
v_add_f32 v70,v70,v120
v_add_f32 v71,v71,v120
v_mfma_f32_16x16x32_bf16 v[92:95],a[164:167],v[196:199],v[92:95]
v_add_f32 v72,v72,v124
v_add_f32 v73,v73,v124
v_mfma_f32_16x16x32_bf16 v[100:103],a[164:167],v[212:215],v[120:123]
v_add_f32 v74,v74,v124
v_add_f32 v75,v75,v124
v_mfma_f32_16x16x32_bf16 v[100:103],a[160:163],v[216:219],v[100:103]
v_add_f32 v76,v76,v124
v_add_f32 v77,v77,v124
v_mfma_f32_16x16x32_bf16 v[108:111],a[160:163],v[232:235],v[124:127]
ds_read_b64_tr_b16 a[160:161],v28 offset:0
ds_read_b64_tr_b16 a[162:163],v28 offset:1024
v_mfma_f32_16x16x32_bf16 v[108:111],a[164:167],v[228:231],v[108:111]
v_add_f32 v78,v78,v124
v_add_f32 v79,v79,v124
v_mfma_f32_16x16x32_bf16 v[104:107],a[172:175],v[236:239],v[104:107]
ds_read_b64_tr_b16 a[164:165],v29 offset:0
ds_read_b64_tr_b16 a[166:167],v29 offset:1024
v_mfma_f32_16x16x32_bf16 v[104:107],a[168:171],v[240:243],v[104:107]
v_exp_f32 v48,v48
v_mfma_f32_16x16x32_bf16 v[96:99],a[168:171],v[224:227],v[96:99]
v_exp_f32 v49,v49
v_mfma_f32_16x16x32_bf16 v[96:99],a[172:175],v[220:223],v[96:99]
v_exp_f32 v50,v50
v_mfma_f32_16x16x32_bf16 v[88:91],a[172:175],v[204:207],v[88:91]
v_exp_f32 v51,v51
v_mfma_f32_16x16x32_bf16 v[88:91],a[168:171],v[208:211],v[88:91]
v_exp_f32 v52,v52
v_mfma_f32_16x16x32_bf16 v[80:83],a[168:171],v[192:195],v[80:83]
v_exp_f32 v53,v53
v_mfma_f32_16x16x32_bf16 v[80:83],a[172:175],v[188:191],v[80:83]
v_exp_f32 v54,v54
v_mfma_f32_16x16x32_bf16 v[144:147],a[172:175],v[132:135],v[144:147]
ds_read_b64_tr_b16 a[172:173],v30 offset:0
ds_read_b64_tr_b16 a[174:175],v30 offset:1024
v_mfma_f32_16x16x32_bf16 v[144:147],a[168:171],v[140:143],v[144:147]
v_exp_f32 v55,v55
v_mfma_f32_16x16x32_bf16 v[148:151],a[176:179],v[140:143],v[148:151]
v_cvt_pk_bf16_f32 v48,v48,v49
v_cvt_pk_bf16_f32 v49,v50,v51
v_mfma_f32_16x16x32_bf16 v[148:151],a[180:183],v[132:135],v[148:151]
v_cvt_pk_bf16_f32 v50,v52,v53
v_cvt_pk_bf16_f32 v51,v54,v55
v_mfma_f32_16x16x32_bf16 v[84:87],a[180:183],v[188:191],v[84:87]
v_exp_f32 v56,v56
v_mfma_f32_16x16x32_bf16 v[84:87],a[176:179],v[192:195],v[84:87]
v_exp_f32 v57,v57
v_mfma_f32_16x16x32_bf16 v[92:95],a[176:179],v[208:211],v[92:95]
v_exp_f32 v58,v58
v_mfma_f32_16x16x32_bf16 v[92:95],a[180:183],v[204:207],v[92:95]
v_exp_f32 v59,v59
v_mfma_f32_16x16x32_bf16 v[100:103],a[180:183],v[220:223],v[100:103]
v_exp_f32 v60,v60
v_mfma_f32_16x16x32_bf16 v[100:103],a[176:179],v[224:227],v[100:103]
v_exp_f32 v61,v61
v_mfma_f32_16x16x32_bf16 v[108:111],a[176:179],v[240:243],v[108:111]
v_exp_f32 v62,v62
v_mfma_f32_16x16x32_bf16 v[108:111],a[180:183],v[236:239],v[108:111]
v_exp_f32 v63,v63
s_waitcnt lgkmcnt(0)
v_mfma_f32_16x16x32_bf16 a[0:3],a[184:187],v[48:51],0
ds_read_b64_tr_b16 a[168:169],v31 offset:0
ds_read_b64_tr_b16 a[170:171],v31 offset:1024
v_cvt_pk_bf16_f32 v56,v56,v57
v_cvt_pk_bf16_f32 v57,v58,v59
v_cvt_pk_bf16_f32 v58,v60,v61
v_cvt_pk_bf16_f32 v59,v62,v63
s_nop 1
v_mfma_f32_16x16x32_bf16 a[4:7],a[184:187],v[56:59],0
v_exp_f32 v64,v64
v_exp_f32 v65,v65
v_exp_f32 v66,v66
v_exp_f32 v67,v67
v_exp_f32 v68,v68
v_exp_f32 v69,v69
v_exp_f32 v70,v70
v_exp_f32 v71,v71
v_cvt_pk_bf16_f32 v64,v64,v65
v_cvt_pk_bf16_f32 v65,v66,v67
v_cvt_pk_bf16_f32 v66,v68,v69
v_cvt_pk_bf16_f32 v67,v70,v71
s_nop 1
v_mfma_f32_16x16x32_bf16 a[8:11],a[184:187],v[64:67],0
v_exp_f32 v72,v72
v_exp_f32 v73,v73
v_exp_f32 v74,v74
v_exp_f32 v75,v75
v_exp_f32 v76,v76
v_exp_f32 v77,v77
v_exp_f32 v78,v78
v_exp_f32 v79,v79
v_cvt_pk_bf16_f32 v72,v72,v73
v_cvt_pk_bf16_f32 v73,v74,v75
v_cvt_pk_bf16_f32 v74,v76,v77
v_cvt_pk_bf16_f32 v75,v78,v79
s_nop 1
v_mfma_f32_16x16x32_bf16 a[12:15],a[184:187],v[72:75],0
v_max3_f32 v1,v80,v81,v82
v_max3_f32 v1,v1,v83,v88
v_mfma_f32_16x16x32_bf16 a[28:31],a[188:191],v[72:75],0
v_max3_f32 v1,v1,v89,v90
v_max3_f32 v1,v1,v91,v96
v_mfma_f32_16x16x32_bf16 a[24:27],a[188:191],v[64:67],0
v_max3_f32 v1,v1,v97,v98
v_max3_f32 v1,v1,v99,v104
v_mfma_f32_16x16x32_bf16 a[20:23],a[188:191],v[56:59],0
v_max3_f32 v1,v1,v105,v106
v_max3_f32 v1,v1,v107,v84
v_mfma_f32_16x16x32_bf16 a[16:19],a[188:191],v[48:51],0
v_max3_f32 v1,v1,v85,v86
v_max3_f32 v1,v1,v87,v92
v_mfma_f32_16x16x32_bf16 v[156:159],v[176:179],v[48:51],0
v_max3_f32 v1,v1,v93,v94
v_max3_f32 v1,v1,v95,v100
v_mfma_f32_16x16x32_bf16 a[32:35],a[196:199],v[48:51],0
v_max3_f32 v1,v1,v101,v102
v_max3_f32 v1,v1,v103,v108
v_mfma_f32_16x16x32_bf16 a[36:39],a[196:199],v[56:59],0
v_max3_f32 v1,v1,v109,v110
v_max_f32 v1,v1,v111
v_mfma_f32_16x16x32_bf16 a[40:43],a[196:199],v[64:67],0
v_cmp_lt_f32 vcc,0x41000000,v1
v_mfma_f32_16x16x32_bf16 a[44:47],a[196:199],v[72:75],0
v_mfma_f32_16x16x32_bf16 v[160:163],v[176:179],v[56:59],0
s_cbranch_vccnz L_noA1_0_o
L_noA1_0:
v_mfma_f32_16x16x32_bf16 a[60:63],a[192:195],v[72:75],0
v_exp_f32 v80,v80
v_mfma_f32_16x16x32_bf16 a[56:59],a[192:195],v[64:67],0
v_exp_f32 v81,v81
v_mfma_f32_16x16x32_bf16 a[52:55],a[192:195],v[56:59],0
v_exp_f32 v82,v82
v_mfma_f32_16x16x32_bf16 a[48:51],a[192:195],v[48:51],0
v_exp_f32 v83,v83
v_mfma_f32_16x16x32_bf16 v[164:167],v[176:179],v[64:67],0
v_exp_f32 v84,v84
v_mfma_f32_16x16x32_bf16 a[64:67],a[160:163],v[48:51],0
s_waitcnt lgkmcnt(0)
s_barrier
s_waitcnt vmcnt(3)
v_mfma_f32_16x16x32_bf16 a[68:71],a[160:163],v[56:59],0
s_add_u32 m0,s85,0
s_xor_b32 s58,s11,16384
v_mfma_f32_16x16x32_bf16 a[72:75],a[160:163],v[64:67],0
buffer_load_dwordx4 v12,s[28:31],s58 offen nt lds
v_mfma_f32_16x16x32_bf16 a[76:79],a[160:163],v[72:75],0
ds_read_b128 a[176:179],v40 offset:32768
ds_read_b128 a[180:183],v41 offset:32768
v_mfma_f32_16x16x32_bf16 v[168:171],v[176:179],v[72:75],0
ds_read_b128 a[184:187],v40 offset:33792
v_mfma_f32_16x16x32_bf16 a[92:95],a[164:167],v[72:75],0
ds_read_b128 a[188:191],v41 offset:33792
ds_read_b128 a[196:199],v42 offset:32768
v_mfma_f32_16x16x32_bf16 a[88:91],a[164:167],v[64:67],0
ds_read_b128 a[192:195],v43 offset:32768
v_mfma_f32_16x16x32_bf16 a[84:87],a[164:167],v[56:59],0
ds_read_b128 a[160:163],v42 offset:33792
v_mfma_f32_16x16x32_bf16 a[80:83],a[164:167],v[48:51],0
ds_read_b128 a[164:167],v43 offset:33792
v_mfma_f32_16x16x32_bf16 a[96:99],a[172:175],v[48:51],0
buffer_load_dwordx4 v12,s[28:31],s58 offen offset:1024 nt lds
v_mfma_f32_16x16x32_bf16 a[100:103],a[172:175],v[56:59],0
s_add_u32 m0,s85,4096
s_xor_b32 s58,s11,49152
v_mfma_f32_16x16x32_bf16 a[104:107],a[172:175],v[64:67],0
v_exp_f32 v85,v85
v_mfma_f32_16x16x32_bf16 a[108:111],a[172:175],v[72:75],0
ds_read_b64_tr_b16 a[172:173],v32 offset:0
ds_read_b64_tr_b16 a[174:175],v32 offset:1024
v_mfma_f32_16x16x32_bf16 a[124:127],a[168:171],v[72:75],0
v_exp_f32 v86,v86
v_mfma_f32_16x16x32_bf16 a[120:123],a[168:171],v[64:67],0
v_exp_f32 v87,v87
v_mfma_f32_16x16x32_bf16 a[116:119],a[168:171],v[56:59],0
v_cvt_pk_bf16_f32 v80,v80,v81
v_cvt_pk_bf16_f32 v81,v82,v83
v_mfma_f32_16x16x32_bf16 a[112:115],a[168:171],v[48:51],0
buffer_load_dwordx4 v13,s[28:31],s58 offen nt lds
v_cvt_pk_bf16_f32 v82,v84,v85
s_waitcnt lgkmcnt(0)
v_mfma_f32_16x16x32_bf16 v[72:75],a[176:179],v[228:231],v[124:127]
ds_read_b64_tr_b16 a[168:169],v33 offset:0
ds_read_b64_tr_b16 a[170:171],v33 offset:1024
v_mfma_f32_16x16x32_bf16 v[72:75],a[180:183],v[232:235],v[72:75]
v_cvt_pk_bf16_f32 v83,v86,v87
v_mfma_f32_16x16x32_bf16 v[64:67],a[180:183],v[216:219],v[120:123]
v_exp_f32 v88,v88
v_mfma_f32_16x16x32_bf16 v[64:67],a[176:179],v[212:215],v[64:67]
v_exp_f32 v89,v89
v_mfma_f32_16x16x32_bf16 v[56:59],a[176:179],v[196:199],v[116:119]
s_cmp_eq_u32 s93,0
s_cbranch_scc0 L_noP1_0_o
L_noP1_0:
v_mfma_f32_16x16x32_bf16 v[56:59],a[180:183],v[200:203],v[56:59]
v_exp_f32 v90,v90
v_mfma_f32_16x16x32_bf16 v[48:51],a[180:183],v[184:187],v[112:115]
buffer_load_dwordx4 v13,s[28:31],s58 offen offset:1024 nt lds
v_mfma_f32_16x16x32_bf16 v[48:51],a[176:179],v[180:183],v[48:51]
ds_read_b64_tr_b16 a[180:181],v34 offset:0
ds_read_b64_tr_b16 a[182:183],v34 offset:1024
v_mfma_f32_16x16x32_bf16 v[52:55],a[184:187],v[180:183],v[112:115]
s_add_u32 m0,s85,8192
s_xor_b32 s58,s11,24576
v_mfma_f32_16x16x32_bf16 v[52:55],a[188:191],v[184:187],v[52:55]
ds_read_b64_tr_b16 a[176:177],v35 offset:0
ds_read_b64_tr_b16 a[178:179],v35 offset:1024
v_mfma_f32_16x16x32_bf16 v[60:63],a[188:191],v[200:203],v[116:119]
v_exp_f32 v91,v91
v_mfma_f32_16x16x32_bf16 v[60:63],a[184:187],v[196:199],v[60:63]
v_exp_f32 v92,v92
v_mfma_f32_16x16x32_bf16 v[68:71],a[184:187],v[212:215],v[120:123]
v_exp_f32 v93,v93
v_mfma_f32_16x16x32_bf16 v[68:71],a[188:191],v[216:219],v[68:71]
buffer_load_dwordx4 v12,s[28:31],s58 offen nt lds
v_mfma_f32_16x16x32_bf16 v[76:79],a[188:191],v[232:235],v[124:127]
ds_read_b64_tr_b16 a[188:189],v36 offset:0
ds_read_b64_tr_b16 a[190:191],v36 offset:1024
v_mfma_f32_16x16x32_bf16 v[76:79],a[184:187],v[228:231],v[76:79]
v_exp_f32 v94,v94
v_mfma_f32_16x16x32_bf16 v[72:75],a[196:199],v[236:239],v[72:75]
ds_read_b64_tr_b16 a[184:185],v37 offset:0
ds_read_b64_tr_b16 a[186:187],v37 offset:1024
v_mfma_f32_16x16x32_bf16 v[72:75],a[192:195],v[240:243],v[72:75]
v_exp_f32 v95,v95
v_mfma_f32_16x16x32_bf16 v[64:67],a[192:195],v[224:227],v[64:67]
v_cvt_pk_bf16_f32 v88,v88,v89
v_cvt_pk_bf16_f32 v89,v90,v91
v_mfma_f32_16x16x32_bf16 v[64:67],a[196:199],v[220:223],v[64:67]
v_cvt_pk_bf16_f32 v90,v92,v93
v_cvt_pk_bf16_f32 v91,v94,v95
v_mfma_f32_16x16x32_bf16 v[56:59],a[196:199],v[204:207],v[56:59]
buffer_load_dwordx4 v12,s[28:31],s58 offen offset:1024 nt lds
v_mfma_f32_16x16x32_bf16 v[56:59],a[192:195],v[208:211],v[56:59]
s_add_u32 m0,s85,12288
s_xor_b32 s58,s11,57344
v_mfma_f32_16x16x32_bf16 v[48:51],a[192:195],v[192:195],v[48:51]
ds_read_b64_tr_b16 a[192:193],v38 offset:0
ds_read_b64_tr_b16 a[194:195],v38 offset:1024
v_mfma_f32_16x16x32_bf16 v[48:51],a[196:199],v[188:191],v[48:51]
v_exp_f32 v96,v96
v_mfma_f32_16x16x32_bf16 v[52:55],a[160:163],v[188:191],v[52:55]
ds_read_b64_tr_b16 a[196:197],v39 offset:0
ds_read_b64_tr_b16 a[198:199],v39 offset:1024
v_mfma_f32_16x16x32_bf16 v[52:55],a[164:167],v[192:195],v[52:55]
v_exp_f32 v97,v97
v_mfma_f32_16x16x32_bf16 v[60:63],a[164:167],v[208:211],v[60:63]
v_exp_f32 v98,v98
v_mfma_f32_16x16x32_bf16 v[60:63],a[160:163],v[204:207],v[60:63]
buffer_load_dwordx4 v13,s[28:31],s58 offen nt lds
v_mfma_f32_16x16x32_bf16 v[68:71],a[160:163],v[220:223],v[68:71]
v_exp_f32 v99,v99
v_mfma_f32_16x16x32_bf16 v[68:71],a[164:167],v[224:227],v[68:71]
v_exp_f32 v100,v100
v_mfma_f32_16x16x32_bf16 v[76:79],a[164:167],v[240:243],v[76:79]
v_exp_f32 v101,v101
v_mfma_f32_16x16x32_bf16 v[76:79],a[160:163],v[236:239],v[76:79]
v_exp_f32 v102,v102
v_mfma_f32_16x16x32_bf16 a[0:3],a[172:175],v[80:83],a[0:3]
v_exp_f32 v103,v103
v_mfma_f32_16x16x32_bf16 a[4:7],a[172:175],v[88:91],a[4:7]
v_cvt_pk_bf16_f32 v96,v96,v97
v_cvt_pk_bf16_f32 v97,v98,v99
v_cvt_pk_bf16_f32 v98,v100,v101
v_cvt_pk_bf16_f32 v99,v102,v103
s_nop 1
v_mfma_f32_16x16x32_bf16 a[8:11],a[172:175],v[96:99],a[8:11]
buffer_load_dwordx4 v13,s[28:31],s58 offen offset:1024 nt lds
v_exp_f32 v104,v104
v_exp_f32 v105,v105
v_exp_f32 v106,v106
v_exp_f32 v107,v107
v_exp_f32 v108,v108
v_exp_f32 v109,v109
v_exp_f32 v110,v110
v_exp_f32 v111,v111
v_cvt_pk_bf16_f32 v104,v104,v105
v_cvt_pk_bf16_f32 v105,v106,v107
v_cvt_pk_bf16_f32 v106,v108,v109
v_cvt_pk_bf16_f32 v107,v110,v111
s_nop 1
v_mfma_f32_16x16x32_bf16 a[12:15],a[172:175],v[104:107],a[12:15]
v_max3_f32 v3,v144,v145,v146
v_max3_f32 v3,v3,v147,v148
v_max3_f32 v3,v3,v149,v150
v_max_f32 v3,v3,v151
v_mov_b32 v4,v3
s_nop 1
v_permlane32_swap_b32 v3,v4
v_max_f32 v3,v3,v4
v_mov_b32 v4,v3
s_nop 1
v_permlane16_swap_b32 v3,v4
v_max_f32 v3,v3,v4
v_sub_f32 v152,0,v3
v_sub_f32 v153,0,v3
v_sub_f32 v154,0,v3
v_sub_f32 v155,0,v3
v_sub_f32 v144,v144,v3
v_sub_f32 v145,v145,v3
v_sub_f32 v146,v146,v3
v_sub_f32 v147,v147,v3
v_sub_f32 v148,v148,v3
v_sub_f32 v149,v149,v3
v_sub_f32 v150,v150,v3
v_sub_f32 v151,v151,v3
v_exp_f32 v144,v144
v_exp_f32 v145,v145
v_exp_f32 v146,v146
v_exp_f32 v147,v147
v_exp_f32 v148,v148
v_exp_f32 v149,v149
v_exp_f32 v150,v150
v_exp_f32 v151,v151
v_cvt_pk_bf16_f32 v144,v144,v145
v_cvt_pk_bf16_f32 v145,v146,v147
v_cvt_pk_bf16_f32 v146,v148,v149
v_cvt_pk_bf16_f32 v147,v150,v151
s_nop 1
v_mfma_f32_16x16x32_bf16 a[128:131],a[172:175],v[144:147],0
v_max3_f32 v1,v48,v49,v50
v_max3_f32 v1,v1,v51,v56
s_waitcnt lgkmcnt(0)
v_mfma_f32_16x16x32_bf16 a[132:135],a[168:171],v[144:147],0
ds_read_b128 a[164:167],v44 offset:32768
ds_read_b128 a[160:163],v45 offset:32768
v_mfma_f32_16x16x32_bf16 a[28:31],a[168:171],v[104:107],a[28:31]
ds_read_b128 a[172:175],v45 offset:33792
v_max3_f32 v1,v1,v57,v58
v_mfma_f32_16x16x32_bf16 a[24:27],a[168:171],v[96:99],a[24:27]
v_max3_f32 v1,v1,v59,v64
v_max3_f32 v1,v1,v65,v66
v_mfma_f32_16x16x32_bf16 a[20:23],a[168:171],v[88:91],a[20:23]
v_max3_f32 v1,v1,v67,v72
v_max3_f32 v1,v1,v73,v74
v_mfma_f32_16x16x32_bf16 a[16:19],a[168:171],v[80:83],a[16:19]
ds_read_b128 a[168:171],v44 offset:33792
v_max3_f32 v1,v1,v75,v52
v_mfma_f32_16x16x32_bf16 v[156:159],v[176:179],v[80:83],v[156:159]
v_max3_f32 v1,v1,v53,v54
v_max3_f32 v1,v1,v55,v60
v_mfma_f32_16x16x32_bf16 a[32:35],a[180:183],v[80:83],a[32:35]
v_max3_f32 v1,v1,v61,v62
v_max3_f32 v1,v1,v63,v68
v_mfma_f32_16x16x32_bf16 a[36:39],a[180:183],v[88:91],a[36:39]
v_max3_f32 v1,v1,v69,v70
v_max3_f32 v1,v1,v71,v76
v_mfma_f32_16x16x32_bf16 a[40:43],a[180:183],v[96:99],a[40:43]
v_max3_f32 v1,v1,v77,v78
v_max_f32 v1,v1,v79
v_mfma_f32_16x16x32_bf16 a[44:47],a[180:183],v[104:107],a[44:47]
v_cmp_lt_f32 vcc,0x41000000,v1
v_mfma_f32_16x16x32_bf16 a[136:139],a[180:183],v[144:147],0
ds_read_b128 a[180:183],v46 offset:32768
v_mfma_f32_16x16x32_bf16 v[160:163],v[176:179],v[88:91],v[160:163]
v_mfma_f32_16x16x32_bf16 a[140:143],a[176:179],v[144:147],0
s_cbranch_vccnz L_noA2_0_o
L_noA2_0:
v_mfma_f32_16x16x32_bf16 a[60:63],a[176:179],v[104:107],a[60:63]
v_exp_f32 v48,v48
v_mfma_f32_16x16x32_bf16 a[56:59],a[176:179],v[96:99],a[56:59]
v_exp_f32 v49,v49
v_mfma_f32_16x16x32_bf16 a[52:55],a[176:179],v[88:91],a[52:55]
v_exp_f32 v50,v50
v_mfma_f32_16x16x32_bf16 a[48:51],a[176:179],v[80:83],a[48:51]
ds_read_b128 a[176:179],v47 offset:32768
v_mfma_f32_16x16x32_bf16 v[164:167],v[176:179],v[96:99],v[164:167]
v_exp_f32 v51,v51
v_mfma_f32_16x16x32_bf16 a[64:67],a[188:191],v[80:83],a[64:67]
v_exp_f32 v52,v52
v_mfma_f32_16x16x32_bf16 a[68:71],a[188:191],v[88:91],a[68:71]
v_exp_f32 v53,v53
v_mfma_f32_16x16x32_bf16 a[72:75],a[188:191],v[96:99],a[72:75]
v_exp_f32 v54,v54
v_mfma_f32_16x16x32_bf16 a[76:79],a[188:191],v[104:107],a[76:79]
v_exp_f32 v55,v55
v_mfma_f32_16x16x32_bf16 a[144:147],a[188:191],v[144:147],0
ds_read_b128 a[188:191],v47 offset:33792
v_cvt_pk_bf16_f32 v48,v48,v49
v_mfma_f32_16x16x32_bf16 v[168:171],v[176:179],v[104:107],v[168:171]
v_cvt_pk_bf16_f32 v49,v50,v51
v_cvt_pk_bf16_f32 v50,v52,v53
v_mfma_f32_16x16x32_bf16 a[148:151],a[184:187],v[144:147],0
v_cvt_pk_bf16_f32 v51,v54,v55
v_mfma_f32_16x16x32_bf16 a[92:95],a[184:187],v[104:107],a[92:95]
v_exp_f32 v56,v56
v_mfma_f32_16x16x32_bf16 a[88:91],a[184:187],v[96:99],a[88:91]
v_exp_f32 v57,v57
v_mfma_f32_16x16x32_bf16 a[84:87],a[184:187],v[88:91],a[84:87]
v_exp_f32 v58,v58
v_mfma_f32_16x16x32_bf16 a[80:83],a[184:187],v[80:83],a[80:83]
ds_read_b128 a[184:187],v46 offset:33792
v_mfma_f32_16x16x32_bf16 v[172:175],v[176:179],v[144:147],0
v_exp_f32 v59,v59
v_mfma_f32_16x16x32_bf16 a[96:99],a[192:195],v[80:83],a[96:99]
v_exp_f32 v60,v60
v_mfma_f32_16x16x32_bf16 a[100:103],a[192:195],v[88:91],a[100:103]
v_exp_f32 v61,v61
v_mfma_f32_16x16x32_bf16 a[104:107],a[192:195],v[96:99],a[104:107]
v_exp_f32 v62,v62
v_mfma_f32_16x16x32_bf16 a[108:111],a[192:195],v[104:107],a[108:111]
v_exp_f32 v63,v63
v_mfma_f32_16x16x32_bf16 a[152:155],a[192:195],v[144:147],0
s_waitcnt vmcnt(8) lgkmcnt(0)
s_barrier
s_waitcnt vmcnt(3)
v_mfma_f32_16x16x32_bf16 a[156:159],a[196:199],v[144:147],0
s_add_u32 m0,s85,65536
s_xor_b32 s58,s11,16384
v_mfma_f32_16x16x32_bf16 a[124:127],a[196:199],v[104:107],a[124:127]
buffer_load_dwordx4 v14,s[32:35],s58 offen nt lds
v_cvt_pk_bf16_f32 v56,v56,v57
v_mfma_f32_16x16x32_bf16 a[120:123],a[196:199],v[96:99],a[120:123]
ds_read_b64_tr_b16 a[192:193],v24 offset:32768
ds_read_b64_tr_b16 a[194:195],v24 offset:33792
v_mfma_f32_16x16x32_bf16 a[116:119],a[196:199],v[88:91],a[116:119]
v_cvt_pk_bf16_f32 v57,v58,v59
v_cvt_pk_bf16_f32 v58,v60,v61
v_mfma_f32_16x16x32_bf16 a[112:115],a[196:199],v[80:83],a[112:115]
ds_read_b64_tr_b16 a[196:197],v25 offset:32768
ds_read_b64_tr_b16 a[198:199],v25 offset:33792
v_mfma_f32_16x16x32_bf16 v[104:107],a[164:167],v[228:231],v[124:127]
v_cvt_pk_bf16_f32 v59,v62,v63
v_mfma_f32_16x16x32_bf16 v[104:107],a[160:163],v[232:235],v[104:107]
v_exp_f32 v64,v64
v_mfma_f32_16x16x32_bf16 v[96:99],a[160:163],v[216:219],v[120:123]
v_exp_f32 v65,v65
v_mfma_f32_16x16x32_bf16 v[96:99],a[164:167],v[212:215],v[96:99]
buffer_load_dwordx4 v14,s[32:35],s58 offen offset:1024 nt lds
v_mfma_f32_16x16x32_bf16 v[88:91],a[164:167],v[196:199],v[116:119]
s_add_u32 m0,s85,69632
s_xor_b32 s58,s11,49152
v_mfma_f32_16x16x32_bf16 v[88:91],a[160:163],v[200:203],v[88:91]
v_exp_f32 v66,v66
v_mfma_f32_16x16x32_bf16 v[80:83],a[160:163],v[184:187],v[112:115]
s_cmp_eq_u32 s93,0
s_cbranch_scc0 L_noP2_0_o
L_noP2_0:
v_mfma_f32_16x16x32_bf16 v[80:83],a[164:167],v[180:183],v[80:83]
v_exp_f32 v67,v67
v_mfma_f32_16x16x32_bf16 v[144:147],a[164:167],v[128:131],v[152:155]
ds_read_b64_tr_b16 a[164:165],v26 offset:32768
ds_read_b64_tr_b16 a[166:167],v26 offset:33792
v_mfma_f32_16x16x32_bf16 v[144:147],a[160:163],v[136:139],v[144:147]
v_exp_f32 v68,v68
v_mfma_f32_16x16x32_bf16 v[148:151],a[172:175],v[136:139],v[152:155]
buffer_load_dwordx4 v14,s[32:35],s58 offen nt lds
v_mfma_f32_16x16x32_bf16 v[148:151],a[168:171],v[128:131],v[148:151]
ds_read_b64_tr_b16 a[160:161],v27 offset:32768
ds_read_b64_tr_b16 a[162:163],v27 offset:33792
v_mfma_f32_16x16x32_bf16 v[84:87],a[168:171],v[180:183],v[112:115]
v_exp_f32 v69,v69
v_mfma_f32_16x16x32_bf16 v[84:87],a[172:175],v[184:187],v[84:87]
v_exp_f32 v70,v70
v_mfma_f32_16x16x32_bf16 v[92:95],a[172:175],v[200:203],v[116:119]
v_exp_f32 v71,v71
v_mfma_f32_16x16x32_bf16 v[92:95],a[168:171],v[196:199],v[92:95]
v_cvt_pk_bf16_f32 v64,v64,v65
v_cvt_pk_bf16_f32 v65,v66,v67
v_mfma_f32_16x16x32_bf16 v[100:103],a[168:171],v[212:215],v[120:123]
v_cvt_pk_bf16_f32 v66,v68,v69
v_cvt_pk_bf16_f32 v67,v70,v71
v_mfma_f32_16x16x32_bf16 v[100:103],a[172:175],v[216:219],v[100:103]
buffer_load_dwordx4 v14,s[32:35],s58 offen offset:1024 nt lds
v_mfma_f32_16x16x32_bf16 v[108:111],a[172:175],v[232:235],v[124:127]
ds_read_b64_tr_b16 a[172:173],v28 offset:32768
ds_read_b64_tr_b16 a[174:175],v28 offset:33792
v_mfma_f32_16x16x32_bf16 v[108:111],a[168:171],v[228:231],v[108:111]
s_add_u32 m0,s85,73728
s_xor_b32 s58,s11,24576
v_mfma_f32_16x16x32_bf16 v[104:107],a[180:183],v[236:239],v[104:107]
ds_read_b64_tr_b16 a[168:169],v29 offset:32768
ds_read_b64_tr_b16 a[170:171],v29 offset:33792
v_mfma_f32_16x16x32_bf16 v[104:107],a[176:179],v[240:243],v[104:107]
v_exp_f32 v72,v72
v_mfma_f32_16x16x32_bf16 v[96:99],a[176:179],v[224:227],v[96:99]
v_exp_f32 v73,v73
v_mfma_f32_16x16x32_bf16 v[96:99],a[180:183],v[220:223],v[96:99]
v_exp_f32 v74,v74
v_mfma_f32_16x16x32_bf16 v[88:91],a[180:183],v[204:207],v[88:91]
buffer_load_dwordx4 v14,s[32:35],s58 offen nt lds
v_mfma_f32_16x16x32_bf16 v[88:91],a[176:179],v[208:211],v[88:91]
v_exp_f32 v75,v75
v_mfma_f32_16x16x32_bf16 v[80:83],a[176:179],v[192:195],v[80:83]
v_exp_f32 v76,v76
v_mfma_f32_16x16x32_bf16 v[80:83],a[180:183],v[188:191],v[80:83]
v_exp_f32 v77,v77
v_mfma_f32_16x16x32_bf16 v[144:147],a[180:183],v[132:135],v[144:147]
ds_read_b64_tr_b16 a[180:181],v30 offset:32768
ds_read_b64_tr_b16 a[182:183],v30 offset:33792
v_mfma_f32_16x16x32_bf16 v[144:147],a[176:179],v[140:143],v[144:147]
v_exp_f32 v78,v78
v_mfma_f32_16x16x32_bf16 v[148:151],a[188:191],v[140:143],v[148:151]
v_exp_f32 v79,v79
v_mfma_f32_16x16x32_bf16 v[148:151],a[184:187],v[132:135],v[148:151]
buffer_load_dwordx4 v14,s[32:35],s58 offen offset:1024 nt lds
v_cvt_pk_bf16_f32 v72,v72,v73
v_mfma_f32_16x16x32_bf16 v[84:87],a[184:187],v[188:191],v[84:87]
s_add_u32 m0,s85,77824
s_xor_b32 s58,s11,57344
v_mfma_f32_16x16x32_bf16 v[84:87],a[188:191],v[192:195],v[84:87]
v_cvt_pk_bf16_f32 v73,v74,v75
v_cvt_pk_bf16_f32 v74,v76,v77
v_mfma_f32_16x16x32_bf16 v[92:95],a[188:191],v[208:211],v[92:95]
v_cvt_pk_bf16_f32 v75,v78,v79
v_mfma_f32_16x16x32_bf16 v[92:95],a[184:187],v[204:207],v[92:95]
v_mfma_f32_16x16x32_bf16 v[100:103],a[184:187],v[220:223],v[100:103]
v_mfma_f32_16x16x32_bf16 v[100:103],a[188:191],v[224:227],v[100:103]
v_mfma_f32_16x16x32_bf16 v[108:111],a[188:191],v[240:243],v[108:111]
buffer_load_dwordx4 v14,s[32:35],s58 offen nt lds
v_mfma_f32_16x16x32_bf16 v[108:111],a[184:187],v[236:239],v[108:111]
v_max3_f32 v1,v144,v145,v146
v_max3_f32 v1,v1,v147,v148
s_waitcnt lgkmcnt(0)
v_mfma_f32_16x16x32_bf16 a[0:3],a[192:195],v[48:51],a[0:3]
ds_read_b64_tr_b16 a[176:177],v31 offset:32768
ds_read_b64_tr_b16 a[178:179],v31 offset:33792
v_mfma_f32_16x16x32_bf16 a[4:7],a[192:195],v[56:59],a[4:7]
v_max3_f32 v1,v1,v149,v150
v_max3_f32 v1,v1,v151,v80
v_mfma_f32_16x16x32_bf16 a[8:11],a[192:195],v[64:67],a[8:11]
v_max3_f32 v1,v1,v81,v82
v_max3_f32 v1,v1,v83,v88
v_mfma_f32_16x16x32_bf16 a[12:15],a[192:195],v[72:75],a[12:15]
v_max3_f32 v1,v1,v89,v90
v_max3_f32 v1,v1,v91,v96
v_mfma_f32_16x16x32_bf16 a[28:31],a[196:199],v[72:75],a[28:31]
v_max3_f32 v1,v1,v97,v98
v_max3_f32 v1,v1,v99,v104
v_mfma_f32_16x16x32_bf16 a[24:27],a[196:199],v[64:67],a[24:27]
buffer_load_dwordx4 v14,s[32:35],s58 offen offset:1024 nt lds
v_max3_f32 v1,v1,v105,v106
v_mfma_f32_16x16x32_bf16 a[20:23],a[196:199],v[56:59],a[20:23]
v_max3_f32 v1,v1,v107,v84
v_max3_f32 v1,v1,v85,v86
v_mfma_f32_16x16x32_bf16 a[16:19],a[196:199],v[48:51],a[16:19]
v_max3_f32 v1,v1,v87,v92
v_max3_f32 v1,v1,v93,v94
v_mfma_f32_16x16x32_bf16 v[156:159],v[176:179],v[48:51],v[156:159]
v_max3_f32 v1,v1,v95,v100
v_max3_f32 v1,v1,v101,v102
v_mfma_f32_16x16x32_bf16 a[32:35],a[164:167],v[48:51],a[32:35]
v_max3_f32 v1,v1,v103,v108
v_max3_f32 v1,v1,v109,v110
v_mfma_f32_16x16x32_bf16 a[36:39],a[164:167],v[56:59],a[36:39]
v_max_f32 v1,v1,v111
v_cmp_lt_f32 vcc,0x41000000,v1
v_mfma_f32_16x16x32_bf16 a[40:43],a[164:167],v[64:67],a[40:43]
v_mfma_f32_16x16x32_bf16 a[44:47],a[164:167],v[72:75],a[44:47]
s_cbranch_vccnz L_noA3_0_o
L_noA3_0:
v_mfma_f32_16x16x32_bf16 v[160:163],v[176:179],v[56:59],v[160:163]
v_exp_f32 v80,v80
v_mfma_f32_16x16x32_bf16 a[60:63],a[160:163],v[72:75],a[60:63]
v_exp_f32 v81,v81
v_mfma_f32_16x16x32_bf16 a[56:59],a[160:163],v[64:67],a[56:59]
v_exp_f32 v82,v82
v_mfma_f32_16x16x32_bf16 a[52:55],a[160:163],v[56:59],a[52:55]
v_exp_f32 v83,v83
v_mfma_f32_16x16x32_bf16 a[48:51],a[160:163],v[48:51],a[48:51]
v_exp_f32 v84,v84
v_mfma_f32_16x16x32_bf16 v[164:167],v[176:179],v[64:67],v[164:167]
v_exp_f32 v85,v85
v_mfma_f32_16x16x32_bf16 a[64:67],a[172:175],v[48:51],a[64:67]
s_waitcnt vmcnt(8) lgkmcnt(0)
s_barrier
s_waitcnt vmcnt(3)
v_mfma_f32_16x16x32_bf16 a[68:71],a[172:175],v[56:59],a[68:71]
s_add_u32 m0,s85,32768
s_xor_b32 s58,s11,20480
v_mfma_f32_16x16x32_bf16 a[72:75],a[172:175],v[64:67],a[72:75]
buffer_load_dwordx4 v12,s[28:31],s58 offen nt lds
v_mfma_f32_16x16x32_bf16 a[76:79],a[172:175],v[72:75],a[76:79]
ds_read_b128 a[188:191],v40 offset:0
ds_read_b128 a[184:187],v41 offset:0
v_mfma_f32_16x16x32_bf16 v[168:171],v[176:179],v[72:75],v[168:171]
ds_read_b128 a[192:195],v40 offset:1024
v_mfma_f32_16x16x32_bf16 a[92:95],a[168:171],v[72:75],a[92:95]
ds_read_b128 a[196:199],v41 offset:1024
ds_read_b128 a[164:167],v42 offset:0
v_mfma_f32_16x16x32_bf16 a[88:91],a[168:171],v[64:67],a[88:91]
ds_read_b128 a[160:163],v43 offset:0
v_mfma_f32_16x16x32_bf16 a[84:87],a[168:171],v[56:59],a[84:87]
ds_read_b128 a[172:175],v42 offset:1024
v_mfma_f32_16x16x32_bf16 a[80:83],a[168:171],v[48:51],a[80:83]
ds_read_b128 a[168:171],v43 offset:1024
v_mfma_f32_16x16x32_bf16 a[96:99],a[180:183],v[48:51],a[96:99]
buffer_load_dwordx4 v12,s[28:31],s58 offen offset:1024 nt lds
v_mfma_f32_16x16x32_bf16 a[100:103],a[180:183],v[56:59],a[100:103]
s_add_u32 m0,s85,36864
s_xor_b32 s58,s11,53248
v_mfma_f32_16x16x32_bf16 a[104:107],a[180:183],v[64:67],a[104:107]
v_exp_f32 v86,v86
v_mfma_f32_16x16x32_bf16 a[108:111],a[180:183],v[72:75],a[108:111]
ds_read_b64_tr_b16 a[180:181],v32 offset:32768
ds_read_b64_tr_b16 a[182:183],v32 offset:33792
v_mfma_f32_16x16x32_bf16 a[124:127],a[176:179],v[72:75],a[124:127]
v_exp_f32 v87,v87
v_mfma_f32_16x16x32_bf16 a[120:123],a[176:179],v[64:67],a[120:123]
v_cvt_pk_bf16_f32 v80,v80,v81
v_cvt_pk_bf16_f32 v81,v82,v83
v_mfma_f32_16x16x32_bf16 a[116:119],a[176:179],v[56:59],a[116:119]
v_cvt_pk_bf16_f32 v82,v84,v85
v_cvt_pk_bf16_f32 v83,v86,v87
v_mfma_f32_16x16x32_bf16 a[112:115],a[176:179],v[48:51],a[112:115]
buffer_load_dwordx4 v13,s[28:31],s58 offen nt lds
s_waitcnt lgkmcnt(0)
v_mfma_f32_16x16x32_bf16 v[72:75],a[188:191],v[228:231],v[124:127]
ds_read_b64_tr_b16 a[176:177],v33 offset:32768
ds_read_b64_tr_b16 a[178:179],v33 offset:33792
v_mfma_f32_16x16x32_bf16 v[72:75],a[184:187],v[232:235],v[72:75]
v_exp_f32 v88,v88
v_mfma_f32_16x16x32_bf16 v[64:67],a[184:187],v[216:219],v[120:123]
v_exp_f32 v89,v89
v_mfma_f32_16x16x32_bf16 v[64:67],a[188:191],v[212:215],v[64:67]
v_exp_f32 v90,v90
v_mfma_f32_16x16x32_bf16 v[56:59],a[188:191],v[196:199],v[116:119]
s_cmp_eq_u32 s93,0
s_cbranch_scc0 L_noP3_0_o
L_noP3_0:
v_mfma_f32_16x16x32_bf16 v[56:59],a[184:187],v[200:203],v[56:59]
v_exp_f32 v91,v91
v_mfma_f32_16x16x32_bf16 v[48:51],a[184:187],v[184:187],v[112:115]
buffer_load_dwordx4 v13,s[28:31],s58 offen offset:1024 nt lds
v_mfma_f32_16x16x32_bf16 v[48:51],a[188:191],v[180:183],v[48:51]
ds_read_b64_tr_b16 a[184:185],v34 offset:32768
ds_read_b64_tr_b16 a[186:187],v34 offset:33792
v_mfma_f32_16x16x32_bf16 v[52:55],a[192:195],v[180:183],v[112:115]
s_add_u32 m0,s85,40960
s_xor_b32 s58,s11,28672
v_mfma_f32_16x16x32_bf16 v[52:55],a[196:199],v[184:187],v[52:55]
ds_read_b64_tr_b16 a[188:189],v35 offset:32768
ds_read_b64_tr_b16 a[190:191],v35 offset:33792
v_mfma_f32_16x16x32_bf16 v[60:63],a[196:199],v[200:203],v[116:119]
v_exp_f32 v92,v92
v_mfma_f32_16x16x32_bf16 v[60:63],a[192:195],v[196:199],v[60:63]
v_exp_f32 v93,v93
v_mfma_f32_16x16x32_bf16 v[68:71],a[192:195],v[212:215],v[120:123]
v_exp_f32 v94,v94
v_mfma_f32_16x16x32_bf16 v[68:71],a[196:199],v[216:219],v[68:71]
buffer_load_dwordx4 v12,s[28:31],s58 offen nt lds
v_mfma_f32_16x16x32_bf16 v[76:79],a[196:199],v[232:235],v[124:127]
ds_read_b64_tr_b16 a[196:197],v36 offset:32768
ds_read_b64_tr_b16 a[198:199],v36 offset:33792
v_mfma_f32_16x16x32_bf16 v[76:79],a[192:195],v[228:231],v[76:79]
v_exp_f32 v95,v95
v_mfma_f32_16x16x32_bf16 v[72:75],a[164:167],v[236:239],v[72:75]
ds_read_b64_tr_b16 a[192:193],v37 offset:32768
ds_read_b64_tr_b16 a[194:195],v37 offset:33792
v_mfma_f32_16x16x32_bf16 v[72:75],a[160:163],v[240:243],v[72:75]
v_cvt_pk_bf16_f32 v88,v88,v89
v_cvt_pk_bf16_f32 v89,v90,v91
v_mfma_f32_16x16x32_bf16 v[64:67],a[160:163],v[224:227],v[64:67]
v_cvt_pk_bf16_f32 v90,v92,v93
v_cvt_pk_bf16_f32 v91,v94,v95
v_mfma_f32_16x16x32_bf16 v[64:67],a[164:167],v[220:223],v[64:67]
v_exp_f32 v96,v96
v_mfma_f32_16x16x32_bf16 v[56:59],a[164:167],v[204:207],v[56:59]
buffer_load_dwordx4 v12,s[28:31],s58 offen offset:1024 nt lds
v_mfma_f32_16x16x32_bf16 v[56:59],a[160:163],v[208:211],v[56:59]
s_add_u32 m0,s85,45056
s_xor_b32 s58,s11,61440
v_mfma_f32_16x16x32_bf16 v[48:51],a[160:163],v[192:195],v[48:51]
ds_read_b64_tr_b16 a[160:161],v38 offset:32768
ds_read_b64_tr_b16 a[162:163],v38 offset:33792
v_mfma_f32_16x16x32_bf16 v[48:51],a[164:167],v[188:191],v[48:51]
v_exp_f32 v97,v97
v_mfma_f32_16x16x32_bf16 v[52:55],a[172:175],v[188:191],v[52:55]
ds_read_b64_tr_b16 a[164:165],v39 offset:32768
ds_read_b64_tr_b16 a[166:167],v39 offset:33792
v_mfma_f32_16x16x32_bf16 v[52:55],a[168:171],v[192:195],v[52:55]
v_exp_f32 v98,v98
v_mfma_f32_16x16x32_bf16 v[60:63],a[168:171],v[208:211],v[60:63]
v_exp_f32 v99,v99
v_mfma_f32_16x16x32_bf16 v[60:63],a[172:175],v[204:207],v[60:63]
buffer_load_dwordx4 v13,s[28:31],s58 offen nt lds
v_mfma_f32_16x16x32_bf16 v[68:71],a[172:175],v[220:223],v[68:71]
v_exp_f32 v100,v100
v_mfma_f32_16x16x32_bf16 v[68:71],a[168:171],v[224:227],v[68:71]
v_exp_f32 v101,v101
v_mfma_f32_16x16x32_bf16 v[76:79],a[168:171],v[240:243],v[76:79]
v_exp_f32 v102,v102
v_mfma_f32_16x16x32_bf16 v[76:79],a[172:175],v[236:239],v[76:79]
v_exp_f32 v103,v103
v_mfma_f32_16x16x32_bf16 a[0:3],a[180:183],v[80:83],a[0:3]
v_cvt_pk_bf16_f32 v96,v96,v97
v_cvt_pk_bf16_f32 v97,v98,v99
v_mfma_f32_16x16x32_bf16 a[4:7],a[180:183],v[88:91],a[4:7]
v_cvt_pk_bf16_f32 v98,v100,v101
v_cvt_pk_bf16_f32 v99,v102,v103
s_nop 1
v_mfma_f32_16x16x32_bf16 a[8:11],a[180:183],v[96:99],a[8:11]
buffer_load_dwordx4 v13,s[28:31],s58 offen offset:1024 nt lds
v_exp_f32 v104,v104
v_exp_f32 v105,v105
v_exp_f32 v106,v106
v_exp_f32 v107,v107
v_exp_f32 v108,v108
v_exp_f32 v109,v109
v_exp_f32 v110,v110
v_exp_f32 v111,v111
v_cvt_pk_bf16_f32 v104,v104,v105
v_cvt_pk_bf16_f32 v105,v106,v107
v_cvt_pk_bf16_f32 v106,v108,v109
v_cvt_pk_bf16_f32 v107,v110,v111
s_nop 1
v_mfma_f32_16x16x32_bf16 a[12:15],a[180:183],v[104:107],a[12:15]
v_exp_f32 v144,v144
v_exp_f32 v145,v145
v_exp_f32 v146,v146
v_exp_f32 v147,v147
v_exp_f32 v148,v148
v_exp_f32 v149,v149
v_exp_f32 v150,v150
v_exp_f32 v151,v151
v_cvt_pk_bf16_f32 v144,v144,v145
v_cvt_pk_bf16_f32 v145,v146,v147
v_cvt_pk_bf16_f32 v146,v148,v149
v_cvt_pk_bf16_f32 v147,v150,v151
s_nop 1
v_mfma_f32_16x16x32_bf16 a[128:131],a[180:183],v[144:147],a[128:131]
v_max3_f32 v1,v48,v49,v50
v_max3_f32 v1,v1,v51,v56
s_waitcnt lgkmcnt(0)
v_mfma_f32_16x16x32_bf16 a[132:135],a[176:179],v[144:147],a[132:135]
ds_read_b128 a[168:171],v44 offset:0
ds_read_b128 a[172:175],v45 offset:0
v_mfma_f32_16x16x32_bf16 a[28:31],a[176:179],v[104:107],a[28:31]
ds_read_b128 a[180:183],v45 offset:1024
v_max3_f32 v1,v1,v57,v58
v_mfma_f32_16x16x32_bf16 a[24:27],a[176:179],v[96:99],a[24:27]
v_max3_f32 v1,v1,v59,v64
v_max3_f32 v1,v1,v65,v66
v_mfma_f32_16x16x32_bf16 a[20:23],a[176:179],v[88:91],a[20:23]
v_max3_f32 v1,v1,v67,v72
v_max3_f32 v1,v1,v73,v74
v_mfma_f32_16x16x32_bf16 a[16:19],a[176:179],v[80:83],a[16:19]
ds_read_b128 a[176:179],v44 offset:1024
v_max3_f32 v1,v1,v75,v52
v_mfma_f32_16x16x32_bf16 v[156:159],v[176:179],v[80:83],v[156:159]
v_max3_f32 v1,v1,v53,v54
v_max3_f32 v1,v1,v55,v60
v_mfma_f32_16x16x32_bf16 a[32:35],a[184:187],v[80:83],a[32:35]
v_max3_f32 v1,v1,v61,v62
v_max3_f32 v1,v1,v63,v68
v_mfma_f32_16x16x32_bf16 a[36:39],a[184:187],v[88:91],a[36:39]
v_max3_f32 v1,v1,v69,v70
v_max3_f32 v1,v1,v71,v76
v_mfma_f32_16x16x32_bf16 a[40:43],a[184:187],v[96:99],a[40:43]
v_max3_f32 v1,v1,v77,v78
v_max_f32 v1,v1,v79
v_mfma_f32_16x16x32_bf16 a[44:47],a[184:187],v[104:107],a[44:47]
v_cmp_lt_f32 vcc,0x41000000,v1
v_mfma_f32_16x16x32_bf16 a[136:139],a[184:187],v[144:147],a[136:139]
ds_read_b128 a[184:187],v46 offset:0
v_mfma_f32_16x16x32_bf16 v[160:163],v[176:179],v[88:91],v[160:163]
v_mfma_f32_16x16x32_bf16 a[140:143],a[188:191],v[144:147],a[140:143]
s_cbranch_vccnz L_noA4_0_o
L_noA4_0:
v_mfma_f32_16x16x32_bf16 a[60:63],a[188:191],v[104:107],a[60:63]
v_exp_f32 v48,v48
v_mfma_f32_16x16x32_bf16 a[56:59],a[188:191],v[96:99],a[56:59]
v_exp_f32 v49,v49
v_mfma_f32_16x16x32_bf16 a[52:55],a[188:191],v[88:91],a[52:55]
v_exp_f32 v50,v50
v_mfma_f32_16x16x32_bf16 a[48:51],a[188:191],v[80:83],a[48:51]
ds_read_b128 a[188:191],v47 offset:0
v_mfma_f32_16x16x32_bf16 v[164:167],v[176:179],v[96:99],v[164:167]
v_exp_f32 v51,v51
v_mfma_f32_16x16x32_bf16 a[64:67],a[196:199],v[80:83],a[64:67]
v_exp_f32 v52,v52
v_mfma_f32_16x16x32_bf16 a[68:71],a[196:199],v[88:91],a[68:71]
v_exp_f32 v53,v53
v_mfma_f32_16x16x32_bf16 a[72:75],a[196:199],v[96:99],a[72:75]
v_exp_f32 v54,v54
v_mfma_f32_16x16x32_bf16 a[76:79],a[196:199],v[104:107],a[76:79]
v_exp_f32 v55,v55
v_mfma_f32_16x16x32_bf16 a[144:147],a[196:199],v[144:147],a[144:147]
ds_read_b128 a[196:199],v47 offset:1024
v_cvt_pk_bf16_f32 v48,v48,v49
v_mfma_f32_16x16x32_bf16 v[168:171],v[176:179],v[104:107],v[168:171]
v_cvt_pk_bf16_f32 v49,v50,v51
v_cvt_pk_bf16_f32 v50,v52,v53
v_mfma_f32_16x16x32_bf16 a[148:151],a[192:195],v[144:147],a[148:151]
v_cvt_pk_bf16_f32 v51,v54,v55
v_mfma_f32_16x16x32_bf16 a[92:95],a[192:195],v[104:107],a[92:95]
v_exp_f32 v56,v56
v_mfma_f32_16x16x32_bf16 a[88:91],a[192:195],v[96:99],a[88:91]
v_exp_f32 v57,v57
v_mfma_f32_16x16x32_bf16 a[84:87],a[192:195],v[88:91],a[84:87]
v_exp_f32 v58,v58
v_mfma_f32_16x16x32_bf16 a[80:83],a[192:195],v[80:83],a[80:83]
ds_read_b128 a[192:195],v46 offset:1024
v_mfma_f32_16x16x32_bf16 v[172:175],v[176:179],v[144:147],v[172:175]
v_exp_f32 v59,v59
v_mfma_f32_16x16x32_bf16 a[96:99],a[160:163],v[80:83],a[96:99]
v_exp_f32 v60,v60
v_mfma_f32_16x16x32_bf16 a[100:103],a[160:163],v[88:91],a[100:103]
v_exp_f32 v61,v61
v_mfma_f32_16x16x32_bf16 a[104:107],a[160:163],v[96:99],a[104:107]
v_exp_f32 v62,v62
v_mfma_f32_16x16x32_bf16 a[108:111],a[160:163],v[104:107],a[108:111]
v_exp_f32 v63,v63
v_mfma_f32_16x16x32_bf16 a[152:155],a[160:163],v[144:147],a[152:155]
s_waitcnt vmcnt(8) lgkmcnt(0)
s_barrier
s_waitcnt vmcnt(3)
v_mfma_f32_16x16x32_bf16 a[156:159],a[164:167],v[144:147],a[156:159]
s_add_u32 m0,s85,98304
s_xor_b32 s58,s11,20480
v_mfma_f32_16x16x32_bf16 a[124:127],a[164:167],v[104:107],a[124:127]
buffer_load_dwordx4 v14,s[32:35],s58 offen nt lds
v_cvt_pk_bf16_f32 v56,v56,v57
v_mfma_f32_16x16x32_bf16 a[120:123],a[164:167],v[96:99],a[120:123]
ds_read_b64_tr_b16 a[160:161],v24 offset:0
ds_read_b64_tr_b16 a[162:163],v24 offset:1024
v_mfma_f32_16x16x32_bf16 a[116:119],a[164:167],v[88:91],a[116:119]
v_cvt_pk_bf16_f32 v57,v58,v59
v_cvt_pk_bf16_f32 v58,v60,v61
v_mfma_f32_16x16x32_bf16 a[112:115],a[164:167],v[80:83],a[112:115]
ds_read_b64_tr_b16 a[164:165],v25 offset:0
ds_read_b64_tr_b16 a[166:167],v25 offset:1024
v_mfma_f32_16x16x32_bf16 v[104:107],a[168:171],v[228:231],v[124:127]
v_cvt_pk_bf16_f32 v59,v62,v63
v_mfma_f32_16x16x32_bf16 v[104:107],a[172:175],v[232:235],v[104:107]
v_exp_f32 v64,v64
v_mfma_f32_16x16x32_bf16 v[96:99],a[172:175],v[216:219],v[120:123]
v_exp_f32 v65,v65
v_mfma_f32_16x16x32_bf16 v[96:99],a[168:171],v[212:215],v[96:99]
buffer_load_dwordx4 v14,s[32:35],s58 offen offset:1024 nt lds
v_mfma_f32_16x16x32_bf16 v[88:91],a[168:171],v[196:199],v[116:119]
s_add_u32 m0,s85,102400
s_xor_b32 s58,s11,53248
v_mfma_f32_16x16x32_bf16 v[88:91],a[172:175],v[200:203],v[88:91]
v_exp_f32 v66,v66
v_mfma_f32_16x16x32_bf16 v[80:83],a[172:175],v[184:187],v[112:115]
s_cmp_eq_u32 s93,0
s_cbranch_scc0 L_noP4_0_o
L_noP4_0:
v_mfma_f32_16x16x32_bf16 v[80:83],a[168:171],v[180:183],v[80:83]
v_exp_f32 v67,v67
v_mfma_f32_16x16x32_bf16 v[144:147],a[168:171],v[128:131],v[152:155]
ds_read_b64_tr_b16 a[168:169],v26 offset:0
ds_read_b64_tr_b16 a[170:171],v26 offset:1024
v_mfma_f32_16x16x32_bf16 v[144:147],a[172:175],v[136:139],v[144:147]
v_exp_f32 v68,v68
v_mfma_f32_16x16x32_bf16 v[148:151],a[180:183],v[136:139],v[152:155]
buffer_load_dwordx4 v14,s[32:35],s58 offen nt lds
v_mfma_f32_16x16x32_bf16 v[148:151],a[176:179],v[128:131],v[148:151]
ds_read_b64_tr_b16 a[172:173],v27 offset:0
ds_read_b64_tr_b16 a[174:175],v27 offset:1024
v_mfma_f32_16x16x32_bf16 v[84:87],a[176:179],v[180:183],v[112:115]
v_exp_f32 v69,v69
v_mfma_f32_16x16x32_bf16 v[84:87],a[180:183],v[184:187],v[84:87]
v_exp_f32 v70,v70
v_mfma_f32_16x16x32_bf16 v[92:95],a[180:183],v[200:203],v[116:119]
v_exp_f32 v71,v71
v_mfma_f32_16x16x32_bf16 v[92:95],a[176:179],v[196:199],v[92:95]
v_cvt_pk_bf16_f32 v64,v64,v65
v_cvt_pk_bf16_f32 v65,v66,v67
v_mfma_f32_16x16x32_bf16 v[100:103],a[176:179],v[212:215],v[120:123]
v_cvt_pk_bf16_f32 v66,v68,v69
v_cvt_pk_bf16_f32 v67,v70,v71
v_mfma_f32_16x16x32_bf16 v[100:103],a[180:183],v[216:219],v[100:103]
buffer_load_dwordx4 v14,s[32:35],s58 offen offset:1024 nt lds
v_mfma_f32_16x16x32_bf16 v[108:111],a[180:183],v[232:235],v[124:127]
ds_read_b64_tr_b16 a[180:181],v28 offset:0
ds_read_b64_tr_b16 a[182:183],v28 offset:1024
v_mfma_f32_16x16x32_bf16 v[108:111],a[176:179],v[228:231],v[108:111]
s_add_u32 m0,s85,106496
s_xor_b32 s58,s11,28672
v_mfma_f32_16x16x32_bf16 v[104:107],a[184:187],v[236:239],v[104:107]
ds_read_b64_tr_b16 a[176:177],v29 offset:0
ds_read_b64_tr_b16 a[178:179],v29 offset:1024
v_mfma_f32_16x16x32_bf16 v[104:107],a[188:191],v[240:243],v[104:107]
v_exp_f32 v72,v72
v_mfma_f32_16x16x32_bf16 v[96:99],a[188:191],v[224:227],v[96:99]
v_exp_f32 v73,v73
v_mfma_f32_16x16x32_bf16 v[96:99],a[184:187],v[220:223],v[96:99]
v_exp_f32 v74,v74
v_mfma_f32_16x16x32_bf16 v[88:91],a[184:187],v[204:207],v[88:91]
buffer_load_dwordx4 v14,s[32:35],s58 offen nt lds
v_mfma_f32_16x16x32_bf16 v[88:91],a[188:191],v[208:211],v[88:91]
v_exp_f32 v75,v75
v_mfma_f32_16x16x32_bf16 v[80:83],a[188:191],v[192:195],v[80:83]
v_exp_f32 v76,v76
v_mfma_f32_16x16x32_bf16 v[80:83],a[184:187],v[188:191],v[80:83]
v_exp_f32 v77,v77
v_mfma_f32_16x16x32_bf16 v[144:147],a[184:187],v[132:135],v[144:147]
ds_read_b64_tr_b16 a[184:185],v30 offset:0
ds_read_b64_tr_b16 a[186:187],v30 offset:1024
v_mfma_f32_16x16x32_bf16 v[144:147],a[188:191],v[140:143],v[144:147]
v_exp_f32 v78,v78
v_mfma_f32_16x16x32_bf16 v[148:151],a[196:199],v[140:143],v[148:151]
v_exp_f32 v79,v79
v_mfma_f32_16x16x32_bf16 v[148:151],a[192:195],v[132:135],v[148:151]
buffer_load_dwordx4 v14,s[32:35],s58 offen offset:1024 nt lds
v_cvt_pk_bf16_f32 v72,v72,v73
v_mfma_f32_16x16x32_bf16 v[84:87],a[192:195],v[188:191],v[84:87]
s_add_u32 m0,s85,110592
s_xor_b32 s58,s11,61440
v_mfma_f32_16x16x32_bf16 v[84:87],a[196:199],v[192:195],v[84:87]
v_cvt_pk_bf16_f32 v73,v74,v75
v_cvt_pk_bf16_f32 v74,v76,v77
v_mfma_f32_16x16x32_bf16 v[92:95],a[196:199],v[208:211],v[92:95]
v_cvt_pk_bf16_f32 v75,v78,v79
v_mfma_f32_16x16x32_bf16 v[92:95],a[192:195],v[204:207],v[92:95]
v_mfma_f32_16x16x32_bf16 v[100:103],a[192:195],v[220:223],v[100:103]
v_mfma_f32_16x16x32_bf16 v[100:103],a[196:199],v[224:227],v[100:103]
v_mfma_f32_16x16x32_bf16 v[108:111],a[196:199],v[240:243],v[108:111]
buffer_load_dwordx4 v14,s[32:35],s58 offen nt lds
v_mfma_f32_16x16x32_bf16 v[108:111],a[192:195],v[236:239],v[108:111]
v_max3_f32 v1,v144,v145,v146
v_max3_f32 v1,v1,v147,v148
s_waitcnt lgkmcnt(0)
v_mfma_f32_16x16x32_bf16 a[0:3],a[160:163],v[48:51],a[0:3]
ds_read_b64_tr_b16 a[188:189],v31 offset:0
ds_read_b64_tr_b16 a[190:191],v31 offset:1024
v_mfma_f32_16x16x32_bf16 a[4:7],a[160:163],v[56:59],a[4:7]
v_max3_f32 v1,v1,v149,v150
v_max3_f32 v1,v1,v151,v80
v_mfma_f32_16x16x32_bf16 a[8:11],a[160:163],v[64:67],a[8:11]
v_max3_f32 v1,v1,v81,v82
v_max3_f32 v1,v1,v83,v88
v_mfma_f32_16x16x32_bf16 a[12:15],a[160:163],v[72:75],a[12:15]
v_max3_f32 v1,v1,v89,v90
v_max3_f32 v1,v1,v91,v96
v_mfma_f32_16x16x32_bf16 a[28:31],a[164:167],v[72:75],a[28:31]
v_max3_f32 v1,v1,v97,v98
v_max3_f32 v1,v1,v99,v104
v_mfma_f32_16x16x32_bf16 a[24:27],a[164:167],v[64:67],a[24:27]
buffer_load_dwordx4 v14,s[32:35],s58 offen offset:1024 nt lds
v_max3_f32 v1,v1,v105,v106
v_mfma_f32_16x16x32_bf16 a[20:23],a[164:167],v[56:59],a[20:23]
v_max3_f32 v1,v1,v107,v84
v_max3_f32 v1,v1,v85,v86
v_mfma_f32_16x16x32_bf16 a[16:19],a[164:167],v[48:51],a[16:19]
v_max3_f32 v1,v1,v87,v92
v_max3_f32 v1,v1,v93,v94
v_mfma_f32_16x16x32_bf16 v[156:159],v[176:179],v[48:51],v[156:159]
v_max3_f32 v1,v1,v95,v100
v_max3_f32 v1,v1,v101,v102
v_mfma_f32_16x16x32_bf16 a[32:35],a[168:171],v[48:51],a[32:35]
v_max3_f32 v1,v1,v103,v108
v_max3_f32 v1,v1,v109,v110
v_mfma_f32_16x16x32_bf16 a[36:39],a[168:171],v[56:59],a[36:39]
v_max_f32 v1,v1,v111
v_cmp_lt_f32 vcc,0x41000000,v1
v_mfma_f32_16x16x32_bf16 a[40:43],a[168:171],v[64:67],a[40:43]
v_mfma_f32_16x16x32_bf16 a[44:47],a[168:171],v[72:75],a[44:47]
s_cbranch_vccnz L_noA5_0_o
L_noA5_0:
v_mfma_f32_16x16x32_bf16 v[160:163],v[176:179],v[56:59],v[160:163]
v_exp_f32 v80,v80
v_mfma_f32_16x16x32_bf16 a[60:63],a[172:175],v[72:75],a[60:63]
v_exp_f32 v81,v81
v_mfma_f32_16x16x32_bf16 a[56:59],a[172:175],v[64:67],a[56:59]
v_exp_f32 v82,v82
v_mfma_f32_16x16x32_bf16 a[52:55],a[172:175],v[56:59],a[52:55]
v_exp_f32 v83,v83
v_mfma_f32_16x16x32_bf16 a[48:51],a[172:175],v[48:51],a[48:51]
v_exp_f32 v84,v84
v_mfma_f32_16x16x32_bf16 v[164:167],v[176:179],v[64:67],v[164:167]
v_exp_f32 v85,v85
v_mfma_f32_16x16x32_bf16 a[64:67],a[180:183],v[48:51],a[64:67]
s_waitcnt vmcnt(8) lgkmcnt(0)
s_barrier
s_cmp_eq_u32 s100,1
s_cbranch_scc1 L_qk3_0
s_waitcnt vmcnt(3)
L_qk3_0:
v_mfma_f32_16x16x32_bf16 a[68:71],a[180:183],v[56:59],a[68:71]
s_add_u32 m0,s85,0
s_xor_b32 s58,s11,65536
v_mfma_f32_16x16x32_bf16 a[72:75],a[180:183],v[64:67],a[72:75]
buffer_load_dwordx4 v12,s[28:31],s58 offen nt lds
v_mfma_f32_16x16x32_bf16 a[76:79],a[180:183],v[72:75],a[76:79]
ds_read_b128 a[196:199],v40 offset:32768
ds_read_b128 a[192:195],v41 offset:32768
v_mfma_f32_16x16x32_bf16 v[168:171],v[176:179],v[72:75],v[168:171]
ds_read_b128 a[160:163],v40 offset:33792
v_mfma_f32_16x16x32_bf16 a[92:95],a[176:179],v[72:75],a[92:95]
ds_read_b128 a[164:167],v41 offset:33792
ds_read_b128 a[168:171],v42 offset:32768
v_mfma_f32_16x16x32_bf16 a[88:91],a[176:179],v[64:67],a[88:91]
ds_read_b128 a[172:175],v43 offset:32768
v_mfma_f32_16x16x32_bf16 a[84:87],a[176:179],v[56:59],a[84:87]
ds_read_b128 a[180:183],v42 offset:33792
v_mfma_f32_16x16x32_bf16 a[80:83],a[176:179],v[48:51],a[80:83]
ds_read_b128 a[176:179],v43 offset:33792
v_mfma_f32_16x16x32_bf16 a[96:99],a[184:187],v[48:51],a[96:99]
buffer_load_dwordx4 v12,s[28:31],s58 offen offset:1024 nt lds
v_mfma_f32_16x16x32_bf16 a[100:103],a[184:187],v[56:59],a[100:103]
s_add_u32 m0,s85,4096
s_xor_b32 s58,s11,98304
v_mfma_f32_16x16x32_bf16 a[104:107],a[184:187],v[64:67],a[104:107]
v_exp_f32 v86,v86
v_mfma_f32_16x16x32_bf16 a[108:111],a[184:187],v[72:75],a[108:111]
ds_read_b64_tr_b16 a[184:185],v32 offset:0
ds_read_b64_tr_b16 a[186:187],v32 offset:1024
v_mfma_f32_16x16x32_bf16 a[124:127],a[188:191],v[72:75],a[124:127]
v_exp_f32 v87,v87
v_mfma_f32_16x16x32_bf16 a[120:123],a[188:191],v[64:67],a[120:123]
v_cvt_pk_bf16_f32 v80,v80,v81
v_cvt_pk_bf16_f32 v81,v82,v83
v_mfma_f32_16x16x32_bf16 a[116:119],a[188:191],v[56:59],a[116:119]
v_cvt_pk_bf16_f32 v82,v84,v85
v_cvt_pk_bf16_f32 v83,v86,v87
v_mfma_f32_16x16x32_bf16 a[112:115],a[188:191],v[48:51],a[112:115]
buffer_load_dwordx4 v13,s[28:31],s58 offen nt lds
s_waitcnt lgkmcnt(0)
v_mfma_f32_16x16x32_bf16 v[72:75],a[196:199],v[228:231],v[124:127]
ds_read_b64_tr_b16 a[188:189],v33 offset:0
ds_read_b64_tr_b16 a[190:191],v33 offset:1024
v_mfma_f32_16x16x32_bf16 v[72:75],a[192:195],v[232:235],v[72:75]
v_exp_f32 v88,v88
v_mfma_f32_16x16x32_bf16 v[64:67],a[192:195],v[216:219],v[120:123]
v_exp_f32 v89,v89
v_mfma_f32_16x16x32_bf16 v[64:67],a[196:199],v[212:215],v[64:67]
v_exp_f32 v90,v90
v_mfma_f32_16x16x32_bf16 v[56:59],a[196:199],v[196:199],v[116:119]
s_cmp_eq_u32 s93,0
s_cbranch_scc0 L_noP5_0_o
L_noP5_0:
v_mfma_f32_16x16x32_bf16 v[56:59],a[192:195],v[200:203],v[56:59]
v_exp_f32 v91,v91
v_mfma_f32_16x16x32_bf16 v[48:51],a[192:195],v[184:187],v[112:115]
buffer_load_dwordx4 v13,s[28:31],s58 offen offset:1024 nt lds
v_mfma_f32_16x16x32_bf16 v[48:51],a[196:199],v[180:183],v[48:51]
ds_read_b64_tr_b16 a[192:193],v34 offset:0
ds_read_b64_tr_b16 a[194:195],v34 offset:1024
v_mfma_f32_16x16x32_bf16 v[52:55],a[160:163],v[180:183],v[112:115]
s_add_u32 m0,s85,8192
s_xor_b32 s58,s11,73728
v_mfma_f32_16x16x32_bf16 v[52:55],a[164:167],v[184:187],v[52:55]
ds_read_b64_tr_b16 a[196:197],v35 offset:0
ds_read_b64_tr_b16 a[198:199],v35 offset:1024
v_mfma_f32_16x16x32_bf16 v[60:63],a[164:167],v[200:203],v[116:119]
v_exp_f32 v92,v92
v_mfma_f32_16x16x32_bf16 v[60:63],a[160:163],v[196:199],v[60:63]
v_exp_f32 v93,v93
v_mfma_f32_16x16x32_bf16 v[68:71],a[160:163],v[212:215],v[120:123]
v_exp_f32 v94,v94
v_mfma_f32_16x16x32_bf16 v[68:71],a[164:167],v[216:219],v[68:71]
buffer_load_dwordx4 v12,s[28:31],s58 offen nt lds
v_mfma_f32_16x16x32_bf16 v[76:79],a[164:167],v[232:235],v[124:127]
ds_read_b64_tr_b16 a[164:165],v36 offset:0
ds_read_b64_tr_b16 a[166:167],v36 offset:1024
v_mfma_f32_16x16x32_bf16 v[76:79],a[160:163],v[228:231],v[76:79]
v_exp_f32 v95,v95
v_mfma_f32_16x16x32_bf16 v[72:75],a[168:171],v[236:239],v[72:75]
ds_read_b64_tr_b16 a[160:161],v37 offset:0
ds_read_b64_tr_b16 a[162:163],v37 offset:1024
v_mfma_f32_16x16x32_bf16 v[72:75],a[172:175],v[240:243],v[72:75]
v_cvt_pk_bf16_f32 v88,v88,v89
v_cvt_pk_bf16_f32 v89,v90,v91
v_mfma_f32_16x16x32_bf16 v[64:67],a[172:175],v[224:227],v[64:67]
v_cvt_pk_bf16_f32 v90,v92,v93
v_cvt_pk_bf16_f32 v91,v94,v95
v_mfma_f32_16x16x32_bf16 v[64:67],a[168:171],v[220:223],v[64:67]
v_exp_f32 v96,v96
v_mfma_f32_16x16x32_bf16 v[56:59],a[168:171],v[204:207],v[56:59]
buffer_load_dwordx4 v12,s[28:31],s58 offen offset:1024 nt lds
v_mfma_f32_16x16x32_bf16 v[56:59],a[172:175],v[208:211],v[56:59]
s_add_u32 m0,s85,12288
s_xor_b32 s58,s11,106496
v_mfma_f32_16x16x32_bf16 v[48:51],a[172:175],v[192:195],v[48:51]
ds_read_b64_tr_b16 a[172:173],v38 offset:0
ds_read_b64_tr_b16 a[174:175],v38 offset:1024
v_mfma_f32_16x16x32_bf16 v[48:51],a[168:171],v[188:191],v[48:51]
v_exp_f32 v97,v97
v_mfma_f32_16x16x32_bf16 v[52:55],a[180:183],v[188:191],v[52:55]
ds_read_b64_tr_b16 a[168:169],v39 offset:0
ds_read_b64_tr_b16 a[170:171],v39 offset:1024
v_mfma_f32_16x16x32_bf16 v[52:55],a[176:179],v[192:195],v[52:55]
v_exp_f32 v98,v98
v_mfma_f32_16x16x32_bf16 v[60:63],a[176:179],v[208:211],v[60:63]
v_exp_f32 v99,v99
v_mfma_f32_16x16x32_bf16 v[60:63],a[180:183],v[204:207],v[60:63]
buffer_load_dwordx4 v13,s[28:31],s58 offen nt lds
v_mfma_f32_16x16x32_bf16 v[68:71],a[180:183],v[220:223],v[68:71]
v_exp_f32 v100,v100
v_mfma_f32_16x16x32_bf16 v[68:71],a[176:179],v[224:227],v[68:71]
v_exp_f32 v101,v101
v_mfma_f32_16x16x32_bf16 v[76:79],a[176:179],v[240:243],v[76:79]
v_exp_f32 v102,v102
v_mfma_f32_16x16x32_bf16 v[76:79],a[180:183],v[236:239],v[76:79]
v_exp_f32 v103,v103
v_mfma_f32_16x16x32_bf16 a[0:3],a[184:187],v[80:83],a[0:3]
v_cvt_pk_bf16_f32 v96,v96,v97
v_cvt_pk_bf16_f32 v97,v98,v99
v_mfma_f32_16x16x32_bf16 a[4:7],a[184:187],v[88:91],a[4:7]
v_cvt_pk_bf16_f32 v98,v100,v101
v_cvt_pk_bf16_f32 v99,v102,v103
s_nop 1
v_mfma_f32_16x16x32_bf16 a[8:11],a[184:187],v[96:99],a[8:11]
buffer_load_dwordx4 v13,s[28:31],s58 offen offset:1024 nt lds
v_exp_f32 v104,v104
v_exp_f32 v105,v105
v_exp_f32 v106,v106
v_exp_f32 v107,v107
v_exp_f32 v108,v108
v_exp_f32 v109,v109
v_exp_f32 v110,v110
v_exp_f32 v111,v111
v_cvt_pk_bf16_f32 v104,v104,v105
v_cvt_pk_bf16_f32 v105,v106,v107
v_cvt_pk_bf16_f32 v106,v108,v109
v_cvt_pk_bf16_f32 v107,v110,v111
s_nop 1
v_mfma_f32_16x16x32_bf16 a[12:15],a[184:187],v[104:107],a[12:15]
v_exp_f32 v144,v144
v_exp_f32 v145,v145
v_exp_f32 v146,v146
v_exp_f32 v147,v147
v_exp_f32 v148,v148
v_exp_f32 v149,v149
v_exp_f32 v150,v150
v_exp_f32 v151,v151
v_cvt_pk_bf16_f32 v144,v144,v145
v_cvt_pk_bf16_f32 v145,v146,v147
v_cvt_pk_bf16_f32 v146,v148,v149
v_cvt_pk_bf16_f32 v147,v150,v151
s_nop 1
v_mfma_f32_16x16x32_bf16 a[128:131],a[184:187],v[144:147],a[128:131]
v_max3_f32 v1,v48,v49,v50
v_max3_f32 v1,v1,v51,v56
s_waitcnt lgkmcnt(0)
v_mfma_f32_16x16x32_bf16 a[132:135],a[188:191],v[144:147],a[132:135]
ds_read_b128 a[176:179],v44 offset:32768
ds_read_b128 a[180:183],v45 offset:32768
v_mfma_f32_16x16x32_bf16 a[28:31],a[188:191],v[104:107],a[28:31]
ds_read_b128 a[184:187],v45 offset:33792
v_max3_f32 v1,v1,v57,v58
v_mfma_f32_16x16x32_bf16 a[24:27],a[188:191],v[96:99],a[24:27]
v_max3_f32 v1,v1,v59,v64
v_max3_f32 v1,v1,v65,v66
v_mfma_f32_16x16x32_bf16 a[20:23],a[188:191],v[88:91],a[20:23]
v_max3_f32 v1,v1,v67,v72
v_max3_f32 v1,v1,v73,v74
v_mfma_f32_16x16x32_bf16 a[16:19],a[188:191],v[80:83],a[16:19]
ds_read_b128 a[188:191],v44 offset:33792
v_max3_f32 v1,v1,v75,v52
v_mfma_f32_16x16x32_bf16 v[156:159],v[176:179],v[80:83],v[156:159]
v_max3_f32 v1,v1,v53,v54
v_max3_f32 v1,v1,v55,v60
v_mfma_f32_16x16x32_bf16 a[32:35],a[192:195],v[80:83],a[32:35]
v_max3_f32 v1,v1,v61,v62
v_max3_f32 v1,v1,v63,v68
v_mfma_f32_16x16x32_bf16 a[36:39],a[192:195],v[88:91],a[36:39]
v_max3_f32 v1,v1,v69,v70
v_max3_f32 v1,v1,v71,v76
v_mfma_f32_16x16x32_bf16 a[40:43],a[192:195],v[96:99],a[40:43]
v_max3_f32 v1,v1,v77,v78
v_max_f32 v1,v1,v79
v_mfma_f32_16x16x32_bf16 a[44:47],a[192:195],v[104:107],a[44:47]
v_cmp_lt_f32 vcc,0x41000000,v1
v_mfma_f32_16x16x32_bf16 a[136:139],a[192:195],v[144:147],a[136:139]
ds_read_b128 a[192:195],v46 offset:32768
v_mfma_f32_16x16x32_bf16 v[160:163],v[176:179],v[88:91],v[160:163]
v_mfma_f32_16x16x32_bf16 a[140:143],a[196:199],v[144:147],a[140:143]
s_cbranch_vccnz L_noA6_0_o
L_noA6_0:
v_mfma_f32_16x16x32_bf16 a[60:63],a[196:199],v[104:107],a[60:63]
v_exp_f32 v48,v48
v_mfma_f32_16x16x32_bf16 a[56:59],a[196:199],v[96:99],a[56:59]
v_exp_f32 v49,v49
v_mfma_f32_16x16x32_bf16 a[52:55],a[196:199],v[88:91],a[52:55]
v_exp_f32 v50,v50
v_mfma_f32_16x16x32_bf16 a[48:51],a[196:199],v[80:83],a[48:51]
ds_read_b128 a[196:199],v47 offset:32768
v_mfma_f32_16x16x32_bf16 v[164:167],v[176:179],v[96:99],v[164:167]
v_exp_f32 v51,v51
v_mfma_f32_16x16x32_bf16 a[64:67],a[164:167],v[80:83],a[64:67]
v_exp_f32 v52,v52
v_mfma_f32_16x16x32_bf16 a[68:71],a[164:167],v[88:91],a[68:71]
v_exp_f32 v53,v53
v_mfma_f32_16x16x32_bf16 a[72:75],a[164:167],v[96:99],a[72:75]
v_exp_f32 v54,v54
v_mfma_f32_16x16x32_bf16 a[76:79],a[164:167],v[104:107],a[76:79]
v_exp_f32 v55,v55
v_mfma_f32_16x16x32_bf16 a[144:147],a[164:167],v[144:147],a[144:147]
ds_read_b128 a[164:167],v47 offset:33792
v_cvt_pk_bf16_f32 v48,v48,v49
v_mfma_f32_16x16x32_bf16 v[168:171],v[176:179],v[104:107],v[168:171]
v_cvt_pk_bf16_f32 v49,v50,v51
v_cvt_pk_bf16_f32 v50,v52,v53
v_mfma_f32_16x16x32_bf16 a[148:151],a[160:163],v[144:147],a[148:151]
v_cvt_pk_bf16_f32 v51,v54,v55
v_mfma_f32_16x16x32_bf16 a[92:95],a[160:163],v[104:107],a[92:95]
v_exp_f32 v56,v56
v_mfma_f32_16x16x32_bf16 a[88:91],a[160:163],v[96:99],a[88:91]
v_exp_f32 v57,v57
v_mfma_f32_16x16x32_bf16 a[84:87],a[160:163],v[88:91],a[84:87]
v_exp_f32 v58,v58
v_mfma_f32_16x16x32_bf16 a[80:83],a[160:163],v[80:83],a[80:83]
ds_read_b128 a[160:163],v46 offset:33792
v_mfma_f32_16x16x32_bf16 v[172:175],v[176:179],v[144:147],v[172:175]
v_exp_f32 v59,v59
v_mfma_f32_16x16x32_bf16 a[96:99],a[172:175],v[80:83],a[96:99]
v_exp_f32 v60,v60
v_mfma_f32_16x16x32_bf16 a[100:103],a[172:175],v[88:91],a[100:103]
v_exp_f32 v61,v61
v_mfma_f32_16x16x32_bf16 a[104:107],a[172:175],v[96:99],a[104:107]
v_exp_f32 v62,v62
v_mfma_f32_16x16x32_bf16 a[108:111],a[172:175],v[104:107],a[108:111]
v_exp_f32 v63,v63
v_mfma_f32_16x16x32_bf16 a[152:155],a[172:175],v[144:147],a[152:155]
s_waitcnt vmcnt(8) lgkmcnt(0)
s_barrier
s_cmp_eq_u32 s100,1
s_cbranch_scc1 L_qv3_0
s_waitcnt vmcnt(3)
L_qv3_0:
v_mfma_f32_16x16x32_bf16 a[156:159],a[168:171],v[144:147],a[156:159]
s_add_u32 m0,s85,65536
s_xor_b32 s58,s11,65536
v_mfma_f32_16x16x32_bf16 a[124:127],a[168:171],v[104:107],a[124:127]
buffer_load_dwordx4 v14,s[32:35],s58 offen nt lds
v_cvt_pk_bf16_f32 v56,v56,v57
v_mfma_f32_16x16x32_bf16 a[120:123],a[168:171],v[96:99],a[120:123]
ds_read_b64_tr_b16 a[172:173],v24 offset:32768
ds_read_b64_tr_b16 a[174:175],v24 offset:33792
v_mfma_f32_16x16x32_bf16 a[116:119],a[168:171],v[88:91],a[116:119]
v_cvt_pk_bf16_f32 v57,v58,v59
v_cvt_pk_bf16_f32 v58,v60,v61
v_mfma_f32_16x16x32_bf16 a[112:115],a[168:171],v[80:83],a[112:115]
ds_read_b64_tr_b16 a[168:169],v25 offset:32768
ds_read_b64_tr_b16 a[170:171],v25 offset:33792
v_mfma_f32_16x16x32_bf16 v[104:107],a[176:179],v[228:231],v[124:127]
v_cvt_pk_bf16_f32 v59,v62,v63
v_mfma_f32_16x16x32_bf16 v[104:107],a[180:183],v[232:235],v[104:107]
v_exp_f32 v64,v64
v_mfma_f32_16x16x32_bf16 v[96:99],a[180:183],v[216:219],v[120:123]
v_exp_f32 v65,v65
v_mfma_f32_16x16x32_bf16 v[96:99],a[176:179],v[212:215],v[96:99]
buffer_load_dwordx4 v14,s[32:35],s58 offen offset:1024 nt lds
v_mfma_f32_16x16x32_bf16 v[88:91],a[176:179],v[196:199],v[116:119]
s_add_u32 m0,s85,69632
s_xor_b32 s58,s11,98304
v_mfma_f32_16x16x32_bf16 v[88:91],a[180:183],v[200:203],v[88:91]
v_exp_f32 v66,v66
v_mfma_f32_16x16x32_bf16 v[80:83],a[180:183],v[184:187],v[112:115]
s_cmp_eq_u32 s93,0
s_cbranch_scc0 L_noP6_0_o
L_noP6_0:
v_mfma_f32_16x16x32_bf16 v[80:83],a[176:179],v[180:183],v[80:83]
v_exp_f32 v67,v67
v_mfma_f32_16x16x32_bf16 v[144:147],a[176:179],v[128:131],v[152:155]
ds_read_b64_tr_b16 a[176:177],v26 offset:32768
ds_read_b64_tr_b16 a[178:179],v26 offset:33792
v_mfma_f32_16x16x32_bf16 v[144:147],a[180:183],v[136:139],v[144:147]
v_exp_f32 v68,v68
v_mfma_f32_16x16x32_bf16 v[148:151],a[184:187],v[136:139],v[152:155]
buffer_load_dwordx4 v14,s[32:35],s58 offen nt lds
v_mfma_f32_16x16x32_bf16 v[148:151],a[188:191],v[128:131],v[148:151]
ds_read_b64_tr_b16 a[180:181],v27 offset:32768
ds_read_b64_tr_b16 a[182:183],v27 offset:33792
v_mfma_f32_16x16x32_bf16 v[84:87],a[188:191],v[180:183],v[112:115]
v_exp_f32 v69,v69
v_mfma_f32_16x16x32_bf16 v[84:87],a[184:187],v[184:187],v[84:87]
v_exp_f32 v70,v70
v_mfma_f32_16x16x32_bf16 v[92:95],a[184:187],v[200:203],v[116:119]
v_exp_f32 v71,v71
v_mfma_f32_16x16x32_bf16 v[92:95],a[188:191],v[196:199],v[92:95]
v_cvt_pk_bf16_f32 v64,v64,v65
v_cvt_pk_bf16_f32 v65,v66,v67
v_mfma_f32_16x16x32_bf16 v[100:103],a[188:191],v[212:215],v[120:123]
v_cvt_pk_bf16_f32 v66,v68,v69
v_cvt_pk_bf16_f32 v67,v70,v71
v_mfma_f32_16x16x32_bf16 v[100:103],a[184:187],v[216:219],v[100:103]
buffer_load_dwordx4 v14,s[32:35],s58 offen offset:1024 nt lds
v_mfma_f32_16x16x32_bf16 v[108:111],a[184:187],v[232:235],v[124:127]
ds_read_b64_tr_b16 a[184:185],v28 offset:32768
ds_read_b64_tr_b16 a[186:187],v28 offset:33792
v_mfma_f32_16x16x32_bf16 v[108:111],a[188:191],v[228:231],v[108:111]
s_add_u32 m0,s85,73728
s_xor_b32 s58,s11,73728
v_mfma_f32_16x16x32_bf16 v[104:107],a[192:195],v[236:239],v[104:107]
ds_read_b64_tr_b16 a[188:189],v29 offset:32768
ds_read_b64_tr_b16 a[190:191],v29 offset:33792
v_mfma_f32_16x16x32_bf16 v[104:107],a[196:199],v[240:243],v[104:107]
v_exp_f32 v72,v72
v_mfma_f32_16x16x32_bf16 v[96:99],a[196:199],v[224:227],v[96:99]
v_exp_f32 v73,v73
v_mfma_f32_16x16x32_bf16 v[96:99],a[192:195],v[220:223],v[96:99]
v_exp_f32 v74,v74
v_mfma_f32_16x16x32_bf16 v[88:91],a[192:195],v[204:207],v[88:91]
buffer_load_dwordx4 v14,s[32:35],s58 offen nt lds
v_mfma_f32_16x16x32_bf16 v[88:91],a[196:199],v[208:211],v[88:91]
v_exp_f32 v75,v75
v_mfma_f32_16x16x32_bf16 v[80:83],a[196:199],v[192:195],v[80:83]
v_exp_f32 v76,v76
v_mfma_f32_16x16x32_bf16 v[80:83],a[192:195],v[188:191],v[80:83]
v_exp_f32 v77,v77
v_mfma_f32_16x16x32_bf16 v[144:147],a[192:195],v[132:135],v[144:147]
ds_read_b64_tr_b16 a[192:193],v30 offset:32768
ds_read_b64_tr_b16 a[194:195],v30 offset:33792
v_mfma_f32_16x16x32_bf16 v[144:147],a[196:199],v[140:143],v[144:147]
v_exp_f32 v78,v78
v_mfma_f32_16x16x32_bf16 v[148:151],a[164:167],v[140:143],v[148:151]
v_exp_f32 v79,v79
v_mfma_f32_16x16x32_bf16 v[148:151],a[160:163],v[132:135],v[148:151]
buffer_load_dwordx4 v14,s[32:35],s58 offen offset:1024 nt lds
v_cvt_pk_bf16_f32 v72,v72,v73
v_mfma_f32_16x16x32_bf16 v[84:87],a[160:163],v[188:191],v[84:87]
s_add_u32 m0,s85,77824
s_xor_b32 s58,s11,106496
v_mfma_f32_16x16x32_bf16 v[84:87],a[164:167],v[192:195],v[84:87]
v_cvt_pk_bf16_f32 v73,v74,v75
v_cvt_pk_bf16_f32 v74,v76,v77
v_mfma_f32_16x16x32_bf16 v[92:95],a[164:167],v[208:211],v[92:95]
v_cvt_pk_bf16_f32 v75,v78,v79
v_mfma_f32_16x16x32_bf16 v[92:95],a[160:163],v[204:207],v[92:95]
v_mfma_f32_16x16x32_bf16 v[100:103],a[160:163],v[220:223],v[100:103]
v_mfma_f32_16x16x32_bf16 v[100:103],a[164:167],v[224:227],v[100:103]
v_mfma_f32_16x16x32_bf16 v[108:111],a[164:167],v[240:243],v[108:111]
buffer_load_dwordx4 v14,s[32:35],s58 offen nt lds
v_mfma_f32_16x16x32_bf16 v[108:111],a[160:163],v[236:239],v[108:111]
v_max3_f32 v1,v144,v145,v146
v_max3_f32 v1,v1,v147,v148
s_waitcnt lgkmcnt(0)
v_mfma_f32_16x16x32_bf16 a[0:3],a[172:175],v[48:51],a[0:3]
ds_read_b64_tr_b16 a[196:197],v31 offset:32768
ds_read_b64_tr_b16 a[198:199],v31 offset:33792
v_mfma_f32_16x16x32_bf16 a[4:7],a[172:175],v[56:59],a[4:7]
v_max3_f32 v1,v1,v149,v150
v_max3_f32 v1,v1,v151,v80
v_mfma_f32_16x16x32_bf16 a[8:11],a[172:175],v[64:67],a[8:11]
v_max3_f32 v1,v1,v81,v82
v_max3_f32 v1,v1,v83,v88
v_mfma_f32_16x16x32_bf16 a[12:15],a[172:175],v[72:75],a[12:15]
v_max3_f32 v1,v1,v89,v90
v_max3_f32 v1,v1,v91,v96
v_mfma_f32_16x16x32_bf16 a[28:31],a[168:171],v[72:75],a[28:31]
v_max3_f32 v1,v1,v97,v98
v_max3_f32 v1,v1,v99,v104
v_mfma_f32_16x16x32_bf16 a[24:27],a[168:171],v[64:67],a[24:27]
buffer_load_dwordx4 v14,s[32:35],s58 offen offset:1024 nt lds
v_max3_f32 v1,v1,v105,v106
v_mfma_f32_16x16x32_bf16 a[20:23],a[168:171],v[56:59],a[20:23]
v_max3_f32 v1,v1,v107,v84
v_max3_f32 v1,v1,v85,v86
v_mfma_f32_16x16x32_bf16 a[16:19],a[168:171],v[48:51],a[16:19]
v_max3_f32 v1,v1,v87,v92
v_max3_f32 v1,v1,v93,v94
v_mfma_f32_16x16x32_bf16 v[156:159],v[176:179],v[48:51],v[156:159]
v_max3_f32 v1,v1,v95,v100
v_max3_f32 v1,v1,v101,v102
v_mfma_f32_16x16x32_bf16 a[32:35],a[176:179],v[48:51],a[32:35]
v_max3_f32 v1,v1,v103,v108
v_max3_f32 v1,v1,v109,v110
v_mfma_f32_16x16x32_bf16 a[36:39],a[176:179],v[56:59],a[36:39]
v_max_f32 v1,v1,v111
v_cmp_lt_f32 vcc,0x41000000,v1
v_mfma_f32_16x16x32_bf16 a[40:43],a[176:179],v[64:67],a[40:43]
v_mfma_f32_16x16x32_bf16 a[44:47],a[176:179],v[72:75],a[44:47]
s_cbranch_vccnz L_noA7_0_o
L_noA7_0:
v_mfma_f32_16x16x32_bf16 v[160:163],v[176:179],v[56:59],v[160:163]
v_exp_f32 v80,v80
v_mfma_f32_16x16x32_bf16 a[60:63],a[180:183],v[72:75],a[60:63]
v_exp_f32 v81,v81
v_mfma_f32_16x16x32_bf16 a[56:59],a[180:183],v[64:67],a[56:59]
v_exp_f32 v82,v82
v_mfma_f32_16x16x32_bf16 a[52:55],a[180:183],v[56:59],a[52:55]
v_exp_f32 v83,v83
v_mfma_f32_16x16x32_bf16 a[48:51],a[180:183],v[48:51],a[48:51]
v_exp_f32 v84,v84
v_mfma_f32_16x16x32_bf16 v[164:167],v[176:179],v[64:67],v[164:167]
v_exp_f32 v85,v85
v_mfma_f32_16x16x32_bf16 a[64:67],a[184:187],v[48:51],a[64:67]
s_waitcnt vmcnt(8) lgkmcnt(0)
s_barrier
s_cmp_eq_u32 s100,1
s_cbranch_scc1 L_qk4_0
s_waitcnt vmcnt(3)
L_qk4_0:
v_mfma_f32_16x16x32_bf16 a[68:71],a[184:187],v[56:59],a[68:71]
s_add_u32 m0,s85,32768
s_xor_b32 s58,s11,69632
v_mfma_f32_16x16x32_bf16 a[72:75],a[184:187],v[64:67],a[72:75]
buffer_load_dwordx4 v12,s[28:31],s58 offen nt lds
v_mfma_f32_16x16x32_bf16 a[76:79],a[184:187],v[72:75],a[76:79]
ds_read_b128 a[164:167],v40 offset:0
ds_read_b128 a[160:163],v41 offset:0
v_mfma_f32_16x16x32_bf16 v[168:171],v[176:179],v[72:75],v[168:171]
ds_read_b128 a[172:175],v40 offset:1024
v_mfma_f32_16x16x32_bf16 a[92:95],a[188:191],v[72:75],a[92:95]
ds_read_b128 a[168:171],v41 offset:1024
ds_read_b128 a[176:179],v42 offset:0
v_mfma_f32_16x16x32_bf16 a[88:91],a[188:191],v[64:67],a[88:91]
ds_read_b128 a[180:183],v43 offset:0
v_mfma_f32_16x16x32_bf16 a[84:87],a[188:191],v[56:59],a[84:87]
ds_read_b128 a[184:187],v42 offset:1024
v_mfma_f32_16x16x32_bf16 a[80:83],a[188:191],v[48:51],a[80:83]
ds_read_b128 a[188:191],v43 offset:1024
v_mfma_f32_16x16x32_bf16 a[96:99],a[192:195],v[48:51],a[96:99]
buffer_load_dwordx4 v12,s[28:31],s58 offen offset:1024 nt lds
v_mfma_f32_16x16x32_bf16 a[100:103],a[192:195],v[56:59],a[100:103]
s_add_u32 m0,s85,36864
s_xor_b32 s58,s11,102400
v_mfma_f32_16x16x32_bf16 a[104:107],a[192:195],v[64:67],a[104:107]
v_exp_f32 v86,v86
v_mfma_f32_16x16x32_bf16 a[108:111],a[192:195],v[72:75],a[108:111]
ds_read_b64_tr_b16 a[192:193],v32 offset:32768
ds_read_b64_tr_b16 a[194:195],v32 offset:33792
v_mfma_f32_16x16x32_bf16 a[124:127],a[196:199],v[72:75],a[124:127]
v_exp_f32 v87,v87
v_mfma_f32_16x16x32_bf16 a[120:123],a[196:199],v[64:67],a[120:123]
v_cvt_pk_bf16_f32 v80,v80,v81
v_cvt_pk_bf16_f32 v81,v82,v83
v_mfma_f32_16x16x32_bf16 a[116:119],a[196:199],v[56:59],a[116:119]
v_cvt_pk_bf16_f32 v82,v84,v85
v_cvt_pk_bf16_f32 v83,v86,v87
v_mfma_f32_16x16x32_bf16 a[112:115],a[196:199],v[48:51],a[112:115]
buffer_load_dwordx4 v13,s[28:31],s58 offen nt lds
s_waitcnt lgkmcnt(0)
v_mfma_f32_16x16x32_bf16 v[72:75],a[164:167],v[228:231],v[124:127]
ds_read_b64_tr_b16 a[196:197],v33 offset:32768
ds_read_b64_tr_b16 a[198:199],v33 offset:33792
v_mfma_f32_16x16x32_bf16 v[72:75],a[160:163],v[232:235],v[72:75]
v_exp_f32 v88,v88
v_mfma_f32_16x16x32_bf16 v[64:67],a[160:163],v[216:219],v[120:123]
v_exp_f32 v89,v89
v_mfma_f32_16x16x32_bf16 v[64:67],a[164:167],v[212:215],v[64:67]
v_exp_f32 v90,v90
v_mfma_f32_16x16x32_bf16 v[56:59],a[164:167],v[196:199],v[116:119]
s_cmp_eq_u32 s93,0
s_cbranch_scc0 L_noP7_0_o
L_noP7_0:
v_mfma_f32_16x16x32_bf16 v[56:59],a[160:163],v[200:203],v[56:59]
v_exp_f32 v91,v91
v_mfma_f32_16x16x32_bf16 v[48:51],a[160:163],v[184:187],v[112:115]
buffer_load_dwordx4 v13,s[28:31],s58 offen offset:1024 nt lds
v_mfma_f32_16x16x32_bf16 v[48:51],a[164:167],v[180:183],v[48:51]
ds_read_b64_tr_b16 a[160:161],v34 offset:32768
ds_read_b64_tr_b16 a[162:163],v34 offset:33792
v_mfma_f32_16x16x32_bf16 v[52:55],a[172:175],v[180:183],v[112:115]
s_add_u32 m0,s85,40960
s_xor_b32 s58,s11,77824
v_mfma_f32_16x16x32_bf16 v[52:55],a[168:171],v[184:187],v[52:55]
ds_read_b64_tr_b16 a[164:165],v35 offset:32768
ds_read_b64_tr_b16 a[166:167],v35 offset:33792
v_mfma_f32_16x16x32_bf16 v[60:63],a[168:171],v[200:203],v[116:119]
v_exp_f32 v92,v92
v_mfma_f32_16x16x32_bf16 v[60:63],a[172:175],v[196:199],v[60:63]
v_exp_f32 v93,v93
v_mfma_f32_16x16x32_bf16 v[68:71],a[172:175],v[212:215],v[120:123]
v_exp_f32 v94,v94
v_mfma_f32_16x16x32_bf16 v[68:71],a[168:171],v[216:219],v[68:71]
buffer_load_dwordx4 v12,s[28:31],s58 offen nt lds
v_mfma_f32_16x16x32_bf16 v[76:79],a[168:171],v[232:235],v[124:127]
ds_read_b64_tr_b16 a[168:169],v36 offset:32768
ds_read_b64_tr_b16 a[170:171],v36 offset:33792
v_mfma_f32_16x16x32_bf16 v[76:79],a[172:175],v[228:231],v[76:79]
v_exp_f32 v95,v95
v_mfma_f32_16x16x32_bf16 v[72:75],a[176:179],v[236:239],v[72:75]
ds_read_b64_tr_b16 a[172:173],v37 offset:32768
ds_read_b64_tr_b16 a[174:175],v37 offset:33792
v_mfma_f32_16x16x32_bf16 v[72:75],a[180:183],v[240:243],v[72:75]
v_cvt_pk_bf16_f32 v88,v88,v89
v_cvt_pk_bf16_f32 v89,v90,v91
v_mfma_f32_16x16x32_bf16 v[64:67],a[180:183],v[224:227],v[64:67]
v_cvt_pk_bf16_f32 v90,v92,v93
v_cvt_pk_bf16_f32 v91,v94,v95
v_mfma_f32_16x16x32_bf16 v[64:67],a[176:179],v[220:223],v[64:67]
v_exp_f32 v96,v96
v_mfma_f32_16x16x32_bf16 v[56:59],a[176:179],v[204:207],v[56:59]
buffer_load_dwordx4 v12,s[28:31],s58 offen offset:1024 nt lds
v_mfma_f32_16x16x32_bf16 v[56:59],a[180:183],v[208:211],v[56:59]
s_add_u32 m0,s85,45056
s_xor_b32 s58,s11,110592
v_mfma_f32_16x16x32_bf16 v[48:51],a[180:183],v[192:195],v[48:51]
ds_read_b64_tr_b16 a[180:181],v38 offset:32768
ds_read_b64_tr_b16 a[182:183],v38 offset:33792
v_mfma_f32_16x16x32_bf16 v[48:51],a[176:179],v[188:191],v[48:51]
v_exp_f32 v97,v97
v_mfma_f32_16x16x32_bf16 v[52:55],a[184:187],v[188:191],v[52:55]
ds_read_b64_tr_b16 a[176:177],v39 offset:32768
ds_read_b64_tr_b16 a[178:179],v39 offset:33792
v_mfma_f32_16x16x32_bf16 v[52:55],a[188:191],v[192:195],v[52:55]
v_exp_f32 v98,v98
v_mfma_f32_16x16x32_bf16 v[60:63],a[188:191],v[208:211],v[60:63]
v_exp_f32 v99,v99
v_mfma_f32_16x16x32_bf16 v[60:63],a[184:187],v[204:207],v[60:63]
buffer_load_dwordx4 v13,s[28:31],s58 offen nt lds
v_mfma_f32_16x16x32_bf16 v[68:71],a[184:187],v[220:223],v[68:71]
v_exp_f32 v100,v100
v_mfma_f32_16x16x32_bf16 v[68:71],a[188:191],v[224:227],v[68:71]
v_exp_f32 v101,v101
v_mfma_f32_16x16x32_bf16 v[76:79],a[188:191],v[240:243],v[76:79]
v_exp_f32 v102,v102
v_mfma_f32_16x16x32_bf16 v[76:79],a[184:187],v[236:239],v[76:79]
v_exp_f32 v103,v103
v_mfma_f32_16x16x32_bf16 a[0:3],a[192:195],v[80:83],a[0:3]
v_cvt_pk_bf16_f32 v96,v96,v97
v_cvt_pk_bf16_f32 v97,v98,v99
v_mfma_f32_16x16x32_bf16 a[4:7],a[192:195],v[88:91],a[4:7]
v_cvt_pk_bf16_f32 v98,v100,v101
v_cvt_pk_bf16_f32 v99,v102,v103
s_nop 1
v_mfma_f32_16x16x32_bf16 a[8:11],a[192:195],v[96:99],a[8:11]
buffer_load_dwordx4 v13,s[28:31],s58 offen offset:1024 nt lds
v_exp_f32 v104,v104
v_exp_f32 v105,v105
v_exp_f32 v106,v106
v_exp_f32 v107,v107
v_exp_f32 v108,v108
v_exp_f32 v109,v109
v_exp_f32 v110,v110
v_exp_f32 v111,v111
v_cvt_pk_bf16_f32 v104,v104,v105
v_cvt_pk_bf16_f32 v105,v106,v107
v_cvt_pk_bf16_f32 v106,v108,v109
v_cvt_pk_bf16_f32 v107,v110,v111
s_nop 1
v_mfma_f32_16x16x32_bf16 a[12:15],a[192:195],v[104:107],a[12:15]
v_exp_f32 v144,v144
v_exp_f32 v145,v145
v_exp_f32 v146,v146
v_exp_f32 v147,v147
v_exp_f32 v148,v148
v_exp_f32 v149,v149
v_exp_f32 v150,v150
v_exp_f32 v151,v151
v_cvt_pk_bf16_f32 v144,v144,v145
v_cvt_pk_bf16_f32 v145,v146,v147
v_cvt_pk_bf16_f32 v146,v148,v149
v_cvt_pk_bf16_f32 v147,v150,v151
s_nop 1
v_mfma_f32_16x16x32_bf16 a[128:131],a[192:195],v[144:147],a[128:131]
v_max3_f32 v1,v48,v49,v50
v_max3_f32 v1,v1,v51,v56
s_waitcnt lgkmcnt(0)
v_mfma_f32_16x16x32_bf16 a[132:135],a[196:199],v[144:147],a[132:135]
ds_read_b128 a[188:191],v44 offset:0
ds_read_b128 a[184:187],v45 offset:0
v_mfma_f32_16x16x32_bf16 a[28:31],a[196:199],v[104:107],a[28:31]
ds_read_b128 a[192:195],v45 offset:1024
v_max3_f32 v1,v1,v57,v58
v_mfma_f32_16x16x32_bf16 a[24:27],a[196:199],v[96:99],a[24:27]
v_max3_f32 v1,v1,v59,v64
v_max3_f32 v1,v1,v65,v66
v_mfma_f32_16x16x32_bf16 a[20:23],a[196:199],v[88:91],a[20:23]
v_max3_f32 v1,v1,v67,v72
v_max3_f32 v1,v1,v73,v74
v_mfma_f32_16x16x32_bf16 a[16:19],a[196:199],v[80:83],a[16:19]
ds_read_b128 a[196:199],v44 offset:1024
v_max3_f32 v1,v1,v75,v52
v_mfma_f32_16x16x32_bf16 v[156:159],v[176:179],v[80:83],v[156:159]
v_max3_f32 v1,v1,v53,v54
v_max3_f32 v1,v1,v55,v60
v_mfma_f32_16x16x32_bf16 a[32:35],a[160:163],v[80:83],a[32:35]
v_max3_f32 v1,v1,v61,v62
v_max3_f32 v1,v1,v63,v68
v_mfma_f32_16x16x32_bf16 a[36:39],a[160:163],v[88:91],a[36:39]
v_max3_f32 v1,v1,v69,v70
v_max3_f32 v1,v1,v71,v76
v_mfma_f32_16x16x32_bf16 a[40:43],a[160:163],v[96:99],a[40:43]
v_max3_f32 v1,v1,v77,v78
v_max_f32 v1,v1,v79
v_mfma_f32_16x16x32_bf16 a[44:47],a[160:163],v[104:107],a[44:47]
v_cmp_lt_f32 vcc,0x41000000,v1
v_mfma_f32_16x16x32_bf16 a[136:139],a[160:163],v[144:147],a[136:139]
ds_read_b128 a[160:163],v46 offset:0
v_mfma_f32_16x16x32_bf16 v[160:163],v[176:179],v[88:91],v[160:163]
v_mfma_f32_16x16x32_bf16 a[140:143],a[164:167],v[144:147],a[140:143]
s_cbranch_vccnz L_noA8_0_o
L_noA8_0:
v_mfma_f32_16x16x32_bf16 a[60:63],a[164:167],v[104:107],a[60:63]
v_exp_f32 v48,v48
v_mfma_f32_16x16x32_bf16 a[56:59],a[164:167],v[96:99],a[56:59]
v_exp_f32 v49,v49
v_mfma_f32_16x16x32_bf16 a[52:55],a[164:167],v[88:91],a[52:55]
v_exp_f32 v50,v50
v_mfma_f32_16x16x32_bf16 a[48:51],a[164:167],v[80:83],a[48:51]
ds_read_b128 a[164:167],v47 offset:0
v_mfma_f32_16x16x32_bf16 v[164:167],v[176:179],v[96:99],v[164:167]
v_exp_f32 v51,v51
v_mfma_f32_16x16x32_bf16 a[64:67],a[168:171],v[80:83],a[64:67]
v_exp_f32 v52,v52
v_mfma_f32_16x16x32_bf16 a[68:71],a[168:171],v[88:91],a[68:71]
v_exp_f32 v53,v53
v_mfma_f32_16x16x32_bf16 a[72:75],a[168:171],v[96:99],a[72:75]
v_exp_f32 v54,v54
v_mfma_f32_16x16x32_bf16 a[76:79],a[168:171],v[104:107],a[76:79]
v_exp_f32 v55,v55
v_mfma_f32_16x16x32_bf16 a[144:147],a[168:171],v[144:147],a[144:147]
ds_read_b128 a[168:171],v47 offset:1024
v_cvt_pk_bf16_f32 v48,v48,v49
v_mfma_f32_16x16x32_bf16 v[168:171],v[176:179],v[104:107],v[168:171]
v_cvt_pk_bf16_f32 v49,v50,v51
v_cvt_pk_bf16_f32 v50,v52,v53
v_mfma_f32_16x16x32_bf16 a[148:151],a[172:175],v[144:147],a[148:151]
v_cvt_pk_bf16_f32 v51,v54,v55
v_mfma_f32_16x16x32_bf16 a[92:95],a[172:175],v[104:107],a[92:95]
v_exp_f32 v56,v56
v_mfma_f32_16x16x32_bf16 a[88:91],a[172:175],v[96:99],a[88:91]
v_exp_f32 v57,v57
v_mfma_f32_16x16x32_bf16 a[84:87],a[172:175],v[88:91],a[84:87]
v_exp_f32 v58,v58
v_mfma_f32_16x16x32_bf16 a[80:83],a[172:175],v[80:83],a[80:83]
ds_read_b128 a[172:175],v46 offset:1024
v_mfma_f32_16x16x32_bf16 v[172:175],v[176:179],v[144:147],v[172:175]
v_exp_f32 v59,v59
v_mfma_f32_16x16x32_bf16 a[96:99],a[180:183],v[80:83],a[96:99]
v_exp_f32 v60,v60
v_mfma_f32_16x16x32_bf16 a[100:103],a[180:183],v[88:91],a[100:103]
v_exp_f32 v61,v61
v_mfma_f32_16x16x32_bf16 a[104:107],a[180:183],v[96:99],a[104:107]
v_exp_f32 v62,v62
v_mfma_f32_16x16x32_bf16 a[108:111],a[180:183],v[104:107],a[108:111]
v_exp_f32 v63,v63
v_mfma_f32_16x16x32_bf16 a[152:155],a[180:183],v[144:147],a[152:155]
s_waitcnt vmcnt(8) lgkmcnt(0)
s_barrier
s_cmp_eq_u32 s100,1
s_cbranch_scc1 L_qv4_0
s_waitcnt vmcnt(3)
L_qv4_0:
v_mfma_f32_16x16x32_bf16 a[156:159],a[176:179],v[144:147],a[156:159]
s_add_u32 m0,s85,98304
s_xor_b32 s58,s11,69632
v_mfma_f32_16x16x32_bf16 a[124:127],a[176:179],v[104:107],a[124:127]
buffer_load_dwordx4 v14,s[32:35],s58 offen nt lds
v_cvt_pk_bf16_f32 v56,v56,v57
v_mfma_f32_16x16x32_bf16 a[120:123],a[176:179],v[96:99],a[120:123]
ds_read_b64_tr_b16 a[180:181],v24 offset:0
ds_read_b64_tr_b16 a[182:183],v24 offset:1024
v_mfma_f32_16x16x32_bf16 a[116:119],a[176:179],v[88:91],a[116:119]
v_cvt_pk_bf16_f32 v57,v58,v59
v_cvt_pk_bf16_f32 v58,v60,v61
v_mfma_f32_16x16x32_bf16 a[112:115],a[176:179],v[80:83],a[112:115]
ds_read_b64_tr_b16 a[176:177],v25 offset:0
ds_read_b64_tr_b16 a[178:179],v25 offset:1024
v_mfma_f32_16x16x32_bf16 v[104:107],a[188:191],v[228:231],v[124:127]
v_cvt_pk_bf16_f32 v59,v62,v63
v_mfma_f32_16x16x32_bf16 v[104:107],a[184:187],v[232:235],v[104:107]
v_exp_f32 v64,v64
v_mfma_f32_16x16x32_bf16 v[96:99],a[184:187],v[216:219],v[120:123]
v_exp_f32 v65,v65
v_mfma_f32_16x16x32_bf16 v[96:99],a[188:191],v[212:215],v[96:99]
buffer_load_dwordx4 v14,s[32:35],s58 offen offset:1024 nt lds
v_mfma_f32_16x16x32_bf16 v[88:91],a[188:191],v[196:199],v[116:119]
s_add_u32 m0,s85,102400
s_xor_b32 s58,s11,102400
v_mfma_f32_16x16x32_bf16 v[88:91],a[184:187],v[200:203],v[88:91]
v_exp_f32 v66,v66
v_mfma_f32_16x16x32_bf16 v[80:83],a[184:187],v[184:187],v[112:115]
s_cmp_eq_u32 s93,0
s_cbranch_scc0 L_noP8_0_o
L_noP8_0:
v_mfma_f32_16x16x32_bf16 v[80:83],a[188:191],v[180:183],v[80:83]
v_exp_f32 v67,v67
v_mfma_f32_16x16x32_bf16 v[144:147],a[188:191],v[128:131],v[152:155]
ds_read_b64_tr_b16 a[188:189],v26 offset:0
ds_read_b64_tr_b16 a[190:191],v26 offset:1024
v_mfma_f32_16x16x32_bf16 v[144:147],a[184:187],v[136:139],v[144:147]
v_exp_f32 v68,v68
v_mfma_f32_16x16x32_bf16 v[148:151],a[192:195],v[136:139],v[152:155]
buffer_load_dwordx4 v14,s[32:35],s58 offen nt lds
v_mfma_f32_16x16x32_bf16 v[148:151],a[196:199],v[128:131],v[148:151]
ds_read_b64_tr_b16 a[184:185],v27 offset:0
ds_read_b64_tr_b16 a[186:187],v27 offset:1024
v_mfma_f32_16x16x32_bf16 v[84:87],a[196:199],v[180:183],v[112:115]
v_exp_f32 v69,v69
v_mfma_f32_16x16x32_bf16 v[84:87],a[192:195],v[184:187],v[84:87]
v_exp_f32 v70,v70
v_mfma_f32_16x16x32_bf16 v[92:95],a[192:195],v[200:203],v[116:119]
v_exp_f32 v71,v71
v_mfma_f32_16x16x32_bf16 v[92:95],a[196:199],v[196:199],v[92:95]
v_cvt_pk_bf16_f32 v64,v64,v65
v_cvt_pk_bf16_f32 v65,v66,v67
v_mfma_f32_16x16x32_bf16 v[100:103],a[196:199],v[212:215],v[120:123]
v_cvt_pk_bf16_f32 v66,v68,v69
v_cvt_pk_bf16_f32 v67,v70,v71
v_mfma_f32_16x16x32_bf16 v[100:103],a[192:195],v[216:219],v[100:103]
buffer_load_dwordx4 v14,s[32:35],s58 offen offset:1024 nt lds
v_mfma_f32_16x16x32_bf16 v[108:111],a[192:195],v[232:235],v[124:127]
ds_read_b64_tr_b16 a[192:193],v28 offset:0
ds_read_b64_tr_b16 a[194:195],v28 offset:1024
v_mfma_f32_16x16x32_bf16 v[108:111],a[196:199],v[228:231],v[108:111]
s_add_u32 m0,s85,106496
s_xor_b32 s58,s11,77824
v_mfma_f32_16x16x32_bf16 v[104:107],a[160:163],v[236:239],v[104:107]
ds_read_b64_tr_b16 a[196:197],v29 offset:0
ds_read_b64_tr_b16 a[198:199],v29 offset:1024
v_mfma_f32_16x16x32_bf16 v[104:107],a[164:167],v[240:243],v[104:107]
v_exp_f32 v72,v72
v_mfma_f32_16x16x32_bf16 v[96:99],a[164:167],v[224:227],v[96:99]
v_exp_f32 v73,v73
v_mfma_f32_16x16x32_bf16 v[96:99],a[160:163],v[220:223],v[96:99]
v_exp_f32 v74,v74
v_mfma_f32_16x16x32_bf16 v[88:91],a[160:163],v[204:207],v[88:91]
buffer_load_dwordx4 v14,s[32:35],s58 offen nt lds
v_mfma_f32_16x16x32_bf16 v[88:91],a[164:167],v[208:211],v[88:91]
v_exp_f32 v75,v75
v_mfma_f32_16x16x32_bf16 v[80:83],a[164:167],v[192:195],v[80:83]
v_exp_f32 v76,v76
v_mfma_f32_16x16x32_bf16 v[80:83],a[160:163],v[188:191],v[80:83]
v_exp_f32 v77,v77
v_mfma_f32_16x16x32_bf16 v[144:147],a[160:163],v[132:135],v[144:147]
ds_read_b64_tr_b16 a[160:161],v30 offset:0
ds_read_b64_tr_b16 a[162:163],v30 offset:1024
v_mfma_f32_16x16x32_bf16 v[144:147],a[164:167],v[140:143],v[144:147]
v_exp_f32 v78,v78
v_mfma_f32_16x16x32_bf16 v[148:151],a[168:171],v[140:143],v[148:151]
v_exp_f32 v79,v79
v_mfma_f32_16x16x32_bf16 v[148:151],a[172:175],v[132:135],v[148:151]
buffer_load_dwordx4 v14,s[32:35],s58 offen offset:1024 nt lds
v_cvt_pk_bf16_f32 v72,v72,v73
v_mfma_f32_16x16x32_bf16 v[84:87],a[172:175],v[188:191],v[84:87]
s_add_u32 m0,s85,110592
s_xor_b32 s58,s11,110592
v_mfma_f32_16x16x32_bf16 v[84:87],a[168:171],v[192:195],v[84:87]
v_cvt_pk_bf16_f32 v73,v74,v75
v_cvt_pk_bf16_f32 v74,v76,v77
v_mfma_f32_16x16x32_bf16 v[92:95],a[168:171],v[208:211],v[92:95]
v_cvt_pk_bf16_f32 v75,v78,v79
v_mfma_f32_16x16x32_bf16 v[92:95],a[172:175],v[204:207],v[92:95]
v_mfma_f32_16x16x32_bf16 v[100:103],a[172:175],v[220:223],v[100:103]
v_mfma_f32_16x16x32_bf16 v[100:103],a[168:171],v[224:227],v[100:103]
v_mfma_f32_16x16x32_bf16 v[108:111],a[168:171],v[240:243],v[108:111]
buffer_load_dwordx4 v14,s[32:35],s58 offen nt lds
v_mfma_f32_16x16x32_bf16 v[108:111],a[172:175],v[236:239],v[108:111]
v_max3_f32 v1,v144,v145,v146
v_max3_f32 v1,v1,v147,v148
s_waitcnt lgkmcnt(0)
v_mfma_f32_16x16x32_bf16 a[0:3],a[180:183],v[48:51],a[0:3]
ds_read_b64_tr_b16 a[164:165],v31 offset:0
ds_read_b64_tr_b16 a[166:167],v31 offset:1024
v_mfma_f32_16x16x32_bf16 a[4:7],a[180:183],v[56:59],a[4:7]
v_max3_f32 v1,v1,v149,v150
v_max3_f32 v1,v1,v151,v80
v_mfma_f32_16x16x32_bf16 a[8:11],a[180:183],v[64:67],a[8:11]
v_max3_f32 v1,v1,v81,v82
v_max3_f32 v1,v1,v83,v88
v_mfma_f32_16x16x32_bf16 a[12:15],a[180:183],v[72:75],a[12:15]
v_max3_f32 v1,v1,v89,v90
v_max3_f32 v1,v1,v91,v96
v_mfma_f32_16x16x32_bf16 a[28:31],a[176:179],v[72:75],a[28:31]
v_max3_f32 v1,v1,v97,v98
v_max3_f32 v1,v1,v99,v104
v_mfma_f32_16x16x32_bf16 a[24:27],a[176:179],v[64:67],a[24:27]
buffer_load_dwordx4 v14,s[32:35],s58 offen offset:1024 nt lds
v_max3_f32 v1,v1,v105,v106
v_mfma_f32_16x16x32_bf16 a[20:23],a[176:179],v[56:59],a[20:23]
v_max3_f32 v1,v1,v107,v84
v_max3_f32 v1,v1,v85,v86
v_mfma_f32_16x16x32_bf16 a[16:19],a[176:179],v[48:51],a[16:19]
v_max3_f32 v1,v1,v87,v92
v_max3_f32 v1,v1,v93,v94
v_mfma_f32_16x16x32_bf16 v[156:159],v[176:179],v[48:51],v[156:159]
v_max3_f32 v1,v1,v95,v100
v_max3_f32 v1,v1,v101,v102
v_mfma_f32_16x16x32_bf16 a[32:35],a[188:191],v[48:51],a[32:35]
v_max3_f32 v1,v1,v103,v108
v_max3_f32 v1,v1,v109,v110
v_mfma_f32_16x16x32_bf16 a[36:39],a[188:191],v[56:59],a[36:39]
v_max_f32 v1,v1,v111
v_cmp_lt_f32 vcc,0x41000000,v1
v_mfma_f32_16x16x32_bf16 a[40:43],a[188:191],v[64:67],a[40:43]
v_mfma_f32_16x16x32_bf16 a[44:47],a[188:191],v[72:75],a[44:47]
s_cbranch_vccnz L_noA9_0_o
L_noA9_0:
v_mfma_f32_16x16x32_bf16 v[160:163],v[176:179],v[56:59],v[160:163]
v_exp_f32 v80,v80
v_mfma_f32_16x16x32_bf16 a[60:63],a[184:187],v[72:75],a[60:63]
v_exp_f32 v81,v81
v_mfma_f32_16x16x32_bf16 a[56:59],a[184:187],v[64:67],a[56:59]
v_exp_f32 v82,v82
v_mfma_f32_16x16x32_bf16 a[52:55],a[184:187],v[56:59],a[52:55]
v_exp_f32 v83,v83
v_mfma_f32_16x16x32_bf16 a[48:51],a[184:187],v[48:51],a[48:51]
v_exp_f32 v84,v84
v_mfma_f32_16x16x32_bf16 v[164:167],v[176:179],v[64:67],v[164:167]
v_exp_f32 v85,v85
v_mfma_f32_16x16x32_bf16 a[64:67],a[192:195],v[48:51],a[64:67]
s_waitcnt vmcnt(8) lgkmcnt(0)
s_barrier
s_cmp_eq_u32 s100,1
s_cbranch_scc1 L_qk5_0
s_waitcnt vmcnt(3)
L_qk5_0:
v_mfma_f32_16x16x32_bf16 a[68:71],a[192:195],v[56:59],a[68:71]
s_add_u32 m0,s85,0
s_xor_b32 s58,s11,81920
v_mfma_f32_16x16x32_bf16 a[72:75],a[192:195],v[64:67],a[72:75]
buffer_load_dwordx4 v12,s[28:31],s58 offen nt lds
v_mfma_f32_16x16x32_bf16 a[76:79],a[192:195],v[72:75],a[76:79]
ds_read_b128 a[168:171],v40 offset:32768
ds_read_b128 a[172:175],v41 offset:32768
v_mfma_f32_16x16x32_bf16 v[168:171],v[176:179],v[72:75],v[168:171]
ds_read_b128 a[180:183],v40 offset:33792
v_mfma_f32_16x16x32_bf16 a[92:95],a[196:199],v[72:75],a[92:95]
ds_read_b128 a[176:179],v41 offset:33792
ds_read_b128 a[188:191],v42 offset:32768
v_mfma_f32_16x16x32_bf16 a[88:91],a[196:199],v[64:67],a[88:91]
ds_read_b128 a[184:187],v43 offset:32768
v_mfma_f32_16x16x32_bf16 a[84:87],a[196:199],v[56:59],a[84:87]
ds_read_b128 a[192:195],v42 offset:33792
v_mfma_f32_16x16x32_bf16 a[80:83],a[196:199],v[48:51],a[80:83]
ds_read_b128 a[196:199],v43 offset:33792
v_mfma_f32_16x16x32_bf16 a[96:99],a[160:163],v[48:51],a[96:99]
buffer_load_dwordx4 v12,s[28:31],s58 offen offset:1024 nt lds
v_mfma_f32_16x16x32_bf16 a[100:103],a[160:163],v[56:59],a[100:103]
s_add_u32 m0,s85,4096
s_xor_b32 s58,s11,114688
v_mfma_f32_16x16x32_bf16 a[104:107],a[160:163],v[64:67],a[104:107]
v_exp_f32 v86,v86
v_mfma_f32_16x16x32_bf16 a[108:111],a[160:163],v[72:75],a[108:111]
ds_read_b64_tr_b16 a[160:161],v32 offset:0
ds_read_b64_tr_b16 a[162:163],v32 offset:1024
v_mfma_f32_16x16x32_bf16 a[124:127],a[164:167],v[72:75],a[124:127]
v_exp_f32 v87,v87
v_mfma_f32_16x16x32_bf16 a[120:123],a[164:167],v[64:67],a[120:123]
v_cvt_pk_bf16_f32 v80,v80,v81
v_cvt_pk_bf16_f32 v81,v82,v83
v_mfma_f32_16x16x32_bf16 a[116:119],a[164:167],v[56:59],a[116:119]
v_cvt_pk_bf16_f32 v82,v84,v85
v_cvt_pk_bf16_f32 v83,v86,v87
v_mfma_f32_16x16x32_bf16 a[112:115],a[164:167],v[48:51],a[112:115]
buffer_load_dwordx4 v13,s[28:31],s58 offen nt lds
s_waitcnt lgkmcnt(0)
v_mfma_f32_16x16x32_bf16 v[72:75],a[168:171],v[228:231],v[124:127]
ds_read_b64_tr_b16 a[164:165],v33 offset:0
ds_read_b64_tr_b16 a[166:167],v33 offset:1024
v_mfma_f32_16x16x32_bf16 v[72:75],a[172:175],v[232:235],v[72:75]
v_exp_f32 v88,v88
v_mfma_f32_16x16x32_bf16 v[64:67],a[172:175],v[216:219],v[120:123]
v_exp_f32 v89,v89
v_mfma_f32_16x16x32_bf16 v[64:67],a[168:171],v[212:215],v[64:67]
v_exp_f32 v90,v90
v_mfma_f32_16x16x32_bf16 v[56:59],a[168:171],v[196:199],v[116:119]
s_cmp_eq_u32 s93,0
s_cbranch_scc0 L_noP9_0_o
L_noP9_0:
v_mfma_f32_16x16x32_bf16 v[56:59],a[172:175],v[200:203],v[56:59]
v_exp_f32 v91,v91
v_mfma_f32_16x16x32_bf16 v[48:51],a[172:175],v[184:187],v[112:115]
buffer_load_dwordx4 v13,s[28:31],s58 offen offset:1024 nt lds
v_mfma_f32_16x16x32_bf16 v[48:51],a[168:171],v[180:183],v[48:51]
ds_read_b64_tr_b16 a[172:173],v34 offset:0
ds_read_b64_tr_b16 a[174:175],v34 offset:1024
v_mfma_f32_16x16x32_bf16 v[52:55],a[180:183],v[180:183],v[112:115]
s_add_u32 m0,s85,8192
s_xor_b32 s58,s11,90112
v_mfma_f32_16x16x32_bf16 v[52:55],a[176:179],v[184:187],v[52:55]
ds_read_b64_tr_b16 a[168:169],v35 offset:0
ds_read_b64_tr_b16 a[170:171],v35 offset:1024
v_mfma_f32_16x16x32_bf16 v[60:63],a[176:179],v[200:203],v[116:119]
v_exp_f32 v92,v92
v_mfma_f32_16x16x32_bf16 v[60:63],a[180:183],v[196:199],v[60:63]
v_exp_f32 v93,v93
v_mfma_f32_16x16x32_bf16 v[68:71],a[180:183],v[212:215],v[120:123]
v_exp_f32 v94,v94
v_mfma_f32_16x16x32_bf16 v[68:71],a[176:179],v[216:219],v[68:71]
buffer_load_dwordx4 v12,s[28:31],s58 offen nt lds
v_mfma_f32_16x16x32_bf16 v[76:79],a[176:179],v[232:235],v[124:127]
ds_read_b64_tr_b16 a[176:177],v36 offset:0
ds_read_b64_tr_b16 a[178:179],v36 offset:1024
v_mfma_f32_16x16x32_bf16 v[76:79],a[180:183],v[228:231],v[76:79]
v_exp_f32 v95,v95
v_mfma_f32_16x16x32_bf16 v[72:75],a[188:191],v[236:239],v[72:75]
ds_read_b64_tr_b16 a[180:181],v37 offset:0
ds_read_b64_tr_b16 a[182:183],v37 offset:1024
v_mfma_f32_16x16x32_bf16 v[72:75],a[184:187],v[240:243],v[72:75]
v_cvt_pk_bf16_f32 v88,v88,v89
v_cvt_pk_bf16_f32 v89,v90,v91
v_mfma_f32_16x16x32_bf16 v[64:67],a[184:187],v[224:227],v[64:67]
v_cvt_pk_bf16_f32 v90,v92,v93
v_cvt_pk_bf16_f32 v91,v94,v95
v_mfma_f32_16x16x32_bf16 v[64:67],a[188:191],v[220:223],v[64:67]
v_exp_f32 v96,v96
v_mfma_f32_16x16x32_bf16 v[56:59],a[188:191],v[204:207],v[56:59]
buffer_load_dwordx4 v12,s[28:31],s58 offen offset:1024 nt lds
v_mfma_f32_16x16x32_bf16 v[56:59],a[184:187],v[208:211],v[56:59]
s_add_u32 m0,s85,12288
s_xor_b32 s58,s11,122880
v_mfma_f32_16x16x32_bf16 v[48:51],a[184:187],v[192:195],v[48:51]
ds_read_b64_tr_b16 a[184:185],v38 offset:0
ds_read_b64_tr_b16 a[186:187],v38 offset:1024
v_mfma_f32_16x16x32_bf16 v[48:51],a[188:191],v[188:191],v[48:51]
v_exp_f32 v97,v97
v_mfma_f32_16x16x32_bf16 v[52:55],a[192:195],v[188:191],v[52:55]
ds_read_b64_tr_b16 a[188:189],v39 offset:0
ds_read_b64_tr_b16 a[190:191],v39 offset:1024
v_mfma_f32_16x16x32_bf16 v[52:55],a[196:199],v[192:195],v[52:55]
v_exp_f32 v98,v98
v_mfma_f32_16x16x32_bf16 v[60:63],a[196:199],v[208:211],v[60:63]
v_exp_f32 v99,v99
v_mfma_f32_16x16x32_bf16 v[60:63],a[192:195],v[204:207],v[60:63]
buffer_load_dwordx4 v13,s[28:31],s58 offen nt lds
v_mfma_f32_16x16x32_bf16 v[68:71],a[192:195],v[220:223],v[68:71]
v_exp_f32 v100,v100
v_mfma_f32_16x16x32_bf16 v[68:71],a[196:199],v[224:227],v[68:71]
v_exp_f32 v101,v101
v_mfma_f32_16x16x32_bf16 v[76:79],a[196:199],v[240:243],v[76:79]
v_exp_f32 v102,v102
v_mfma_f32_16x16x32_bf16 v[76:79],a[192:195],v[236:239],v[76:79]
v_exp_f32 v103,v103
v_mfma_f32_16x16x32_bf16 a[0:3],a[160:163],v[80:83],a[0:3]
v_cvt_pk_bf16_f32 v96,v96,v97
v_cvt_pk_bf16_f32 v97,v98,v99
v_mfma_f32_16x16x32_bf16 a[4:7],a[160:163],v[88:91],a[4:7]
v_cvt_pk_bf16_f32 v98,v100,v101
v_cvt_pk_bf16_f32 v99,v102,v103
s_nop 1
v_mfma_f32_16x16x32_bf16 a[8:11],a[160:163],v[96:99],a[8:11]
buffer_load_dwordx4 v13,s[28:31],s58 offen offset:1024 nt lds
v_exp_f32 v104,v104
v_exp_f32 v105,v105
v_exp_f32 v106,v106
v_exp_f32 v107,v107
v_exp_f32 v108,v108
v_exp_f32 v109,v109
v_exp_f32 v110,v110
v_exp_f32 v111,v111
v_cvt_pk_bf16_f32 v104,v104,v105
v_cvt_pk_bf16_f32 v105,v106,v107
v_cvt_pk_bf16_f32 v106,v108,v109
v_cvt_pk_bf16_f32 v107,v110,v111
s_nop 1
v_mfma_f32_16x16x32_bf16 a[12:15],a[160:163],v[104:107],a[12:15]
v_exp_f32 v144,v144
v_exp_f32 v145,v145
v_exp_f32 v146,v146
v_exp_f32 v147,v147
v_exp_f32 v148,v148
v_exp_f32 v149,v149
v_exp_f32 v150,v150
v_exp_f32 v151,v151
v_cvt_pk_bf16_f32 v144,v144,v145
v_cvt_pk_bf16_f32 v145,v146,v147
v_cvt_pk_bf16_f32 v146,v148,v149
v_cvt_pk_bf16_f32 v147,v150,v151
s_nop 1
v_mfma_f32_16x16x32_bf16 a[128:131],a[160:163],v[144:147],a[128:131]
v_max3_f32 v1,v48,v49,v50
v_max3_f32 v1,v1,v51,v56
s_waitcnt lgkmcnt(0)
v_mfma_f32_16x16x32_bf16 a[132:135],a[164:167],v[144:147],a[132:135]
ds_read_b128 a[196:199],v44 offset:32768
ds_read_b128 a[192:195],v45 offset:32768
v_mfma_f32_16x16x32_bf16 a[28:31],a[164:167],v[104:107],a[28:31]
ds_read_b128 a[160:163],v45 offset:33792
v_max3_f32 v1,v1,v57,v58
v_mfma_f32_16x16x32_bf16 a[24:27],a[164:167],v[96:99],a[24:27]
v_max3_f32 v1,v1,v59,v64
v_max3_f32 v1,v1,v65,v66
v_mfma_f32_16x16x32_bf16 a[20:23],a[164:167],v[88:91],a[20:23]
v_max3_f32 v1,v1,v67,v72
v_max3_f32 v1,v1,v73,v74
v_mfma_f32_16x16x32_bf16 a[16:19],a[164:167],v[80:83],a[16:19]
ds_read_b128 a[164:167],v44 offset:33792
v_max3_f32 v1,v1,v75,v52
v_mfma_f32_16x16x32_bf16 v[156:159],v[176:179],v[80:83],v[156:159]
v_max3_f32 v1,v1,v53,v54
v_max3_f32 v1,v1,v55,v60
v_mfma_f32_16x16x32_bf16 a[32:35],a[172:175],v[80:83],a[32:35]
v_max3_f32 v1,v1,v61,v62
v_max3_f32 v1,v1,v63,v68
v_mfma_f32_16x16x32_bf16 a[36:39],a[172:175],v[88:91],a[36:39]
v_max3_f32 v1,v1,v69,v70
v_max3_f32 v1,v1,v71,v76
v_mfma_f32_16x16x32_bf16 a[40:43],a[172:175],v[96:99],a[40:43]
v_max3_f32 v1,v1,v77,v78
v_max_f32 v1,v1,v79
v_mfma_f32_16x16x32_bf16 a[44:47],a[172:175],v[104:107],a[44:47]
v_cmp_lt_f32 vcc,0x41000000,v1
v_mfma_f32_16x16x32_bf16 a[136:139],a[172:175],v[144:147],a[136:139]
ds_read_b128 a[172:175],v46 offset:32768
v_mfma_f32_16x16x32_bf16 v[160:163],v[176:179],v[88:91],v[160:163]
v_mfma_f32_16x16x32_bf16 a[140:143],a[168:171],v[144:147],a[140:143]
s_cbranch_vccnz L_noA10_0_o
L_noA10_0:
v_mfma_f32_16x16x32_bf16 a[60:63],a[168:171],v[104:107],a[60:63]
v_exp_f32 v48,v48
v_mfma_f32_16x16x32_bf16 a[56:59],a[168:171],v[96:99],a[56:59]
v_exp_f32 v49,v49
v_mfma_f32_16x16x32_bf16 a[52:55],a[168:171],v[88:91],a[52:55]
v_exp_f32 v50,v50
v_mfma_f32_16x16x32_bf16 a[48:51],a[168:171],v[80:83],a[48:51]
ds_read_b128 a[168:171],v47 offset:32768
v_mfma_f32_16x16x32_bf16 v[164:167],v[176:179],v[96:99],v[164:167]
v_exp_f32 v51,v51
v_mfma_f32_16x16x32_bf16 a[64:67],a[176:179],v[80:83],a[64:67]
v_exp_f32 v52,v52
v_mfma_f32_16x16x32_bf16 a[68:71],a[176:179],v[88:91],a[68:71]
v_exp_f32 v53,v53
v_mfma_f32_16x16x32_bf16 a[72:75],a[176:179],v[96:99],a[72:75]
v_exp_f32 v54,v54
v_mfma_f32_16x16x32_bf16 a[76:79],a[176:179],v[104:107],a[76:79]
v_exp_f32 v55,v55
v_mfma_f32_16x16x32_bf16 a[144:147],a[176:179],v[144:147],a[144:147]
ds_read_b128 a[176:179],v47 offset:33792
v_cvt_pk_bf16_f32 v48,v48,v49
v_mfma_f32_16x16x32_bf16 v[168:171],v[176:179],v[104:107],v[168:171]
v_cvt_pk_bf16_f32 v49,v50,v51
v_cvt_pk_bf16_f32 v50,v52,v53
v_mfma_f32_16x16x32_bf16 a[148:151],a[180:183],v[144:147],a[148:151]
v_cvt_pk_bf16_f32 v51,v54,v55
v_mfma_f32_16x16x32_bf16 a[92:95],a[180:183],v[104:107],a[92:95]
v_exp_f32 v56,v56
v_mfma_f32_16x16x32_bf16 a[88:91],a[180:183],v[96:99],a[88:91]
v_exp_f32 v57,v57
v_mfma_f32_16x16x32_bf16 a[84:87],a[180:183],v[88:91],a[84:87]
v_exp_f32 v58,v58
v_mfma_f32_16x16x32_bf16 a[80:83],a[180:183],v[80:83],a[80:83]
ds_read_b128 a[180:183],v46 offset:33792
v_mfma_f32_16x16x32_bf16 v[172:175],v[176:179],v[144:147],v[172:175]
v_exp_f32 v59,v59
v_mfma_f32_16x16x32_bf16 a[96:99],a[184:187],v[80:83],a[96:99]
v_exp_f32 v60,v60
v_mfma_f32_16x16x32_bf16 a[100:103],a[184:187],v[88:91],a[100:103]
v_exp_f32 v61,v61
v_mfma_f32_16x16x32_bf16 a[104:107],a[184:187],v[96:99],a[104:107]
v_exp_f32 v62,v62
v_mfma_f32_16x16x32_bf16 a[108:111],a[184:187],v[104:107],a[108:111]
v_exp_f32 v63,v63
v_mfma_f32_16x16x32_bf16 a[152:155],a[184:187],v[144:147],a[152:155]
s_waitcnt vmcnt(8) lgkmcnt(0)
s_barrier
s_cmp_eq_u32 s100,1
s_cbranch_scc1 L_qv5_0
s_waitcnt vmcnt(3)
L_qv5_0:
v_mfma_f32_16x16x32_bf16 a[156:159],a[188:191],v[144:147],a[156:159]
s_add_u32 m0,s85,65536
s_xor_b32 s58,s11,81920
v_mfma_f32_16x16x32_bf16 a[124:127],a[188:191],v[104:107],a[124:127]
buffer_load_dwordx4 v14,s[32:35],s58 offen nt lds
v_cvt_pk_bf16_f32 v56,v56,v57
v_mfma_f32_16x16x32_bf16 a[120:123],a[188:191],v[96:99],a[120:123]
ds_read_b64_tr_b16 a[184:185],v24 offset:32768
ds_read_b64_tr_b16 a[186:187],v24 offset:33792
v_mfma_f32_16x16x32_bf16 a[116:119],a[188:191],v[88:91],a[116:119]
v_cvt_pk_bf16_f32 v57,v58,v59
v_cvt_pk_bf16_f32 v58,v60,v61
v_mfma_f32_16x16x32_bf16 a[112:115],a[188:191],v[80:83],a[112:115]
ds_read_b64_tr_b16 a[188:189],v25 offset:32768
ds_read_b64_tr_b16 a[190:191],v25 offset:33792
v_mfma_f32_16x16x32_bf16 v[104:107],a[196:199],v[228:231],v[124:127]
v_cvt_pk_bf16_f32 v59,v62,v63
v_mfma_f32_16x16x32_bf16 v[104:107],a[192:195],v[232:235],v[104:107]
v_exp_f32 v64,v64
v_mfma_f32_16x16x32_bf16 v[96:99],a[192:195],v[216:219],v[120:123]
v_exp_f32 v65,v65
v_mfma_f32_16x16x32_bf16 v[96:99],a[196:199],v[212:215],v[96:99]
buffer_load_dwordx4 v14,s[32:35],s58 offen offset:1024 nt lds
v_mfma_f32_16x16x32_bf16 v[88:91],a[196:199],v[196:199],v[116:119]
s_add_u32 m0,s85,69632
s_xor_b32 s58,s11,114688
v_mfma_f32_16x16x32_bf16 v[88:91],a[192:195],v[200:203],v[88:91]
v_exp_f32 v66,v66
v_mfma_f32_16x16x32_bf16 v[80:83],a[192:195],v[184:187],v[112:115]
s_cmp_eq_u32 s93,0
s_cbranch_scc0 L_noP10_0_o
L_noP10_0:
v_mfma_f32_16x16x32_bf16 v[80:83],a[196:199],v[180:183],v[80:83]
v_exp_f32 v67,v67
v_mfma_f32_16x16x32_bf16 v[144:147],a[196:199],v[128:131],v[152:155]
ds_read_b64_tr_b16 a[196:197],v26 offset:32768
ds_read_b64_tr_b16 a[198:199],v26 offset:33792
v_mfma_f32_16x16x32_bf16 v[144:147],a[192:195],v[136:139],v[144:147]
v_exp_f32 v68,v68
v_mfma_f32_16x16x32_bf16 v[148:151],a[160:163],v[136:139],v[152:155]
buffer_load_dwordx4 v14,s[32:35],s58 offen nt lds
v_mfma_f32_16x16x32_bf16 v[148:151],a[164:167],v[128:131],v[148:151]
ds_read_b64_tr_b16 a[192:193],v27 offset:32768
ds_read_b64_tr_b16 a[194:195],v27 offset:33792
v_mfma_f32_16x16x32_bf16 v[84:87],a[164:167],v[180:183],v[112:115]
v_exp_f32 v69,v69
v_mfma_f32_16x16x32_bf16 v[84:87],a[160:163],v[184:187],v[84:87]
v_exp_f32 v70,v70
v_mfma_f32_16x16x32_bf16 v[92:95],a[160:163],v[200:203],v[116:119]
v_exp_f32 v71,v71
v_mfma_f32_16x16x32_bf16 v[92:95],a[164:167],v[196:199],v[92:95]
v_cvt_pk_bf16_f32 v64,v64,v65
v_cvt_pk_bf16_f32 v65,v66,v67
v_mfma_f32_16x16x32_bf16 v[100:103],a[164:167],v[212:215],v[120:123]
v_cvt_pk_bf16_f32 v66,v68,v69
v_cvt_pk_bf16_f32 v67,v70,v71
v_mfma_f32_16x16x32_bf16 v[100:103],a[160:163],v[216:219],v[100:103]
buffer_load_dwordx4 v14,s[32:35],s58 offen offset:1024 nt lds
v_mfma_f32_16x16x32_bf16 v[108:111],a[160:163],v[232:235],v[124:127]
ds_read_b64_tr_b16 a[160:161],v28 offset:32768
ds_read_b64_tr_b16 a[162:163],v28 offset:33792
v_mfma_f32_16x16x32_bf16 v[108:111],a[164:167],v[228:231],v[108:111]
s_add_u32 m0,s85,73728
s_xor_b32 s58,s11,90112
v_mfma_f32_16x16x32_bf16 v[104:107],a[172:175],v[236:239],v[104:107]
ds_read_b64_tr_b16 a[164:165],v29 offset:32768
ds_read_b64_tr_b16 a[166:167],v29 offset:33792
v_mfma_f32_16x16x32_bf16 v[104:107],a[168:171],v[240:243],v[104:107]
v_exp_f32 v72,v72
v_mfma_f32_16x16x32_bf16 v[96:99],a[168:171],v[224:227],v[96:99]
v_exp_f32 v73,v73
v_mfma_f32_16x16x32_bf16 v[96:99],a[172:175],v[220:223],v[96:99]
v_exp_f32 v74,v74
v_mfma_f32_16x16x32_bf16 v[88:91],a[172:175],v[204:207],v[88:91]
buffer_load_dwordx4 v14,s[32:35],s58 offen nt lds
v_mfma_f32_16x16x32_bf16 v[88:91],a[168:171],v[208:211],v[88:91]
v_exp_f32 v75,v75
v_mfma_f32_16x16x32_bf16 v[80:83],a[168:171],v[192:195],v[80:83]
v_exp_f32 v76,v76
v_mfma_f32_16x16x32_bf16 v[80:83],a[172:175],v[188:191],v[80:83]
v_exp_f32 v77,v77
v_mfma_f32_16x16x32_bf16 v[144:147],a[172:175],v[132:135],v[144:147]
ds_read_b64_tr_b16 a[172:173],v30 offset:32768
ds_read_b64_tr_b16 a[174:175],v30 offset:33792
v_mfma_f32_16x16x32_bf16 v[144:147],a[168:171],v[140:143],v[144:147]
v_exp_f32 v78,v78
v_mfma_f32_16x16x32_bf16 v[148:151],a[176:179],v[140:143],v[148:151]
v_exp_f32 v79,v79
v_mfma_f32_16x16x32_bf16 v[148:151],a[180:183],v[132:135],v[148:151]
buffer_load_dwordx4 v14,s[32:35],s58 offen offset:1024 nt lds
v_cvt_pk_bf16_f32 v72,v72,v73
v_mfma_f32_16x16x32_bf16 v[84:87],a[180:183],v[188:191],v[84:87]
s_add_u32 m0,s85,77824
s_xor_b32 s58,s11,122880
v_mfma_f32_16x16x32_bf16 v[84:87],a[176:179],v[192:195],v[84:87]
v_cvt_pk_bf16_f32 v73,v74,v75
v_cvt_pk_bf16_f32 v74,v76,v77
v_mfma_f32_16x16x32_bf16 v[92:95],a[176:179],v[208:211],v[92:95]
v_cvt_pk_bf16_f32 v75,v78,v79
v_mfma_f32_16x16x32_bf16 v[92:95],a[180:183],v[204:207],v[92:95]
v_mfma_f32_16x16x32_bf16 v[100:103],a[180:183],v[220:223],v[100:103]
v_mfma_f32_16x16x32_bf16 v[100:103],a[176:179],v[224:227],v[100:103]
v_mfma_f32_16x16x32_bf16 v[108:111],a[176:179],v[240:243],v[108:111]
buffer_load_dwordx4 v14,s[32:35],s58 offen nt lds
v_mfma_f32_16x16x32_bf16 v[108:111],a[180:183],v[236:239],v[108:111]
v_max3_f32 v1,v144,v145,v146
v_max3_f32 v1,v1,v147,v148
s_waitcnt lgkmcnt(0)
v_mfma_f32_16x16x32_bf16 a[0:3],a[184:187],v[48:51],a[0:3]
ds_read_b64_tr_b16 a[168:169],v31 offset:32768
ds_read_b64_tr_b16 a[170:171],v31 offset:33792
v_mfma_f32_16x16x32_bf16 a[4:7],a[184:187],v[56:59],a[4:7]
v_max3_f32 v1,v1,v149,v150
v_max3_f32 v1,v1,v151,v80
v_mfma_f32_16x16x32_bf16 a[8:11],a[184:187],v[64:67],a[8:11]
v_max3_f32 v1,v1,v81,v82
v_max3_f32 v1,v1,v83,v88
v_mfma_f32_16x16x32_bf16 a[12:15],a[184:187],v[72:75],a[12:15]
v_max3_f32 v1,v1,v89,v90
v_max3_f32 v1,v1,v91,v96
v_mfma_f32_16x16x32_bf16 a[28:31],a[188:191],v[72:75],a[28:31]
v_max3_f32 v1,v1,v97,v98
v_max3_f32 v1,v1,v99,v104
v_mfma_f32_16x16x32_bf16 a[24:27],a[188:191],v[64:67],a[24:27]
buffer_load_dwordx4 v14,s[32:35],s58 offen offset:1024 nt lds
v_max3_f32 v1,v1,v105,v106
v_mfma_f32_16x16x32_bf16 a[20:23],a[188:191],v[56:59],a[20:23]
v_max3_f32 v1,v1,v107,v84
v_max3_f32 v1,v1,v85,v86
v_mfma_f32_16x16x32_bf16 a[16:19],a[188:191],v[48:51],a[16:19]
v_max3_f32 v1,v1,v87,v92
v_max3_f32 v1,v1,v93,v94
v_mfma_f32_16x16x32_bf16 v[156:159],v[176:179],v[48:51],v[156:159]
v_max3_f32 v1,v1,v95,v100
v_max3_f32 v1,v1,v101,v102
v_mfma_f32_16x16x32_bf16 a[32:35],a[196:199],v[48:51],a[32:35]
v_max3_f32 v1,v1,v103,v108
v_max3_f32 v1,v1,v109,v110
v_mfma_f32_16x16x32_bf16 a[36:39],a[196:199],v[56:59],a[36:39]
v_max_f32 v1,v1,v111
v_cmp_lt_f32 vcc,0x41000000,v1
v_mfma_f32_16x16x32_bf16 a[40:43],a[196:199],v[64:67],a[40:43]
v_mfma_f32_16x16x32_bf16 a[44:47],a[196:199],v[72:75],a[44:47]
s_cbranch_vccnz L_noA11_0_o
L_noA11_0:
v_mfma_f32_16x16x32_bf16 v[160:163],v[176:179],v[56:59],v[160:163]
v_exp_f32 v80,v80
v_mfma_f32_16x16x32_bf16 a[60:63],a[192:195],v[72:75],a[60:63]
v_exp_f32 v81,v81
v_mfma_f32_16x16x32_bf16 a[56:59],a[192:195],v[64:67],a[56:59]
v_exp_f32 v82,v82
v_mfma_f32_16x16x32_bf16 a[52:55],a[192:195],v[56:59],a[52:55]
v_exp_f32 v83,v83
v_mfma_f32_16x16x32_bf16 a[48:51],a[192:195],v[48:51],a[48:51]
v_exp_f32 v84,v84
v_mfma_f32_16x16x32_bf16 v[164:167],v[176:179],v[64:67],v[164:167]
v_exp_f32 v85,v85
v_mfma_f32_16x16x32_bf16 a[64:67],a[160:163],v[48:51],a[64:67]
s_waitcnt vmcnt(8) lgkmcnt(0)
s_barrier
s_cmp_eq_u32 s100,1
s_cbranch_scc1 L_qk6_0
s_waitcnt vmcnt(3)
L_qk6_0:
v_mfma_f32_16x16x32_bf16 a[68:71],a[160:163],v[56:59],a[68:71]
s_add_u32 m0,s85,32768
s_xor_b32 s58,s11,86016
v_mfma_f32_16x16x32_bf16 a[72:75],a[160:163],v[64:67],a[72:75]
buffer_load_dwordx4 v12,s[28:31],s58 offen nt lds
v_mfma_f32_16x16x32_bf16 a[76:79],a[160:163],v[72:75],a[76:79]
ds_read_b128 a[176:179],v40 offset:0
ds_read_b128 a[180:183],v41 offset:0
v_mfma_f32_16x16x32_bf16 v[168:171],v[176:179],v[72:75],v[168:171]
ds_read_b128 a[184:187],v40 offset:1024
v_mfma_f32_16x16x32_bf16 a[92:95],a[164:167],v[72:75],a[92:95]
ds_read_b128 a[188:191],v41 offset:1024
ds_read_b128 a[196:199],v42 offset:0
v_mfma_f32_16x16x32_bf16 a[88:91],a[164:167],v[64:67],a[88:91]
ds_read_b128 a[192:195],v43 offset:0
v_mfma_f32_16x16x32_bf16 a[84:87],a[164:167],v[56:59],a[84:87]
ds_read_b128 a[160:163],v42 offset:1024
v_mfma_f32_16x16x32_bf16 a[80:83],a[164:167],v[48:51],a[80:83]
ds_read_b128 a[164:167],v43 offset:1024
v_mfma_f32_16x16x32_bf16 a[96:99],a[172:175],v[48:51],a[96:99]
buffer_load_dwordx4 v12,s[28:31],s58 offen offset:1024 nt lds
v_mfma_f32_16x16x32_bf16 a[100:103],a[172:175],v[56:59],a[100:103]
s_add_u32 m0,s85,36864
s_xor_b32 s58,s11,118784
v_mfma_f32_16x16x32_bf16 a[104:107],a[172:175],v[64:67],a[104:107]
v_exp_f32 v86,v86
v_mfma_f32_16x16x32_bf16 a[108:111],a[172:175],v[72:75],a[108:111]
ds_read_b64_tr_b16 a[172:173],v32 offset:32768
ds_read_b64_tr_b16 a[174:175],v32 offset:33792
v_mfma_f32_16x16x32_bf16 a[124:127],a[168:171],v[72:75],a[124:127]
v_exp_f32 v87,v87
v_mfma_f32_16x16x32_bf16 a[120:123],a[168:171],v[64:67],a[120:123]
v_cvt_pk_bf16_f32 v80,v80,v81
v_cvt_pk_bf16_f32 v81,v82,v83
v_mfma_f32_16x16x32_bf16 a[116:119],a[168:171],v[56:59],a[116:119]
v_cvt_pk_bf16_f32 v82,v84,v85
v_cvt_pk_bf16_f32 v83,v86,v87
v_mfma_f32_16x16x32_bf16 a[112:115],a[168:171],v[48:51],a[112:115]
buffer_load_dwordx4 v13,s[28:31],s58 offen nt lds
s_waitcnt lgkmcnt(0)
v_mfma_f32_16x16x32_bf16 v[72:75],a[176:179],v[228:231],v[124:127]
ds_read_b64_tr_b16 a[168:169],v33 offset:32768
ds_read_b64_tr_b16 a[170:171],v33 offset:33792
v_mfma_f32_16x16x32_bf16 v[72:75],a[180:183],v[232:235],v[72:75]
v_exp_f32 v88,v88
v_mfma_f32_16x16x32_bf16 v[64:67],a[180:183],v[216:219],v[120:123]
v_exp_f32 v89,v89
v_mfma_f32_16x16x32_bf16 v[64:67],a[176:179],v[212:215],v[64:67]
v_exp_f32 v90,v90
v_mfma_f32_16x16x32_bf16 v[56:59],a[176:179],v[196:199],v[116:119]
s_cmp_eq_u32 s93,0
s_cbranch_scc0 L_noP11_0_o
L_noP11_0:
v_mfma_f32_16x16x32_bf16 v[56:59],a[180:183],v[200:203],v[56:59]
v_exp_f32 v91,v91
v_mfma_f32_16x16x32_bf16 v[48:51],a[180:183],v[184:187],v[112:115]
buffer_load_dwordx4 v13,s[28:31],s58 offen offset:1024 nt lds
v_mfma_f32_16x16x32_bf16 v[48:51],a[176:179],v[180:183],v[48:51]
ds_read_b64_tr_b16 a[180:181],v34 offset:32768
ds_read_b64_tr_b16 a[182:183],v34 offset:33792
v_mfma_f32_16x16x32_bf16 v[52:55],a[184:187],v[180:183],v[112:115]
s_add_u32 m0,s85,40960
s_xor_b32 s58,s11,94208
v_mfma_f32_16x16x32_bf16 v[52:55],a[188:191],v[184:187],v[52:55]
ds_read_b64_tr_b16 a[176:177],v35 offset:32768
ds_read_b64_tr_b16 a[178:179],v35 offset:33792
v_mfma_f32_16x16x32_bf16 v[60:63],a[188:191],v[200:203],v[116:119]
v_exp_f32 v92,v92
v_mfma_f32_16x16x32_bf16 v[60:63],a[184:187],v[196:199],v[60:63]
v_exp_f32 v93,v93
v_mfma_f32_16x16x32_bf16 v[68:71],a[184:187],v[212:215],v[120:123]
v_exp_f32 v94,v94
v_mfma_f32_16x16x32_bf16 v[68:71],a[188:191],v[216:219],v[68:71]
buffer_load_dwordx4 v12,s[28:31],s58 offen nt lds
v_mfma_f32_16x16x32_bf16 v[76:79],a[188:191],v[232:235],v[124:127]
ds_read_b64_tr_b16 a[188:189],v36 offset:32768
ds_read_b64_tr_b16 a[190:191],v36 offset:33792
v_mfma_f32_16x16x32_bf16 v[76:79],a[184:187],v[228:231],v[76:79]
v_exp_f32 v95,v95
v_mfma_f32_16x16x32_bf16 v[72:75],a[196:199],v[236:239],v[72:75]
ds_read_b64_tr_b16 a[184:185],v37 offset:32768
ds_read_b64_tr_b16 a[186:187],v37 offset:33792
v_mfma_f32_16x16x32_bf16 v[72:75],a[192:195],v[240:243],v[72:75]
v_cvt_pk_bf16_f32 v88,v88,v89
v_cvt_pk_bf16_f32 v89,v90,v91
v_mfma_f32_16x16x32_bf16 v[64:67],a[192:195],v[224:227],v[64:67]
v_cvt_pk_bf16_f32 v90,v92,v93
v_cvt_pk_bf16_f32 v91,v94,v95
v_mfma_f32_16x16x32_bf16 v[64:67],a[196:199],v[220:223],v[64:67]
v_exp_f32 v96,v96
v_mfma_f32_16x16x32_bf16 v[56:59],a[196:199],v[204:207],v[56:59]
buffer_load_dwordx4 v12,s[28:31],s58 offen offset:1024 nt lds
v_mfma_f32_16x16x32_bf16 v[56:59],a[192:195],v[208:211],v[56:59]
s_add_u32 m0,s85,45056
s_xor_b32 s58,s11,126976
v_mfma_f32_16x16x32_bf16 v[48:51],a[192:195],v[192:195],v[48:51]
ds_read_b64_tr_b16 a[192:193],v38 offset:32768
ds_read_b64_tr_b16 a[194:195],v38 offset:33792
v_mfma_f32_16x16x32_bf16 v[48:51],a[196:199],v[188:191],v[48:51]
v_exp_f32 v97,v97
v_mfma_f32_16x16x32_bf16 v[52:55],a[160:163],v[188:191],v[52:55]
ds_read_b64_tr_b16 a[196:197],v39 offset:32768
ds_read_b64_tr_b16 a[198:199],v39 offset:33792
v_mfma_f32_16x16x32_bf16 v[52:55],a[164:167],v[192:195],v[52:55]
v_exp_f32 v98,v98
v_mfma_f32_16x16x32_bf16 v[60:63],a[164:167],v[208:211],v[60:63]
v_exp_f32 v99,v99
v_mfma_f32_16x16x32_bf16 v[60:63],a[160:163],v[204:207],v[60:63]
buffer_load_dwordx4 v13,s[28:31],s58 offen nt lds
v_mfma_f32_16x16x32_bf16 v[68:71],a[160:163],v[220:223],v[68:71]
v_exp_f32 v100,v100
v_mfma_f32_16x16x32_bf16 v[68:71],a[164:167],v[224:227],v[68:71]
v_exp_f32 v101,v101
v_mfma_f32_16x16x32_bf16 v[76:79],a[164:167],v[240:243],v[76:79]
v_exp_f32 v102,v102
v_mfma_f32_16x16x32_bf16 v[76:79],a[160:163],v[236:239],v[76:79]
v_exp_f32 v103,v103
v_mfma_f32_16x16x32_bf16 a[0:3],a[172:175],v[80:83],a[0:3]
v_cvt_pk_bf16_f32 v96,v96,v97
v_cvt_pk_bf16_f32 v97,v98,v99
v_mfma_f32_16x16x32_bf16 a[4:7],a[172:175],v[88:91],a[4:7]
v_cvt_pk_bf16_f32 v98,v100,v101
v_cvt_pk_bf16_f32 v99,v102,v103
s_nop 1
v_mfma_f32_16x16x32_bf16 a[8:11],a[172:175],v[96:99],a[8:11]
buffer_load_dwordx4 v13,s[28:31],s58 offen offset:1024 nt lds
v_exp_f32 v104,v104
v_exp_f32 v105,v105
v_exp_f32 v106,v106
v_exp_f32 v107,v107
v_exp_f32 v108,v108
v_exp_f32 v109,v109
v_exp_f32 v110,v110
v_exp_f32 v111,v111
v_cvt_pk_bf16_f32 v104,v104,v105
v_cvt_pk_bf16_f32 v105,v106,v107
v_cvt_pk_bf16_f32 v106,v108,v109
v_cvt_pk_bf16_f32 v107,v110,v111
s_nop 1
v_mfma_f32_16x16x32_bf16 a[12:15],a[172:175],v[104:107],a[12:15]
v_exp_f32 v144,v144
v_exp_f32 v145,v145
v_exp_f32 v146,v146
v_exp_f32 v147,v147
v_exp_f32 v148,v148
v_exp_f32 v149,v149
v_exp_f32 v150,v150
v_exp_f32 v151,v151
v_cvt_pk_bf16_f32 v144,v144,v145
v_cvt_pk_bf16_f32 v145,v146,v147
v_cvt_pk_bf16_f32 v146,v148,v149
v_cvt_pk_bf16_f32 v147,v150,v151
s_nop 1
v_mfma_f32_16x16x32_bf16 a[128:131],a[172:175],v[144:147],a[128:131]
v_max3_f32 v1,v48,v49,v50
v_max3_f32 v1,v1,v51,v56
s_waitcnt lgkmcnt(0)
v_mfma_f32_16x16x32_bf16 a[132:135],a[168:171],v[144:147],a[132:135]
ds_read_b128 a[164:167],v44 offset:0
ds_read_b128 a[160:163],v45 offset:0
v_mfma_f32_16x16x32_bf16 a[28:31],a[168:171],v[104:107],a[28:31]
ds_read_b128 a[172:175],v45 offset:1024
v_max3_f32 v1,v1,v57,v58
v_mfma_f32_16x16x32_bf16 a[24:27],a[168:171],v[96:99],a[24:27]
v_max3_f32 v1,v1,v59,v64
v_max3_f32 v1,v1,v65,v66
v_mfma_f32_16x16x32_bf16 a[20:23],a[168:171],v[88:91],a[20:23]
v_max3_f32 v1,v1,v67,v72
v_max3_f32 v1,v1,v73,v74
v_mfma_f32_16x16x32_bf16 a[16:19],a[168:171],v[80:83],a[16:19]
ds_read_b128 a[168:171],v44 offset:1024
v_max3_f32 v1,v1,v75,v52
v_mfma_f32_16x16x32_bf16 v[156:159],v[176:179],v[80:83],v[156:159]
v_max3_f32 v1,v1,v53,v54
v_max3_f32 v1,v1,v55,v60
v_mfma_f32_16x16x32_bf16 a[32:35],a[180:183],v[80:83],a[32:35]
v_max3_f32 v1,v1,v61,v62
v_max3_f32 v1,v1,v63,v68
v_mfma_f32_16x16x32_bf16 a[36:39],a[180:183],v[88:91],a[36:39]
v_max3_f32 v1,v1,v69,v70
v_max3_f32 v1,v1,v71,v76
v_mfma_f32_16x16x32_bf16 a[40:43],a[180:183],v[96:99],a[40:43]
v_max3_f32 v1,v1,v77,v78
v_max_f32 v1,v1,v79
v_mfma_f32_16x16x32_bf16 a[44:47],a[180:183],v[104:107],a[44:47]
v_cmp_lt_f32 vcc,0x41000000,v1
v_mfma_f32_16x16x32_bf16 a[136:139],a[180:183],v[144:147],a[136:139]
ds_read_b128 a[180:183],v46 offset:0
v_mfma_f32_16x16x32_bf16 v[160:163],v[176:179],v[88:91],v[160:163]
v_mfma_f32_16x16x32_bf16 a[140:143],a[176:179],v[144:147],a[140:143]
s_cbranch_vccnz L_noA12_0_o
L_noA12_0:
v_mfma_f32_16x16x32_bf16 a[60:63],a[176:179],v[104:107],a[60:63]
v_exp_f32 v48,v48
v_mfma_f32_16x16x32_bf16 a[56:59],a[176:179],v[96:99],a[56:59]
v_exp_f32 v49,v49
v_mfma_f32_16x16x32_bf16 a[52:55],a[176:179],v[88:91],a[52:55]
v_exp_f32 v50,v50
v_mfma_f32_16x16x32_bf16 a[48:51],a[176:179],v[80:83],a[48:51]
ds_read_b128 a[176:179],v47 offset:0
v_mfma_f32_16x16x32_bf16 v[164:167],v[176:179],v[96:99],v[164:167]
v_exp_f32 v51,v51
v_mfma_f32_16x16x32_bf16 a[64:67],a[188:191],v[80:83],a[64:67]
v_exp_f32 v52,v52
v_mfma_f32_16x16x32_bf16 a[68:71],a[188:191],v[88:91],a[68:71]
v_exp_f32 v53,v53
v_mfma_f32_16x16x32_bf16 a[72:75],a[188:191],v[96:99],a[72:75]
v_exp_f32 v54,v54
v_mfma_f32_16x16x32_bf16 a[76:79],a[188:191],v[104:107],a[76:79]
v_exp_f32 v55,v55
v_mfma_f32_16x16x32_bf16 a[144:147],a[188:191],v[144:147],a[144:147]
ds_read_b128 a[188:191],v47 offset:1024
v_cvt_pk_bf16_f32 v48,v48,v49
v_mfma_f32_16x16x32_bf16 v[168:171],v[176:179],v[104:107],v[168:171]
v_cvt_pk_bf16_f32 v49,v50,v51
v_cvt_pk_bf16_f32 v50,v52,v53
v_mfma_f32_16x16x32_bf16 a[148:151],a[184:187],v[144:147],a[148:151]
v_cvt_pk_bf16_f32 v51,v54,v55
v_mfma_f32_16x16x32_bf16 a[92:95],a[184:187],v[104:107],a[92:95]
v_exp_f32 v56,v56
v_mfma_f32_16x16x32_bf16 a[88:91],a[184:187],v[96:99],a[88:91]
v_exp_f32 v57,v57
v_mfma_f32_16x16x32_bf16 a[84:87],a[184:187],v[88:91],a[84:87]
v_exp_f32 v58,v58
v_mfma_f32_16x16x32_bf16 a[80:83],a[184:187],v[80:83],a[80:83]
ds_read_b128 a[184:187],v46 offset:1024
v_mfma_f32_16x16x32_bf16 v[172:175],v[176:179],v[144:147],v[172:175]
v_exp_f32 v59,v59
v_mfma_f32_16x16x32_bf16 a[96:99],a[192:195],v[80:83],a[96:99]
v_exp_f32 v60,v60
v_mfma_f32_16x16x32_bf16 a[100:103],a[192:195],v[88:91],a[100:103]
v_exp_f32 v61,v61
v_mfma_f32_16x16x32_bf16 a[104:107],a[192:195],v[96:99],a[104:107]
v_exp_f32 v62,v62
v_mfma_f32_16x16x32_bf16 a[108:111],a[192:195],v[104:107],a[108:111]
v_exp_f32 v63,v63
v_mfma_f32_16x16x32_bf16 a[152:155],a[192:195],v[144:147],a[152:155]
s_waitcnt vmcnt(8) lgkmcnt(0)
s_barrier
s_cmp_eq_u32 s100,1
s_cbranch_scc1 L_qv6_0
s_waitcnt vmcnt(3)
L_qv6_0:
v_mfma_f32_16x16x32_bf16 a[156:159],a[196:199],v[144:147],a[156:159]
s_add_u32 m0,s85,98304
s_xor_b32 s58,s11,86016
v_mfma_f32_16x16x32_bf16 a[124:127],a[196:199],v[104:107],a[124:127]
buffer_load_dwordx4 v14,s[32:35],s58 offen nt lds
v_cvt_pk_bf16_f32 v56,v56,v57
v_mfma_f32_16x16x32_bf16 a[120:123],a[196:199],v[96:99],a[120:123]
ds_read_b64_tr_b16 a[192:193],v24 offset:0
ds_read_b64_tr_b16 a[194:195],v24 offset:1024
v_mfma_f32_16x16x32_bf16 a[116:119],a[196:199],v[88:91],a[116:119]
v_cvt_pk_bf16_f32 v57,v58,v59
v_cvt_pk_bf16_f32 v58,v60,v61
v_mfma_f32_16x16x32_bf16 a[112:115],a[196:199],v[80:83],a[112:115]
ds_read_b64_tr_b16 a[196:197],v25 offset:0
ds_read_b64_tr_b16 a[198:199],v25 offset:1024
v_mfma_f32_16x16x32_bf16 v[104:107],a[164:167],v[228:231],v[124:127]
v_cvt_pk_bf16_f32 v59,v62,v63
v_mfma_f32_16x16x32_bf16 v[104:107],a[160:163],v[232:235],v[104:107]
v_exp_f32 v64,v64
v_mfma_f32_16x16x32_bf16 v[96:99],a[160:163],v[216:219],v[120:123]
v_exp_f32 v65,v65
v_mfma_f32_16x16x32_bf16 v[96:99],a[164:167],v[212:215],v[96:99]
buffer_load_dwordx4 v14,s[32:35],s58 offen offset:1024 nt lds
v_mfma_f32_16x16x32_bf16 v[88:91],a[164:167],v[196:199],v[116:119]
s_add_u32 m0,s85,102400
s_xor_b32 s58,s11,118784
v_mfma_f32_16x16x32_bf16 v[88:91],a[160:163],v[200:203],v[88:91]
v_exp_f32 v66,v66
v_mfma_f32_16x16x32_bf16 v[80:83],a[160:163],v[184:187],v[112:115]
s_cmp_eq_u32 s93,0
s_cbranch_scc0 L_noP12_0_o
L_noP12_0:
v_mfma_f32_16x16x32_bf16 v[80:83],a[164:167],v[180:183],v[80:83]
v_exp_f32 v67,v67
v_mfma_f32_16x16x32_bf16 v[144:147],a[164:167],v[128:131],v[152:155]
ds_read_b64_tr_b16 a[164:165],v26 offset:0
ds_read_b64_tr_b16 a[166:167],v26 offset:1024
v_mfma_f32_16x16x32_bf16 v[144:147],a[160:163],v[136:139],v[144:147]
v_exp_f32 v68,v68
v_mfma_f32_16x16x32_bf16 v[148:151],a[172:175],v[136:139],v[152:155]
buffer_load_dwordx4 v14,s[32:35],s58 offen nt lds
v_mfma_f32_16x16x32_bf16 v[148:151],a[168:171],v[128:131],v[148:151]
ds_read_b64_tr_b16 a[160:161],v27 offset:0
ds_read_b64_tr_b16 a[162:163],v27 offset:1024
v_mfma_f32_16x16x32_bf16 v[84:87],a[168:171],v[180:183],v[112:115]
v_exp_f32 v69,v69
v_mfma_f32_16x16x32_bf16 v[84:87],a[172:175],v[184:187],v[84:87]
v_exp_f32 v70,v70
v_mfma_f32_16x16x32_bf16 v[92:95],a[172:175],v[200:203],v[116:119]
v_exp_f32 v71,v71
v_mfma_f32_16x16x32_bf16 v[92:95],a[168:171],v[196:199],v[92:95]
v_cvt_pk_bf16_f32 v64,v64,v65
v_cvt_pk_bf16_f32 v65,v66,v67
v_mfma_f32_16x16x32_bf16 v[100:103],a[168:171],v[212:215],v[120:123]
v_cvt_pk_bf16_f32 v66,v68,v69
v_cvt_pk_bf16_f32 v67,v70,v71
v_mfma_f32_16x16x32_bf16 v[100:103],a[172:175],v[216:219],v[100:103]
buffer_load_dwordx4 v14,s[32:35],s58 offen offset:1024 nt lds
v_mfma_f32_16x16x32_bf16 v[108:111],a[172:175],v[232:235],v[124:127]
ds_read_b64_tr_b16 a[172:173],v28 offset:0
ds_read_b64_tr_b16 a[174:175],v28 offset:1024
v_mfma_f32_16x16x32_bf16 v[108:111],a[168:171],v[228:231],v[108:111]
s_add_u32 m0,s85,106496
s_xor_b32 s58,s11,94208
v_mfma_f32_16x16x32_bf16 v[104:107],a[180:183],v[236:239],v[104:107]
ds_read_b64_tr_b16 a[168:169],v29 offset:0
ds_read_b64_tr_b16 a[170:171],v29 offset:1024
v_mfma_f32_16x16x32_bf16 v[104:107],a[176:179],v[240:243],v[104:107]
v_exp_f32 v72,v72
v_mfma_f32_16x16x32_bf16 v[96:99],a[176:179],v[224:227],v[96:99]
v_exp_f32 v73,v73
v_mfma_f32_16x16x32_bf16 v[96:99],a[180:183],v[220:223],v[96:99]
v_exp_f32 v74,v74
v_mfma_f32_16x16x32_bf16 v[88:91],a[180:183],v[204:207],v[88:91]
buffer_load_dwordx4 v14,s[32:35],s58 offen nt lds
v_mfma_f32_16x16x32_bf16 v[88:91],a[176:179],v[208:211],v[88:91]
v_exp_f32 v75,v75
v_mfma_f32_16x16x32_bf16 v[80:83],a[176:179],v[192:195],v[80:83]
v_exp_f32 v76,v76
v_mfma_f32_16x16x32_bf16 v[80:83],a[180:183],v[188:191],v[80:83]
v_exp_f32 v77,v77
v_mfma_f32_16x16x32_bf16 v[144:147],a[180:183],v[132:135],v[144:147]
ds_read_b64_tr_b16 a[180:181],v30 offset:0
ds_read_b64_tr_b16 a[182:183],v30 offset:1024
v_mfma_f32_16x16x32_bf16 v[144:147],a[176:179],v[140:143],v[144:147]
v_exp_f32 v78,v78
v_mfma_f32_16x16x32_bf16 v[148:151],a[188:191],v[140:143],v[148:151]
v_exp_f32 v79,v79
v_mfma_f32_16x16x32_bf16 v[148:151],a[184:187],v[132:135],v[148:151]
buffer_load_dwordx4 v14,s[32:35],s58 offen offset:1024 nt lds
v_cvt_pk_bf16_f32 v72,v72,v73
v_mfma_f32_16x16x32_bf16 v[84:87],a[184:187],v[188:191],v[84:87]
s_add_u32 m0,s85,110592
s_xor_b32 s58,s11,126976
v_mfma_f32_16x16x32_bf16 v[84:87],a[188:191],v[192:195],v[84:87]
v_cvt_pk_bf16_f32 v73,v74,v75
v_cvt_pk_bf16_f32 v74,v76,v77
v_mfma_f32_16x16x32_bf16 v[92:95],a[188:191],v[208:211],v[92:95]
v_cvt_pk_bf16_f32 v75,v78,v79
v_mfma_f32_16x16x32_bf16 v[92:95],a[184:187],v[204:207],v[92:95]
v_mfma_f32_16x16x32_bf16 v[100:103],a[184:187],v[220:223],v[100:103]
v_mfma_f32_16x16x32_bf16 v[100:103],a[188:191],v[224:227],v[100:103]
v_mfma_f32_16x16x32_bf16 v[108:111],a[188:191],v[240:243],v[108:111]
buffer_load_dwordx4 v14,s[32:35],s58 offen nt lds
v_mfma_f32_16x16x32_bf16 v[108:111],a[184:187],v[236:239],v[108:111]
v_max3_f32 v1,v144,v145,v146
v_max3_f32 v1,v1,v147,v148
s_waitcnt lgkmcnt(0)
v_mfma_f32_16x16x32_bf16 a[0:3],a[192:195],v[48:51],a[0:3]
ds_read_b64_tr_b16 a[176:177],v31 offset:0
ds_read_b64_tr_b16 a[178:179],v31 offset:1024
v_mfma_f32_16x16x32_bf16 a[4:7],a[192:195],v[56:59],a[4:7]
v_max3_f32 v1,v1,v149,v150
v_max3_f32 v1,v1,v151,v80
v_mfma_f32_16x16x32_bf16 a[8:11],a[192:195],v[64:67],a[8:11]
v_max3_f32 v1,v1,v81,v82
v_max3_f32 v1,v1,v83,v88
v_mfma_f32_16x16x32_bf16 a[12:15],a[192:195],v[72:75],a[12:15]
v_max3_f32 v1,v1,v89,v90
v_max3_f32 v1,v1,v91,v96
v_mfma_f32_16x16x32_bf16 a[28:31],a[196:199],v[72:75],a[28:31]
v_max3_f32 v1,v1,v97,v98
v_max3_f32 v1,v1,v99,v104
v_mfma_f32_16x16x32_bf16 a[24:27],a[196:199],v[64:67],a[24:27]
buffer_load_dwordx4 v14,s[32:35],s58 offen offset:1024 nt lds
v_max3_f32 v1,v1,v105,v106
v_mfma_f32_16x16x32_bf16 a[20:23],a[196:199],v[56:59],a[20:23]
v_max3_f32 v1,v1,v107,v84
v_max3_f32 v1,v1,v85,v86
v_mfma_f32_16x16x32_bf16 a[16:19],a[196:199],v[48:51],a[16:19]
v_max3_f32 v1,v1,v87,v92
v_max3_f32 v1,v1,v93,v94
v_mfma_f32_16x16x32_bf16 v[156:159],v[176:179],v[48:51],v[156:159]
v_max3_f32 v1,v1,v95,v100
v_max3_f32 v1,v1,v101,v102
v_mfma_f32_16x16x32_bf16 a[32:35],a[164:167],v[48:51],a[32:35]
v_max3_f32 v1,v1,v103,v108
v_max3_f32 v1,v1,v109,v110
v_mfma_f32_16x16x32_bf16 a[36:39],a[164:167],v[56:59],a[36:39]
v_max_f32 v1,v1,v111
v_cmp_lt_f32 vcc,0x41000000,v1
v_mfma_f32_16x16x32_bf16 a[40:43],a[164:167],v[64:67],a[40:43]
v_mfma_f32_16x16x32_bf16 a[44:47],a[164:167],v[72:75],a[44:47]
s_cbranch_vccnz L_noA13_0_o
L_noA13_0:
v_mfma_f32_16x16x32_bf16 v[160:163],v[176:179],v[56:59],v[160:163]
v_exp_f32 v80,v80
v_mfma_f32_16x16x32_bf16 a[60:63],a[160:163],v[72:75],a[60:63]
v_exp_f32 v81,v81
v_mfma_f32_16x16x32_bf16 a[56:59],a[160:163],v[64:67],a[56:59]
v_exp_f32 v82,v82
v_mfma_f32_16x16x32_bf16 a[52:55],a[160:163],v[56:59],a[52:55]
v_exp_f32 v83,v83
v_mfma_f32_16x16x32_bf16 a[48:51],a[160:163],v[48:51],a[48:51]
v_exp_f32 v84,v84
v_mfma_f32_16x16x32_bf16 v[164:167],v[176:179],v[64:67],v[164:167]
v_exp_f32 v85,v85
v_mfma_f32_16x16x32_bf16 a[64:67],a[172:175],v[48:51],a[64:67]
s_waitcnt vmcnt(8) lgkmcnt(0)
s_barrier
v_mfma_f32_16x16x32_bf16 a[68:71],a[172:175],v[56:59],a[68:71]
s_add_u32 m0,s85,0
s_xor_b32 s58,s11,2097152
v_mfma_f32_16x16x32_bf16 a[72:75],a[172:175],v[64:67],a[72:75]
buffer_load_dwordx4 v12,s[28:31],s58 offen nt lds
v_mfma_f32_16x16x32_bf16 a[76:79],a[172:175],v[72:75],a[76:79]
ds_read_b128 a[188:191],v40 offset:32768
ds_read_b128 a[184:187],v41 offset:32768
v_mfma_f32_16x16x32_bf16 v[168:171],v[176:179],v[72:75],v[168:171]
ds_read_b128 a[192:195],v40 offset:33792
v_mfma_f32_16x16x32_bf16 a[92:95],a[168:171],v[72:75],a[92:95]
ds_read_b128 a[196:199],v41 offset:33792
ds_read_b128 a[164:167],v42 offset:32768
v_mfma_f32_16x16x32_bf16 a[88:91],a[168:171],v[64:67],a[88:91]
ds_read_b128 a[160:163],v43 offset:32768
v_mfma_f32_16x16x32_bf16 a[84:87],a[168:171],v[56:59],a[84:87]
ds_read_b128 a[172:175],v42 offset:33792
v_mfma_f32_16x16x32_bf16 a[80:83],a[168:171],v[48:51],a[80:83]
ds_read_b128 a[168:171],v43 offset:33792
v_mfma_f32_16x16x32_bf16 a[96:99],a[180:183],v[48:51],a[96:99]
buffer_load_dwordx4 v12,s[28:31],s58 offen offset:1024 nt lds
v_mfma_f32_16x16x32_bf16 a[100:103],a[180:183],v[56:59],a[100:103]
s_add_u32 m0,s85,4096
s_xor_b32 s58,s11,2129920
v_mfma_f32_16x16x32_bf16 a[104:107],a[180:183],v[64:67],a[104:107]
v_exp_f32 v86,v86
v_mfma_f32_16x16x32_bf16 a[108:111],a[180:183],v[72:75],a[108:111]
ds_read_b64_tr_b16 a[180:181],v32 offset:0
ds_read_b64_tr_b16 a[182:183],v32 offset:1024
v_mfma_f32_16x16x32_bf16 a[124:127],a[176:179],v[72:75],a[124:127]
v_exp_f32 v87,v87
v_mfma_f32_16x16x32_bf16 a[120:123],a[176:179],v[64:67],a[120:123]
v_cvt_pk_bf16_f32 v80,v80,v81
v_cvt_pk_bf16_f32 v81,v82,v83
v_mfma_f32_16x16x32_bf16 a[116:119],a[176:179],v[56:59],a[116:119]
v_cvt_pk_bf16_f32 v82,v84,v85
v_cvt_pk_bf16_f32 v83,v86,v87
v_mfma_f32_16x16x32_bf16 a[112:115],a[176:179],v[48:51],a[112:115]
buffer_load_dwordx4 v13,s[28:31],s58 offen nt lds
s_waitcnt lgkmcnt(0)
v_mfma_f32_16x16x32_bf16 v[72:75],a[188:191],v[228:231],v[124:127]
ds_read_b64_tr_b16 a[176:177],v33 offset:0
ds_read_b64_tr_b16 a[178:179],v33 offset:1024
v_mfma_f32_16x16x32_bf16 v[72:75],a[184:187],v[232:235],v[72:75]
v_exp_f32 v88,v88
v_mfma_f32_16x16x32_bf16 v[64:67],a[184:187],v[216:219],v[120:123]
v_exp_f32 v89,v89
v_mfma_f32_16x16x32_bf16 v[64:67],a[188:191],v[212:215],v[64:67]
v_exp_f32 v90,v90
v_mfma_f32_16x16x32_bf16 v[56:59],a[188:191],v[196:199],v[116:119]
s_cmp_eq_u32 s93,0
s_cbranch_scc0 L_noP13_0_o
L_noP13_0:
v_mfma_f32_16x16x32_bf16 v[56:59],a[184:187],v[200:203],v[56:59]
v_exp_f32 v91,v91
v_mfma_f32_16x16x32_bf16 v[48:51],a[184:187],v[184:187],v[112:115]
buffer_load_dwordx4 v13,s[28:31],s58 offen offset:1024 nt lds
v_mfma_f32_16x16x32_bf16 v[48:51],a[188:191],v[180:183],v[48:51]
ds_read_b64_tr_b16 a[184:185],v34 offset:0
ds_read_b64_tr_b16 a[186:187],v34 offset:1024
v_mfma_f32_16x16x32_bf16 v[52:55],a[192:195],v[180:183],v[112:115]
s_add_u32 m0,s85,8192
s_xor_b32 s58,s11,2105344
v_mfma_f32_16x16x32_bf16 v[52:55],a[196:199],v[184:187],v[52:55]
ds_read_b64_tr_b16 a[188:189],v35 offset:0
ds_read_b64_tr_b16 a[190:191],v35 offset:1024
v_mfma_f32_16x16x32_bf16 v[60:63],a[196:199],v[200:203],v[116:119]
v_exp_f32 v92,v92
v_mfma_f32_16x16x32_bf16 v[60:63],a[192:195],v[196:199],v[60:63]
v_exp_f32 v93,v93
v_mfma_f32_16x16x32_bf16 v[68:71],a[192:195],v[212:215],v[120:123]
v_exp_f32 v94,v94
v_mfma_f32_16x16x32_bf16 v[68:71],a[196:199],v[216:219],v[68:71]
buffer_load_dwordx4 v12,s[28:31],s58 offen nt lds
v_mfma_f32_16x16x32_bf16 v[76:79],a[196:199],v[232:235],v[124:127]
ds_read_b64_tr_b16 a[196:197],v36 offset:0
ds_read_b64_tr_b16 a[198:199],v36 offset:1024
v_mfma_f32_16x16x32_bf16 v[76:79],a[192:195],v[228:231],v[76:79]
v_exp_f32 v95,v95
v_mfma_f32_16x16x32_bf16 v[72:75],a[164:167],v[236:239],v[72:75]
ds_read_b64_tr_b16 a[192:193],v37 offset:0
ds_read_b64_tr_b16 a[194:195],v37 offset:1024
v_mfma_f32_16x16x32_bf16 v[72:75],a[160:163],v[240:243],v[72:75]
v_cvt_pk_bf16_f32 v88,v88,v89
v_cvt_pk_bf16_f32 v89,v90,v91
v_mfma_f32_16x16x32_bf16 v[64:67],a[160:163],v[224:227],v[64:67]
v_cvt_pk_bf16_f32 v90,v92,v93
v_cvt_pk_bf16_f32 v91,v94,v95
v_mfma_f32_16x16x32_bf16 v[64:67],a[164:167],v[220:223],v[64:67]
v_exp_f32 v96,v96
v_mfma_f32_16x16x32_bf16 v[56:59],a[164:167],v[204:207],v[56:59]
buffer_load_dwordx4 v12,s[28:31],s58 offen offset:1024 nt lds
v_mfma_f32_16x16x32_bf16 v[56:59],a[160:163],v[208:211],v[56:59]
s_add_u32 m0,s85,12288
s_xor_b32 s58,s11,2138112
v_mfma_f32_16x16x32_bf16 v[48:51],a[160:163],v[192:195],v[48:51]
ds_read_b64_tr_b16 a[160:161],v38 offset:0
ds_read_b64_tr_b16 a[162:163],v38 offset:1024
v_mfma_f32_16x16x32_bf16 v[48:51],a[164:167],v[188:191],v[48:51]
v_exp_f32 v97,v97
v_mfma_f32_16x16x32_bf16 v[52:55],a[172:175],v[188:191],v[52:55]
ds_read_b64_tr_b16 a[164:165],v39 offset:0
ds_read_b64_tr_b16 a[166:167],v39 offset:1024
v_mfma_f32_16x16x32_bf16 v[52:55],a[168:171],v[192:195],v[52:55]
v_exp_f32 v98,v98
v_mfma_f32_16x16x32_bf16 v[60:63],a[168:171],v[208:211],v[60:63]
v_exp_f32 v99,v99
v_mfma_f32_16x16x32_bf16 v[60:63],a[172:175],v[204:207],v[60:63]
buffer_load_dwordx4 v13,s[28:31],s58 offen nt lds
v_mfma_f32_16x16x32_bf16 v[68:71],a[172:175],v[220:223],v[68:71]
v_exp_f32 v100,v100
v_mfma_f32_16x16x32_bf16 v[68:71],a[168:171],v[224:227],v[68:71]
v_exp_f32 v101,v101
v_mfma_f32_16x16x32_bf16 v[76:79],a[168:171],v[240:243],v[76:79]
v_exp_f32 v102,v102
v_mfma_f32_16x16x32_bf16 v[76:79],a[172:175],v[236:239],v[76:79]
v_exp_f32 v103,v103
v_mfma_f32_16x16x32_bf16 a[0:3],a[180:183],v[80:83],a[0:3]
v_cvt_pk_bf16_f32 v96,v96,v97
v_cvt_pk_bf16_f32 v97,v98,v99
v_mfma_f32_16x16x32_bf16 a[4:7],a[180:183],v[88:91],a[4:7]
v_cvt_pk_bf16_f32 v98,v100,v101
v_cvt_pk_bf16_f32 v99,v102,v103
s_nop 1
v_mfma_f32_16x16x32_bf16 a[8:11],a[180:183],v[96:99],a[8:11]
buffer_load_dwordx4 v13,s[28:31],s58 offen offset:1024 nt lds
v_exp_f32 v104,v104
v_exp_f32 v105,v105
v_exp_f32 v106,v106
v_exp_f32 v107,v107
v_exp_f32 v108,v108
v_exp_f32 v109,v109
v_exp_f32 v110,v110
v_exp_f32 v111,v111
v_cvt_pk_bf16_f32 v104,v104,v105
v_cvt_pk_bf16_f32 v105,v106,v107
v_cvt_pk_bf16_f32 v106,v108,v109
v_cvt_pk_bf16_f32 v107,v110,v111
s_nop 1
v_mfma_f32_16x16x32_bf16 a[12:15],a[180:183],v[104:107],a[12:15]
v_exp_f32 v144,v144
v_exp_f32 v145,v145
v_exp_f32 v146,v146
v_exp_f32 v147,v147
v_exp_f32 v148,v148
v_exp_f32 v149,v149
v_exp_f32 v150,v150
v_exp_f32 v151,v151
v_cvt_pk_bf16_f32 v144,v144,v145
v_cvt_pk_bf16_f32 v145,v146,v147
v_cvt_pk_bf16_f32 v146,v148,v149
v_cvt_pk_bf16_f32 v147,v150,v151
s_nop 1
v_mfma_f32_16x16x32_bf16 a[128:131],a[180:183],v[144:147],a[128:131]
v_max3_f32 v1,v48,v49,v50
v_max3_f32 v1,v1,v51,v56
s_waitcnt lgkmcnt(0)
v_mfma_f32_16x16x32_bf16 a[132:135],a[176:179],v[144:147],a[132:135]
ds_read_b128 a[168:171],v44 offset:32768
ds_read_b128 a[172:175],v45 offset:32768
v_mfma_f32_16x16x32_bf16 a[28:31],a[176:179],v[104:107],a[28:31]
ds_read_b128 a[180:183],v45 offset:33792
v_max3_f32 v1,v1,v57,v58
v_mfma_f32_16x16x32_bf16 a[24:27],a[176:179],v[96:99],a[24:27]
v_max3_f32 v1,v1,v59,v64
v_max3_f32 v1,v1,v65,v66
v_mfma_f32_16x16x32_bf16 a[20:23],a[176:179],v[88:91],a[20:23]
v_max3_f32 v1,v1,v67,v72
v_max3_f32 v1,v1,v73,v74
v_mfma_f32_16x16x32_bf16 a[16:19],a[176:179],v[80:83],a[16:19]
ds_read_b128 a[176:179],v44 offset:33792
v_max3_f32 v1,v1,v75,v52
v_mfma_f32_16x16x32_bf16 v[156:159],v[176:179],v[80:83],v[156:159]
v_max3_f32 v1,v1,v53,v54
v_max3_f32 v1,v1,v55,v60
v_mfma_f32_16x16x32_bf16 a[32:35],a[184:187],v[80:83],a[32:35]
v_max3_f32 v1,v1,v61,v62
v_max3_f32 v1,v1,v63,v68
v_mfma_f32_16x16x32_bf16 a[36:39],a[184:187],v[88:91],a[36:39]
v_max3_f32 v1,v1,v69,v70
v_max3_f32 v1,v1,v71,v76
v_mfma_f32_16x16x32_bf16 a[40:43],a[184:187],v[96:99],a[40:43]
v_max3_f32 v1,v1,v77,v78
v_max_f32 v1,v1,v79
v_mfma_f32_16x16x32_bf16 a[44:47],a[184:187],v[104:107],a[44:47]
v_cmp_lt_f32 vcc,0x41000000,v1
v_mfma_f32_16x16x32_bf16 a[136:139],a[184:187],v[144:147],a[136:139]
ds_read_b128 a[184:187],v46 offset:32768
v_mfma_f32_16x16x32_bf16 v[160:163],v[176:179],v[88:91],v[160:163]
v_mfma_f32_16x16x32_bf16 a[140:143],a[188:191],v[144:147],a[140:143]
s_cbranch_vccnz L_noA14_0_o
L_noA14_0:
v_mfma_f32_16x16x32_bf16 a[60:63],a[188:191],v[104:107],a[60:63]
v_exp_f32 v48,v48
v_mfma_f32_16x16x32_bf16 a[56:59],a[188:191],v[96:99],a[56:59]
v_exp_f32 v49,v49
v_mfma_f32_16x16x32_bf16 a[52:55],a[188:191],v[88:91],a[52:55]
v_exp_f32 v50,v50
v_mfma_f32_16x16x32_bf16 a[48:51],a[188:191],v[80:83],a[48:51]
ds_read_b128 a[188:191],v47 offset:32768
v_mfma_f32_16x16x32_bf16 v[164:167],v[176:179],v[96:99],v[164:167]
v_exp_f32 v51,v51
v_mfma_f32_16x16x32_bf16 a[64:67],a[196:199],v[80:83],a[64:67]
v_exp_f32 v52,v52
v_mfma_f32_16x16x32_bf16 a[68:71],a[196:199],v[88:91],a[68:71]
v_exp_f32 v53,v53
v_mfma_f32_16x16x32_bf16 a[72:75],a[196:199],v[96:99],a[72:75]
v_exp_f32 v54,v54
v_mfma_f32_16x16x32_bf16 a[76:79],a[196:199],v[104:107],a[76:79]
v_exp_f32 v55,v55
v_mfma_f32_16x16x32_bf16 a[144:147],a[196:199],v[144:147],a[144:147]
ds_read_b128 a[196:199],v47 offset:33792
v_cvt_pk_bf16_f32 v48,v48,v49
v_mfma_f32_16x16x32_bf16 v[168:171],v[176:179],v[104:107],v[168:171]
v_cvt_pk_bf16_f32 v49,v50,v51
v_cvt_pk_bf16_f32 v50,v52,v53
v_mfma_f32_16x16x32_bf16 a[148:151],a[192:195],v[144:147],a[148:151]
v_cvt_pk_bf16_f32 v51,v54,v55
v_mfma_f32_16x16x32_bf16 a[92:95],a[192:195],v[104:107],a[92:95]
v_exp_f32 v56,v56
v_mfma_f32_16x16x32_bf16 a[88:91],a[192:195],v[96:99],a[88:91]
v_exp_f32 v57,v57
v_mfma_f32_16x16x32_bf16 a[84:87],a[192:195],v[88:91],a[84:87]
v_exp_f32 v58,v58
v_mfma_f32_16x16x32_bf16 a[80:83],a[192:195],v[80:83],a[80:83]
ds_read_b128 a[192:195],v46 offset:33792
v_mfma_f32_16x16x32_bf16 v[172:175],v[176:179],v[144:147],v[172:175]
v_exp_f32 v59,v59
v_mfma_f32_16x16x32_bf16 a[96:99],a[160:163],v[80:83],a[96:99]
v_exp_f32 v60,v60
v_mfma_f32_16x16x32_bf16 a[100:103],a[160:163],v[88:91],a[100:103]
v_exp_f32 v61,v61
v_mfma_f32_16x16x32_bf16 a[104:107],a[160:163],v[96:99],a[104:107]
v_exp_f32 v62,v62
v_mfma_f32_16x16x32_bf16 a[108:111],a[160:163],v[104:107],a[108:111]
v_exp_f32 v63,v63
v_mfma_f32_16x16x32_bf16 a[152:155],a[160:163],v[144:147],a[152:155]
s_waitcnt vmcnt(8) lgkmcnt(0)
s_barrier
s_bitcmp1_b32 s2,3
s_cbranch_scc1 L_endv
s_waitcnt vmcnt(0)
L_endv:
v_mfma_f32_16x16x32_bf16 a[156:159],a[164:167],v[144:147],a[156:159]
s_sub_u32 s92,s92,1048576
s_cselect_b32 s59,5242880,0
s_add_u32 s92,s92,s59
v_mfma_f32_16x16x32_bf16 a[124:127],a[164:167],v[104:107],a[124:127]
s_add_u32 m0,s101,65536
s_add_u32 s58,s92,4096
v_mfma_f32_16x16x32_bf16 a[120:123],a[164:167],v[96:99],a[120:123]
buffer_load_dwordx4 v15,s[24:27],s58 offen lds
v_cvt_pk_bf16_f32 v56,v56,v57
v_mfma_f32_16x16x32_bf16 a[116:119],a[164:167],v[88:91],a[116:119]
ds_read_b64_tr_b16 a[160:161],v24 offset:32768
ds_read_b64_tr_b16 a[162:163],v24 offset:33792
v_mfma_f32_16x16x32_bf16 a[112:115],a[164:167],v[80:83],a[112:115]
s_add_u32 m0,s101,67584
s_add_u32 s58,s92,135168
v_mfma_f32_16x16x32_bf16 v[104:107],a[168:171],v[228:231],v[124:127]
ds_read_b64_tr_b16 a[164:165],v25 offset:32768
ds_read_b64_tr_b16 a[166:167],v25 offset:33792
v_mfma_f32_16x16x32_bf16 v[104:107],a[172:175],v[232:235],v[104:107]
v_cvt_pk_bf16_f32 v57,v58,v59
v_cvt_pk_bf16_f32 v58,v60,v61
v_mfma_f32_16x16x32_bf16 v[96:99],a[172:175],v[216:219],v[120:123]
v_cvt_pk_bf16_f32 v59,v62,v63
v_mfma_f32_16x16x32_bf16 v[96:99],a[168:171],v[212:215],v[96:99]
v_exp_f32 v64,v64
v_mfma_f32_16x16x32_bf16 v[88:91],a[168:171],v[196:199],v[116:119]
buffer_load_dwordx4 v15,s[24:27],s58 offen lds
v_mfma_f32_16x16x32_bf16 v[88:91],a[172:175],v[200:203],v[88:91]
s_add_u32 m0,s101,69632
s_add_u32 s58,s92,266240
v_mfma_f32_16x16x32_bf16 v[80:83],a[172:175],v[184:187],v[112:115]
s_cmp_eq_u32 s93,0
s_cbranch_scc0 L_noP14_0_o
L_noP14_0:
v_mfma_f32_16x16x32_bf16 v[80:83],a[168:171],v[180:183],v[80:83]
v_exp_f32 v65,v65
v_mfma_f32_16x16x32_bf16 v[144:147],a[168:171],v[128:131],v[152:155]
ds_read_b64_tr_b16 a[168:169],v26 offset:32768
ds_read_b64_tr_b16 a[170:171],v26 offset:33792
v_mfma_f32_16x16x32_bf16 v[144:147],a[172:175],v[136:139],v[144:147]
v_exp_f32 v66,v66
v_mfma_f32_16x16x32_bf16 v[148:151],a[180:183],v[136:139],v[152:155]
ds_read_b64_tr_b16 a[172:173],v27 offset:32768
ds_read_b64_tr_b16 a[174:175],v27 offset:33792
v_mfma_f32_16x16x32_bf16 v[148:151],a[176:179],v[128:131],v[148:151]
buffer_load_dwordx4 v15,s[24:27],s58 offen lds
v_mfma_f32_16x16x32_bf16 v[84:87],a[176:179],v[180:183],v[112:115]
s_add_u32 m0,s101,71680
s_add_u32 s58,s92,397312
v_mfma_f32_16x16x32_bf16 v[84:87],a[180:183],v[184:187],v[84:87]
v_exp_f32 v67,v67
v_mfma_f32_16x16x32_bf16 v[92:95],a[180:183],v[200:203],v[116:119]
v_exp_f32 v68,v68
v_mfma_f32_16x16x32_bf16 v[92:95],a[176:179],v[196:199],v[92:95]
v_exp_f32 v69,v69
v_mfma_f32_16x16x32_bf16 v[100:103],a[176:179],v[212:215],v[120:123]
v_exp_f32 v70,v70
v_mfma_f32_16x16x32_bf16 v[100:103],a[180:183],v[216:219],v[100:103]
v_exp_f32 v71,v71
v_mfma_f32_16x16x32_bf16 v[108:111],a[180:183],v[232:235],v[124:127]
buffer_load_dwordx4 v15,s[24:27],s58 offen lds
v_cvt_pk_bf16_f32 v64,v64,v65
v_mfma_f32_16x16x32_bf16 v[108:111],a[176:179],v[228:231],v[108:111]
ds_read_b64_tr_b16 a[180:181],v28 offset:32768
ds_read_b64_tr_b16 a[182:183],v28 offset:33792
v_mfma_f32_16x16x32_bf16 v[104:107],a[184:187],v[236:239],v[104:107]
s_add_u32 m0,s101,73728
s_add_u32 s58,s92,4224
v_mfma_f32_16x16x32_bf16 v[104:107],a[188:191],v[240:243],v[104:107]
ds_read_b64_tr_b16 a[176:177],v29 offset:32768
ds_read_b64_tr_b16 a[178:179],v29 offset:33792
v_mfma_f32_16x16x32_bf16 v[96:99],a[188:191],v[224:227],v[96:99]
v_cvt_pk_bf16_f32 v65,v66,v67
v_cvt_pk_bf16_f32 v66,v68,v69
v_mfma_f32_16x16x32_bf16 v[96:99],a[184:187],v[220:223],v[96:99]
v_cvt_pk_bf16_f32 v67,v70,v71
v_mfma_f32_16x16x32_bf16 v[88:91],a[184:187],v[204:207],v[88:91]
v_exp_f32 v72,v72
v_mfma_f32_16x16x32_bf16 v[88:91],a[188:191],v[208:211],v[88:91]
buffer_load_dwordx4 v15,s[24:27],s58 offen lds
v_mfma_f32_16x16x32_bf16 v[80:83],a[188:191],v[192:195],v[80:83]
s_add_u32 m0,s101,75776
s_add_u32 s58,s92,135296
v_mfma_f32_16x16x32_bf16 v[80:83],a[184:187],v[188:191],v[80:83]
v_exp_f32 v73,v73
v_mfma_f32_16x16x32_bf16 v[144:147],a[184:187],v[132:135],v[144:147]
ds_read_b64_tr_b16 a[184:185],v30 offset:32768
ds_read_b64_tr_b16 a[186:187],v30 offset:33792
v_mfma_f32_16x16x32_bf16 v[144:147],a[188:191],v[140:143],v[144:147]
v_exp_f32 v74,v74
v_mfma_f32_16x16x32_bf16 v[148:151],a[196:199],v[140:143],v[148:151]
v_exp_f32 v75,v75
v_mfma_f32_16x16x32_bf16 v[148:151],a[192:195],v[132:135],v[148:151]
v_exp_f32 v76,v76
v_mfma_f32_16x16x32_bf16 v[84:87],a[192:195],v[188:191],v[84:87]
buffer_load_dwordx4 v15,s[24:27],s58 offen lds
v_mfma_f32_16x16x32_bf16 v[84:87],a[196:199],v[192:195],v[84:87]
s_add_u32 m0,s101,77824
s_add_u32 s58,s92,266368
v_mfma_f32_16x16x32_bf16 v[92:95],a[196:199],v[208:211],v[92:95]
v_exp_f32 v77,v77
v_mfma_f32_16x16x32_bf16 v[92:95],a[192:195],v[204:207],v[92:95]
v_exp_f32 v78,v78
v_mfma_f32_16x16x32_bf16 v[100:103],a[192:195],v[220:223],v[100:103]
v_exp_f32 v79,v79
v_mfma_f32_16x16x32_bf16 v[100:103],a[196:199],v[224:227],v[100:103]
v_cvt_pk_bf16_f32 v72,v72,v73
v_cvt_pk_bf16_f32 v73,v74,v75
v_mfma_f32_16x16x32_bf16 v[108:111],a[196:199],v[240:243],v[108:111]
v_cvt_pk_bf16_f32 v74,v76,v77
v_cvt_pk_bf16_f32 v75,v78,v79
v_mfma_f32_16x16x32_bf16 v[108:111],a[192:195],v[236:239],v[108:111]
buffer_load_dwordx4 v15,s[24:27],s58 offen lds
v_max3_f32 v1,v144,v145,v146
s_waitcnt lgkmcnt(0)
v_mfma_f32_16x16x32_bf16 a[0:3],a[160:163],v[48:51],a[0:3]
ds_read_b64_tr_b16 a[188:189],v31 offset:32768
ds_read_b64_tr_b16 a[190:191],v31 offset:33792
v_mfma_f32_16x16x32_bf16 a[4:7],a[160:163],v[56:59],a[4:7]
s_add_u32 m0,s101,79872
s_add_u32 s58,s92,397440
v_mfma_f32_16x16x32_bf16 a[8:11],a[160:163],v[64:67],a[8:11]
ds_read_b64_tr_b16 a[196:197],v32 offset:32768
ds_read_b64_tr_b16 a[198:199],v32 offset:33792
v_mfma_f32_16x16x32_bf16 a[12:15],a[160:163],v[72:75],a[12:15]
v_max3_f32 v1,v1,v147,v148
v_max3_f32 v1,v1,v149,v150
v_mfma_f32_16x16x32_bf16 a[28:31],a[164:167],v[72:75],a[28:31]
ds_read_b64_tr_b16 a[192:193],v33 offset:32768
ds_read_b64_tr_b16 a[194:195],v33 offset:33792
v_mfma_f32_16x16x32_bf16 a[24:27],a[164:167],v[64:67],a[24:27]
v_max3_f32 v1,v1,v151,v80
v_max3_f32 v1,v1,v81,v82
v_mfma_f32_16x16x32_bf16 a[20:23],a[164:167],v[56:59],a[20:23]
buffer_load_dwordx4 v15,s[24:27],s58 offen lds
v_max3_f32 v1,v1,v83,v88
v_mfma_f32_16x16x32_bf16 a[16:19],a[164:167],v[48:51],a[16:19]
ds_read_b64_tr_b16 a[160:161],v34 offset:32768
ds_read_b64_tr_b16 a[162:163],v34 offset:33792
v_mfma_f32_16x16x32_bf16 v[156:159],v[176:179],v[48:51],v[156:159]
s_add_u32 s92,s92,524288
v_max3_f32 v1,v1,v89,v90
v_mfma_f32_16x16x32_bf16 a[32:35],a[168:171],v[48:51],a[32:35]
ds_read_b64_tr_b16 a[164:165],v35 offset:32768
ds_read_b64_tr_b16 a[166:167],v35 offset:33792
v_mfma_f32_16x16x32_bf16 a[36:39],a[168:171],v[56:59],a[36:39]
s_cmp_eq_u32 s92,5242880
s_cselect_b32 s92,0,s92
v_mfma_f32_16x16x32_bf16 a[40:43],a[168:171],v[64:67],a[40:43]
v_max3_f32 v1,v1,v91,v96
v_max3_f32 v1,v1,v97,v98
v_mfma_f32_16x16x32_bf16 a[44:47],a[168:171],v[72:75],a[44:47]
ds_read_b64_tr_b16 a[168:169],v36 offset:32768
ds_read_b64_tr_b16 a[170:171],v36 offset:33792
v_mfma_f32_16x16x32_bf16 v[160:163],v[176:179],v[56:59],v[160:163]
v_max3_f32 v1,v1,v99,v104
v_max3_f32 v1,v1,v105,v106
v_mfma_f32_16x16x32_bf16 a[60:63],a[172:175],v[72:75],a[60:63]
v_max3_f32 v1,v1,v107,v84
v_max3_f32 v1,v1,v85,v86
v_mfma_f32_16x16x32_bf16 a[56:59],a[172:175],v[64:67],a[56:59]
v_max3_f32 v1,v1,v87,v92
v_max3_f32 v1,v1,v93,v94
v_mfma_f32_16x16x32_bf16 a[52:55],a[172:175],v[56:59],a[52:55]
v_max3_f32 v1,v1,v95,v100
v_max3_f32 v1,v1,v101,v102
v_mfma_f32_16x16x32_bf16 a[48:51],a[172:175],v[48:51],a[48:51]
ds_read_b64_tr_b16 a[172:173],v37 offset:32768
ds_read_b64_tr_b16 a[174:175],v37 offset:33792
v_mfma_f32_16x16x32_bf16 v[164:167],v[176:179],v[64:67],v[164:167]
v_max3_f32 v1,v1,v103,v108
v_max3_f32 v1,v1,v109,v110
v_mfma_f32_16x16x32_bf16 a[64:67],a[180:183],v[48:51],a[64:67]
v_max_f32 v1,v1,v111
v_cmp_lt_f32 vcc,0x41000000,v1
v_mfma_f32_16x16x32_bf16 a[68:71],a[180:183],v[56:59],a[68:71]
v_mfma_f32_16x16x32_bf16 a[72:75],a[180:183],v[64:67],a[72:75]
s_cbranch_vccnz L_noA15_0_o
L_noA15_0:
v_mfma_f32_16x16x32_bf16 a[76:79],a[180:183],v[72:75],a[76:79]
v_exp_f32 v80,v80
v_mfma_f32_16x16x32_bf16 v[168:171],v[176:179],v[72:75],v[168:171]
v_exp_f32 v81,v81
v_mfma_f32_16x16x32_bf16 a[92:95],a[176:179],v[72:75],a[92:95]
v_exp_f32 v82,v82
v_mfma_f32_16x16x32_bf16 a[88:91],a[176:179],v[64:67],a[88:91]
v_exp_f32 v83,v83
v_mfma_f32_16x16x32_bf16 a[84:87],a[176:179],v[56:59],a[84:87]
v_exp_f32 v84,v84
v_mfma_f32_16x16x32_bf16 a[80:83],a[176:179],v[48:51],a[80:83]
v_exp_f32 v85,v85
v_mfma_f32_16x16x32_bf16 a[96:99],a[184:187],v[48:51],a[96:99]
v_exp_f32 v86,v86
v_mfma_f32_16x16x32_bf16 a[100:103],a[184:187],v[56:59],a[100:103]
v_exp_f32 v87,v87
v_mfma_f32_16x16x32_bf16 a[104:107],a[184:187],v[64:67],a[104:107]
v_cvt_pk_bf16_f32 v80,v80,v81
v_cvt_pk_bf16_f32 v81,v82,v83
v_mfma_f32_16x16x32_bf16 a[108:111],a[184:187],v[72:75],a[108:111]
v_cvt_pk_bf16_f32 v82,v84,v85
v_cvt_pk_bf16_f32 v83,v86,v87
s_waitcnt lgkmcnt(0)
v_mfma_f32_16x16x32_bf16 a[124:127],a[188:191],v[72:75],a[124:127]
ds_read_b64_tr_b16 a[180:181],v38 offset:32768
ds_read_b64_tr_b16 a[182:183],v38 offset:33792
v_mfma_f32_16x16x32_bf16 a[120:123],a[188:191],v[64:67],a[120:123]
v_exp_f32 v144,v144
v_mfma_f32_16x16x32_bf16 a[116:119],a[188:191],v[56:59],a[116:119]
ds_read_b64_tr_b16 a[176:177],v39 offset:32768
ds_read_b64_tr_b16 a[178:179],v39 offset:33792
v_mfma_f32_16x16x32_bf16 a[112:115],a[188:191],v[48:51],a[112:115]
v_exp_f32 v145,v145
s_nop 1
s_cmp_eq_u32 s93,0
s_cbranch_scc0 L_noP15_0_o
L_noP15_0:
v_mfma_f32_16x16x32_bf16 v[156:159],v[176:179],v[80:83],v[156:159]
v_exp_f32 v146,v146
v_mfma_f32_16x16x32_bf16 a[0:3],a[196:199],v[80:83],a[0:3]
v_exp_f32 v147,v147
v_mfma_f32_16x16x32_bf16 a[16:19],a[192:195],v[80:83],a[16:19]
v_exp_f32 v148,v148
v_mfma_f32_16x16x32_bf16 a[32:35],a[160:163],v[80:83],a[32:35]
v_exp_f32 v149,v149
v_mfma_f32_16x16x32_bf16 a[48:51],a[164:167],v[80:83],a[48:51]
v_exp_f32 v150,v150
v_mfma_f32_16x16x32_bf16 a[64:67],a[168:171],v[80:83],a[64:67]
v_exp_f32 v151,v151
v_mfma_f32_16x16x32_bf16 a[80:83],a[172:175],v[80:83],a[80:83]
v_cvt_pk_bf16_f32 v144,v144,v145
v_cvt_pk_bf16_f32 v145,v146,v147
s_waitcnt lgkmcnt(0)
v_mfma_f32_16x16x32_bf16 a[96:99],a[180:183],v[80:83],a[96:99]
v_cvt_pk_bf16_f32 v146,v148,v149
v_cvt_pk_bf16_f32 v147,v150,v151
v_mfma_f32_16x16x32_bf16 a[112:115],a[176:179],v[80:83],a[112:115]
v_exp_f32 v88,v88
v_mfma_f32_16x16x32_bf16 v[172:175],v[176:179],v[144:147],v[172:175]
v_exp_f32 v89,v89
v_mfma_f32_16x16x32_bf16 a[144:147],a[168:171],v[144:147],a[144:147]
v_exp_f32 v90,v90
v_mfma_f32_16x16x32_bf16 a[148:151],a[172:175],v[144:147],a[148:151]
v_exp_f32 v91,v91
v_mfma_f32_16x16x32_bf16 a[152:155],a[180:183],v[144:147],a[152:155]
v_exp_f32 v92,v92
v_mfma_f32_16x16x32_bf16 a[156:159],a[176:179],v[144:147],a[156:159]
v_exp_f32 v93,v93
v_mfma_f32_16x16x32_bf16 a[128:131],a[196:199],v[144:147],a[128:131]
v_exp_f32 v94,v94
v_mfma_f32_16x16x32_bf16 a[132:135],a[192:195],v[144:147],a[132:135]
v_exp_f32 v95,v95
v_mfma_f32_16x16x32_bf16 a[136:139],a[160:163],v[144:147],a[136:139]
v_cvt_pk_bf16_f32 v88,v88,v89
v_cvt_pk_bf16_f32 v89,v90,v91
v_mfma_f32_16x16x32_bf16 a[140:143],a[164:167],v[144:147],a[140:143]
v_cvt_pk_bf16_f32 v90,v92,v93
v_cvt_pk_bf16_f32 v91,v94,v95
s_nop 1
v_mfma_f32_16x16x32_bf16 v[160:163],v[176:179],v[88:91],v[160:163]
v_exp_f32 v96,v96
v_mfma_f32_16x16x32_bf16 a[4:7],a[196:199],v[88:91],a[4:7]
v_exp_f32 v97,v97
v_mfma_f32_16x16x32_bf16 a[20:23],a[192:195],v[88:91],a[20:23]
v_exp_f32 v98,v98
v_mfma_f32_16x16x32_bf16 a[36:39],a[160:163],v[88:91],a[36:39]
v_exp_f32 v99,v99
v_mfma_f32_16x16x32_bf16 a[52:55],a[164:167],v[88:91],a[52:55]
v_exp_f32 v100,v100
v_mfma_f32_16x16x32_bf16 a[68:71],a[168:171],v[88:91],a[68:71]
v_exp_f32 v101,v101
v_mfma_f32_16x16x32_bf16 a[84:87],a[172:175],v[88:91],a[84:87]
v_exp_f32 v102,v102
v_mfma_f32_16x16x32_bf16 a[100:103],a[180:183],v[88:91],a[100:103]
v_exp_f32 v103,v103
v_mfma_f32_16x16x32_bf16 a[116:119],a[176:179],v[88:91],a[116:119]
v_cvt_pk_bf16_f32 v96,v96,v97
v_cvt_pk_bf16_f32 v97,v98,v99
v_cvt_pk_bf16_f32 v98,v100,v101
v_cvt_pk_bf16_f32 v99,v102,v103
s_nop 1
v_mfma_f32_16x16x32_bf16 v[164:167],v[176:179],v[96:99],v[164:167]
v_lshrrev_b32 v1,1,v10
s_add_u32 s59,s88,49152
v_add_u32 v1,s59,v1
v_mfma_f32_16x16x32_bf16 a[8:11],a[196:199],v[96:99],a[8:11]
v_mov_b32 v153,v172
ds_write_b64 v1,v[152:153] offset:0
v_mfma_f32_16x16x32_bf16 a[24:27],a[192:195],v[96:99],a[24:27]
s_add_u32 s59,s87,32768
v_add_u32 v6,s59,v10
ds_write_b128 v6,a[144:147] offset:0
v_mfma_f32_16x16x32_bf16 a[40:43],a[160:163],v[96:99],a[40:43]
ds_write_b128 v6,a[148:151] offset:1024
ds_write_b128 v6,a[152:155] offset:2048
v_mfma_f32_16x16x32_bf16 a[56:59],a[164:167],v[96:99],a[56:59]
ds_write_b128 v6,a[156:159] offset:3072
v_xor_b32 v1,512,v1
v_mfma_f32_16x16x32_bf16 a[72:75],a[168:171],v[96:99],a[72:75]
v_xor_b32 v6,4096,v6
v_xor_b32 v24,v19,v24
v_mfma_f32_16x16x32_bf16 a[88:91],a[172:175],v[96:99],a[88:91]
v_xor_b32 v26,v19,v26
v_mfma_f32_16x16x32_bf16 a[104:107],a[180:183],v[96:99],a[104:107]
v_exp_f32 v104,v104
v_mfma_f32_16x16x32_bf16 a[120:123],a[176:179],v[96:99],a[120:123]
v_exp_f32 v105,v105
v_exp_f32 v106,v106
v_exp_f32 v107,v107
v_exp_f32 v108,v108
v_exp_f32 v109,v109
v_exp_f32 v110,v110
v_exp_f32 v111,v111
v_cvt_pk_bf16_f32 v104,v104,v105
v_cvt_pk_bf16_f32 v105,v106,v107
v_cvt_pk_bf16_f32 v106,v108,v109
v_cvt_pk_bf16_f32 v107,v110,v111
s_nop 1
v_mfma_f32_16x16x32_bf16 v[168:171],v[176:179],v[104:107],v[168:171]
s_waitcnt vmcnt(4) lgkmcnt(0)
s_barrier
ds_read_b64 v[174:175],v1 offset:0
ds_read_b128 v[112:115],v6 offset:0
ds_read_b128 v[116:119],v6 offset:1024
ds_read_b128 v[120:123],v6 offset:2048
ds_read_b128 v[124:127],v6 offset:3072
v_mfma_f32_16x16x32_bf16 a[12:15],a[196:199],v[104:107],a[12:15]
s_add_u32 m0,s101,98304
s_add_u32 s58,s92,4096
v_mfma_f32_16x16x32_bf16 a[28:31],a[192:195],v[104:107],a[28:31]
buffer_load_dwordx4 v15,s[24:27],s58 offen lds
v_add_u32 v6,143360,v252
v_mfma_f32_16x16x32_bf16 a[44:47],a[160:163],v[104:107],a[44:47]
ds_read_b64_tr_b16 a[184:185],v24 offset:0
ds_read_b64_tr_b16 a[186:187],v24 offset:512
v_mfma_f32_16x16x32_bf16 a[60:63],a[164:167],v[104:107],a[60:63]
s_add_u32 m0,s101,100352
s_add_u32 s58,s92,135168
v_mfma_f32_16x16x32_bf16 a[76:79],a[168:171],v[104:107],a[76:79]
ds_read_b64_tr_b16 a[188:189],v24 offset:4096
ds_read_b64_tr_b16 a[190:191],v24 offset:4608
v_mfma_f32_16x16x32_bf16 a[92:95],a[172:175],v[104:107],a[92:95]
v_add_u32 v7,143360,v253
v_accvgpr_read_b32 v136,a128
v_mfma_f32_16x16x32_bf16 a[108:111],a[180:183],v[104:107],a[108:111]
ds_read_b64_tr_b16 a[196:197],v24 offset:8
ds_read_b64_tr_b16 a[198:199],v24 offset:520
v_mfma_f32_16x16x32_bf16 a[124:127],a[176:179],v[104:107],a[124:127]
v_accvgpr_read_b32 v137,a129
v_accvgpr_read_b32 v138,a130
v_accvgpr_read_b32 v139,a131
v_accvgpr_read_b32 v140,a132
v_accvgpr_read_b32 v141,a133
v_accvgpr_read_b32 v142,a134
v_accvgpr_read_b32 v143,a135
v_accvgpr_read_b32 v144,a136
v_accvgpr_read_b32 v145,a137
v_accvgpr_read_b32 v146,a138
v_accvgpr_read_b32 v147,a139
v_accvgpr_read_b32 v148,a140
v_accvgpr_read_b32 v149,a141
v_accvgpr_read_b32 v150,a142
v_accvgpr_read_b32 v151,a143
s_waitcnt lgkmcnt(4)
v_mfma_f32_16x16x32_bf16 a[128:131],a[184:187],a[216:219],0
buffer_load_dwordx4 v15,s[24:27],s58 offen lds
v_min_f32 v4,v152,v174
s_waitcnt lgkmcnt(2)
v_mfma_f32_16x16x32_bf16 a[128:131],a[188:191],a[236:239],a[128:131]
ds_read_b64_tr_b16 a[192:193],v24 offset:4104
ds_read_b64_tr_b16 a[194:195],v24 offset:4616
v_mfma_f32_16x16x32_bf16 v[128:131],a[188:191],a[220:223],0
s_add_u32 m0,s101,102400
s_add_u32 s58,s92,266240
v_mfma_f32_16x16x32_bf16 v[128:131],a[184:187],a[200:203],v[128:131]
ds_read_b64_tr_b16 a[160:161],v26 offset:0
ds_read_b64_tr_b16 a[162:163],v26 offset:512
v_mfma_f32_16x16x32_bf16 v[132:135],a[184:187],a[204:207],0
buffer_load_dwordx4 v15,s[24:27],s58 offen lds
v_sub_f32 v152,v4,v152
v_mfma_f32_16x16x32_bf16 v[132:135],a[188:191],a[224:227],v[132:135]
ds_read_b64_tr_b16 a[164:165],v26 offset:4096
ds_read_b64_tr_b16 a[166:167],v26 offset:4608
v_mfma_f32_16x16x32_bf16 v[48:51],a[188:191],a[228:231],0
s_add_u32 m0,s101,104448
s_add_u32 s58,s92,397312
v_mfma_f32_16x16x32_bf16 v[48:51],a[184:187],a[208:211],v[48:51]
ds_read_b64_tr_b16 a[168:169],v26 offset:8
ds_read_b64_tr_b16 a[170:171],v26 offset:520
v_mfma_f32_16x16x32_bf16 v[52:55],a[184:187],a[212:215],0
buffer_load_dwordx4 v15,s[24:27],s58 offen lds
v_sub_f32 v174,v4,v174
v_mfma_f32_16x16x32_bf16 v[52:55],a[188:191],a[232:235],v[52:55]
ds_read_b64_tr_b16 a[172:173],v26 offset:4104
ds_read_b64_tr_b16 a[174:175],v26 offset:4616
s_waitcnt lgkmcnt(4)
v_mfma_f32_16x16x32_bf16 v[68:71],a[192:195],a[232:235],0
s_add_u32 m0,s101,106496
s_add_u32 s58,s92,4224
v_mfma_f32_16x16x32_bf16 v[68:71],a[196:199],a[212:215],v[68:71]
v_exp_f32 v152,v152
v_exp_f32 v174,v174
v_mfma_f32_16x16x32_bf16 v[64:67],a[196:199],a[208:211],0
buffer_load_dwordx4 v15,s[24:27],s58 offen lds
v_mul_f32 v5,v152,v153
v_mfma_f32_16x16x32_bf16 v[64:67],a[192:195],a[228:231],v[64:67]
s_add_u32 m0,s101,108544
s_add_u32 s58,s92,135296
v_mfma_f32_16x16x32_bf16 v[60:63],a[192:195],a[224:227],0
v_fmac_f32 v5,v174,v175
v_rcp_f32 v5,v5
v_mfma_f32_16x16x32_bf16 v[60:63],a[196:199],a[204:207],v[60:63]
s_waitcnt vmcnt(5) lgkmcnt(0)
s_barrier
v_mfma_f32_16x16x32_bf16 v[56:59],a[196:199],a[200:203],0
buffer_load_dwordx4 v15,s[24:27],s58 offen lds
v_mul_f32 v152,v152,v5
v_mfma_f32_16x16x32_bf16 v[56:59],a[192:195],a[220:223],v[56:59]
ds_read_b128 a[240:243],v6 offset:0
v_mul_f32 v174,v174,v5
v_mfma_f32_16x16x32_bf16 a[132:135],a[192:195],a[236:239],0
ds_read_b64_tr_b16 a[180:181],v24 offset:8192
ds_read_b64_tr_b16 a[182:183],v24 offset:8704
v_mfma_f32_16x16x32_bf16 a[132:135],a[196:199],a[216:219],a[132:135]
s_add_u32 m0,s101,110592
s_add_u32 s58,s92,266368
v_mul_f32 v136,v136,v152
v_mul_f32 v137,v137,v152
v_mul_f32 v138,v138,v152
v_mul_f32 v139,v139,v152
v_mul_f32 v140,v140,v152
v_mul_f32 v141,v141,v152
v_mul_f32 v142,v142,v152
v_mul_f32 v143,v143,v152
v_mul_f32 v144,v144,v152
v_mul_f32 v145,v145,v152
v_mul_f32 v146,v146,v152
v_mul_f32 v147,v147,v152
v_mul_f32 v148,v148,v152
v_mul_f32 v149,v149,v152
v_mul_f32 v150,v150,v152
v_mul_f32 v151,v151,v152
v_fmac_f32 v136,v112,v174
v_fmac_f32 v137,v113,v174
v_fmac_f32 v138,v114,v174
v_fmac_f32 v139,v115,v174
v_fmac_f32 v140,v116,v174
v_fmac_f32 v141,v117,v174
v_fmac_f32 v142,v118,v174
v_fmac_f32 v143,v119,v174
v_fmac_f32 v144,v120,v174
v_fmac_f32 v145,v121,v174
v_fmac_f32 v146,v122,v174
v_fmac_f32 v147,v123,v174
v_fmac_f32 v148,v124,v174
v_fmac_f32 v149,v125,v174
v_fmac_f32 v150,v126,v174
v_fmac_f32 v151,v127,v174
v_cvt_pk_bf16_f32 v244,v136,v137
v_cvt_pk_bf16_f32 v245,v138,v139
v_cvt_pk_bf16_f32 v246,v140,v141
v_cvt_pk_bf16_f32 v247,v142,v143
v_cvt_pk_bf16_f32 v248,v144,v145
v_cvt_pk_bf16_f32 v249,v146,v147
v_cvt_pk_bf16_f32 v250,v148,v149
v_cvt_pk_bf16_f32 v251,v150,v151
v_mfma_f32_16x16x32_bf16 v[72:75],a[160:163],a[200:203],0
buffer_load_dwordx4 v15,s[24:27],s58 offen lds
v_mfma_f32_16x16x32_bf16 v[72:75],a[164:167],a[220:223],v[72:75]
ds_read_b128 a[244:247],v6 offset:2048
v_mfma_f32_16x16x32_bf16 v[76:79],a[164:167],a[224:227],0
ds_read_b64_tr_b16 a[176:177],v24 offset:12288
ds_read_b64_tr_b16 a[178:179],v24 offset:12800
v_mfma_f32_16x16x32_bf16 v[76:79],a[160:163],a[204:207],v[76:79]
s_add_u32 m0,s101,112640
s_add_u32 s58,s92,397440
v_mfma_f32_16x16x32_bf16 v[136:139],a[160:163],a[208:211],0
buffer_load_dwordx4 v15,s[24:27],s58 offen lds
v_mfma_f32_16x16x32_bf16 v[136:139],a[164:167],a[228:231],v[136:139]
ds_read_b128 a[248:251],v6 offset:4096
v_mfma_f32_16x16x32_bf16 v[140:143],a[164:167],a[232:235],0
ds_read_b64_tr_b16 a[184:185],v24 offset:8200
ds_read_b64_tr_b16 a[186:187],v24 offset:8712
v_mfma_f32_16x16x32_bf16 v[140:143],a[160:163],a[212:215],v[140:143]
s_add_u32 s92,s92,524288
v_mfma_f32_16x16x32_bf16 v[124:127],a[168:171],a[212:215],0
s_cmp_eq_u32 s92,5242880
s_cselect_b32 s92,0,s92
v_mfma_f32_16x16x32_bf16 v[124:127],a[172:175],a[232:235],v[124:127]
s_cmp_eq_u32 s54,0
s_cbranch_scc1 L_arr0_o
L_arr0:
v_mfma_f32_16x16x32_bf16 v[120:123],a[172:175],a[228:231],0
s_add_u32 m0,s87,32768
s_add_u32 s58,s91,0
v_mfma_f32_16x16x32_bf16 v[120:123],a[168:171],a[208:211],v[120:123]
buffer_load_dwordx4 v16,s[20:23],s58 offen lds
v_mfma_f32_16x16x32_bf16 v[116:119],a[168:171],a[204:207],0
ds_read_b128 a[252:255],v6 offset:6144
v_mfma_f32_16x16x32_bf16 v[116:119],a[172:175],a[224:227],v[116:119]
ds_read_b64_tr_b16 a[188:189],v24 offset:12296
ds_read_b64_tr_b16 a[190:191],v24 offset:12808
v_mfma_f32_16x16x32_bf16 v[112:115],a[172:175],a[220:223],0
s_add_u32 m0,s87,33792
s_add_u32 s58,s91,10240
v_mfma_f32_16x16x32_bf16 v[112:115],a[168:171],a[200:203],v[112:115]
buffer_load_dwordx4 v17,s[20:23],s58 offen lds
s_waitcnt lgkmcnt(3)
v_mfma_f32_16x16x32_bf16 a[136:139],a[180:183],a[216:219],0
ds_read_b128 a[144:147],v254 offset:2048
v_mfma_f32_16x16x32_bf16 a[136:139],a[176:179],a[236:239],a[136:139]
ds_read_b64_tr_b16 a[192:193],v26 offset:8192
ds_read_b64_tr_b16 a[194:195],v26 offset:8704
v_mfma_f32_16x16x32_bf16 v[80:83],a[176:179],a[220:223],0
s_add_u32 m0,s87,34816
s_add_u32 s58,s91,20480
v_mfma_f32_16x16x32_bf16 v[80:83],a[180:183],a[200:203],v[80:83]
buffer_load_dwordx4 v16,s[20:23],s58 offen lds
v_mfma_f32_16x16x32_bf16 v[84:87],a[180:183],a[204:207],0
ds_read_b128 a[148:151],v7 offset:0
ds_read_b128 a[152:155],v7 offset:2048
v_mfma_f32_16x16x32_bf16 v[84:87],a[176:179],a[224:227],v[84:87]
s_add_u32 m0,s87,35840
s_add_u32 s58,s91,30720
v_mfma_f32_16x16x32_bf16 v[88:91],a[176:179],a[228:231],0
ds_read_b64_tr_b16 a[196:197],v26 offset:12288
ds_read_b64_tr_b16 a[198:199],v26 offset:12800
v_mfma_f32_16x16x32_bf16 v[88:91],a[180:183],a[208:211],v[88:91]
buffer_load_dwordx4 v17,s[20:23],s58 offen lds
v_mfma_f32_16x16x32_bf16 v[92:95],a[180:183],a[212:215],0
ds_read_b128 a[156:159],v7 offset:4096
v_rcp_f32 v20,v156
v_rcp_f32 v21,v160
v_rcp_f32 v22,v164
v_rcp_f32 v23,v168
v_accvgpr_read_b32 v180,a0
v_accvgpr_read_b32 v181,a1
v_accvgpr_read_b32 v182,a2
v_accvgpr_read_b32 v183,a3
v_accvgpr_read_b32 v2,a16
v_accvgpr_read_b32 v3,a17
v_accvgpr_read_b32 v4,a18
v_accvgpr_read_b32 v5,a19
v_mul_f32 v180,v180,v20
v_mul_f32 v181,v181,v20
v_mul_f32 v182,v182,v20
v_mul_f32 v183,v183,v20
v_mul_f32 v2,v2,v20
v_mul_f32 v3,v3,v20
v_mul_f32 v4,v4,v20
v_mul_f32 v5,v5,v20
v_cvt_pk_bf16_f32 v180,v180,v181
v_cvt_pk_bf16_f32 v181,v182,v183
v_cvt_pk_bf16_f32 v182,v2,v3
v_cvt_pk_bf16_f32 v183,v4,v5
ds_read_b128 a[0:3],v7 offset:6144
v_mfma_f32_16x16x32_bf16 v[92:95],a[176:179],a[232:235],v[92:95]
s_add_u32 m0,s88,131072
v_accvgpr_read_b32 v184,a4
s_waitcnt lgkmcnt(4)
v_mfma_f32_16x16x32_bf16 v[108:111],a[188:191],a[232:235],0
ds_read_b64_tr_b16 a[164:165],v26 offset:8200
ds_read_b64_tr_b16 a[166:167],v26 offset:8712
v_mfma_f32_16x16x32_bf16 v[108:111],a[184:187],a[212:215],v[108:111]
s_mov_b64 exec,0xffffffff
buffer_load_dwordx4 v18,s[20:23],s91 offen lds
s_mov_b64 exec,-1
v_mfma_f32_16x16x32_bf16 v[104:107],a[184:187],a[208:211],0
ds_read_b128 a[16:19],v255 offset:2048
v_accvgpr_read_b32 v185,a5
v_mfma_f32_16x16x32_bf16 v[104:107],a[188:191],a[228:231],v[104:107]
ds_read_b64_tr_b16 a[160:161],v26 offset:12296
ds_read_b64_tr_b16 a[162:163],v26 offset:12808
v_mfma_f32_16x16x32_bf16 v[100:103],a[188:191],a[224:227],0
s_add_u32 s91,s91,128
v_accvgpr_read_b32 v186,a6
v_mfma_f32_16x16x32_bf16 v[100:103],a[184:187],a[204:207],v[100:103]
s_cmp_eq_u32 s91,1280
s_cselect_b32 s91,0,s91
v_mfma_f32_16x16x32_bf16 v[96:99],a[184:187],a[200:203],0
s_add_u32 m0,s101,65536
s_add_u32 s58,s92,4096
v_mfma_f32_16x16x32_bf16 v[96:99],a[188:191],a[220:223],v[96:99]
buffer_load_dwordx4 v15,s[24:27],s58 offen lds
v_accvgpr_read_b32 v187,a7
v_mfma_f32_16x16x32_bf16 a[140:143],a[188:191],a[236:239],0
s_add_u32 m0,s101,67584
s_add_u32 s58,s92,135168
v_mfma_f32_16x16x32_bf16 a[140:143],a[184:187],a[216:219],a[140:143]
s_waitcnt vmcnt(10) lgkmcnt(0)
s_barrier
v_mfma_f32_16x16x32_bf16 v[144:147],a[192:195],a[200:203],0
ds_read_b64_tr_b16 a[172:173],v24 offset:32768
ds_read_b64_tr_b16 a[174:175],v24 offset:33280
v_mfma_f32_16x16x32_bf16 v[144:147],a[196:199],a[220:223],v[144:147]
buffer_load_dwordx4 v15,s[24:27],s58 offen lds
v_accvgpr_read_b32 v2,a20
v_mfma_f32_16x16x32_bf16 v[148:151],a[196:199],a[224:227],0
ds_read_b64_tr_b16 a[168:169],v24 offset:36864
ds_read_b64_tr_b16 a[170:171],v24 offset:37376
v_mfma_f32_16x16x32_bf16 v[148:151],a[192:195],a[204:207],v[148:151]
s_add_u32 m0,s101,69632
s_add_u32 s58,s92,266240
v_mfma_f32_16x16x32_bf16 v[152:155],a[192:195],a[208:211],0
ds_read_b64_tr_b16 a[180:181],v24 offset:32776
ds_read_b64_tr_b16 a[182:183],v24 offset:33288
v_mfma_f32_16x16x32_bf16 v[152:155],a[196:199],a[228:231],v[152:155]
buffer_load_dwordx4 v15,s[24:27],s58 offen lds
v_accvgpr_read_b32 v3,a21
v_mfma_f32_16x16x32_bf16 v[156:159],a[196:199],a[232:235],0
ds_read_b64_tr_b16 a[176:177],v24 offset:36872
ds_read_b64_tr_b16 a[178:179],v24 offset:37384
v_mfma_f32_16x16x32_bf16 v[156:159],a[192:195],a[212:215],v[156:159]
s_add_u32 m0,s101,71680
s_add_u32 s58,s92,397312
v_mfma_f32_16x16x32_bf16 v[172:175],a[164:167],a[212:215],0
ds_read_b64_tr_b16 a[188:189],v26 offset:32768
ds_read_b64_tr_b16 a[190:191],v26 offset:33280
v_mfma_f32_16x16x32_bf16 v[172:175],a[160:163],a[232:235],v[172:175]
buffer_load_dwordx4 v15,s[24:27],s58 offen lds
v_accvgpr_read_b32 v4,a22
v_mfma_f32_16x16x32_bf16 v[168:171],a[160:163],a[228:231],0
ds_read_b64_tr_b16 a[184:185],v26 offset:36864
ds_read_b64_tr_b16 a[186:187],v26 offset:37376
v_mfma_f32_16x16x32_bf16 v[168:171],a[164:167],a[208:211],v[168:171]
s_add_u32 m0,s87,49152
s_add_u32 s58,s91,0
v_mfma_f32_16x16x32_bf16 v[164:167],a[164:167],a[204:207],0
ds_read_b64_tr_b16 a[196:197],v26 offset:32776
ds_read_b64_tr_b16 a[198:199],v26 offset:33288
v_mfma_f32_16x16x32_bf16 v[164:167],a[160:163],a[224:227],v[164:167]
buffer_load_dwordx4 v16,s[20:23],s58 offen lds
v_accvgpr_read_b32 v5,a23
v_mfma_f32_16x16x32_bf16 v[160:163],a[160:163],a[220:223],0
s_add_u32 m0,s87,50176
s_add_u32 s58,s91,10240
v_mfma_f32_16x16x32_bf16 v[160:163],a[164:167],a[200:203],v[160:163]
v_mul_f32 v184,v184,v21
v_mul_f32 v185,v185,v21
s_waitcnt lgkmcnt(2)
v_mfma_f32_16x16x32_bf16 a[128:131],a[172:175],a[144:147],a[128:131]
ds_read_b64_tr_b16 a[192:193],v26 offset:36872
ds_read_b64_tr_b16 a[194:195],v26 offset:37384
v_mfma_f32_16x16x32_bf16 a[128:131],a[168:171],a[16:19],a[128:131]
buffer_load_dwordx4 v17,s[20:23],s58 offen lds
v_mul_f32 v186,v186,v21
v_mfma_f32_16x16x32_bf16 v[128:131],a[168:171],a[148:151],v[128:131]
s_add_u32 m0,s87,51200
s_add_u32 s58,s91,20480
v_mfma_f32_16x16x32_bf16 v[128:131],a[172:175],a[240:243],v[128:131]
v_mul_f32 v187,v187,v21
v_mul_f32 v2,v2,v21
v_mfma_f32_16x16x32_bf16 v[132:135],a[172:175],a[244:247],v[132:135]
v_mul_f32 v3,v3,v21
v_mul_f32 v4,v4,v21
v_mfma_f32_16x16x32_bf16 v[132:135],a[168:171],a[152:155],v[132:135]
buffer_load_dwordx4 v16,s[20:23],s58 offen lds
v_mul_f32 v5,v5,v21
v_mfma_f32_16x16x32_bf16 v[48:51],a[168:171],a[156:159],v[48:51]
s_waitcnt vmcnt(7) lgkmcnt(0)
s_barrier
v_mfma_f32_16x16x32_bf16 v[48:51],a[172:175],a[248:251],v[48:51]
ds_read_b128 a[200:203],v252 offset:32768
v_cvt_pk_bf16_f32 v184,v184,v185
v_mfma_f32_16x16x32_bf16 v[52:55],a[172:175],a[252:255],v[52:55]
s_add_u32 m0,s87,52224
s_add_u32 s58,s91,30720
v_mfma_f32_16x16x32_bf16 v[52:55],a[168:171],a[0:3],v[52:55]
buffer_load_dwordx4 v17,s[20:23],s58 offen lds
v_cvt_pk_bf16_f32 v185,v186,v187
v_mfma_f32_16x16x32_bf16 v[68:71],a[176:179],a[0:3],v[68:71]
ds_read_b64_tr_b16 a[160:161],v24 offset:40960
ds_read_b64_tr_b16 a[162:163],v24 offset:41472
v_mfma_f32_16x16x32_bf16 v[68:71],a[180:183],a[252:255],v[68:71]
s_add_u32 m0,s88,133120
v_cvt_pk_bf16_f32 v186,v2,v3
v_mfma_f32_16x16x32_bf16 v[64:67],a[180:183],a[248:251],v[64:67]
ds_read_b128 a[204:207],v252 offset:34816
v_cvt_pk_bf16_f32 v187,v4,v5
v_mfma_f32_16x16x32_bf16 v[64:67],a[176:179],a[156:159],v[64:67]
s_mov_b64 exec,0xffffffff
buffer_load_dwordx4 v18,s[20:23],s91 offen lds
s_mov_b64 exec,-1
v_mfma_f32_16x16x32_bf16 v[60:63],a[176:179],a[152:155],v[60:63]
ds_read_b64_tr_b16 a[164:165],v24 offset:45056
ds_read_b64_tr_b16 a[166:167],v24 offset:45568
v_mfma_f32_16x16x32_bf16 v[60:63],a[180:183],a[244:247],v[60:63]
s_add_u32 s91,s91,128
v_accvgpr_read_b32 v188,a8
v_mfma_f32_16x16x32_bf16 v[56:59],a[180:183],a[240:243],v[56:59]
s_cmp_eq_u32 s91,1280
s_cselect_b32 s91,0,s91
v_mfma_f32_16x16x32_bf16 v[56:59],a[176:179],a[148:151],v[56:59]
s_add_u32 m0,s101,73728
s_add_u32 s58,s92,4224
v_mfma_f32_16x16x32_bf16 a[132:135],a[176:179],a[16:19],a[132:135]
buffer_load_dwordx4 v15,s[24:27],s58 offen lds
v_accvgpr_read_b32 v189,a9
v_mfma_f32_16x16x32_bf16 a[132:135],a[180:183],a[144:147],a[132:135]
ds_read_b128 a[208:211],v252 offset:36864
v_accvgpr_read_b32 v190,a10
v_mfma_f32_16x16x32_bf16 v[72:75],a[188:191],a[240:243],v[72:75]
ds_read_b64_tr_b16 a[172:173],v24 offset:40968
ds_read_b64_tr_b16 a[174:175],v24 offset:41480
v_mfma_f32_16x16x32_bf16 v[72:75],a[184:187],a[148:151],v[72:75]
s_add_u32 m0,s101,75776
s_add_u32 s58,s92,135296
v_mfma_f32_16x16x32_bf16 v[76:79],a[184:187],a[152:155],v[76:79]
buffer_load_dwordx4 v15,s[24:27],s58 offen lds
v_accvgpr_read_b32 v191,a11
v_mfma_f32_16x16x32_bf16 v[76:79],a[188:191],a[244:247],v[76:79]
ds_read_b128 a[212:215],v252 offset:38912
v_accvgpr_read_b32 v2,a24
v_mfma_f32_16x16x32_bf16 v[136:139],a[188:191],a[248:251],v[136:139]
ds_read_b64_tr_b16 a[168:169],v24 offset:45064
ds_read_b64_tr_b16 a[170:171],v24 offset:45576
v_mfma_f32_16x16x32_bf16 v[136:139],a[184:187],a[156:159],v[136:139]
s_add_u32 m0,s101,77824
s_add_u32 s58,s92,266368
v_mfma_f32_16x16x32_bf16 v[140:143],a[184:187],a[0:3],v[140:143]
buffer_load_dwordx4 v15,s[24:27],s58 offen lds
v_accvgpr_read_b32 v3,a25
v_mfma_f32_16x16x32_bf16 v[140:143],a[188:191],a[252:255],v[140:143]
ds_read_b128 a[216:219],v254 offset:0
v_accvgpr_read_b32 v4,a26
v_mfma_f32_16x16x32_bf16 v[124:127],a[196:199],a[252:255],v[124:127]
s_add_u32 m0,s101,79872
s_add_u32 s58,s92,397440
v_mfma_f32_16x16x32_bf16 v[124:127],a[192:195],a[0:3],v[124:127]
v_accvgpr_read_b32 v5,a27
v_mul_f32 v188,v188,v22
v_mfma_f32_16x16x32_bf16 v[120:123],a[192:195],a[156:159],v[120:123]
buffer_load_dwordx4 v15,s[24:27],s58 offen lds
v_mul_f32 v189,v189,v22
v_mfma_f32_16x16x32_bf16 v[120:123],a[196:199],a[248:251],v[120:123]
s_add_u32 s92,s92,524288
v_mul_f32 v190,v190,v22
v_mfma_f32_16x16x32_bf16 v[116:119],a[196:199],a[244:247],v[116:119]
s_cmp_eq_u32 s92,5242880
s_cselect_b32 s92,0,s92
v_mfma_f32_16x16x32_bf16 v[116:119],a[192:195],a[152:155],v[116:119]
v_mul_f32 v191,v191,v22
v_mul_f32 v2,v2,v22
v_mfma_f32_16x16x32_bf16 v[112:115],a[192:195],a[148:151],v[112:115]
s_add_u32 s58,s89,0
buffer_store_dwordx4 v[244:247],v10,s[36:39],s58 offen sc1
v_mfma_f32_16x16x32_bf16 v[112:115],a[196:199],a[240:243],v[112:115]
v_mul_f32 v3,v3,v22
v_mul_f32 v4,v4,v22
s_waitcnt lgkmcnt(0)
v_mfma_f32_16x16x32_bf16 a[136:139],a[160:163],a[144:147],a[136:139]
ds_read_b64_tr_b16 a[176:177],v26 offset:40960
ds_read_b64_tr_b16 a[178:179],v26 offset:41472
v_mfma_f32_16x16x32_bf16 a[136:139],a[164:167],a[16:19],a[136:139]
v_mul_f32 v5,v5,v22
v_cvt_pk_bf16_f32 v188,v188,v189
v_mfma_f32_16x16x32_bf16 v[80:83],a[164:167],a[148:151],v[80:83]
s_add_u32 s58,s89,9216
buffer_store_dwordx4 v[248:251],v10,s[36:39],s58 offen sc1
v_mfma_f32_16x16x32_bf16 v[80:83],a[160:163],a[240:243],v[80:83]
ds_read_b128 a[220:223],v253 offset:32768
ds_read_b128 a[224:227],v253 offset:34816
v_mfma_f32_16x16x32_bf16 v[84:87],a[160:163],a[244:247],v[84:87]
v_cvt_pk_bf16_f32 v189,v190,v191
v_cvt_pk_bf16_f32 v190,v2,v3
v_mfma_f32_16x16x32_bf16 v[84:87],a[164:167],a[152:155],v[84:87]
ds_read_b64_tr_b16 a[180:181],v26 offset:45056
ds_read_b64_tr_b16 a[182:183],v26 offset:45568
v_mfma_f32_16x16x32_bf16 v[88:91],a[164:167],a[156:159],v[88:91]
s_add_u32 s58,s90,0
buffer_store_dwordx4 v[180:183],v10,s[36:39],s58 offen sc1
v_mfma_f32_16x16x32_bf16 v[88:91],a[160:163],a[248:251],v[88:91]
ds_read_b128 a[228:231],v253 offset:36864
ds_read_b128 a[232:235],v253 offset:38912
v_mfma_f32_16x16x32_bf16 v[92:95],a[160:163],a[252:255],v[92:95]
v_cvt_pk_bf16_f32 v191,v4,v5
v_accvgpr_read_b32 v192,a12
v_mfma_f32_16x16x32_bf16 v[92:95],a[164:167],a[0:3],v[92:95]
ds_read_b64_tr_b16 a[184:185],v26 offset:40968
ds_read_b64_tr_b16 a[186:187],v26 offset:41480
v_mfma_f32_16x16x32_bf16 v[108:111],a[168:171],a[0:3],v[108:111]
s_add_u32 s58,s90,0
buffer_store_dwordx4 v[184:187],v10,s[36:39],s58 offen offset:1024 sc1
v_mfma_f32_16x16x32_bf16 v[108:111],a[172:175],a[252:255],v[108:111]
ds_read_b128 a[236:239],v255 offset:0
v_accvgpr_read_b32 v193,a13
v_mfma_f32_16x16x32_bf16 v[104:107],a[172:175],a[248:251],v[104:107]
ds_read_b64_tr_b16 a[188:189],v26 offset:45064
ds_read_b64_tr_b16 a[190:191],v26 offset:45576
v_mfma_f32_16x16x32_bf16 v[104:107],a[168:171],a[156:159],v[104:107]
s_cmp_eq_u32 s54,1
s_cbranch_scc1 L_arr1_o
L_arr1:
v_mfma_f32_16x16x32_bf16 v[100:103],a[168:171],a[152:155],v[100:103]
s_add_u32 m0,s101,98304
s_add_u32 s58,s92,4096
v_mfma_f32_16x16x32_bf16 v[100:103],a[172:175],a[244:247],v[100:103]
buffer_load_dwordx4 v15,s[24:27],s58 offen lds
v_accvgpr_read_b32 v194,a14
v_mfma_f32_16x16x32_bf16 v[96:99],a[172:175],a[240:243],v[96:99]
s_add_u32 m0,s101,100352
s_add_u32 s58,s92,135168
v_mfma_f32_16x16x32_bf16 v[96:99],a[168:171],a[148:151],v[96:99]
v_accvgpr_read_b32 v195,a15
v_accvgpr_read_b32 v2,a28
v_mfma_f32_16x16x32_bf16 a[140:143],a[168:171],a[16:19],a[140:143]
s_waitcnt vmcnt(14) lgkmcnt(0)
s_barrier
v_mfma_f32_16x16x32_bf16 a[140:143],a[172:175],a[144:147],a[140:143]
buffer_load_dwordx4 v15,s[24:27],s58 offen lds
v_accvgpr_read_b32 v3,a29
v_mfma_f32_16x16x32_bf16 v[144:147],a[176:179],a[240:243],v[144:147]
ds_read_b64_tr_b16 a[192:193],v24 offset:0
ds_read_b64_tr_b16 a[194:195],v24 offset:512
v_mfma_f32_16x16x32_bf16 v[144:147],a[180:183],a[148:151],v[144:147]
s_add_u32 m0,s101,102400
s_add_u32 s58,s92,266240
v_mfma_f32_16x16x32_bf16 v[148:151],a[180:183],a[152:155],v[148:151]
ds_read_b64_tr_b16 a[196:197],v24 offset:4096
ds_read_b64_tr_b16 a[198:199],v24 offset:4608
v_mfma_f32_16x16x32_bf16 v[148:151],a[176:179],a[244:247],v[148:151]
buffer_load_dwordx4 v15,s[24:27],s58 offen lds
v_accvgpr_read_b32 v4,a30
v_mfma_f32_16x16x32_bf16 v[152:155],a[176:179],a[248:251],v[152:155]
ds_read_b64_tr_b16 a[160:161],v24 offset:8
ds_read_b64_tr_b16 a[162:163],v24 offset:520
v_mfma_f32_16x16x32_bf16 v[152:155],a[180:183],a[156:159],v[152:155]
s_add_u32 m0,s101,104448
s_add_u32 s58,s92,397312
v_mfma_f32_16x16x32_bf16 v[156:159],a[180:183],a[0:3],v[156:159]
ds_read_b64_tr_b16 a[164:165],v24 offset:4104
ds_read_b64_tr_b16 a[166:167],v24 offset:4616
v_mfma_f32_16x16x32_bf16 v[156:159],a[176:179],a[252:255],v[156:159]
buffer_load_dwordx4 v15,s[24:27],s58 offen lds
v_accvgpr_read_b32 v5,a31
v_mfma_f32_16x16x32_bf16 v[172:175],a[184:187],a[252:255],v[172:175]
ds_read_b64_tr_b16 a[168:169],v26 offset:0
ds_read_b64_tr_b16 a[170:171],v26 offset:512
v_mfma_f32_16x16x32_bf16 v[172:175],a[188:191],a[0:3],v[172:175]
s_add_u32 m0,s87,32768
s_add_u32 s58,s91,0
v_mfma_f32_16x16x32_bf16 v[168:171],a[188:191],a[156:159],v[168:171]
ds_read_b64_tr_b16 a[172:173],v26 offset:4096
ds_read_b64_tr_b16 a[174:175],v26 offset:4608
v_mfma_f32_16x16x32_bf16 v[168:171],a[184:187],a[248:251],v[168:171]
buffer_load_dwordx4 v16,s[20:23],s58 offen lds
v_mul_f32 v192,v192,v23
v_mfma_f32_16x16x32_bf16 v[164:167],a[184:187],a[244:247],v[164:167]
ds_read_b64_tr_b16 a[180:181],v26 offset:8
ds_read_b64_tr_b16 a[182:183],v26 offset:520
v_mfma_f32_16x16x32_bf16 v[164:167],a[188:191],a[152:155],v[164:167]
s_add_u32 m0,s87,33792
s_add_u32 s58,s91,10240
v_mfma_f32_16x16x32_bf16 v[160:163],a[188:191],a[148:151],v[160:163]
v_mul_f32 v193,v193,v23
v_mul_f32 v194,v194,v23
v_mfma_f32_16x16x32_bf16 v[160:163],a[184:187],a[240:243],v[160:163]
buffer_load_dwordx4 v17,s[20:23],s58 offen lds
v_mul_f32 v195,v195,v23
s_waitcnt lgkmcnt(2)
v_mfma_f32_16x16x32_bf16 a[128:131],a[192:195],a[216:219],a[128:131]
ds_read_b64_tr_b16 a[176:177],v26 offset:4104
ds_read_b64_tr_b16 a[178:179],v26 offset:4616
v_mfma_f32_16x16x32_bf16 a[128:131],a[196:199],a[236:239],a[128:131]
s_add_u32 m0,s87,34816
s_add_u32 s58,s91,20480
v_mfma_f32_16x16x32_bf16 v[128:131],a[196:199],a[220:223],v[128:131]
v_mul_f32 v2,v2,v23
v_mul_f32 v3,v3,v23
v_mfma_f32_16x16x32_bf16 v[128:131],a[192:195],a[200:203],v[128:131]
buffer_load_dwordx4 v16,s[20:23],s58 offen lds
v_mul_f32 v4,v4,v23
v_mfma_f32_16x16x32_bf16 v[132:135],a[192:195],a[204:207],v[132:135]
s_add_u32 m0,s87,35840
s_add_u32 s58,s91,30720
v_mfma_f32_16x16x32_bf16 v[132:135],a[196:199],a[224:227],v[132:135]
v_mul_f32 v5,v5,v23
v_cvt_pk_bf16_f32 v192,v192,v193
v_mfma_f32_16x16x32_bf16 v[48:51],a[196:199],a[228:231],v[48:51]
s_waitcnt vmcnt(11) lgkmcnt(0)
s_barrier
v_mfma_f32_16x16x32_bf16 v[48:51],a[192:195],a[208:211],v[48:51]
buffer_load_dwordx4 v17,s[20:23],s58 offen lds
v_cvt_pk_bf16_f32 v193,v194,v195
v_mfma_f32_16x16x32_bf16 v[52:55],a[192:195],a[212:215],v[52:55]
ds_read_b128 a[240:243],v252 offset:49152
v_cvt_pk_bf16_f32 v194,v2,v3
v_mfma_f32_16x16x32_bf16 v[52:55],a[196:199],a[232:235],v[52:55]
ds_read_b64_tr_b16 a[188:189],v24 offset:8192
ds_read_b64_tr_b16 a[190:191],v24 offset:8704
v_mfma_f32_16x16x32_bf16 v[68:71],a[164:167],a[232:235],v[68:71]
s_add_u32 m0,s88,131072
v_cvt_pk_bf16_f32 v195,v4,v5
v_mfma_f32_16x16x32_bf16 v[68:71],a[160:163],a[212:215],v[68:71]
s_mov_b64 exec,0xffffffff
buffer_load_dwordx4 v18,s[20:23],s91 offen lds
s_mov_b64 exec,-1
v_mfma_f32_16x16x32_bf16 v[64:67],a[160:163],a[208:211],v[64:67]
ds_read_b128 a[244:247],v252 offset:51200
v_accvgpr_read_b32 v196,a32
v_mfma_f32_16x16x32_bf16 v[64:67],a[164:167],a[228:231],v[64:67]
ds_read_b64_tr_b16 a[184:185],v24 offset:12288
ds_read_b64_tr_b16 a[186:187],v24 offset:12800
v_mfma_f32_16x16x32_bf16 v[60:63],a[164:167],a[224:227],v[60:63]
s_add_u32 s91,s91,128
v_accvgpr_read_b32 v197,a33
v_mfma_f32_16x16x32_bf16 v[60:63],a[160:163],a[204:207],v[60:63]
s_cmp_eq_u32 s91,1280
s_cselect_b32 s91,0,s91
v_mfma_f32_16x16x32_bf16 v[56:59],a[160:163],a[200:203],v[56:59]
s_add_u32 m0,s101,106496
s_add_u32 s58,s92,4224
v_mfma_f32_16x16x32_bf16 v[56:59],a[164:167],a[220:223],v[56:59]
buffer_load_dwordx4 v15,s[24:27],s58 offen lds
v_accvgpr_read_b32 v198,a34
v_mfma_f32_16x16x32_bf16 a[132:135],a[164:167],a[236:239],a[132:135]
ds_read_b128 a[248:251],v252 offset:53248
v_accvgpr_read_b32 v199,a35
v_mfma_f32_16x16x32_bf16 a[132:135],a[160:163],a[216:219],a[132:135]
ds_read_b64_tr_b16 a[192:193],v24 offset:8200
ds_read_b64_tr_b16 a[194:195],v24 offset:8712
v_mfma_f32_16x16x32_bf16 v[72:75],a[168:171],a[200:203],v[72:75]
s_add_u32 m0,s101,108544
s_add_u32 s58,s92,135296
v_mfma_f32_16x16x32_bf16 v[72:75],a[172:175],a[220:223],v[72:75]
buffer_load_dwordx4 v15,s[24:27],s58 offen lds
v_accvgpr_read_b32 v2,a48
v_mfma_f32_16x16x32_bf16 v[76:79],a[172:175],a[224:227],v[76:79]
ds_read_b128 a[252:255],v252 offset:55296
v_accvgpr_read_b32 v3,a49
v_mfma_f32_16x16x32_bf16 v[76:79],a[168:171],a[204:207],v[76:79]
ds_read_b64_tr_b16 a[196:197],v24 offset:12296
ds_read_b64_tr_b16 a[198:199],v24 offset:12808
v_mfma_f32_16x16x32_bf16 v[136:139],a[168:171],a[208:211],v[136:139]
s_add_u32 m0,s101,110592
s_add_u32 s58,s92,266368
v_mfma_f32_16x16x32_bf16 v[136:139],a[172:175],a[228:231],v[136:139]
buffer_load_dwordx4 v15,s[24:27],s58 offen lds
v_accvgpr_read_b32 v4,a50
v_mfma_f32_16x16x32_bf16 v[140:143],a[172:175],a[232:235],v[140:143]
ds_read_b128 a[144:147],v254 offset:2048
v_accvgpr_read_b32 v5,a51
v_mfma_f32_16x16x32_bf16 v[140:143],a[168:171],a[212:215],v[140:143]
s_add_u32 m0,s101,112640
s_add_u32 s58,s92,397440
v_mfma_f32_16x16x32_bf16 v[124:127],a[180:183],a[212:215],v[124:127]
v_mul_f32 v196,v196,v20
v_mul_f32 v197,v197,v20
v_mfma_f32_16x16x32_bf16 v[124:127],a[176:179],a[232:235],v[124:127]
buffer_load_dwordx4 v15,s[24:27],s58 offen lds
v_mul_f32 v198,v198,v20
v_mfma_f32_16x16x32_bf16 v[120:123],a[176:179],a[228:231],v[120:123]
s_add_u32 s92,s92,524288
v_mul_f32 v199,v199,v20
v_mfma_f32_16x16x32_bf16 v[120:123],a[180:183],a[208:211],v[120:123]
s_cmp_eq_u32 s92,5242880
s_cselect_b32 s92,0,s92
v_mfma_f32_16x16x32_bf16 v[116:119],a[180:183],a[204:207],v[116:119]
v_mul_f32 v2,v2,v20
v_mul_f32 v3,v3,v20
v_mfma_f32_16x16x32_bf16 v[116:119],a[176:179],a[224:227],v[116:119]
s_add_u32 s58,s90,0
buffer_store_dwordx4 v[188:191],v10,s[36:39],s58 offen offset:2048 sc1
v_mfma_f32_16x16x32_bf16 v[112:115],a[176:179],a[220:223],v[112:115]
v_mul_f32 v4,v4,v20
v_mul_f32 v5,v5,v20
v_mfma_f32_16x16x32_bf16 v[112:115],a[180:183],a[200:203],v[112:115]
v_cvt_pk_bf16_f32 v196,v196,v197
v_cvt_pk_bf16_f32 v197,v198,v199
s_waitcnt lgkmcnt(0)
v_mfma_f32_16x16x32_bf16 a[136:139],a[188:191],a[216:219],a[136:139]
ds_read_b64_tr_b16 a[164:165],v26 offset:8192
ds_read_b64_tr_b16 a[166:167],v26 offset:8704
v_mfma_f32_16x16x32_bf16 a[136:139],a[184:187],a[236:239],a[136:139]
s_add_u32 s58,s90,0
buffer_store_dwordx4 v[192:195],v10,s[36:39],s58 offen offset:3072 sc1
v_mfma_f32_16x16x32_bf16 v[80:83],a[184:187],a[220:223],v[80:83]
ds_read_b128 a[148:151],v253 offset:49152
ds_read_b128 a[152:155],v253 offset:51200
v_mfma_f32_16x16x32_bf16 v[80:83],a[188:191],a[200:203],v[80:83]
v_cvt_pk_bf16_f32 v198,v2,v3
v_cvt_pk_bf16_f32 v199,v4,v5
v_mfma_f32_16x16x32_bf16 v[84:87],a[188:191],a[204:207],v[84:87]
ds_read_b64_tr_b16 a[160:161],v26 offset:12288
ds_read_b64_tr_b16 a[162:163],v26 offset:12800
v_mfma_f32_16x16x32_bf16 v[84:87],a[184:187],a[224:227],v[84:87]
s_add_u32 s58,s90,9216
buffer_store_dwordx4 v[196:199],v10,s[36:39],s58 offen sc1
v_mfma_f32_16x16x32_bf16 v[88:91],a[184:187],a[228:231],v[88:91]
ds_read_b128 a[156:159],v253 offset:53248
ds_read_b128 a[0:3],v253 offset:55296
v_mfma_f32_16x16x32_bf16 v[88:91],a[188:191],a[208:211],v[88:91]
v_accvgpr_read_b32 v200,a36
v_accvgpr_read_b32 v201,a37
v_mfma_f32_16x16x32_bf16 v[92:95],a[188:191],a[212:215],v[92:95]
ds_read_b64_tr_b16 a[172:173],v26 offset:8200
ds_read_b64_tr_b16 a[174:175],v26 offset:8712
v_mfma_f32_16x16x32_bf16 v[92:95],a[184:187],a[232:235],v[92:95]
v_accvgpr_read_b32 v202,a38
v_accvgpr_read_b32 v203,a39
v_accvgpr_read_b32 v2,a52
v_accvgpr_read_b32 v3,a53
v_accvgpr_read_b32 v4,a54
v_accvgpr_read_b32 v5,a55
v_mul_f32 v200,v200,v21
v_mul_f32 v201,v201,v21
v_mul_f32 v202,v202,v21
v_mul_f32 v203,v203,v21
v_mul_f32 v2,v2,v21
v_mul_f32 v3,v3,v21
v_mul_f32 v4,v4,v21
v_mul_f32 v5,v5,v21
v_cvt_pk_bf16_f32 v200,v200,v201
v_cvt_pk_bf16_f32 v201,v202,v203
v_cvt_pk_bf16_f32 v202,v2,v3
v_cvt_pk_bf16_f32 v203,v4,v5
s_add_u32 s58,s90,9216
buffer_store_dwordx4 v[200:203],v10,s[36:39],s58 offen offset:1024 sc1
v_mfma_f32_16x16x32_bf16 v[108:111],a[196:199],a[232:235],v[108:111]
ds_read_b128 a[16:19],v255 offset:2048
v_accvgpr_read_b32 v204,a40
v_mfma_f32_16x16x32_bf16 v[108:111],a[192:195],a[212:215],v[108:111]
ds_read_b64_tr_b16 a[168:169],v26 offset:12296
ds_read_b64_tr_b16 a[170:171],v26 offset:12808
v_mfma_f32_16x16x32_bf16 v[104:107],a[192:195],a[208:211],v[104:107]
s_cmp_eq_u32 s54,2
s_cbranch_scc1 L_arr2_o
L_arr2:
v_mfma_f32_16x16x32_bf16 v[104:107],a[196:199],a[228:231],v[104:107]
s_add_u32 m0,s101,65536
s_add_u32 s58,s92,4096
v_mfma_f32_16x16x32_bf16 v[100:103],a[196:199],a[224:227],v[100:103]
buffer_load_dwordx4 v15,s[24:27],s58 offen lds
v_accvgpr_read_b32 v205,a41
v_mfma_f32_16x16x32_bf16 v[100:103],a[192:195],a[204:207],v[100:103]
s_add_u32 m0,s101,67584
s_add_u32 s58,s92,135168
v_mfma_f32_16x16x32_bf16 v[96:99],a[192:195],a[200:203],v[96:99]
v_accvgpr_read_b32 v206,a42
v_accvgpr_read_b32 v207,a43
v_mfma_f32_16x16x32_bf16 v[96:99],a[196:199],a[220:223],v[96:99]
s_waitcnt vmcnt(14) lgkmcnt(0)
s_barrier
v_mfma_f32_16x16x32_bf16 a[140:143],a[196:199],a[236:239],a[140:143]
buffer_load_dwordx4 v15,s[24:27],s58 offen lds
v_accvgpr_read_b32 v2,a56
v_mfma_f32_16x16x32_bf16 a[140:143],a[192:195],a[216:219],a[140:143]
ds_read_b64_tr_b16 a[176:177],v24 offset:32768
ds_read_b64_tr_b16 a[178:179],v24 offset:33280
v_mfma_f32_16x16x32_bf16 v[144:147],a[164:167],a[200:203],v[144:147]
s_add_u32 m0,s101,69632
s_add_u32 s58,s92,266240
v_mfma_f32_16x16x32_bf16 v[144:147],a[160:163],a[220:223],v[144:147]
ds_read_b64_tr_b16 a[180:181],v24 offset:36864
ds_read_b64_tr_b16 a[182:183],v24 offset:37376
v_mfma_f32_16x16x32_bf16 v[148:151],a[160:163],a[224:227],v[148:151]
buffer_load_dwordx4 v15,s[24:27],s58 offen lds
v_accvgpr_read_b32 v3,a57
v_mfma_f32_16x16x32_bf16 v[148:151],a[164:167],a[204:207],v[148:151]
ds_read_b64_tr_b16 a[188:189],v24 offset:32776
ds_read_b64_tr_b16 a[190:191],v24 offset:33288
v_mfma_f32_16x16x32_bf16 v[152:155],a[164:167],a[208:211],v[152:155]
s_add_u32 m0,s101,71680
s_add_u32 s58,s92,397312
v_mfma_f32_16x16x32_bf16 v[152:155],a[160:163],a[228:231],v[152:155]
ds_read_b64_tr_b16 a[184:185],v24 offset:36872
ds_read_b64_tr_b16 a[186:187],v24 offset:37384
v_mfma_f32_16x16x32_bf16 v[156:159],a[160:163],a[232:235],v[156:159]
buffer_load_dwordx4 v15,s[24:27],s58 offen lds
v_accvgpr_read_b32 v4,a58
v_mfma_f32_16x16x32_bf16 v[156:159],a[164:167],a[212:215],v[156:159]
ds_read_b64_tr_b16 a[196:197],v26 offset:32768
ds_read_b64_tr_b16 a[198:199],v26 offset:33280
v_mfma_f32_16x16x32_bf16 v[172:175],a[172:175],a[212:215],v[172:175]
s_add_u32 m0,s87,49152
s_add_u32 s58,s91,0
v_mfma_f32_16x16x32_bf16 v[172:175],a[168:171],a[232:235],v[172:175]
ds_read_b64_tr_b16 a[192:193],v26 offset:36864
ds_read_b64_tr_b16 a[194:195],v26 offset:37376
v_mfma_f32_16x16x32_bf16 v[168:171],a[168:171],a[228:231],v[168:171]
buffer_load_dwordx4 v16,s[20:23],s58 offen lds
v_accvgpr_read_b32 v5,a59
v_mfma_f32_16x16x32_bf16 v[168:171],a[172:175],a[208:211],v[168:171]
ds_read_b64_tr_b16 a[160:161],v26 offset:32776
ds_read_b64_tr_b16 a[162:163],v26 offset:33288
v_mfma_f32_16x16x32_bf16 v[164:167],a[172:175],a[204:207],v[164:167]
s_add_u32 m0,s87,50176
s_add_u32 s58,s91,10240
v_mfma_f32_16x16x32_bf16 v[164:167],a[168:171],a[224:227],v[164:167]
v_mul_f32 v204,v204,v22
v_mul_f32 v205,v205,v22
v_mfma_f32_16x16x32_bf16 v[160:163],a[168:171],a[220:223],v[160:163]
buffer_load_dwordx4 v17,s[20:23],s58 offen lds
v_mul_f32 v206,v206,v22
v_mfma_f32_16x16x32_bf16 v[160:163],a[172:175],a[200:203],v[160:163]
s_add_u32 m0,s87,51200
s_add_u32 s58,s91,20480
s_waitcnt lgkmcnt(0)
v_mfma_f32_16x16x32_bf16 a[128:131],a[176:179],a[144:147],a[128:131]
ds_read_b64_tr_b16 a[164:165],v26 offset:36872
ds_read_b64_tr_b16 a[166:167],v26 offset:37384
v_mfma_f32_16x16x32_bf16 a[128:131],a[180:183],a[16:19],a[128:131]
v_mul_f32 v207,v207,v22
v_mul_f32 v2,v2,v22
v_mfma_f32_16x16x32_bf16 v[128:131],a[180:183],a[148:151],v[128:131]
buffer_load_dwordx4 v16,s[20:23],s58 offen lds
v_mul_f32 v3,v3,v22
v_mfma_f32_16x16x32_bf16 v[128:131],a[176:179],a[240:243],v[128:131]
s_add_u32 m0,s87,52224
s_add_u32 s58,s91,30720
v_mfma_f32_16x16x32_bf16 v[132:135],a[176:179],a[244:247],v[132:135]
v_mul_f32 v4,v4,v22
v_mul_f32 v5,v5,v22
v_mfma_f32_16x16x32_bf16 v[132:135],a[180:183],a[152:155],v[132:135]
v_cvt_pk_bf16_f32 v204,v204,v205
v_cvt_pk_bf16_f32 v205,v206,v207
v_mfma_f32_16x16x32_bf16 v[48:51],a[180:183],a[156:159],v[48:51]
buffer_load_dwordx4 v17,s[20:23],s58 offen lds
v_cvt_pk_bf16_f32 v206,v2,v3
v_mfma_f32_16x16x32_bf16 v[48:51],a[176:179],a[248:251],v[48:51]
s_waitcnt vmcnt(12) lgkmcnt(0)
s_barrier
v_mfma_f32_16x16x32_bf16 v[52:55],a[176:179],a[252:255],v[52:55]
ds_read_b128 a[200:203],v252 offset:32768
v_cvt_pk_bf16_f32 v207,v4,v5
v_mfma_f32_16x16x32_bf16 v[52:55],a[180:183],a[0:3],v[52:55]
s_add_u32 m0,s88,133120
v_accvgpr_read_b32 v208,a44
v_mfma_f32_16x16x32_bf16 v[68:71],a[184:187],a[0:3],v[68:71]
s_mov_b64 exec,0xffffffff
buffer_load_dwordx4 v18,s[20:23],s91 offen lds
s_mov_b64 exec,-1
v_mfma_f32_16x16x32_bf16 v[68:71],a[188:191],a[252:255],v[68:71]
ds_read_b64_tr_b16 a[168:169],v24 offset:40960
ds_read_b64_tr_b16 a[170:171],v24 offset:41472
v_mfma_f32_16x16x32_bf16 v[64:67],a[188:191],a[248:251],v[64:67]
s_add_u32 s91,s91,128
v_accvgpr_read_b32 v209,a45
v_mfma_f32_16x16x32_bf16 v[64:67],a[184:187],a[156:159],v[64:67]
s_cmp_eq_u32 s91,1280
s_cselect_b32 s91,0,s91
v_mfma_f32_16x16x32_bf16 v[60:63],a[184:187],a[152:155],v[60:63]
s_add_u32 m0,s101,73728
s_add_u32 s58,s92,4224
v_mfma_f32_16x16x32_bf16 v[60:63],a[188:191],a[244:247],v[60:63]
buffer_load_dwordx4 v15,s[24:27],s58 offen lds
v_accvgpr_read_b32 v210,a46
v_mfma_f32_16x16x32_bf16 v[56:59],a[188:191],a[240:243],v[56:59]
ds_read_b128 a[204:207],v252 offset:34816
v_accvgpr_read_b32 v211,a47
v_mfma_f32_16x16x32_bf16 v[56:59],a[184:187],a[148:151],v[56:59]
ds_read_b64_tr_b16 a[172:173],v24 offset:45056
ds_read_b64_tr_b16 a[174:175],v24 offset:45568
v_mfma_f32_16x16x32_bf16 a[132:135],a[184:187],a[16:19],a[132:135]
s_add_u32 m0,s101,75776
s_add_u32 s58,s92,135296
v_mfma_f32_16x16x32_bf16 a[132:135],a[188:191],a[144:147],a[132:135]
buffer_load_dwordx4 v15,s[24:27],s58 offen lds
v_accvgpr_read_b32 v2,a60
v_mfma_f32_16x16x32_bf16 v[72:75],a[196:199],a[240:243],v[72:75]
ds_read_b128 a[208:211],v252 offset:36864
v_accvgpr_read_b32 v3,a61
v_mfma_f32_16x16x32_bf16 v[72:75],a[192:195],a[148:151],v[72:75]
ds_read_b64_tr_b16 a[176:177],v24 offset:40968
ds_read_b64_tr_b16 a[178:179],v24 offset:41480
v_mfma_f32_16x16x32_bf16 v[76:79],a[192:195],a[152:155],v[76:79]
s_add_u32 m0,s101,77824
s_add_u32 s58,s92,266368
v_mfma_f32_16x16x32_bf16 v[76:79],a[196:199],a[244:247],v[76:79]
buffer_load_dwordx4 v15,s[24:27],s58 offen lds
v_accvgpr_read_b32 v4,a62
v_mfma_f32_16x16x32_bf16 v[136:139],a[196:199],a[248:251],v[136:139]
ds_read_b128 a[212:215],v252 offset:38912
v_accvgpr_read_b32 v5,a63
v_mfma_f32_16x16x32_bf16 v[136:139],a[192:195],a[156:159],v[136:139]
ds_read_b64_tr_b16 a[180:181],v24 offset:45064
ds_read_b64_tr_b16 a[182:183],v24 offset:45576
v_mfma_f32_16x16x32_bf16 v[140:143],a[192:195],a[0:3],v[140:143]
s_add_u32 m0,s101,79872
s_add_u32 s58,s92,397440
v_mfma_f32_16x16x32_bf16 v[140:143],a[196:199],a[252:255],v[140:143]
buffer_load_dwordx4 v15,s[24:27],s58 offen lds
v_mul_f32 v208,v208,v23
v_mfma_f32_16x16x32_bf16 v[124:127],a[160:163],a[252:255],v[124:127]
ds_read_b128 a[216:219],v254 offset:0
v_mul_f32 v209,v209,v23
v_mfma_f32_16x16x32_bf16 v[124:127],a[164:167],a[0:3],v[124:127]
s_add_u32 s92,s92,524288
v_mul_f32 v210,v210,v23
v_mfma_f32_16x16x32_bf16 v[120:123],a[164:167],a[156:159],v[120:123]
s_cmp_eq_u32 s92,5242880
s_cselect_b32 s92,0,s92
v_mfma_f32_16x16x32_bf16 v[120:123],a[160:163],a[248:251],v[120:123]
s_add_u32 s58,s90,9216
buffer_store_dwordx4 v[204:207],v10,s[36:39],s58 offen offset:2048 sc1
v_mfma_f32_16x16x32_bf16 v[116:119],a[160:163],a[244:247],v[116:119]
v_mul_f32 v211,v211,v23
v_mul_f32 v2,v2,v23
v_mfma_f32_16x16x32_bf16 v[116:119],a[164:167],a[152:155],v[116:119]
v_mul_f32 v3,v3,v23
v_mul_f32 v4,v4,v23
v_mfma_f32_16x16x32_bf16 v[112:115],a[164:167],a[148:151],v[112:115]
v_mul_f32 v5,v5,v23
v_cvt_pk_bf16_f32 v208,v208,v209
v_mfma_f32_16x16x32_bf16 v[112:115],a[160:163],a[240:243],v[112:115]
v_cvt_pk_bf16_f32 v209,v210,v211
v_cvt_pk_bf16_f32 v210,v2,v3
v_cvt_pk_bf16_f32 v211,v4,v5
s_add_u32 s58,s90,9216
buffer_store_dwordx4 v[208:211],v10,s[36:39],s58 offen offset:3072 sc1
s_waitcnt lgkmcnt(0)
v_mfma_f32_16x16x32_bf16 a[136:139],a[168:171],a[144:147],a[136:139]
ds_read_b64_tr_b16 a[184:185],v26 offset:40960
ds_read_b64_tr_b16 a[186:187],v26 offset:41472
v_mfma_f32_16x16x32_bf16 a[136:139],a[172:175],a[16:19],a[136:139]
v_accvgpr_read_b32 v212,a64
v_accvgpr_read_b32 v213,a65
v_mfma_f32_16x16x32_bf16 v[80:83],a[172:175],a[148:151],v[80:83]
ds_read_b128 a[220:223],v253 offset:32768
ds_read_b128 a[224:227],v253 offset:34816
v_mfma_f32_16x16x32_bf16 v[80:83],a[168:171],a[240:243],v[80:83]
v_accvgpr_read_b32 v214,a66
v_accvgpr_read_b32 v215,a67
v_accvgpr_read_b32 v2,a80
v_accvgpr_read_b32 v3,a81
v_accvgpr_read_b32 v4,a82
v_accvgpr_read_b32 v5,a83
v_mul_f32 v212,v212,v20
v_mul_f32 v213,v213,v20
v_mul_f32 v214,v214,v20
v_mul_f32 v215,v215,v20
v_mul_f32 v2,v2,v20
v_mul_f32 v3,v3,v20
v_mul_f32 v4,v4,v20
v_mul_f32 v5,v5,v20
v_cvt_pk_bf16_f32 v212,v212,v213
v_cvt_pk_bf16_f32 v213,v214,v215
v_cvt_pk_bf16_f32 v214,v2,v3
v_cvt_pk_bf16_f32 v215,v4,v5
s_add_u32 s58,s86,0
buffer_store_dwordx4 v[212:215],v10,s[36:39],s58 offen sc1
v_mfma_f32_16x16x32_bf16 v[84:87],a[168:171],a[244:247],v[84:87]
ds_read_b64_tr_b16 a[188:189],v26 offset:45056
ds_read_b64_tr_b16 a[190:191],v26 offset:45568
v_mfma_f32_16x16x32_bf16 v[84:87],a[172:175],a[152:155],v[84:87]
v_accvgpr_read_b32 v216,a68
v_accvgpr_read_b32 v217,a69
v_mfma_f32_16x16x32_bf16 v[88:91],a[172:175],a[156:159],v[88:91]
ds_read_b128 a[228:231],v253 offset:36864
ds_read_b128 a[232:235],v253 offset:38912
v_mfma_f32_16x16x32_bf16 v[88:91],a[168:171],a[248:251],v[88:91]
v_accvgpr_read_b32 v218,a70
v_accvgpr_read_b32 v219,a71
v_accvgpr_read_b32 v2,a84
v_accvgpr_read_b32 v3,a85
v_accvgpr_read_b32 v4,a86
v_accvgpr_read_b32 v5,a87
v_mul_f32 v216,v216,v21
v_mul_f32 v217,v217,v21
v_mul_f32 v218,v218,v21
v_mul_f32 v219,v219,v21
v_mul_f32 v2,v2,v21
v_mul_f32 v3,v3,v21
v_mul_f32 v4,v4,v21
v_mul_f32 v5,v5,v21
v_cvt_pk_bf16_f32 v216,v216,v217
v_cvt_pk_bf16_f32 v217,v218,v219
v_cvt_pk_bf16_f32 v218,v2,v3
v_cvt_pk_bf16_f32 v219,v4,v5
s_add_u32 s58,s86,0
buffer_store_dwordx4 v[216:219],v10,s[36:39],s58 offen offset:1024 sc1
v_mfma_f32_16x16x32_bf16 v[92:95],a[168:171],a[252:255],v[92:95]
ds_read_b64_tr_b16 a[192:193],v26 offset:40968
ds_read_b64_tr_b16 a[194:195],v26 offset:41480
v_mfma_f32_16x16x32_bf16 v[92:95],a[172:175],a[0:3],v[92:95]
s_cmp_eq_u32 s54,3
s_cbranch_scc1 L_arr3_o
L_arr3:
v_mfma_f32_16x16x32_bf16 v[108:111],a[180:183],a[0:3],v[108:111]
s_add_u32 m0,s101,98304
s_add_u32 s58,s92,4096
v_mfma_f32_16x16x32_bf16 v[108:111],a[176:179],a[252:255],v[108:111]
buffer_load_dwordx4 v15,s[24:27],s58 offen lds
v_accvgpr_read_b32 v220,a72
v_mfma_f32_16x16x32_bf16 v[104:107],a[176:179],a[248:251],v[104:107]
ds_read_b128 a[236:239],v255 offset:0
v_accvgpr_read_b32 v221,a73
v_mfma_f32_16x16x32_bf16 v[104:107],a[180:183],a[156:159],v[104:107]
ds_read_b64_tr_b16 a[196:197],v26 offset:45064
ds_read_b64_tr_b16 a[198:199],v26 offset:45576
v_mfma_f32_16x16x32_bf16 v[100:103],a[180:183],a[152:155],v[100:103]
s_add_u32 m0,s101,100352
s_add_u32 s58,s92,135168
v_mfma_f32_16x16x32_bf16 v[100:103],a[176:179],a[244:247],v[100:103]
buffer_load_dwordx4 v15,s[24:27],s58 offen lds
v_accvgpr_read_b32 v222,a74
v_mfma_f32_16x16x32_bf16 v[96:99],a[176:179],a[240:243],v[96:99]
s_add_u32 m0,s101,102400
s_add_u32 s58,s92,266240
v_mfma_f32_16x16x32_bf16 v[96:99],a[180:183],a[148:151],v[96:99]
v_accvgpr_read_b32 v223,a75
v_accvgpr_read_b32 v2,a88
v_mfma_f32_16x16x32_bf16 a[140:143],a[180:183],a[16:19],a[140:143]
v_accvgpr_read_b32 v3,a89
v_accvgpr_read_b32 v4,a90
v_mfma_f32_16x16x32_bf16 a[140:143],a[176:179],a[144:147],a[140:143]
buffer_load_dwordx4 v15,s[24:27],s58 offen lds
v_accvgpr_read_b32 v5,a91
s_waitcnt lgkmcnt(0)
v_mfma_f32_16x16x32_bf16 v[144:147],a[184:187],a[240:243],v[144:147]
s_waitcnt vmcnt(16)
s_barrier
v_mfma_f32_16x16x32_bf16 v[144:147],a[188:191],a[148:151],v[144:147]
ds_read_b64_tr_b16 a[164:165],v24 offset:0
ds_read_b64_tr_b16 a[166:167],v24 offset:512
v_mfma_f32_16x16x32_bf16 v[148:151],a[188:191],a[152:155],v[148:151]
s_add_u32 m0,s101,104448
s_add_u32 s58,s92,397312
v_mfma_f32_16x16x32_bf16 v[148:151],a[184:187],a[244:247],v[148:151]
buffer_load_dwordx4 v15,s[24:27],s58 offen lds
v_mul_f32 v220,v220,v22
v_mfma_f32_16x16x32_bf16 v[152:155],a[184:187],a[248:251],v[152:155]
ds_read_b64_tr_b16 a[160:161],v24 offset:4096
ds_read_b64_tr_b16 a[162:163],v24 offset:4608
v_mfma_f32_16x16x32_bf16 v[152:155],a[188:191],a[156:159],v[152:155]
s_add_u32 m0,s87,32768
s_add_u32 s58,s91,0
v_mfma_f32_16x16x32_bf16 v[156:159],a[188:191],a[0:3],v[156:159]
ds_read_b64_tr_b16 a[168:169],v24 offset:8
ds_read_b64_tr_b16 a[170:171],v24 offset:520
v_mfma_f32_16x16x32_bf16 v[156:159],a[184:187],a[252:255],v[156:159]
buffer_load_dwordx4 v16,s[20:23],s58 offen lds
v_mul_f32 v221,v221,v22
v_mfma_f32_16x16x32_bf16 v[172:175],a[192:195],a[252:255],v[172:175]
ds_read_b64_tr_b16 a[172:173],v24 offset:4104
ds_read_b64_tr_b16 a[174:175],v24 offset:4616
v_mfma_f32_16x16x32_bf16 v[172:175],a[196:199],a[0:3],v[172:175]
s_add_u32 m0,s87,33792
s_add_u32 s58,s91,10240
v_mfma_f32_16x16x32_bf16 v[168:171],a[196:199],a[156:159],v[168:171]
ds_read_b64_tr_b16 a[180:181],v26 offset:0
ds_read_b64_tr_b16 a[182:183],v26 offset:512
v_mfma_f32_16x16x32_bf16 v[168:171],a[192:195],a[248:251],v[168:171]
buffer_load_dwordx4 v17,s[20:23],s58 offen lds
v_mul_f32 v222,v222,v22
v_mfma_f32_16x16x32_bf16 v[164:167],a[192:195],a[244:247],v[164:167]
ds_read_b64_tr_b16 a[176:177],v26 offset:4096
ds_read_b64_tr_b16 a[178:179],v26 offset:4608
v_mfma_f32_16x16x32_bf16 v[164:167],a[196:199],a[152:155],v[164:167]
s_add_u32 m0,s87,34816
s_add_u32 s58,s91,20480
v_mfma_f32_16x16x32_bf16 v[160:163],a[196:199],a[148:151],v[160:163]
ds_read_b64_tr_b16 a[188:189],v26 offset:8
ds_read_b64_tr_b16 a[190:191],v26 offset:520
v_mfma_f32_16x16x32_bf16 v[160:163],a[192:195],a[240:243],v[160:163]
buffer_load_dwordx4 v16,s[20:23],s58 offen lds
v_mul_f32 v223,v223,v22
s_waitcnt lgkmcnt(4)
v_mfma_f32_16x16x32_bf16 a[128:131],a[164:167],a[216:219],a[128:131]
ds_read_b64_tr_b16 a[184:185],v26 offset:4104
ds_read_b64_tr_b16 a[186:187],v26 offset:4616
v_mfma_f32_16x16x32_bf16 a[128:131],a[160:163],a[236:239],a[128:131]
s_add_u32 m0,s87,35840
s_add_u32 s58,s91,30720
v_mfma_f32_16x16x32_bf16 v[128:131],a[160:163],a[220:223],v[128:131]
v_mul_f32 v2,v2,v22
v_mul_f32 v3,v3,v22
v_mfma_f32_16x16x32_bf16 v[128:131],a[164:167],a[200:203],v[128:131]
buffer_load_dwordx4 v17,s[20:23],s58 offen lds
v_mul_f32 v4,v4,v22
v_mfma_f32_16x16x32_bf16 v[132:135],a[164:167],a[204:207],v[132:135]
s_add_u32 m0,s88,131072
v_mul_f32 v5,v5,v22
v_mfma_f32_16x16x32_bf16 v[132:135],a[160:163],a[224:227],v[132:135]
v_cvt_pk_bf16_f32 v220,v220,v221
v_cvt_pk_bf16_f32 v221,v222,v223
v_mfma_f32_16x16x32_bf16 v[48:51],a[160:163],a[228:231],v[48:51]
s_waitcnt vmcnt(12) lgkmcnt(0)
s_barrier
v_mfma_f32_16x16x32_bf16 v[48:51],a[164:167],a[208:211],v[48:51]
s_mov_b64 exec,0xffffffff
buffer_load_dwordx4 v18,s[20:23],s91 offen lds
s_mov_b64 exec,-1
v_mfma_f32_16x16x32_bf16 v[52:55],a[164:167],a[212:215],v[52:55]
ds_read_b128 a[240:243],v252 offset:49152
v_cvt_pk_bf16_f32 v222,v2,v3
v_mfma_f32_16x16x32_bf16 v[52:55],a[160:163],a[232:235],v[52:55]
ds_read_b64_tr_b16 a[196:197],v24 offset:8192
ds_read_b64_tr_b16 a[198:199],v24 offset:8704
v_mfma_f32_16x16x32_bf16 v[68:71],a[172:175],a[232:235],v[68:71]
s_add_u32 s91,s91,128
v_cvt_pk_bf16_f32 v223,v4,v5
v_mfma_f32_16x16x32_bf16 v[68:71],a[168:171],a[212:215],v[68:71]
s_cmp_eq_u32 s91,1280
s_cselect_b32 s91,0,s91
v_mfma_f32_16x16x32_bf16 v[64:67],a[168:171],a[208:211],v[64:67]
s_add_u32 m0,s101,106496
s_add_u32 s58,s92,4224
v_mfma_f32_16x16x32_bf16 v[64:67],a[172:175],a[228:231],v[64:67]
buffer_load_dwordx4 v15,s[24:27],s58 offen lds
v_accvgpr_read_b32 v224,a76
v_mfma_f32_16x16x32_bf16 v[60:63],a[172:175],a[224:227],v[60:63]
ds_read_b128 a[244:247],v252 offset:51200
v_accvgpr_read_b32 v225,a77
v_mfma_f32_16x16x32_bf16 v[60:63],a[168:171],a[204:207],v[60:63]
ds_read_b64_tr_b16 a[192:193],v24 offset:12288
ds_read_b64_tr_b16 a[194:195],v24 offset:12800
v_mfma_f32_16x16x32_bf16 v[56:59],a[168:171],a[200:203],v[56:59]
s_add_u32 m0,s101,108544
s_add_u32 s58,s92,135296
v_mfma_f32_16x16x32_bf16 v[56:59],a[172:175],a[220:223],v[56:59]
buffer_load_dwordx4 v15,s[24:27],s58 offen lds
v_accvgpr_read_b32 v226,a78
v_mfma_f32_16x16x32_bf16 a[132:135],a[172:175],a[236:239],a[132:135]
ds_read_b128 a[248:251],v252 offset:53248
v_accvgpr_read_b32 v227,a79
v_mfma_f32_16x16x32_bf16 a[132:135],a[168:171],a[216:219],a[132:135]
ds_read_b64_tr_b16 a[164:165],v24 offset:8200
ds_read_b64_tr_b16 a[166:167],v24 offset:8712
v_mfma_f32_16x16x32_bf16 v[72:75],a[180:183],a[200:203],v[72:75]
s_add_u32 m0,s101,110592
s_add_u32 s58,s92,266368
v_mfma_f32_16x16x32_bf16 v[72:75],a[176:179],a[220:223],v[72:75]
buffer_load_dwordx4 v15,s[24:27],s58 offen lds
v_accvgpr_read_b32 v2,a92
v_mfma_f32_16x16x32_bf16 v[76:79],a[176:179],a[224:227],v[76:79]
ds_read_b128 a[252:255],v252 offset:55296
v_accvgpr_read_b32 v3,a93
v_mfma_f32_16x16x32_bf16 v[76:79],a[180:183],a[204:207],v[76:79]
ds_read_b64_tr_b16 a[160:161],v24 offset:12296
ds_read_b64_tr_b16 a[162:163],v24 offset:12808
v_mfma_f32_16x16x32_bf16 v[136:139],a[180:183],a[208:211],v[136:139]
s_add_u32 m0,s101,112640
s_add_u32 s58,s92,397440
v_mfma_f32_16x16x32_bf16 v[136:139],a[176:179],a[228:231],v[136:139]
buffer_load_dwordx4 v15,s[24:27],s58 offen lds
v_accvgpr_read_b32 v4,a94
v_mfma_f32_16x16x32_bf16 v[140:143],a[176:179],a[232:235],v[140:143]
ds_read_b128 a[144:147],v254 offset:2048
v_accvgpr_read_b32 v5,a95
v_mfma_f32_16x16x32_bf16 v[140:143],a[180:183],a[212:215],v[140:143]
s_add_u32 s92,s92,524288
v_mul_f32 v224,v224,v23
v_mfma_f32_16x16x32_bf16 v[124:127],a[188:191],a[212:215],v[124:127]
s_cmp_eq_u32 s92,5242880
s_cselect_b32 s92,0,s92
v_mfma_f32_16x16x32_bf16 v[124:127],a[184:187],a[232:235],v[124:127]
s_add_u32 s58,s86,0
buffer_store_dwordx4 v[220:223],v10,s[36:39],s58 offen offset:2048 sc1
v_mfma_f32_16x16x32_bf16 v[120:123],a[184:187],a[228:231],v[120:123]
v_mul_f32 v225,v225,v23
v_mul_f32 v226,v226,v23
v_mfma_f32_16x16x32_bf16 v[120:123],a[188:191],a[208:211],v[120:123]
v_mul_f32 v227,v227,v23
v_mul_f32 v2,v2,v23
v_mfma_f32_16x16x32_bf16 v[116:119],a[188:191],a[204:207],v[116:119]
v_mul_f32 v3,v3,v23
v_mul_f32 v4,v4,v23
v_mfma_f32_16x16x32_bf16 v[116:119],a[184:187],a[224:227],v[116:119]
v_mul_f32 v5,v5,v23
v_cvt_pk_bf16_f32 v224,v224,v225
v_cvt_pk_bf16_f32 v225,v226,v227
v_cvt_pk_bf16_f32 v226,v2,v3
v_cvt_pk_bf16_f32 v227,v4,v5
s_add_u32 s58,s86,0
buffer_store_dwordx4 v[224:227],v10,s[36:39],s58 offen offset:3072 sc1
v_mfma_f32_16x16x32_bf16 v[112:115],a[184:187],a[220:223],v[112:115]
v_accvgpr_read_b32 v228,a96
v_accvgpr_read_b32 v229,a97
v_mfma_f32_16x16x32_bf16 v[112:115],a[188:191],a[200:203],v[112:115]
v_accvgpr_read_b32 v230,a98
v_accvgpr_read_b32 v231,a99
s_waitcnt lgkmcnt(0)
v_mfma_f32_16x16x32_bf16 a[136:139],a[196:199],a[216:219],a[136:139]
ds_read_b64_tr_b16 a[172:173],v26 offset:8192
ds_read_b64_tr_b16 a[174:175],v26 offset:8704
v_mfma_f32_16x16x32_bf16 a[136:139],a[192:195],a[236:239],a[136:139]
v_accvgpr_read_b32 v2,a112
v_accvgpr_read_b32 v3,a113
v_accvgpr_read_b32 v4,a114
v_accvgpr_read_b32 v5,a115
v_mul_f32 v228,v228,v20
v_mul_f32 v229,v229,v20
v_mul_f32 v230,v230,v20
v_mul_f32 v231,v231,v20
v_mul_f32 v2,v2,v20
v_mul_f32 v3,v3,v20
v_mul_f32 v4,v4,v20
v_mul_f32 v5,v5,v20
v_cvt_pk_bf16_f32 v228,v228,v229
v_cvt_pk_bf16_f32 v229,v230,v231
v_cvt_pk_bf16_f32 v230,v2,v3
v_cvt_pk_bf16_f32 v231,v4,v5
s_add_u32 s58,s86,9216
buffer_store_dwordx4 v[228:231],v10,s[36:39],s58 offen sc1
v_mfma_f32_16x16x32_bf16 v[80:83],a[192:195],a[220:223],v[80:83]
ds_read_b128 a[148:151],v253 offset:49152
ds_read_b128 a[152:155],v253 offset:51200
v_mfma_f32_16x16x32_bf16 v[80:83],a[196:199],a[200:203],v[80:83]
v_accvgpr_read_b32 v232,a100
v_accvgpr_read_b32 v233,a101
v_mfma_f32_16x16x32_bf16 v[84:87],a[196:199],a[204:207],v[84:87]
ds_read_b64_tr_b16 a[168:169],v26 offset:12288
ds_read_b64_tr_b16 a[170:171],v26 offset:12800
v_mfma_f32_16x16x32_bf16 v[84:87],a[192:195],a[224:227],v[84:87]
v_accvgpr_read_b32 v234,a102
v_accvgpr_read_b32 v235,a103
v_accvgpr_read_b32 v2,a116
v_accvgpr_read_b32 v3,a117
v_accvgpr_read_b32 v4,a118
v_accvgpr_read_b32 v5,a119
v_mul_f32 v232,v232,v21
v_mul_f32 v233,v233,v21
v_mul_f32 v234,v234,v21
v_mul_f32 v235,v235,v21
v_mul_f32 v2,v2,v21
v_mul_f32 v3,v3,v21
v_mul_f32 v4,v4,v21
v_mul_f32 v5,v5,v21
v_cvt_pk_bf16_f32 v232,v232,v233
v_cvt_pk_bf16_f32 v233,v234,v235
v_cvt_pk_bf16_f32 v234,v2,v3
v_cvt_pk_bf16_f32 v235,v4,v5
s_add_u32 s58,s86,9216
buffer_store_dwordx4 v[232:235],v10,s[36:39],s58 offen offset:1024 sc1
v_mfma_f32_16x16x32_bf16 v[88:91],a[192:195],a[228:231],v[88:91]
ds_read_b128 a[156:159],v253 offset:53248
ds_read_b128 a[0:3],v253 offset:55296
v_mfma_f32_16x16x32_bf16 v[88:91],a[196:199],a[208:211],v[88:91]
s_cmp_eq_u32 s54,4
s_cbranch_scc1 L_arr4_o
L_arr4:
v_mfma_f32_16x16x32_bf16 v[92:95],a[196:199],a[212:215],v[92:95]
s_add_u32 m0,s101,65536
s_add_u32 s58,s92,4096
v_mfma_f32_16x16x32_bf16 v[92:95],a[192:195],a[232:235],v[92:95]
buffer_load_dwordx4 v15,s[24:27],s58 offen lds
v_accvgpr_read_b32 v236,a104
v_mfma_f32_16x16x32_bf16 v[108:111],a[160:163],a[232:235],v[108:111]
ds_read_b64_tr_b16 a[176:177],v26 offset:8200
ds_read_b64_tr_b16 a[178:179],v26 offset:8712
v_mfma_f32_16x16x32_bf16 v[108:111],a[164:167],a[212:215],v[108:111]
s_add_u32 m0,s101,67584
s_add_u32 s58,s92,135168
v_mfma_f32_16x16x32_bf16 v[104:107],a[164:167],a[208:211],v[104:107]
ds_read_b128 a[16:19],v255 offset:2048
v_accvgpr_read_b32 v237,a105
v_mfma_f32_16x16x32_bf16 v[104:107],a[160:163],a[228:231],v[104:107]
buffer_load_dwordx4 v15,s[24:27],s58 offen lds
v_accvgpr_read_b32 v238,a106
v_mfma_f32_16x16x32_bf16 v[100:103],a[160:163],a[224:227],v[100:103]
ds_read_b64_tr_b16 a[180:181],v26 offset:12296
ds_read_b64_tr_b16 a[182:183],v26 offset:12808
v_mfma_f32_16x16x32_bf16 v[100:103],a[164:167],a[204:207],v[100:103]
s_add_u32 m0,s101,69632
s_add_u32 s58,s92,266240
v_mfma_f32_16x16x32_bf16 v[96:99],a[164:167],a[200:203],v[96:99]
v_accvgpr_read_b32 v239,a107
v_accvgpr_read_b32 v2,a120
v_mfma_f32_16x16x32_bf16 v[96:99],a[160:163],a[220:223],v[96:99]
buffer_load_dwordx4 v15,s[24:27],s58 offen lds
v_accvgpr_read_b32 v3,a121
v_mfma_f32_16x16x32_bf16 a[140:143],a[160:163],a[236:239],a[140:143]
s_add_u32 m0,s101,71680
s_add_u32 s58,s92,397312
v_mfma_f32_16x16x32_bf16 a[140:143],a[164:167],a[216:219],a[140:143]
v_accvgpr_read_b32 v4,a122
v_accvgpr_read_b32 v5,a123
s_waitcnt lgkmcnt(0)
v_mfma_f32_16x16x32_bf16 v[144:147],a[172:175],a[200:203],v[144:147]
s_waitcnt vmcnt(16)
s_barrier
v_mfma_f32_16x16x32_bf16 v[144:147],a[168:171],a[220:223],v[144:147]
buffer_load_dwordx4 v15,s[24:27],s58 offen lds
v_mul_f32 v236,v236,v22
v_mfma_f32_16x16x32_bf16 v[148:151],a[168:171],a[224:227],v[148:151]
ds_read_b64_tr_b16 a[184:185],v24 offset:32768
ds_read_b64_tr_b16 a[186:187],v24 offset:33280
v_mfma_f32_16x16x32_bf16 v[148:151],a[172:175],a[204:207],v[148:151]
s_add_u32 m0,s87,49152
s_add_u32 s58,s91,0
v_mfma_f32_16x16x32_bf16 v[152:155],a[172:175],a[208:211],v[152:155]
ds_read_b64_tr_b16 a[188:189],v24 offset:36864
ds_read_b64_tr_b16 a[190:191],v24 offset:37376
v_mfma_f32_16x16x32_bf16 v[152:155],a[168:171],a[228:231],v[152:155]
buffer_load_dwordx4 v16,s[20:23],s58 offen lds
v_mul_f32 v237,v237,v22
v_mfma_f32_16x16x32_bf16 v[156:159],a[168:171],a[232:235],v[156:159]
ds_read_b64_tr_b16 a[196:197],v24 offset:32776
ds_read_b64_tr_b16 a[198:199],v24 offset:33288
v_mfma_f32_16x16x32_bf16 v[156:159],a[172:175],a[212:215],v[156:159]
s_add_u32 m0,s87,50176
s_add_u32 s58,s91,10240
v_mfma_f32_16x16x32_bf16 v[172:175],a[176:179],a[212:215],v[172:175]
ds_read_b64_tr_b16 a[192:193],v24 offset:36872
ds_read_b64_tr_b16 a[194:195],v24 offset:37384
v_mfma_f32_16x16x32_bf16 v[172:175],a[180:183],a[232:235],v[172:175]
buffer_load_dwordx4 v17,s[20:23],s58 offen lds
v_mul_f32 v238,v238,v22
v_mfma_f32_16x16x32_bf16 v[168:171],a[180:183],a[228:231],v[168:171]
ds_read_b64_tr_b16 a[160:161],v26 offset:32768
ds_read_b64_tr_b16 a[162:163],v26 offset:33280
v_mfma_f32_16x16x32_bf16 v[168:171],a[176:179],a[208:211],v[168:171]
s_add_u32 m0,s87,51200
s_add_u32 s58,s91,20480
v_mfma_f32_16x16x32_bf16 v[164:167],a[176:179],a[204:207],v[164:167]
ds_read_b64_tr_b16 a[164:165],v26 offset:36864
ds_read_b64_tr_b16 a[166:167],v26 offset:37376
v_mfma_f32_16x16x32_bf16 v[164:167],a[180:183],a[224:227],v[164:167]
buffer_load_dwordx4 v16,s[20:23],s58 offen lds
v_mul_f32 v239,v239,v22
v_mfma_f32_16x16x32_bf16 v[160:163],a[180:183],a[220:223],v[160:163]
ds_read_b64_tr_b16 a[168:169],v26 offset:32776
ds_read_b64_tr_b16 a[170:171],v26 offset:33288
v_mfma_f32_16x16x32_bf16 v[160:163],a[176:179],a[200:203],v[160:163]
s_add_u32 m0,s87,52224
s_add_u32 s58,s91,30720
s_waitcnt lgkmcnt(4)
v_mfma_f32_16x16x32_bf16 a[128:131],a[184:187],a[144:147],a[128:131]
ds_read_b64_tr_b16 a[172:173],v26 offset:36872
ds_read_b64_tr_b16 a[174:175],v26 offset:37384
v_mfma_f32_16x16x32_bf16 a[128:131],a[188:191],a[16:19],a[128:131]
buffer_load_dwordx4 v17,s[20:23],s58 offen lds
v_mul_f32 v2,v2,v22
v_mfma_f32_16x16x32_bf16 v[128:131],a[188:191],a[148:151],v[128:131]
s_add_u32 m0,s88,133120
v_mul_f32 v3,v3,v22
v_mfma_f32_16x16x32_bf16 v[128:131],a[184:187],a[240:243],v[128:131]
v_mul_f32 v4,v4,v22
v_mul_f32 v5,v5,v22
v_mfma_f32_16x16x32_bf16 v[132:135],a[184:187],a[244:247],v[132:135]
v_cvt_pk_bf16_f32 v236,v236,v237
v_cvt_pk_bf16_f32 v237,v238,v239
v_mfma_f32_16x16x32_bf16 v[132:135],a[188:191],a[152:155],v[132:135]
s_mov_b64 exec,0xffffffff
buffer_load_dwordx4 v18,s[20:23],s91 offen lds
s_mov_b64 exec,-1
v_mfma_f32_16x16x32_bf16 v[48:51],a[188:191],a[156:159],v[48:51]
s_waitcnt vmcnt(13) lgkmcnt(0)
s_barrier
v_mfma_f32_16x16x32_bf16 v[48:51],a[184:187],a[248:251],v[48:51]
ds_read_b128 a[200:203],v252 offset:32768
v_cvt_pk_bf16_f32 v238,v2,v3
v_mfma_f32_16x16x32_bf16 v[52:55],a[184:187],a[252:255],v[52:55]
s_add_u32 s91,s91,128
v_cvt_pk_bf16_f32 v239,v4,v5
v_mfma_f32_16x16x32_bf16 v[52:55],a[188:191],a[0:3],v[52:55]
s_cmp_eq_u32 s91,1280
s_cselect_b32 s91,0,s91
v_mfma_f32_16x16x32_bf16 v[68:71],a[192:195],a[0:3],v[68:71]
s_add_u32 m0,s101,73728
s_add_u32 s58,s92,4224
v_mfma_f32_16x16x32_bf16 v[68:71],a[196:199],a[252:255],v[68:71]
buffer_load_dwordx4 v15,s[24:27],s58 offen lds
v_accvgpr_read_b32 v240,a108
v_mfma_f32_16x16x32_bf16 v[64:67],a[196:199],a[248:251],v[64:67]
ds_read_b64_tr_b16 a[180:181],v24 offset:40960
ds_read_b64_tr_b16 a[182:183],v24 offset:41472
v_mfma_f32_16x16x32_bf16 v[64:67],a[192:195],a[156:159],v[64:67]
s_add_u32 m0,s101,75776
s_add_u32 s58,s92,135296
v_mfma_f32_16x16x32_bf16 v[60:63],a[192:195],a[152:155],v[60:63]
ds_read_b128 a[204:207],v252 offset:34816
v_accvgpr_read_b32 v241,a109
v_mfma_f32_16x16x32_bf16 v[60:63],a[196:199],a[244:247],v[60:63]
buffer_load_dwordx4 v15,s[24:27],s58 offen lds
v_accvgpr_read_b32 v242,a110
v_mfma_f32_16x16x32_bf16 v[56:59],a[196:199],a[240:243],v[56:59]
ds_read_b64_tr_b16 a[176:177],v24 offset:45056
ds_read_b64_tr_b16 a[178:179],v24 offset:45568
v_mfma_f32_16x16x32_bf16 v[56:59],a[192:195],a[148:151],v[56:59]
s_add_u32 m0,s101,77824
s_add_u32 s58,s92,266368
v_mfma_f32_16x16x32_bf16 a[132:135],a[192:195],a[16:19],a[132:135]
ds_read_b128 a[208:211],v252 offset:36864
v_accvgpr_read_b32 v243,a111
v_mfma_f32_16x16x32_bf16 a[132:135],a[196:199],a[144:147],a[132:135]
buffer_load_dwordx4 v15,s[24:27],s58 offen lds
v_accvgpr_read_b32 v2,a124
v_mfma_f32_16x16x32_bf16 v[72:75],a[160:163],a[240:243],v[72:75]
ds_read_b64_tr_b16 a[184:185],v24 offset:40968
ds_read_b64_tr_b16 a[186:187],v24 offset:41480
v_mfma_f32_16x16x32_bf16 v[72:75],a[164:167],a[148:151],v[72:75]
s_add_u32 m0,s101,79872
s_add_u32 s58,s92,397440
v_mfma_f32_16x16x32_bf16 v[76:79],a[164:167],a[152:155],v[76:79]
ds_read_b128 a[212:215],v252 offset:38912
v_accvgpr_read_b32 v3,a125
v_mfma_f32_16x16x32_bf16 v[76:79],a[160:163],a[244:247],v[76:79]
buffer_load_dwordx4 v15,s[24:27],s58 offen lds
v_accvgpr_read_b32 v4,a126
v_mfma_f32_16x16x32_bf16 v[136:139],a[160:163],a[248:251],v[136:139]
ds_read_b64_tr_b16 a[188:189],v24 offset:45064
ds_read_b64_tr_b16 a[190:191],v24 offset:45576
v_mfma_f32_16x16x32_bf16 v[136:139],a[164:167],a[156:159],v[136:139]
s_add_u32 s92,s92,524288
v_accvgpr_read_b32 v5,a127
v_mfma_f32_16x16x32_bf16 v[140:143],a[164:167],a[0:3],v[140:143]
s_cmp_eq_u32 s92,5242880
s_cselect_b32 s92,0,s92
v_mfma_f32_16x16x32_bf16 v[140:143],a[160:163],a[252:255],v[140:143]
s_add_u32 s58,s86,9216
buffer_store_dwordx4 v[236:239],v10,s[36:39],s58 offen offset:2048 sc1
v_mfma_f32_16x16x32_bf16 v[124:127],a[168:171],a[252:255],v[124:127]
ds_read_b128 a[216:219],v254 offset:0
v_mul_f32 v240,v240,v23
v_mfma_f32_16x16x32_bf16 v[124:127],a[172:175],a[0:3],v[124:127]
v_mul_f32 v241,v241,v23
v_mul_f32 v242,v242,v23
v_mfma_f32_16x16x32_bf16 v[120:123],a[172:175],a[156:159],v[120:123]
v_mul_f32 v243,v243,v23
v_mul_f32 v2,v2,v23
v_mfma_f32_16x16x32_bf16 v[120:123],a[168:171],a[248:251],v[120:123]
v_mul_f32 v3,v3,v23
v_mul_f32 v4,v4,v23
v_mul_f32 v5,v5,v23
v_cvt_pk_bf16_f32 v240,v240,v241
v_cvt_pk_bf16_f32 v241,v242,v243
v_cvt_pk_bf16_f32 v242,v2,v3
v_cvt_pk_bf16_f32 v243,v4,v5
s_add_u32 s58,s86,9216
buffer_store_dwordx4 v[240:243],v10,s[36:39],s58 offen offset:3072 sc1
v_mfma_f32_16x16x32_bf16 v[116:119],a[168:171],a[244:247],v[116:119]
s_cmp_eq_u32 s54,5
s_cbranch_scc1 L_arr5_o
L_arr5:
v_mfma_f32_16x16x32_bf16 v[116:119],a[172:175],a[152:155],v[116:119]
s_add_u32 m0,s101,98304
s_add_u32 s58,s92,4096
v_mfma_f32_16x16x32_bf16 v[112:115],a[172:175],a[148:151],v[112:115]
v_mfma_f32_16x16x32_bf16 v[112:115],a[168:171],a[240:243],v[112:115]
buffer_load_dwordx4 v15,s[24:27],s58 offen lds
s_waitcnt lgkmcnt(0)
v_mfma_f32_16x16x32_bf16 a[136:139],a[180:183],a[144:147],a[136:139]
ds_read_b64_tr_b16 a[192:193],v26 offset:40960
ds_read_b64_tr_b16 a[194:195],v26 offset:41472
v_mfma_f32_16x16x32_bf16 a[136:139],a[176:179],a[16:19],a[136:139]
s_add_u32 m0,s101,100352
s_add_u32 s58,s92,135168
v_mfma_f32_16x16x32_bf16 v[80:83],a[176:179],a[148:151],v[80:83]
ds_read_b128 a[220:223],v253 offset:32768
ds_read_b128 a[224:227],v253 offset:34816
v_mfma_f32_16x16x32_bf16 v[80:83],a[180:183],a[240:243],v[80:83]
buffer_load_dwordx4 v15,s[24:27],s58 offen lds
v_mfma_f32_16x16x32_bf16 v[84:87],a[180:183],a[244:247],v[84:87]
ds_read_b64_tr_b16 a[196:197],v26 offset:45056
ds_read_b64_tr_b16 a[198:199],v26 offset:45568
v_mfma_f32_16x16x32_bf16 v[84:87],a[176:179],a[152:155],v[84:87]
s_add_u32 m0,s101,102400
s_add_u32 s58,s92,266240
v_mfma_f32_16x16x32_bf16 v[88:91],a[176:179],a[156:159],v[88:91]
ds_read_b128 a[228:231],v253 offset:36864
ds_read_b128 a[232:235],v253 offset:38912
v_mfma_f32_16x16x32_bf16 v[88:91],a[180:183],a[248:251],v[88:91]
buffer_load_dwordx4 v15,s[24:27],s58 offen lds
v_mfma_f32_16x16x32_bf16 v[92:95],a[180:183],a[252:255],v[92:95]
ds_read_b64_tr_b16 a[164:165],v26 offset:40968
ds_read_b64_tr_b16 a[166:167],v26 offset:41480
v_mfma_f32_16x16x32_bf16 v[92:95],a[176:179],a[0:3],v[92:95]
s_add_u32 m0,s101,104448
s_add_u32 s58,s92,397312
v_mfma_f32_16x16x32_bf16 v[108:111],a[188:191],a[0:3],v[108:111]
ds_read_b128 a[236:239],v255 offset:0
v_mfma_f32_16x16x32_bf16 v[108:111],a[184:187],a[252:255],v[108:111]
buffer_load_dwordx4 v15,s[24:27],s58 offen lds
v_mfma_f32_16x16x32_bf16 v[104:107],a[184:187],a[248:251],v[104:107]
ds_read_b64_tr_b16 a[160:161],v26 offset:45064
ds_read_b64_tr_b16 a[162:163],v26 offset:45576
v_mfma_f32_16x16x32_bf16 v[104:107],a[188:191],a[156:159],v[104:107]
v_mfma_f32_16x16x32_bf16 v[100:103],a[188:191],a[152:155],v[100:103]
v_mfma_f32_16x16x32_bf16 v[100:103],a[184:187],a[244:247],v[100:103]
v_mfma_f32_16x16x32_bf16 v[96:99],a[184:187],a[240:243],v[96:99]
v_mfma_f32_16x16x32_bf16 v[96:99],a[188:191],a[148:151],v[96:99]
v_mfma_f32_16x16x32_bf16 a[140:143],a[188:191],a[16:19],a[140:143]
s_waitcnt vmcnt(15) lgkmcnt(0)
s_barrier
v_mfma_f32_16x16x32_bf16 a[140:143],a[184:187],a[144:147],a[140:143]
s_add_u32 m0,s87,32768
s_add_u32 s58,s91,0
v_mfma_f32_16x16x32_bf16 v[144:147],a[192:195],a[240:243],v[144:147]
buffer_load_dwordx4 v16,s[20:23],s58 offen lds
v_mfma_f32_16x16x32_bf16 v[144:147],a[196:199],a[148:151],v[144:147]
ds_read_b64_tr_b16 a[172:173],v24 offset:0
ds_read_b64_tr_b16 a[174:175],v24 offset:512
v_mfma_f32_16x16x32_bf16 v[148:151],a[196:199],a[152:155],v[148:151]
s_add_u32 m0,s87,33792
s_add_u32 s58,s91,10240
v_mfma_f32_16x16x32_bf16 v[148:151],a[192:195],a[244:247],v[148:151]
ds_read_b64_tr_b16 a[168:169],v24 offset:4096
ds_read_b64_tr_b16 a[170:171],v24 offset:4608
v_mfma_f32_16x16x32_bf16 v[152:155],a[192:195],a[248:251],v[152:155]
buffer_load_dwordx4 v17,s[20:23],s58 offen lds
v_mfma_f32_16x16x32_bf16 v[152:155],a[196:199],a[156:159],v[152:155]
ds_read_b64_tr_b16 a[180:181],v24 offset:8
ds_read_b64_tr_b16 a[182:183],v24 offset:520
v_mfma_f32_16x16x32_bf16 v[156:159],a[196:199],a[0:3],v[156:159]
s_add_u32 m0,s87,34816
s_add_u32 s58,s91,20480
v_mfma_f32_16x16x32_bf16 v[156:159],a[192:195],a[252:255],v[156:159]
ds_read_b64_tr_b16 a[176:177],v24 offset:4104
ds_read_b64_tr_b16 a[178:179],v24 offset:4616
v_mfma_f32_16x16x32_bf16 v[172:175],a[164:167],a[252:255],v[172:175]
buffer_load_dwordx4 v16,s[20:23],s58 offen lds
v_mfma_f32_16x16x32_bf16 v[172:175],a[160:163],a[0:3],v[172:175]
ds_read_b64_tr_b16 a[188:189],v26 offset:0
ds_read_b64_tr_b16 a[190:191],v26 offset:512
v_mfma_f32_16x16x32_bf16 v[168:171],a[160:163],a[156:159],v[168:171]
s_add_u32 m0,s87,35840
s_add_u32 s58,s91,30720
v_mfma_f32_16x16x32_bf16 v[168:171],a[164:167],a[248:251],v[168:171]
ds_read_b64_tr_b16 a[184:185],v26 offset:4096
ds_read_b64_tr_b16 a[186:187],v26 offset:4608
v_mfma_f32_16x16x32_bf16 v[164:167],a[164:167],a[244:247],v[164:167]
buffer_load_dwordx4 v17,s[20:23],s58 offen lds
v_mfma_f32_16x16x32_bf16 v[164:167],a[160:163],a[152:155],v[164:167]
ds_read_b64_tr_b16 a[196:197],v26 offset:8
ds_read_b64_tr_b16 a[198:199],v26 offset:520
v_mfma_f32_16x16x32_bf16 v[160:163],a[160:163],a[148:151],v[160:163]
s_add_u32 m0,s88,131072
v_mfma_f32_16x16x32_bf16 v[160:163],a[164:167],a[240:243],v[160:163]
s_waitcnt lgkmcnt(2)
v_mfma_f32_16x16x32_bf16 a[128:131],a[172:175],a[216:219],a[128:131]
s_mov_b64 exec,0xffffffff
buffer_load_dwordx4 v18,s[20:23],s91 offen lds
s_mov_b64 exec,-1
v_mfma_f32_16x16x32_bf16 a[128:131],a[168:171],a[236:239],a[128:131]
ds_read_b64_tr_b16 a[192:193],v26 offset:4104
ds_read_b64_tr_b16 a[194:195],v26 offset:4616
v_mfma_f32_16x16x32_bf16 v[128:131],a[168:171],a[220:223],v[128:131]
s_add_u32 s91,s91,128
v_mfma_f32_16x16x32_bf16 v[128:131],a[172:175],a[200:203],v[128:131]
s_cmp_eq_u32 s91,1280
s_cselect_b32 s91,0,s91
v_mfma_f32_16x16x32_bf16 v[132:135],a[172:175],a[204:207],v[132:135]
s_add_u32 m0,s101,106496
s_add_u32 s58,s92,4224
v_mfma_f32_16x16x32_bf16 v[132:135],a[168:171],a[224:227],v[132:135]
buffer_load_dwordx4 v15,s[24:27],s58 offen lds
v_mfma_f32_16x16x32_bf16 v[48:51],a[168:171],a[228:231],v[48:51]
s_add_u32 m0,s101,108544
s_add_u32 s58,s92,135296
v_mfma_f32_16x16x32_bf16 v[48:51],a[172:175],a[208:211],v[48:51]
s_waitcnt vmcnt(12) lgkmcnt(0)
s_barrier
v_mfma_f32_16x16x32_bf16 v[52:55],a[172:175],a[212:215],v[52:55]
ds_read_b128 a[240:243],v252 offset:49152
v_mfma_f32_16x16x32_bf16 v[52:55],a[168:171],a[232:235],v[52:55]
buffer_load_dwordx4 v15,s[24:27],s58 offen lds
v_mfma_f32_16x16x32_bf16 v[68:71],a[176:179],a[232:235],v[68:71]
ds_read_b64_tr_b16 a[160:161],v24 offset:8192
ds_read_b64_tr_b16 a[162:163],v24 offset:8704
v_mfma_f32_16x16x32_bf16 v[68:71],a[180:183],a[212:215],v[68:71]
s_add_u32 m0,s101,110592
s_add_u32 s58,s92,266368
v_mfma_f32_16x16x32_bf16 v[64:67],a[180:183],a[208:211],v[64:67]
ds_read_b128 a[244:247],v252 offset:51200
v_mfma_f32_16x16x32_bf16 v[64:67],a[176:179],a[228:231],v[64:67]
buffer_load_dwordx4 v15,s[24:27],s58 offen lds
v_mfma_f32_16x16x32_bf16 v[60:63],a[176:179],a[224:227],v[60:63]
ds_read_b64_tr_b16 a[164:165],v24 offset:12288
ds_read_b64_tr_b16 a[166:167],v24 offset:12800
v_mfma_f32_16x16x32_bf16 v[60:63],a[180:183],a[204:207],v[60:63]
s_add_u32 m0,s101,112640
s_add_u32 s58,s92,397440
v_mfma_f32_16x16x32_bf16 v[56:59],a[180:183],a[200:203],v[56:59]
ds_read_b128 a[248:251],v252 offset:53248
v_mfma_f32_16x16x32_bf16 v[56:59],a[176:179],a[220:223],v[56:59]
buffer_load_dwordx4 v15,s[24:27],s58 offen lds
v_mfma_f32_16x16x32_bf16 a[132:135],a[176:179],a[236:239],a[132:135]
ds_read_b64_tr_b16 a[172:173],v24 offset:8200
ds_read_b64_tr_b16 a[174:175],v24 offset:8712
v_mfma_f32_16x16x32_bf16 a[132:135],a[180:183],a[216:219],a[132:135]
s_add_u32 s92,s92,524288
v_mfma_f32_16x16x32_bf16 v[72:75],a[188:191],a[200:203],v[72:75]
s_cmp_eq_u32 s92,5242880
s_cselect_b32 s92,0,s92
v_mfma_f32_16x16x32_bf16 v[72:75],a[184:187],a[220:223],v[72:75]
s_cmp_eq_u32 s54,6
s_cbranch_scc1 L_arr6_o
L_arr6:
v_mfma_f32_16x16x32_bf16 v[76:79],a[184:187],a[224:227],v[76:79]
s_add_u32 m0,s101,65536
s_add_u32 s58,s92,4096
v_mfma_f32_16x16x32_bf16 v[76:79],a[188:191],a[204:207],v[76:79]
buffer_load_dwordx4 v15,s[24:27],s58 offen lds
v_mfma_f32_16x16x32_bf16 v[136:139],a[188:191],a[208:211],v[136:139]
ds_read_b128 a[252:255],v252 offset:55296
v_mfma_f32_16x16x32_bf16 v[136:139],a[184:187],a[228:231],v[136:139]
ds_read_b64_tr_b16 a[168:169],v24 offset:12296
ds_read_b64_tr_b16 a[170:171],v24 offset:12808
v_mfma_f32_16x16x32_bf16 v[140:143],a[184:187],a[232:235],v[140:143]
s_add_u32 m0,s101,67584
s_add_u32 s58,s92,135168
v_mfma_f32_16x16x32_bf16 v[140:143],a[188:191],a[212:215],v[140:143]
buffer_load_dwordx4 v15,s[24:27],s58 offen lds
v_mfma_f32_16x16x32_bf16 v[124:127],a[196:199],a[212:215],v[124:127]
ds_read_b128 a[144:147],v254 offset:2048
v_mfma_f32_16x16x32_bf16 v[124:127],a[192:195],a[232:235],v[124:127]
s_add_u32 m0,s101,69632
s_add_u32 s58,s92,266240
v_mfma_f32_16x16x32_bf16 v[120:123],a[192:195],a[228:231],v[120:123]
v_mfma_f32_16x16x32_bf16 v[120:123],a[196:199],a[208:211],v[120:123]
buffer_load_dwordx4 v15,s[24:27],s58 offen lds
v_mfma_f32_16x16x32_bf16 v[116:119],a[196:199],a[204:207],v[116:119]
s_add_u32 m0,s101,71680
s_add_u32 s58,s92,397312
v_mfma_f32_16x16x32_bf16 v[116:119],a[192:195],a[224:227],v[116:119]
v_mfma_f32_16x16x32_bf16 v[112:115],a[192:195],a[220:223],v[112:115]
v_mfma_f32_16x16x32_bf16 v[112:115],a[196:199],a[200:203],v[112:115]
buffer_load_dwordx4 v15,s[24:27],s58 offen lds
s_waitcnt lgkmcnt(0)
v_mfma_f32_16x16x32_bf16 a[136:139],a[160:163],a[216:219],a[136:139]
ds_read_b64_tr_b16 a[176:177],v26 offset:8192
ds_read_b64_tr_b16 a[178:179],v26 offset:8704
v_mfma_f32_16x16x32_bf16 a[136:139],a[164:167],a[236:239],a[136:139]
v_mfma_f32_16x16x32_bf16 v[80:83],a[164:167],a[220:223],v[80:83]
ds_read_b128 a[148:151],v253 offset:49152
ds_read_b128 a[152:155],v253 offset:51200
v_mfma_f32_16x16x32_bf16 v[80:83],a[160:163],a[200:203],v[80:83]
v_mfma_f32_16x16x32_bf16 v[84:87],a[160:163],a[204:207],v[84:87]
ds_read_b64_tr_b16 a[180:181],v26 offset:12288
ds_read_b64_tr_b16 a[182:183],v26 offset:12800
v_mfma_f32_16x16x32_bf16 v[84:87],a[164:167],a[224:227],v[84:87]
v_mfma_f32_16x16x32_bf16 v[88:91],a[164:167],a[228:231],v[88:91]
ds_read_b128 a[156:159],v253 offset:53248
ds_read_b128 a[0:3],v253 offset:55296
v_mfma_f32_16x16x32_bf16 v[88:91],a[160:163],a[208:211],v[88:91]
v_mfma_f32_16x16x32_bf16 v[92:95],a[160:163],a[212:215],v[92:95]
ds_read_b64_tr_b16 a[184:185],v26 offset:8200
ds_read_b64_tr_b16 a[186:187],v26 offset:8712
v_mfma_f32_16x16x32_bf16 v[92:95],a[164:167],a[232:235],v[92:95]
v_mfma_f32_16x16x32_bf16 v[108:111],a[168:171],a[232:235],v[108:111]
ds_read_b128 a[16:19],v255 offset:2048
v_mfma_f32_16x16x32_bf16 v[108:111],a[172:175],a[212:215],v[108:111]
ds_read_b64_tr_b16 a[188:189],v26 offset:12296
ds_read_b64_tr_b16 a[190:191],v26 offset:12808
v_mfma_f32_16x16x32_bf16 v[104:107],a[172:175],a[208:211],v[104:107]
v_mfma_f32_16x16x32_bf16 v[104:107],a[168:171],a[228:231],v[104:107]
v_mfma_f32_16x16x32_bf16 v[100:103],a[168:171],a[224:227],v[100:103]
v_mfma_f32_16x16x32_bf16 v[100:103],a[172:175],a[204:207],v[100:103]
v_mfma_f32_16x16x32_bf16 v[96:99],a[172:175],a[200:203],v[96:99]
v_mfma_f32_16x16x32_bf16 v[96:99],a[168:171],a[220:223],v[96:99]
s_waitcnt vmcnt(13) lgkmcnt(0)
s_barrier
v_mfma_f32_16x16x32_bf16 a[140:143],a[168:171],a[236:239],a[140:143]
s_add_u32 m0,s87,143360
s_add_u32 s58,s91,0
v_mfma_f32_16x16x32_bf16 a[140:143],a[172:175],a[216:219],a[140:143]
buffer_load_dwordx4 v16,s[20:23],s58 offen lds
v_mfma_f32_16x16x32_bf16 v[144:147],a[176:179],a[200:203],v[144:147]
ds_read_b64_tr_b16 a[192:193],v24 offset:32768
ds_read_b64_tr_b16 a[194:195],v24 offset:33280
v_mfma_f32_16x16x32_bf16 v[144:147],a[180:183],a[220:223],v[144:147]
s_add_u32 m0,s87,144384
s_add_u32 s58,s91,10240
v_mfma_f32_16x16x32_bf16 v[148:151],a[180:183],a[224:227],v[148:151]
ds_read_b64_tr_b16 a[196:197],v24 offset:36864
ds_read_b64_tr_b16 a[198:199],v24 offset:37376
v_mfma_f32_16x16x32_bf16 v[148:151],a[176:179],a[204:207],v[148:151]
buffer_load_dwordx4 v17,s[20:23],s58 offen lds
v_mfma_f32_16x16x32_bf16 v[152:155],a[176:179],a[208:211],v[152:155]
ds_read_b64_tr_b16 a[160:161],v24 offset:32776
ds_read_b64_tr_b16 a[162:163],v24 offset:33288
v_mfma_f32_16x16x32_bf16 v[152:155],a[180:183],a[228:231],v[152:155]
s_add_u32 m0,s87,145408
s_add_u32 s58,s91,20480
v_mfma_f32_16x16x32_bf16 v[156:159],a[180:183],a[232:235],v[156:159]
ds_read_b64_tr_b16 a[164:165],v24 offset:36872
ds_read_b64_tr_b16 a[166:167],v24 offset:37384
v_mfma_f32_16x16x32_bf16 v[156:159],a[176:179],a[212:215],v[156:159]
buffer_load_dwordx4 v16,s[20:23],s58 offen lds
v_mfma_f32_16x16x32_bf16 v[172:175],a[184:187],a[212:215],v[172:175]
ds_read_b64_tr_b16 a[168:169],v26 offset:32768
ds_read_b64_tr_b16 a[170:171],v26 offset:33280
v_mfma_f32_16x16x32_bf16 v[172:175],a[188:191],a[232:235],v[172:175]
s_add_u32 m0,s87,146432
s_add_u32 s58,s91,30720
v_mfma_f32_16x16x32_bf16 v[168:171],a[188:191],a[228:231],v[168:171]
ds_read_b64_tr_b16 a[172:173],v26 offset:36864
ds_read_b64_tr_b16 a[174:175],v26 offset:37376
v_mfma_f32_16x16x32_bf16 v[168:171],a[184:187],a[208:211],v[168:171]
buffer_load_dwordx4 v17,s[20:23],s58 offen lds
v_mfma_f32_16x16x32_bf16 v[164:167],a[184:187],a[204:207],v[164:167]
ds_read_b64_tr_b16 a[180:181],v26 offset:32776
ds_read_b64_tr_b16 a[182:183],v26 offset:33288
v_mfma_f32_16x16x32_bf16 v[164:167],a[188:191],a[224:227],v[164:167]
s_add_u32 m0,s88,133120
v_mfma_f32_16x16x32_bf16 v[160:163],a[188:191],a[220:223],v[160:163]
v_mfma_f32_16x16x32_bf16 v[160:163],a[184:187],a[200:203],v[160:163]
s_mov_b64 exec,0xffffffff
buffer_load_dwordx4 v18,s[20:23],s91 offen lds
s_mov_b64 exec,-1
s_waitcnt lgkmcnt(2)
v_mfma_f32_16x16x32_bf16 a[128:131],a[192:195],a[144:147],a[128:131]
ds_read_b64_tr_b16 a[176:177],v26 offset:36872
ds_read_b64_tr_b16 a[178:179],v26 offset:37384
v_mfma_f32_16x16x32_bf16 a[128:131],a[196:199],a[16:19],a[128:131]
s_add_u32 s91,s91,128
v_mfma_f32_16x16x32_bf16 v[128:131],a[196:199],a[148:151],v[128:131]
s_cmp_eq_u32 s91,1280
s_cselect_b32 s91,0,s91
v_mfma_f32_16x16x32_bf16 v[128:131],a[192:195],a[240:243],v[128:131]
s_add_u32 m0,s101,73728
s_add_u32 s58,s92,4224
v_mfma_f32_16x16x32_bf16 v[132:135],a[192:195],a[244:247],v[132:135]
buffer_load_dwordx4 v15,s[24:27],s58 offen lds
v_mfma_f32_16x16x32_bf16 v[132:135],a[196:199],a[152:155],v[132:135]
s_add_u32 m0,s101,75776
s_add_u32 s58,s92,135296
v_mfma_f32_16x16x32_bf16 v[48:51],a[196:199],a[156:159],v[48:51]
s_waitcnt vmcnt(10) lgkmcnt(0)
s_barrier
v_mfma_f32_16x16x32_bf16 v[48:51],a[192:195],a[248:251],v[48:51]
ds_read_b128 a[200:203],v252 offset:32768
v_mfma_f32_16x16x32_bf16 v[52:55],a[192:195],a[252:255],v[52:55]
buffer_load_dwordx4 v15,s[24:27],s58 offen lds
v_mfma_f32_16x16x32_bf16 v[52:55],a[196:199],a[0:3],v[52:55]
ds_read_b64_tr_b16 a[188:189],v24 offset:40960
ds_read_b64_tr_b16 a[190:191],v24 offset:41472
v_mfma_f32_16x16x32_bf16 v[68:71],a[164:167],a[0:3],v[68:71]
s_add_u32 m0,s101,77824
s_add_u32 s58,s92,266368
v_mfma_f32_16x16x32_bf16 v[68:71],a[160:163],a[252:255],v[68:71]
ds_read_b128 a[204:207],v252 offset:34816
v_mfma_f32_16x16x32_bf16 v[64:67],a[160:163],a[248:251],v[64:67]
buffer_load_dwordx4 v15,s[24:27],s58 offen lds
v_mfma_f32_16x16x32_bf16 v[64:67],a[164:167],a[156:159],v[64:67]
ds_read_b64_tr_b16 a[184:185],v24 offset:45056
ds_read_b64_tr_b16 a[186:187],v24 offset:45568
v_mfma_f32_16x16x32_bf16 v[60:63],a[164:167],a[152:155],v[60:63]
s_add_u32 m0,s101,79872
s_add_u32 s58,s92,397440
v_mfma_f32_16x16x32_bf16 v[60:63],a[160:163],a[244:247],v[60:63]
ds_read_b128 a[208:211],v252 offset:36864
v_mfma_f32_16x16x32_bf16 v[56:59],a[160:163],a[240:243],v[56:59]
buffer_load_dwordx4 v15,s[24:27],s58 offen lds
v_mfma_f32_16x16x32_bf16 v[56:59],a[164:167],a[148:151],v[56:59]
ds_read_b64_tr_b16 a[192:193],v24 offset:40968
ds_read_b64_tr_b16 a[194:195],v24 offset:41480
v_mfma_f32_16x16x32_bf16 a[132:135],a[164:167],a[16:19],a[132:135]
s_add_u32 s92,s92,524288
v_mfma_f32_16x16x32_bf16 a[132:135],a[160:163],a[144:147],a[132:135]
s_cmp_eq_u32 s92,5242880
s_cselect_b32 s92,0,s92
v_mfma_f32_16x16x32_bf16 v[72:75],a[168:171],a[240:243],v[72:75]
v_add_u32 v1,143360,v252
v_add_u32 v2,143360,v253
v_mfma_f32_16x16x32_bf16 v[72:75],a[172:175],a[148:151],v[72:75]
s_add_u32 m0,s101,98304
s_add_u32 s58,s92,4096
v_mfma_f32_16x16x32_bf16 v[76:79],a[172:175],a[152:155],v[76:79]
buffer_load_dwordx4 v15,s[24:27],s58 offen lds
v_mfma_f32_16x16x32_bf16 v[76:79],a[168:171],a[244:247],v[76:79]
ds_read_b128 a[212:215],v252 offset:38912
v_mfma_f32_16x16x32_bf16 v[136:139],a[168:171],a[248:251],v[136:139]
ds_read_b64_tr_b16 a[196:197],v24 offset:45064
ds_read_b64_tr_b16 a[198:199],v24 offset:45576
v_mfma_f32_16x16x32_bf16 v[136:139],a[172:175],a[156:159],v[136:139]
s_add_u32 m0,s101,100352
s_add_u32 s58,s92,135168
v_mfma_f32_16x16x32_bf16 v[140:143],a[172:175],a[0:3],v[140:143]
buffer_load_dwordx4 v15,s[24:27],s58 offen lds
v_mfma_f32_16x16x32_bf16 v[140:143],a[168:171],a[252:255],v[140:143]
ds_read_b128 a[216:219],v254 offset:0
v_mfma_f32_16x16x32_bf16 v[124:127],a[180:183],a[252:255],v[124:127]
s_add_u32 m0,s101,102400
s_add_u32 s58,s92,266240
v_mfma_f32_16x16x32_bf16 v[124:127],a[176:179],a[0:3],v[124:127]
v_mfma_f32_16x16x32_bf16 v[120:123],a[176:179],a[156:159],v[120:123]
buffer_load_dwordx4 v15,s[24:27],s58 offen lds
v_mfma_f32_16x16x32_bf16 v[120:123],a[180:183],a[248:251],v[120:123]
s_add_u32 m0,s101,104448
s_add_u32 s58,s92,397312
v_mfma_f32_16x16x32_bf16 v[116:119],a[180:183],a[244:247],v[116:119]
v_mfma_f32_16x16x32_bf16 v[116:119],a[176:179],a[152:155],v[116:119]
v_mfma_f32_16x16x32_bf16 v[112:115],a[176:179],a[148:151],v[112:115]
buffer_load_dwordx4 v15,s[24:27],s58 offen lds
v_mfma_f32_16x16x32_bf16 v[112:115],a[180:183],a[240:243],v[112:115]
s_waitcnt lgkmcnt(0)
v_mfma_f32_16x16x32_bf16 a[136:139],a[188:191],a[144:147],a[136:139]
ds_read_b64_tr_b16 a[164:165],v26 offset:40960
ds_read_b64_tr_b16 a[166:167],v26 offset:41472
v_mfma_f32_16x16x32_bf16 a[136:139],a[184:187],a[16:19],a[136:139]
v_mfma_f32_16x16x32_bf16 v[80:83],a[184:187],a[148:151],v[80:83]
ds_read_b128 a[220:223],v253 offset:32768
ds_read_b128 a[224:227],v253 offset:34816
v_mfma_f32_16x16x32_bf16 v[80:83],a[188:191],a[240:243],v[80:83]
v_mfma_f32_16x16x32_bf16 v[84:87],a[188:191],a[244:247],v[84:87]
ds_read_b64_tr_b16 a[160:161],v26 offset:45056
ds_read_b64_tr_b16 a[162:163],v26 offset:45568
v_mfma_f32_16x16x32_bf16 v[84:87],a[184:187],a[152:155],v[84:87]
v_mfma_f32_16x16x32_bf16 v[88:91],a[184:187],a[156:159],v[88:91]
ds_read_b128 a[228:231],v253 offset:36864
ds_read_b128 a[232:235],v253 offset:38912
v_mfma_f32_16x16x32_bf16 v[88:91],a[188:191],a[248:251],v[88:91]
v_mfma_f32_16x16x32_bf16 v[92:95],a[188:191],a[252:255],v[92:95]
ds_read_b64_tr_b16 a[172:173],v26 offset:40968
ds_read_b64_tr_b16 a[174:175],v26 offset:41480
v_mfma_f32_16x16x32_bf16 v[92:95],a[184:187],a[0:3],v[92:95]
v_mfma_f32_16x16x32_bf16 v[108:111],a[196:199],a[0:3],v[108:111]
ds_read_b128 a[236:239],v255 offset:0
v_mfma_f32_16x16x32_bf16 v[108:111],a[192:195],a[252:255],v[108:111]
ds_read_b64_tr_b16 a[168:169],v26 offset:45064
ds_read_b64_tr_b16 a[170:171],v26 offset:45576
v_mfma_f32_16x16x32_bf16 v[104:107],a[192:195],a[248:251],v[104:107]
v_mfma_f32_16x16x32_bf16 v[104:107],a[196:199],a[156:159],v[104:107]
v_mfma_f32_16x16x32_bf16 v[100:103],a[196:199],a[152:155],v[100:103]
v_mfma_f32_16x16x32_bf16 v[100:103],a[192:195],a[244:247],v[100:103]
v_mfma_f32_16x16x32_bf16 v[96:99],a[192:195],a[240:243],v[96:99]
v_mfma_f32_16x16x32_bf16 v[96:99],a[196:199],a[148:151],v[96:99]
s_waitcnt vmcnt(13) lgkmcnt(0)
s_barrier
v_mfma_f32_16x16x32_bf16 a[140:143],a[196:199],a[16:19],a[140:143]
s_add_u32 m0,s101,106496
s_add_u32 s58,s92,4224
v_mfma_f32_16x16x32_bf16 a[140:143],a[192:195],a[144:147],a[140:143]
buffer_load_dwordx4 v15,s[24:27],s58 offen lds
v_mfma_f32_16x16x32_bf16 v[144:147],a[164:167],a[240:243],v[144:147]
ds_read_b64_tr_b16 a[176:177],v24 offset:0
ds_read_b64_tr_b16 a[178:179],v24 offset:512
v_mfma_f32_16x16x32_bf16 v[144:147],a[160:163],a[148:151],v[144:147]
s_add_u32 m0,s101,108544
s_add_u32 s58,s92,135296
v_mfma_f32_16x16x32_bf16 v[148:151],a[160:163],a[152:155],v[148:151]
ds_read_b64_tr_b16 a[180:181],v24 offset:4096
ds_read_b64_tr_b16 a[182:183],v24 offset:4608
v_mfma_f32_16x16x32_bf16 v[148:151],a[164:167],a[244:247],v[148:151]
buffer_load_dwordx4 v15,s[24:27],s58 offen lds
v_mfma_f32_16x16x32_bf16 v[152:155],a[164:167],a[248:251],v[152:155]
ds_read_b64_tr_b16 a[188:189],v24 offset:8
ds_read_b64_tr_b16 a[190:191],v24 offset:520
v_mfma_f32_16x16x32_bf16 v[152:155],a[160:163],a[156:159],v[152:155]
s_add_u32 m0,s101,110592
s_add_u32 s58,s92,266368
v_mfma_f32_16x16x32_bf16 v[156:159],a[160:163],a[0:3],v[156:159]
ds_read_b64_tr_b16 a[184:185],v24 offset:4104
ds_read_b64_tr_b16 a[186:187],v24 offset:4616
v_mfma_f32_16x16x32_bf16 v[156:159],a[164:167],a[252:255],v[156:159]
buffer_load_dwordx4 v15,s[24:27],s58 offen lds
v_mfma_f32_16x16x32_bf16 v[172:175],a[172:175],a[252:255],v[172:175]
ds_read_b64_tr_b16 a[196:197],v26 offset:0
ds_read_b64_tr_b16 a[198:199],v26 offset:512
v_mfma_f32_16x16x32_bf16 v[172:175],a[168:171],a[0:3],v[172:175]
s_add_u32 m0,s101,112640
s_add_u32 s58,s92,397440
v_mfma_f32_16x16x32_bf16 v[168:171],a[168:171],a[156:159],v[168:171]
ds_read_b64_tr_b16 a[192:193],v26 offset:4096
ds_read_b64_tr_b16 a[194:195],v26 offset:4608
v_mfma_f32_16x16x32_bf16 v[168:171],a[172:175],a[248:251],v[168:171]
buffer_load_dwordx4 v15,s[24:27],s58 offen lds
v_mfma_f32_16x16x32_bf16 v[164:167],a[172:175],a[244:247],v[164:167]
ds_read_b64_tr_b16 a[160:161],v26 offset:8
ds_read_b64_tr_b16 a[162:163],v26 offset:520
v_mfma_f32_16x16x32_bf16 v[164:167],a[168:171],a[152:155],v[164:167]
s_add_u32 s92,s92,524288
v_mfma_f32_16x16x32_bf16 v[160:163],a[168:171],a[148:151],v[160:163]
s_cmp_eq_u32 s92,5242880
s_cselect_b32 s92,0,s92
v_mfma_f32_16x16x32_bf16 v[160:163],a[172:175],a[240:243],v[160:163]
s_add_u32 m0,s85,32768
s_xor_b32 s58,s11,2101248
s_waitcnt lgkmcnt(2)
v_mfma_f32_16x16x32_bf16 a[128:131],a[176:179],a[216:219],a[128:131]
buffer_load_dwordx4 v12,s[28:31],s58 offen nt lds
v_mfma_f32_16x16x32_bf16 a[128:131],a[180:183],a[236:239],a[128:131]
ds_read_b64_tr_b16 a[164:165],v26 offset:4104
ds_read_b64_tr_b16 a[166:167],v26 offset:4616
v_mfma_f32_16x16x32_bf16 v[128:131],a[180:183],a[220:223],v[128:131]
v_mfma_f32_16x16x32_bf16 v[128:131],a[176:179],a[200:203],v[128:131]
v_mfma_f32_16x16x32_bf16 v[132:135],a[176:179],a[204:207],v[132:135]
buffer_load_dwordx4 v12,s[28:31],s58 offen offset:1024 nt lds
v_mfma_f32_16x16x32_bf16 v[132:135],a[180:183],a[224:227],v[132:135]
s_add_u32 m0,s85,36864
s_xor_b32 s58,s11,2134016
v_mfma_f32_16x16x32_bf16 v[48:51],a[180:183],a[228:231],v[48:51]
v_mfma_f32_16x16x32_bf16 v[48:51],a[176:179],a[208:211],v[48:51]
s_waitcnt vmcnt(10) lgkmcnt(0)
s_barrier
v_mfma_f32_16x16x32_bf16 v[52:55],a[176:179],a[212:215],v[52:55]
buffer_load_dwordx4 v13,s[28:31],s58 offen nt lds
v_mfma_f32_16x16x32_bf16 v[52:55],a[180:183],a[232:235],v[52:55]
ds_read_b128 a[240:243],v1 offset:0
v_mfma_f32_16x16x32_bf16 v[68:71],a[184:187],a[232:235],v[68:71]
ds_read_b64_tr_b16 a[168:169],v24 offset:8192
ds_read_b64_tr_b16 a[170:171],v24 offset:8704
v_mfma_f32_16x16x32_bf16 v[68:71],a[188:191],a[212:215],v[68:71]
v_mfma_f32_16x16x32_bf16 v[64:67],a[188:191],a[208:211],v[64:67]
buffer_load_dwordx4 v13,s[28:31],s58 offen offset:1024 nt lds
v_mfma_f32_16x16x32_bf16 v[64:67],a[184:187],a[228:231],v[64:67]
ds_read_b128 a[244:247],v1 offset:2048
v_mfma_f32_16x16x32_bf16 v[60:63],a[184:187],a[224:227],v[60:63]
ds_read_b64_tr_b16 a[172:173],v24 offset:12288
ds_read_b64_tr_b16 a[174:175],v24 offset:12800
v_mfma_f32_16x16x32_bf16 v[60:63],a[188:191],a[204:207],v[60:63]
s_add_u32 m0,s85,40960
s_xor_b32 s58,s11,2109440
v_mfma_f32_16x16x32_bf16 v[56:59],a[188:191],a[200:203],v[56:59]
buffer_load_dwordx4 v12,s[28:31],s58 offen nt lds
v_mfma_f32_16x16x32_bf16 v[56:59],a[184:187],a[220:223],v[56:59]
ds_read_b128 a[248:251],v1 offset:4096
v_mfma_f32_16x16x32_bf16 a[132:135],a[184:187],a[236:239],a[132:135]
ds_read_b64_tr_b16 a[176:177],v24 offset:8200
ds_read_b64_tr_b16 a[178:179],v24 offset:8712
v_mfma_f32_16x16x32_bf16 a[132:135],a[188:191],a[216:219],a[132:135]
v_mfma_f32_16x16x32_bf16 v[72:75],a[196:199],a[200:203],v[72:75]
buffer_load_dwordx4 v12,s[28:31],s58 offen offset:1024 nt lds
v_mfma_f32_16x16x32_bf16 v[72:75],a[192:195],a[220:223],v[72:75]
ds_read_b128 a[252:255],v1 offset:6144
v_mfma_f32_16x16x32_bf16 v[76:79],a[192:195],a[224:227],v[76:79]
ds_read_b64_tr_b16 a[180:181],v24 offset:12296
ds_read_b64_tr_b16 a[182:183],v24 offset:12808
v_mfma_f32_16x16x32_bf16 v[76:79],a[196:199],a[204:207],v[76:79]
s_add_u32 m0,s85,45056
s_xor_b32 s58,s11,2142208
v_mfma_f32_16x16x32_bf16 v[136:139],a[196:199],a[208:211],v[136:139]
buffer_load_dwordx4 v13,s[28:31],s58 offen nt lds
v_mfma_f32_16x16x32_bf16 v[136:139],a[192:195],a[228:231],v[136:139]
ds_read_b128 a[144:147],v254 offset:2048
v_mfma_f32_16x16x32_bf16 v[140:143],a[192:195],a[232:235],v[140:143]
v_mfma_f32_16x16x32_bf16 v[140:143],a[196:199],a[212:215],v[140:143]
v_mfma_f32_16x16x32_bf16 v[124:127],a[160:163],a[212:215],v[124:127]
buffer_load_dwordx4 v13,s[28:31],s58 offen offset:1024 nt lds
v_mfma_f32_16x16x32_bf16 v[124:127],a[164:167],a[232:235],v[124:127]
s_add_u32 m0,s85,65536
s_xor_b32 s58,s11,2097152
v_mfma_f32_16x16x32_bf16 v[120:123],a[164:167],a[228:231],v[120:123]
v_mfma_f32_16x16x32_bf16 v[120:123],a[160:163],a[208:211],v[120:123]
v_mfma_f32_16x16x32_bf16 v[116:119],a[160:163],a[204:207],v[116:119]
buffer_load_dwordx4 v14,s[32:35],s58 offen nt lds
v_mfma_f32_16x16x32_bf16 v[116:119],a[164:167],a[224:227],v[116:119]
v_mfma_f32_16x16x32_bf16 v[112:115],a[164:167],a[220:223],v[112:115]
v_mfma_f32_16x16x32_bf16 v[112:115],a[160:163],a[200:203],v[112:115]
s_waitcnt lgkmcnt(0)
v_mfma_f32_16x16x32_bf16 a[136:139],a[168:171],a[216:219],a[136:139]
buffer_load_dwordx4 v14,s[32:35],s58 offen offset:1024 nt lds
v_mfma_f32_16x16x32_bf16 a[136:139],a[172:175],a[236:239],a[136:139]
ds_read_b64_tr_b16 a[184:185],v26 offset:8192
ds_read_b64_tr_b16 a[186:187],v26 offset:8704
v_mfma_f32_16x16x32_bf16 v[80:83],a[172:175],a[220:223],v[80:83]
s_add_u32 m0,s85,69632
s_xor_b32 s58,s11,2129920
v_mfma_f32_16x16x32_bf16 v[80:83],a[168:171],a[200:203],v[80:83]
ds_read_b128 a[148:151],v2 offset:0
ds_read_b128 a[152:155],v2 offset:2048
v_mfma_f32_16x16x32_bf16 v[84:87],a[168:171],a[204:207],v[84:87]
buffer_load_dwordx4 v14,s[32:35],s58 offen nt lds
v_mfma_f32_16x16x32_bf16 v[84:87],a[172:175],a[224:227],v[84:87]
ds_read_b64_tr_b16 a[188:189],v26 offset:12288
ds_read_b64_tr_b16 a[190:191],v26 offset:12800
v_mfma_f32_16x16x32_bf16 v[88:91],a[172:175],a[228:231],v[88:91]
v_mfma_f32_16x16x32_bf16 v[88:91],a[168:171],a[208:211],v[88:91]
ds_read_b128 a[156:159],v2 offset:4096
ds_read_b128 a[0:3],v2 offset:6144
v_mfma_f32_16x16x32_bf16 v[92:95],a[168:171],a[212:215],v[92:95]
buffer_load_dwordx4 v14,s[32:35],s58 offen offset:1024 nt lds
v_mfma_f32_16x16x32_bf16 v[92:95],a[172:175],a[232:235],v[92:95]
ds_read_b64_tr_b16 a[192:193],v26 offset:8200
ds_read_b64_tr_b16 a[194:195],v26 offset:8712
v_mfma_f32_16x16x32_bf16 v[108:111],a[180:183],a[232:235],v[108:111]
v_mfma_f32_16x16x32_bf16 v[108:111],a[176:179],a[212:215],v[108:111]
ds_read_b128 a[16:19],v255 offset:2048
v_mfma_f32_16x16x32_bf16 v[104:107],a[176:179],a[208:211],v[104:107]
ds_read_b64_tr_b16 a[196:197],v26 offset:12296
ds_read_b64_tr_b16 a[198:199],v26 offset:12808
v_mfma_f32_16x16x32_bf16 v[104:107],a[180:183],a[228:231],v[104:107]
v_mfma_f32_16x16x32_bf16 v[100:103],a[180:183],a[224:227],v[100:103]
v_mfma_f32_16x16x32_bf16 v[100:103],a[176:179],a[204:207],v[100:103]
v_mfma_f32_16x16x32_bf16 v[96:99],a[176:179],a[200:203],v[96:99]
v_mfma_f32_16x16x32_bf16 v[96:99],a[180:183],a[220:223],v[96:99]
v_mfma_f32_16x16x32_bf16 a[140:143],a[180:183],a[236:239],a[140:143]
s_waitcnt vmcnt(12) lgkmcnt(0)
s_barrier
v_mfma_f32_16x16x32_bf16 a[140:143],a[176:179],a[216:219],a[140:143]
s_add_u32 m0,s85,73728
s_xor_b32 s58,s11,2105344
v_mfma_f32_16x16x32_bf16 v[144:147],a[184:187],a[200:203],v[144:147]
buffer_load_dwordx4 v14,s[32:35],s58 offen nt lds
v_mfma_f32_16x16x32_bf16 v[144:147],a[188:191],a[220:223],v[144:147]
ds_read_b64_tr_b16 a[164:165],v24 offset:32768
ds_read_b64_tr_b16 a[166:167],v24 offset:33280
v_mfma_f32_16x16x32_bf16 v[148:151],a[188:191],a[224:227],v[148:151]
v_mfma_f32_16x16x32_bf16 v[148:151],a[184:187],a[204:207],v[148:151]
ds_read_b64_tr_b16 a[160:161],v24 offset:36864
ds_read_b64_tr_b16 a[162:163],v24 offset:37376
v_mfma_f32_16x16x32_bf16 v[152:155],a[184:187],a[208:211],v[152:155]
buffer_load_dwordx4 v14,s[32:35],s58 offen offset:1024 nt lds
v_mfma_f32_16x16x32_bf16 v[152:155],a[188:191],a[228:231],v[152:155]
ds_read_b64_tr_b16 a[168:169],v24 offset:32776
ds_read_b64_tr_b16 a[170:171],v24 offset:33288
v_mfma_f32_16x16x32_bf16 v[156:159],a[188:191],a[232:235],v[156:159]
s_add_u32 m0,s85,77824
s_xor_b32 s58,s11,2138112
v_mfma_f32_16x16x32_bf16 v[156:159],a[184:187],a[212:215],v[156:159]
ds_read_b64_tr_b16 a[172:173],v24 offset:36872
ds_read_b64_tr_b16 a[174:175],v24 offset:37384
v_mfma_f32_16x16x32_bf16 v[172:175],a[192:195],a[212:215],v[172:175]
buffer_load_dwordx4 v14,s[32:35],s58 offen nt lds
v_mfma_f32_16x16x32_bf16 v[172:175],a[196:199],a[232:235],v[172:175]
ds_read_b64_tr_b16 a[180:181],v24 offset:40960
ds_read_b64_tr_b16 a[182:183],v24 offset:41472
v_mfma_f32_16x16x32_bf16 v[168:171],a[196:199],a[228:231],v[168:171]
v_mfma_f32_16x16x32_bf16 v[168:171],a[192:195],a[208:211],v[168:171]
ds_read_b64_tr_b16 a[176:177],v24 offset:45056
ds_read_b64_tr_b16 a[178:179],v24 offset:45568
v_mfma_f32_16x16x32_bf16 v[164:167],a[192:195],a[204:207],v[164:167]
buffer_load_dwordx4 v14,s[32:35],s58 offen offset:1024 nt lds
v_mfma_f32_16x16x32_bf16 v[164:167],a[196:199],a[224:227],v[164:167]
ds_read_b64_tr_b16 a[188:189],v24 offset:40968
ds_read_b64_tr_b16 a[190:191],v24 offset:41480
v_mfma_f32_16x16x32_bf16 v[160:163],a[196:199],a[220:223],v[160:163]
v_mfma_f32_16x16x32_bf16 v[160:163],a[192:195],a[200:203],v[160:163]
s_waitcnt lgkmcnt(2)
v_mfma_f32_16x16x32_bf16 a[128:131],a[164:167],a[144:147],a[128:131]
ds_read_b64_tr_b16 a[184:185],v24 offset:45064
ds_read_b64_tr_b16 a[186:187],v24 offset:45576
v_mfma_f32_16x16x32_bf16 a[128:131],a[160:163],a[16:19],a[128:131]
v_mfma_f32_16x16x32_bf16 v[128:131],a[160:163],a[148:151],v[128:131]
ds_read_b64_tr_b16 a[196:197],v26 offset:32768
ds_read_b64_tr_b16 a[198:199],v26 offset:33280
v_mfma_f32_16x16x32_bf16 v[128:131],a[164:167],a[240:243],v[128:131]
v_mfma_f32_16x16x32_bf16 v[132:135],a[164:167],a[244:247],v[132:135]
ds_read_b64_tr_b16 a[192:193],v26 offset:36864
ds_read_b64_tr_b16 a[194:195],v26 offset:37376
v_mfma_f32_16x16x32_bf16 v[132:135],a[160:163],a[152:155],v[132:135]
v_mfma_f32_16x16x32_bf16 v[48:51],a[160:163],a[156:159],v[48:51]
v_mfma_f32_16x16x32_bf16 v[48:51],a[164:167],a[248:251],v[48:51]
v_mfma_f32_16x16x32_bf16 v[52:55],a[164:167],a[252:255],v[52:55]
ds_read_b64_tr_b16 a[164:165],v26 offset:32776
ds_read_b64_tr_b16 a[166:167],v26 offset:33288
v_mfma_f32_16x16x32_bf16 v[52:55],a[160:163],a[0:3],v[52:55]
v_mul_f32 v128,s74,v128
v_mul_f32 v129,s74,v129
v_mfma_f32_16x16x32_bf16 a[132:135],a[172:175],a[16:19],a[132:135]
ds_read_b64_tr_b16 a[160:161],v26 offset:36872
ds_read_b64_tr_b16 a[162:163],v26 offset:37384
v_mfma_f32_16x16x32_bf16 a[132:135],a[168:171],a[144:147],a[132:135]
v_mul_f32 v130,s74,v130
v_mul_f32 v131,s74,v131
v_mfma_f32_16x16x32_bf16 v[56:59],a[168:171],a[240:243],v[56:59]
v_mul_f32 v132,s74,v132
v_mul_f32 v133,s74,v133
v_mfma_f32_16x16x32_bf16 v[56:59],a[172:175],a[148:151],v[56:59]
v_mul_f32 v134,s74,v134
v_mul_f32 v135,s74,v135
v_mfma_f32_16x16x32_bf16 v[60:63],a[172:175],a[152:155],v[60:63]
v_mul_f32 v48,s74,v48
v_mul_f32 v49,s74,v49
v_mfma_f32_16x16x32_bf16 v[60:63],a[168:171],a[244:247],v[60:63]
v_mul_f32 v50,s74,v50
v_mul_f32 v51,s74,v51
v_mfma_f32_16x16x32_bf16 v[64:67],a[168:171],a[248:251],v[64:67]
v_mul_f32 v52,s74,v52
v_mul_f32 v53,s74,v53
v_mfma_f32_16x16x32_bf16 v[64:67],a[172:175],a[156:159],v[64:67]
v_mul_f32 v54,s74,v54
v_mul_f32 v55,s74,v55
v_mfma_f32_16x16x32_bf16 v[68:71],a[172:175],a[0:3],v[68:71]
ds_read_b64_tr_b16 a[172:173],v26 offset:40960
ds_read_b64_tr_b16 a[174:175],v26 offset:41472
v_mfma_f32_16x16x32_bf16 v[68:71],a[168:171],a[252:255],v[68:71]
v_cvt_pk_bf16_f32 v180,v128,v129
v_cvt_pk_bf16_f32 v181,v130,v131
v_mfma_f32_16x16x32_bf16 a[136:139],a[180:183],a[144:147],a[136:139]
v_cvt_pk_bf16_f32 v196,v132,v133
v_cvt_pk_bf16_f32 v197,v134,v135
v_mfma_f32_16x16x32_bf16 a[136:139],a[176:179],a[16:19],a[136:139]
v_cvt_pk_bf16_f32 v212,v48,v49
v_cvt_pk_bf16_f32 v213,v50,v51
v_mfma_f32_16x16x32_bf16 v[80:83],a[176:179],a[148:151],v[80:83]
v_cvt_pk_bf16_f32 v228,v52,v53
v_cvt_pk_bf16_f32 v229,v54,v55
v_mfma_f32_16x16x32_bf16 v[80:83],a[180:183],a[240:243],v[80:83]
v_mul_f32 v56,s74,v56
v_mul_f32 v57,s74,v57
v_mfma_f32_16x16x32_bf16 v[84:87],a[180:183],a[244:247],v[84:87]
v_mul_f32 v58,s74,v58
v_mul_f32 v59,s74,v59
v_mfma_f32_16x16x32_bf16 v[84:87],a[176:179],a[152:155],v[84:87]
v_mul_f32 v60,s74,v60
v_mul_f32 v61,s74,v61
v_mfma_f32_16x16x32_bf16 v[88:91],a[176:179],a[156:159],v[88:91]
v_mul_f32 v62,s74,v62
v_mul_f32 v63,s74,v63
v_mfma_f32_16x16x32_bf16 v[88:91],a[180:183],a[248:251],v[88:91]
v_mul_f32 v64,s74,v64
v_mul_f32 v65,s74,v65
v_mfma_f32_16x16x32_bf16 v[92:95],a[180:183],a[252:255],v[92:95]
v_mul_f32 v66,s74,v66
v_mul_f32 v67,s74,v67
v_mfma_f32_16x16x32_bf16 v[92:95],a[176:179],a[0:3],v[92:95]
v_mul_f32 v68,s74,v68
v_mul_f32 v69,s74,v69
s_waitcnt lgkmcnt(0)
v_mfma_f32_16x16x32_bf16 a[140:143],a[184:187],a[16:19],a[140:143]
ds_read_b64_tr_b16 a[168:169],v26 offset:45056
ds_read_b64_tr_b16 a[170:171],v26 offset:45568
v_mfma_f32_16x16x32_bf16 a[140:143],a[188:191],a[144:147],a[140:143]
v_mul_f32 v70,s74,v70
v_mul_f32 v71,s74,v71
v_mfma_f32_16x16x32_bf16 v[96:99],a[188:191],a[240:243],v[96:99]
ds_read_b64_tr_b16 a[180:181],v26 offset:40968
ds_read_b64_tr_b16 a[182:183],v26 offset:41480
v_mfma_f32_16x16x32_bf16 v[96:99],a[184:187],a[148:151],v[96:99]
v_cvt_pk_bf16_f32 v182,v56,v57
v_cvt_pk_bf16_f32 v183,v58,v59
v_mfma_f32_16x16x32_bf16 v[100:103],a[184:187],a[152:155],v[100:103]
ds_read_b64_tr_b16 a[176:177],v26 offset:45064
ds_read_b64_tr_b16 a[178:179],v26 offset:45576
v_mfma_f32_16x16x32_bf16 v[100:103],a[188:191],a[244:247],v[100:103]
v_cvt_pk_bf16_f32 v198,v60,v61
v_cvt_pk_bf16_f32 v199,v62,v63
v_mfma_f32_16x16x32_bf16 v[104:107],a[188:191],a[248:251],v[104:107]
v_cvt_pk_bf16_f32 v214,v64,v65
v_cvt_pk_bf16_f32 v215,v66,v67
v_mfma_f32_16x16x32_bf16 v[104:107],a[184:187],a[156:159],v[104:107]
v_cvt_pk_bf16_f32 v230,v68,v69
v_cvt_pk_bf16_f32 v231,v70,v71
v_mfma_f32_16x16x32_bf16 v[108:111],a[184:187],a[0:3],v[108:111]
v_mul_f32 v80,s74,v80
v_mul_f32 v81,s74,v81
v_mfma_f32_16x16x32_bf16 v[108:111],a[188:191],a[252:255],v[108:111]
v_mul_f32 v82,s74,v82
v_mul_f32 v83,s74,v83
v_mfma_f32_16x16x32_bf16 v[72:75],a[196:199],a[240:243],v[72:75]
v_mul_f32 v84,s74,v84
v_mul_f32 v85,s74,v85
v_mfma_f32_16x16x32_bf16 v[72:75],a[192:195],a[148:151],v[72:75]
v_mul_f32 v86,s74,v86
v_mul_f32 v87,s74,v87
v_mfma_f32_16x16x32_bf16 v[76:79],a[192:195],a[152:155],v[76:79]
v_mul_f32 v88,s74,v88
v_mul_f32 v89,s74,v89
v_mfma_f32_16x16x32_bf16 v[76:79],a[196:199],a[244:247],v[76:79]
v_mul_f32 v90,s74,v90
v_mul_f32 v91,s74,v91
v_mfma_f32_16x16x32_bf16 v[136:139],a[196:199],a[248:251],v[136:139]
v_mul_f32 v92,s74,v92
v_mul_f32 v93,s74,v93
v_mfma_f32_16x16x32_bf16 v[136:139],a[192:195],a[156:159],v[136:139]
v_mul_f32 v94,s74,v94
v_mul_f32 v95,s74,v95
v_mfma_f32_16x16x32_bf16 v[140:143],a[192:195],a[0:3],v[140:143]
v_cvt_pk_bf16_f32 v188,v80,v81
v_cvt_pk_bf16_f32 v189,v82,v83
v_mfma_f32_16x16x32_bf16 v[140:143],a[196:199],a[252:255],v[140:143]
v_cvt_pk_bf16_f32 v204,v84,v85
v_cvt_pk_bf16_f32 v205,v86,v87
v_mfma_f32_16x16x32_bf16 v[112:115],a[164:167],a[240:243],v[112:115]
v_cvt_pk_bf16_f32 v220,v88,v89
v_cvt_pk_bf16_f32 v221,v90,v91
v_mfma_f32_16x16x32_bf16 v[112:115],a[160:163],a[148:151],v[112:115]
v_cvt_pk_bf16_f32 v236,v92,v93
v_cvt_pk_bf16_f32 v237,v94,v95
v_mfma_f32_16x16x32_bf16 v[116:119],a[160:163],a[152:155],v[116:119]
v_mul_f32 v96,s74,v96
v_mul_f32 v97,s74,v97
v_mfma_f32_16x16x32_bf16 v[116:119],a[164:167],a[244:247],v[116:119]
v_mul_f32 v98,s74,v98
v_mul_f32 v99,s74,v99
v_mfma_f32_16x16x32_bf16 v[120:123],a[164:167],a[248:251],v[120:123]
v_mul_f32 v100,s74,v100
v_mul_f32 v101,s74,v101
v_mfma_f32_16x16x32_bf16 v[120:123],a[160:163],a[156:159],v[120:123]
v_mul_f32 v102,s74,v102
v_mul_f32 v103,s74,v103
v_mfma_f32_16x16x32_bf16 v[124:127],a[160:163],a[0:3],v[124:127]
v_mul_f32 v104,s74,v104
v_mul_f32 v105,s74,v105
v_mfma_f32_16x16x32_bf16 v[124:127],a[164:167],a[252:255],v[124:127]
v_mul_f32 v106,s74,v106
v_mul_f32 v107,s74,v107
v_mfma_f32_16x16x32_bf16 v[144:147],a[172:175],a[240:243],v[144:147]
v_mul_f32 v108,s74,v108
v_mul_f32 v109,s74,v109
s_waitcnt lgkmcnt(0)
v_mfma_f32_16x16x32_bf16 v[144:147],a[168:171],a[148:151],v[144:147]
v_mul_f32 v110,s74,v110
v_mul_f32 v111,s74,v111
v_mfma_f32_16x16x32_bf16 v[148:151],a[168:171],a[152:155],v[148:151]
v_cvt_pk_bf16_f32 v190,v96,v97
v_cvt_pk_bf16_f32 v191,v98,v99
v_mfma_f32_16x16x32_bf16 v[148:151],a[172:175],a[244:247],v[148:151]
v_cvt_pk_bf16_f32 v206,v100,v101
v_cvt_pk_bf16_f32 v207,v102,v103
v_cvt_pk_bf16_f32 v222,v104,v105
v_cvt_pk_bf16_f32 v223,v106,v107
v_cvt_pk_bf16_f32 v238,v108,v109
v_cvt_pk_bf16_f32 v239,v110,v111
v_accvgpr_read_b32 v192,a128
v_accvgpr_read_b32 v193,a129
v_accvgpr_read_b32 v194,a130
v_accvgpr_read_b32 v195,a131
v_accvgpr_read_b32 v208,a132
v_accvgpr_read_b32 v209,a133
v_accvgpr_read_b32 v210,a134
v_accvgpr_read_b32 v211,a135
v_accvgpr_read_b32 v224,a136
v_accvgpr_read_b32 v225,a137
v_accvgpr_read_b32 v226,a138
v_accvgpr_read_b32 v227,a139
v_accvgpr_read_b32 v240,a140
v_accvgpr_read_b32 v241,a141
v_accvgpr_read_b32 v242,a142
v_accvgpr_read_b32 v243,a143
v_mul_f32 v192,s74,v192
v_mul_f32 v193,s74,v193
v_mul_f32 v194,s74,v194
v_mul_f32 v195,s74,v195
v_mul_f32 v208,s74,v208
v_mul_f32 v209,s74,v209
v_mul_f32 v210,s74,v210
v_mul_f32 v211,s74,v211
v_mul_f32 v224,s74,v224
v_mul_f32 v225,s74,v225
v_mul_f32 v226,s74,v226
v_mul_f32 v227,s74,v227
v_mul_f32 v240,s74,v240
v_mul_f32 v241,s74,v241
v_mul_f32 v242,s74,v242
v_mul_f32 v243,s74,v243
v_cvt_pk_bf16_f32 v128,v192,v193
v_cvt_pk_bf16_f32 v129,v194,v195
v_cvt_pk_bf16_f32 v130,v208,v209
v_cvt_pk_bf16_f32 v131,v210,v211
v_cvt_pk_bf16_f32 v132,v224,v225
v_cvt_pk_bf16_f32 v133,v226,v227
v_cvt_pk_bf16_f32 v134,v240,v241
v_cvt_pk_bf16_f32 v135,v242,v243
s_lshl_b32 s59,s48,11
s_add_u32 s59,s59,135168
v_add_u32 v6,s59,v10
v_xor_b32 v7,2048,v6
ds_write_b128 v6,v[128:131] offset:0
ds_write_b128 v6,v[132:135] offset:1024
s_waitcnt lgkmcnt(0)
s_barrier
v_mfma_f32_16x16x32_bf16 v[152:155],a[172:175],a[248:251],v[152:155]
s_add_u32 m0,s85,98304
s_xor_b32 s58,s11,2101248
v_mfma_f32_16x16x32_bf16 v[152:155],a[168:171],a[156:159],v[152:155]
buffer_load_dwordx4 v14,s[32:35],s58 offen nt lds
v_mul_f32 v72,s74,v72
v_mfma_f32_16x16x32_bf16 v[156:159],a[168:171],a[0:3],v[156:159]
ds_read_b128 a[184:187],v40 offset:0
ds_read_b128 a[188:191],v40 offset:1024
v_mfma_f32_16x16x32_bf16 v[156:159],a[172:175],a[252:255],v[156:159]
v_mul_f32 v73,s74,v73
v_mul_f32 v74,s74,v74
v_mfma_f32_16x16x32_bf16 v[160:163],a[180:183],a[240:243],v[160:163]
ds_read_b128 a[192:195],v41 offset:0
ds_read_b128 a[196:199],v41 offset:1024
v_mfma_f32_16x16x32_bf16 v[160:163],a[176:179],a[148:151],v[160:163]
buffer_load_dwordx4 v14,s[32:35],s58 offen offset:1024 nt lds
v_mul_f32 v75,s74,v75
v_mfma_f32_16x16x32_bf16 v[164:167],a[176:179],a[152:155],v[164:167]
ds_read_b128 a[160:163],v42 offset:0
ds_read_b128 a[164:167],v42 offset:1024
v_mfma_f32_16x16x32_bf16 v[164:167],a[180:183],a[244:247],v[164:167]
s_add_u32 m0,s85,102400
s_xor_b32 s58,s11,2134016
v_mfma_f32_16x16x32_bf16 v[168:171],a[180:183],a[248:251],v[168:171]
ds_read_b128 a[168:171],v43 offset:0
ds_read_b128 a[172:175],v43 offset:1024
v_mfma_f32_16x16x32_bf16 v[168:171],a[176:179],a[156:159],v[168:171]
buffer_load_dwordx4 v14,s[32:35],s58 offen nt lds
v_mul_f32 v76,s74,v76
v_mfma_f32_16x16x32_bf16 v[172:175],a[176:179],a[0:3],v[172:175]
ds_read_b128 a[176:179],v44 offset:0
v_mul_f32 v77,s74,v77
v_mfma_f32_16x16x32_bf16 v[172:175],a[180:183],a[252:255],v[172:175]
ds_read_b128 a[180:183],v45 offset:0
v_mul_f32 v78,s74,v78
v_mul_f32 v79,s74,v79
v_mul_f32 v136,s74,v136
v_mul_f32 v137,s74,v137
v_mul_f32 v138,s74,v138
v_mul_f32 v139,s74,v139
v_mul_f32 v140,s74,v140
v_mul_f32 v141,s74,v141
v_mul_f32 v142,s74,v142
v_mul_f32 v143,s74,v143
v_cvt_pk_bf16_f32 v184,v72,v73
v_cvt_pk_bf16_f32 v185,v74,v75
v_cvt_pk_bf16_f32 v200,v76,v77
v_cvt_pk_bf16_f32 v201,v78,v79
v_cvt_pk_bf16_f32 v216,v136,v137
v_cvt_pk_bf16_f32 v217,v138,v139
v_cvt_pk_bf16_f32 v232,v140,v141
v_cvt_pk_bf16_f32 v233,v142,v143
v_mul_f32 v112,s74,v112
v_mul_f32 v113,s74,v113
v_mul_f32 v114,s74,v114
v_mul_f32 v115,s74,v115
v_mul_f32 v116,s74,v116
v_mul_f32 v117,s74,v117
v_mul_f32 v118,s74,v118
v_mul_f32 v119,s74,v119
v_mul_f32 v120,s74,v120
v_mul_f32 v121,s74,v121
v_mul_f32 v122,s74,v122
v_mul_f32 v123,s74,v123
v_mul_f32 v124,s74,v124
v_mul_f32 v125,s74,v125
v_mul_f32 v126,s74,v126
v_mul_f32 v127,s74,v127
v_cvt_pk_bf16_f32 v186,v112,v113
v_cvt_pk_bf16_f32 v187,v114,v115
v_cvt_pk_bf16_f32 v202,v116,v117
v_cvt_pk_bf16_f32 v203,v118,v119
v_cvt_pk_bf16_f32 v218,v120,v121
v_cvt_pk_bf16_f32 v219,v122,v123
v_cvt_pk_bf16_f32 v234,v124,v125
v_cvt_pk_bf16_f32 v235,v126,v127
s_waitcnt lgkmcnt(4)
v_mfma_f32_16x16x32_bf16 v[48:51],a[184:187],v[180:183],0
v_mul_f32 v144,s74,v144
v_mul_f32 v145,s74,v145
v_mfma_f32_16x16x32_bf16 v[56:59],a[184:187],v[196:199],0
v_mul_f32 v146,s74,v146
v_mul_f32 v147,s74,v147
v_mfma_f32_16x16x32_bf16 v[64:67],a[184:187],v[212:215],0
v_mul_f32 v148,s74,v148
v_mul_f32 v149,s74,v149
v_mfma_f32_16x16x32_bf16 v[72:75],a[184:187],v[228:231],0
ds_read_b128 a[184:187],v45 offset:1024
v_mul_f32 v150,s74,v150
v_mfma_f32_16x16x32_bf16 v[52:55],a[188:191],v[180:183],0
buffer_load_dwordx4 v14,s[32:35],s58 offen offset:1024 nt lds
v_mul_f32 v151,s74,v151
v_mfma_f32_16x16x32_bf16 v[60:63],a[188:191],v[196:199],0
s_add_u32 m0,s85,106496
s_xor_b32 s58,s11,2109440
v_mfma_f32_16x16x32_bf16 v[68:71],a[188:191],v[212:215],0
v_mul_f32 v152,s74,v152
v_mul_f32 v153,s74,v153
v_mfma_f32_16x16x32_bf16 v[76:79],a[188:191],v[228:231],0
ds_read_b128 a[188:191],v44 offset:1024
v_mul_f32 v154,s74,v154
v_mfma_f32_16x16x32_bf16 v[48:51],a[192:195],v[184:187],v[48:51]
v_mul_f32 v155,s74,v155
v_mul_f32 v156,s74,v156
v_mfma_f32_16x16x32_bf16 v[56:59],a[192:195],v[200:203],v[56:59]
v_mul_f32 v157,s74,v157
v_mul_f32 v158,s74,v158
v_mfma_f32_16x16x32_bf16 v[64:67],a[192:195],v[216:219],v[64:67]
v_mul_f32 v159,s74,v159
v_cvt_pk_bf16_f32 v192,v144,v145
v_mfma_f32_16x16x32_bf16 v[72:75],a[192:195],v[232:235],v[72:75]
buffer_load_dwordx4 v14,s[32:35],s58 offen nt lds
v_cvt_pk_bf16_f32 v193,v146,v147
v_mfma_f32_16x16x32_bf16 v[52:55],a[196:199],v[184:187],v[52:55]
ds_read_b128 a[192:195],v46 offset:0
v_cvt_pk_bf16_f32 v208,v148,v149
v_mfma_f32_16x16x32_bf16 v[60:63],a[196:199],v[200:203],v[60:63]
v_cvt_pk_bf16_f32 v209,v150,v151
v_cvt_pk_bf16_f32 v224,v152,v153
v_mfma_f32_16x16x32_bf16 v[68:71],a[196:199],v[216:219],v[68:71]
v_cvt_pk_bf16_f32 v225,v154,v155
v_cvt_pk_bf16_f32 v240,v156,v157
v_mfma_f32_16x16x32_bf16 v[76:79],a[196:199],v[232:235],v[76:79]
ds_read_b128 a[196:199],v47 offset:0
v_cvt_pk_bf16_f32 v241,v158,v159
ds_read_b128 v[136:139],v7 offset:0
ds_read_b128 v[140:143],v7 offset:1024
v_mfma_f32_16x16x32_bf16 v[48:51],a[160:163],v[188:191],v[48:51]
v_mul_f32 v160,s74,v160
v_mul_f32 v161,s74,v161
v_mfma_f32_16x16x32_bf16 v[56:59],a[160:163],v[204:207],v[56:59]
v_mul_f32 v162,s74,v162
v_mul_f32 v163,s74,v163
v_mfma_f32_16x16x32_bf16 v[64:67],a[160:163],v[220:223],v[64:67]
buffer_load_dwordx4 v14,s[32:35],s58 offen offset:1024 nt lds
v_mul_f32 v164,s74,v164
v_mfma_f32_16x16x32_bf16 v[72:75],a[160:163],v[236:239],v[72:75]
ds_read_b128 a[160:163],v47 offset:1024
v_mul_f32 v165,s74,v165
v_mfma_f32_16x16x32_bf16 v[52:55],a[164:167],v[188:191],v[52:55]
s_add_u32 m0,s85,110592
s_xor_b32 s58,s11,2142208
v_mfma_f32_16x16x32_bf16 v[60:63],a[164:167],v[204:207],v[60:63]
v_mul_f32 v166,s74,v166
v_mul_f32 v167,s74,v167
v_mfma_f32_16x16x32_bf16 v[68:71],a[164:167],v[220:223],v[68:71]
v_mul_f32 v168,s74,v168
v_mul_f32 v169,s74,v169
v_mfma_f32_16x16x32_bf16 v[76:79],a[164:167],v[236:239],v[76:79]
ds_read_b128 a[164:167],v46 offset:1024
v_mul_f32 v170,s74,v170
v_mul_f32 v171,s74,v171
v_mul_f32 v172,s74,v172
v_mul_f32 v173,s74,v173
v_mul_f32 v174,s74,v174
v_mul_f32 v175,s74,v175
v_cvt_pk_bf16_f32 v194,v160,v161
v_cvt_pk_bf16_f32 v195,v162,v163
v_cvt_pk_bf16_f32 v210,v164,v165
v_cvt_pk_bf16_f32 v211,v166,v167
v_cvt_pk_bf16_f32 v226,v168,v169
v_cvt_pk_bf16_f32 v227,v170,v171
v_cvt_pk_bf16_f32 v242,v172,v173
v_cvt_pk_bf16_f32 v243,v174,v175
s_waitcnt lgkmcnt(1)
v_mfma_f32_16x16x32_bf16 v[48:51],a[168:171],v[192:195],v[48:51]
v_mfma_f32_16x16x32_bf16 v[56:59],a[168:171],v[208:211],v[56:59]
buffer_load_dwordx4 v14,s[32:35],s58 offen nt lds
v_mfma_f32_16x16x32_bf16 v[64:67],a[168:171],v[224:227],v[64:67]
v_mfma_f32_16x16x32_bf16 v[72:75],a[168:171],v[240:243],v[72:75]
v_mfma_f32_16x16x32_bf16 v[52:55],a[172:175],v[192:195],v[52:55]
v_mfma_f32_16x16x32_bf16 v[60:63],a[172:175],v[208:211],v[60:63]
buffer_load_dwordx4 v14,s[32:35],s58 offen offset:1024 nt lds
v_xor_b32 v24,v19,v24
v_xor_b32 v26,v19,v26
s_waitcnt vmcnt(8) lgkmcnt(0)
s_barrier
v_mfma_f32_16x16x32_bf16 v[68:71],a[172:175],v[224:227],v[68:71]
ds_read_b64_tr_b16 a[168:169],v24 offset:0
ds_read_b64_tr_b16 a[170:171],v24 offset:1024
v_mfma_f32_16x16x32_bf16 v[76:79],a[172:175],v[240:243],v[76:79]
v_max3_f32 v112,v48,v49,v50
v_max3_f32 v116,v56,v57,v58
v_max3_f32 v120,v64,v65,v66
v_max3_f32 v124,v72,v73,v74
v_max3_f32 v112,v112,v51,v52
v_max3_f32 v116,v116,v59,v60
v_max3_f32 v120,v120,v67,v68
s_nop 0
v_max3_f32 v124,v124,v75,v76
v_max3_f32 v112,v112,v53,v54
v_max3_f32 v116,v116,v61,v62
v_max3_f32 v120,v120,v69,v70
v_max3_f32 v124,v124,v77,v78
v_max_f32 v112,v112,v55
v_max_f32 v116,v116,v63
v_max_f32 v120,v120,v71
v_max_f32 v124,v124,v79
v_mov_b32 v113,v112
v_mov_b32 v117,v116
v_mov_b32 v121,v120
v_mov_b32 v125,v124
v_permlane32_swap_b32 v112,v113
v_permlane32_swap_b32 v116,v117
v_permlane32_swap_b32 v120,v121
v_permlane32_swap_b32 v124,v125
v_max_f32 v112,v112,v113
v_max_f32 v116,v116,v117
v_max_f32 v120,v120,v121
v_max_f32 v124,v124,v125
v_mov_b32 v113,v112
v_mov_b32 v117,v116
v_mov_b32 v121,v120
v_mov_b32 v125,v124
v_permlane16_swap_b32 v112,v113
v_permlane16_swap_b32 v116,v117
v_permlane16_swap_b32 v120,v121
v_permlane16_swap_b32 v124,v125
v_max_f32 v112,v112,v113
v_max_f32 v116,v116,v117
v_max_f32 v120,v120,v121
v_max_f32 v124,v124,v125
v_sub_f32 v113,0,v112
v_sub_f32 v117,0,v116
v_sub_f32 v121,0,v120
v_sub_f32 v125,0,v124
v_sub_f32 v114,0,v112
v_sub_f32 v118,0,v116
v_sub_f32 v122,0,v120
v_sub_f32 v126,0,v124
v_sub_f32 v115,0,v112
v_sub_f32 v119,0,v116
v_sub_f32 v123,0,v120
v_sub_f32 v127,0,v124
v_sub_f32 v112,0,v112
v_sub_f32 v116,0,v116
v_sub_f32 v120,0,v120
v_sub_f32 v124,0,v124
s_nop 1
v_mfma_f32_16x16x32_bf16 v[104:107],a[176:179],v[228:231],v[124:127]
ds_read_b64_tr_b16 a[172:173],v25 offset:0
ds_read_b64_tr_b16 a[174:175],v25 offset:1024
v_mfma_f32_16x16x32_bf16 v[104:107],a[180:183],v[232:235],v[104:107]
v_add_f32 v48,v48,v112
v_add_f32 v49,v49,v112
v_mfma_f32_16x16x32_bf16 v[96:99],a[180:183],v[216:219],v[120:123]
v_add_f32 v50,v50,v112
v_add_f32 v51,v51,v112
v_mfma_f32_16x16x32_bf16 v[96:99],a[176:179],v[212:215],v[96:99]
v_add_f32 v52,v52,v112
v_add_f32 v53,v53,v112
v_mfma_f32_16x16x32_bf16 v[88:91],a[176:179],v[196:199],v[116:119]
v_add_f32 v54,v54,v112
v_add_f32 v55,v55,v112
v_mfma_f32_16x16x32_bf16 v[88:91],a[180:183],v[200:203],v[88:91]
v_add_f32 v56,v56,v116
v_add_f32 v57,v57,v116
v_mfma_f32_16x16x32_bf16 v[80:83],a[180:183],v[184:187],v[112:115]
v_add_f32 v58,v58,v116
v_add_f32 v59,v59,v116
v_mfma_f32_16x16x32_bf16 v[80:83],a[176:179],v[180:183],v[80:83]
v_add_f32 v60,v60,v116
v_add_f32 v61,v61,v116
v_mfma_f32_16x16x32_bf16 v[144:147],a[176:179],v[128:131],0
ds_read_b64_tr_b16 a[176:177],v26 offset:0
ds_read_b64_tr_b16 a[178:179],v26 offset:1024
v_mfma_f32_16x16x32_bf16 v[144:147],a[180:183],v[136:139],v[144:147]
v_add_f32 v62,v62,v116
v_add_f32 v63,v63,v116
v_mfma_f32_16x16x32_bf16 v[148:151],a[184:187],v[136:139],0
ds_read_b64_tr_b16 a[180:181],v27 offset:0
ds_read_b64_tr_b16 a[182:183],v27 offset:1024
v_mfma_f32_16x16x32_bf16 v[148:151],a[188:191],v[128:131],v[148:151]
v_add_f32 v64,v64,v120
v_add_f32 v65,v65,v120
v_mfma_f32_16x16x32_bf16 v[84:87],a[188:191],v[180:183],v[112:115]
v_add_f32 v66,v66,v120
v_add_f32 v67,v67,v120
v_mfma_f32_16x16x32_bf16 v[84:87],a[184:187],v[184:187],v[84:87]
v_add_f32 v68,v68,v120
v_add_f32 v69,v69,v120
v_mfma_f32_16x16x32_bf16 v[92:95],a[184:187],v[200:203],v[116:119]
v_add_f32 v70,v70,v120
v_add_f32 v71,v71,v120
v_mfma_f32_16x16x32_bf16 v[92:95],a[188:191],v[196:199],v[92:95]
v_add_f32 v72,v72,v124
v_add_f32 v73,v73,v124
v_mfma_f32_16x16x32_bf16 v[100:103],a[188:191],v[212:215],v[120:123]
v_add_f32 v74,v74,v124
v_add_f32 v75,v75,v124
v_mfma_f32_16x16x32_bf16 v[100:103],a[184:187],v[216:219],v[100:103]
v_add_f32 v76,v76,v124
v_add_f32 v77,v77,v124
v_mfma_f32_16x16x32_bf16 v[108:111],a[184:187],v[232:235],v[124:127]
ds_read_b64_tr_b16 a[184:185],v28 offset:0
ds_read_b64_tr_b16 a[186:187],v28 offset:1024
v_mfma_f32_16x16x32_bf16 v[108:111],a[188:191],v[228:231],v[108:111]
v_add_f32 v78,v78,v124
v_add_f32 v79,v79,v124
v_mfma_f32_16x16x32_bf16 v[104:107],a[192:195],v[236:239],v[104:107]
ds_read_b64_tr_b16 a[188:189],v29 offset:0
ds_read_b64_tr_b16 a[190:191],v29 offset:1024
v_mfma_f32_16x16x32_bf16 v[104:107],a[196:199],v[240:243],v[104:107]
v_exp_f32 v48,v48
v_mfma_f32_16x16x32_bf16 v[96:99],a[196:199],v[224:227],v[96:99]
v_exp_f32 v49,v49
v_mfma_f32_16x16x32_bf16 v[96:99],a[192:195],v[220:223],v[96:99]
v_exp_f32 v50,v50
v_mfma_f32_16x16x32_bf16 v[88:91],a[192:195],v[204:207],v[88:91]
v_exp_f32 v51,v51
v_mfma_f32_16x16x32_bf16 v[88:91],a[196:199],v[208:211],v[88:91]
v_exp_f32 v52,v52
v_mfma_f32_16x16x32_bf16 v[80:83],a[196:199],v[192:195],v[80:83]
v_exp_f32 v53,v53
v_mfma_f32_16x16x32_bf16 v[80:83],a[192:195],v[188:191],v[80:83]
v_exp_f32 v54,v54
v_mfma_f32_16x16x32_bf16 v[144:147],a[192:195],v[132:135],v[144:147]
ds_read_b64_tr_b16 a[192:193],v30 offset:0
ds_read_b64_tr_b16 a[194:195],v30 offset:1024
v_mfma_f32_16x16x32_bf16 v[144:147],a[196:199],v[140:143],v[144:147]
v_exp_f32 v55,v55
v_mfma_f32_16x16x32_bf16 v[148:151],a[160:163],v[140:143],v[148:151]
v_cvt_pk_bf16_f32 v48,v48,v49
v_cvt_pk_bf16_f32 v49,v50,v51
v_mfma_f32_16x16x32_bf16 v[148:151],a[164:167],v[132:135],v[148:151]
v_cvt_pk_bf16_f32 v50,v52,v53
v_cvt_pk_bf16_f32 v51,v54,v55
v_mfma_f32_16x16x32_bf16 v[84:87],a[164:167],v[188:191],v[84:87]
v_exp_f32 v56,v56
v_mfma_f32_16x16x32_bf16 v[84:87],a[160:163],v[192:195],v[84:87]
v_exp_f32 v57,v57
v_mfma_f32_16x16x32_bf16 v[92:95],a[160:163],v[208:211],v[92:95]
v_exp_f32 v58,v58
v_mfma_f32_16x16x32_bf16 v[92:95],a[164:167],v[204:207],v[92:95]
v_exp_f32 v59,v59
v_mfma_f32_16x16x32_bf16 v[100:103],a[164:167],v[220:223],v[100:103]
v_exp_f32 v60,v60
v_mfma_f32_16x16x32_bf16 v[100:103],a[160:163],v[224:227],v[100:103]
v_exp_f32 v61,v61
v_mfma_f32_16x16x32_bf16 v[108:111],a[160:163],v[240:243],v[108:111]
v_exp_f32 v62,v62
v_mfma_f32_16x16x32_bf16 v[108:111],a[164:167],v[236:239],v[108:111]
v_exp_f32 v63,v63
s_waitcnt lgkmcnt(0)
v_mfma_f32_16x16x32_bf16 a[0:3],a[168:171],v[48:51],0
ds_read_b64_tr_b16 a[196:197],v31 offset:0
ds_read_b64_tr_b16 a[198:199],v31 offset:1024
v_cvt_pk_bf16_f32 v56,v56,v57
v_cvt_pk_bf16_f32 v57,v58,v59
v_cvt_pk_bf16_f32 v58,v60,v61
v_cvt_pk_bf16_f32 v59,v62,v63
s_nop 1
v_mfma_f32_16x16x32_bf16 a[4:7],a[168:171],v[56:59],0
v_exp_f32 v64,v64
v_exp_f32 v65,v65
v_exp_f32 v66,v66
v_exp_f32 v67,v67
v_exp_f32 v68,v68
v_exp_f32 v69,v69
v_exp_f32 v70,v70
v_exp_f32 v71,v71
v_cvt_pk_bf16_f32 v64,v64,v65
v_cvt_pk_bf16_f32 v65,v66,v67
v_cvt_pk_bf16_f32 v66,v68,v69
v_cvt_pk_bf16_f32 v67,v70,v71
s_nop 1
v_mfma_f32_16x16x32_bf16 a[8:11],a[168:171],v[64:67],0
v_exp_f32 v72,v72
v_exp_f32 v73,v73
v_exp_f32 v74,v74
v_exp_f32 v75,v75
v_exp_f32 v76,v76
v_exp_f32 v77,v77
v_exp_f32 v78,v78
v_exp_f32 v79,v79
v_cvt_pk_bf16_f32 v72,v72,v73
v_cvt_pk_bf16_f32 v73,v74,v75
v_cvt_pk_bf16_f32 v74,v76,v77
v_cvt_pk_bf16_f32 v75,v78,v79
s_nop 1
v_mfma_f32_16x16x32_bf16 a[12:15],a[168:171],v[72:75],0
v_max3_f32 v1,v80,v81,v82
v_max3_f32 v1,v1,v83,v88
v_mfma_f32_16x16x32_bf16 a[28:31],a[172:175],v[72:75],0
v_max3_f32 v1,v1,v89,v90
v_max3_f32 v1,v1,v91,v96
v_mfma_f32_16x16x32_bf16 a[24:27],a[172:175],v[64:67],0
v_max3_f32 v1,v1,v97,v98
v_max3_f32 v1,v1,v99,v104
v_mfma_f32_16x16x32_bf16 a[20:23],a[172:175],v[56:59],0
v_max3_f32 v1,v1,v105,v106
v_max3_f32 v1,v1,v107,v84
v_mfma_f32_16x16x32_bf16 a[16:19],a[172:175],v[48:51],0
v_max3_f32 v1,v1,v85,v86
v_max3_f32 v1,v1,v87,v92
v_mfma_f32_16x16x32_bf16 v[156:159],v[176:179],v[48:51],0
v_max3_f32 v1,v1,v93,v94
v_max3_f32 v1,v1,v95,v100
v_mfma_f32_16x16x32_bf16 a[32:35],a[176:179],v[48:51],0
v_max3_f32 v1,v1,v101,v102
v_max3_f32 v1,v1,v103,v108
v_mfma_f32_16x16x32_bf16 a[36:39],a[176:179],v[56:59],0
v_max3_f32 v1,v1,v109,v110
v_max_f32 v1,v1,v111
v_mfma_f32_16x16x32_bf16 a[40:43],a[176:179],v[64:67],0
v_cmp_lt_f32 vcc,0x41000000,v1
v_mfma_f32_16x16x32_bf16 a[44:47],a[176:179],v[72:75],0
v_mfma_f32_16x16x32_bf16 v[160:163],v[176:179],v[56:59],0
s_cbranch_vccnz L_noA1_1_o
L_noA1_1:
v_mfma_f32_16x16x32_bf16 a[60:63],a[180:183],v[72:75],0
v_exp_f32 v80,v80
v_mfma_f32_16x16x32_bf16 a[56:59],a[180:183],v[64:67],0
v_exp_f32 v81,v81
v_mfma_f32_16x16x32_bf16 a[52:55],a[180:183],v[56:59],0
v_exp_f32 v82,v82
v_mfma_f32_16x16x32_bf16 a[48:51],a[180:183],v[48:51],0
v_exp_f32 v83,v83
v_mfma_f32_16x16x32_bf16 v[164:167],v[176:179],v[64:67],0
v_exp_f32 v84,v84
v_mfma_f32_16x16x32_bf16 a[64:67],a[184:187],v[48:51],0
s_waitcnt lgkmcnt(0)
s_barrier
s_cmp_eq_u32 s100,1
s_cbranch_scc1 L_qk1_1
s_waitcnt vmcnt(3)
L_qk1_1:
v_mfma_f32_16x16x32_bf16 a[68:71],a[184:187],v[56:59],0
s_add_u32 m0,s85,0
s_xor_b32 s58,s11,2113536
v_mfma_f32_16x16x32_bf16 a[72:75],a[184:187],v[64:67],0
buffer_load_dwordx4 v12,s[28:31],s58 offen nt lds
v_mfma_f32_16x16x32_bf16 a[76:79],a[184:187],v[72:75],0
ds_read_b128 a[160:163],v40 offset:32768
ds_read_b128 a[164:167],v41 offset:32768
v_mfma_f32_16x16x32_bf16 v[168:171],v[176:179],v[72:75],0
ds_read_b128 a[168:171],v40 offset:33792
v_mfma_f32_16x16x32_bf16 a[92:95],a[188:191],v[72:75],0
ds_read_b128 a[172:175],v41 offset:33792
ds_read_b128 a[176:179],v42 offset:32768
v_mfma_f32_16x16x32_bf16 a[88:91],a[188:191],v[64:67],0
ds_read_b128 a[180:183],v43 offset:32768
v_mfma_f32_16x16x32_bf16 a[84:87],a[188:191],v[56:59],0
ds_read_b128 a[184:187],v42 offset:33792
v_mfma_f32_16x16x32_bf16 a[80:83],a[188:191],v[48:51],0
ds_read_b128 a[188:191],v43 offset:33792
v_mfma_f32_16x16x32_bf16 a[96:99],a[192:195],v[48:51],0
buffer_load_dwordx4 v12,s[28:31],s58 offen offset:1024 nt lds
v_mfma_f32_16x16x32_bf16 a[100:103],a[192:195],v[56:59],0
s_add_u32 m0,s85,4096
s_xor_b32 s58,s11,2146304
v_mfma_f32_16x16x32_bf16 a[104:107],a[192:195],v[64:67],0
v_exp_f32 v85,v85
v_mfma_f32_16x16x32_bf16 a[108:111],a[192:195],v[72:75],0
ds_read_b64_tr_b16 a[192:193],v32 offset:0
ds_read_b64_tr_b16 a[194:195],v32 offset:1024
v_mfma_f32_16x16x32_bf16 a[124:127],a[196:199],v[72:75],0
v_exp_f32 v86,v86
v_mfma_f32_16x16x32_bf16 a[120:123],a[196:199],v[64:67],0
v_exp_f32 v87,v87
v_mfma_f32_16x16x32_bf16 a[116:119],a[196:199],v[56:59],0
v_cvt_pk_bf16_f32 v80,v80,v81
v_cvt_pk_bf16_f32 v81,v82,v83
v_mfma_f32_16x16x32_bf16 a[112:115],a[196:199],v[48:51],0
buffer_load_dwordx4 v13,s[28:31],s58 offen nt lds
v_cvt_pk_bf16_f32 v82,v84,v85
s_waitcnt lgkmcnt(0)
v_mfma_f32_16x16x32_bf16 v[72:75],a[160:163],v[228:231],v[124:127]
ds_read_b64_tr_b16 a[196:197],v33 offset:0
ds_read_b64_tr_b16 a[198:199],v33 offset:1024
v_mfma_f32_16x16x32_bf16 v[72:75],a[164:167],v[232:235],v[72:75]
v_cvt_pk_bf16_f32 v83,v86,v87
v_mfma_f32_16x16x32_bf16 v[64:67],a[164:167],v[216:219],v[120:123]
v_exp_f32 v88,v88
v_mfma_f32_16x16x32_bf16 v[64:67],a[160:163],v[212:215],v[64:67]
v_exp_f32 v89,v89
v_mfma_f32_16x16x32_bf16 v[56:59],a[160:163],v[196:199],v[116:119]
s_cmp_eq_u32 s93,0
s_cbranch_scc0 L_noP1_1_o
L_noP1_1:
v_mfma_f32_16x16x32_bf16 v[56:59],a[164:167],v[200:203],v[56:59]
v_exp_f32 v90,v90
v_mfma_f32_16x16x32_bf16 v[48:51],a[164:167],v[184:187],v[112:115]
buffer_load_dwordx4 v13,s[28:31],s58 offen offset:1024 nt lds
v_mfma_f32_16x16x32_bf16 v[48:51],a[160:163],v[180:183],v[48:51]
ds_read_b64_tr_b16 a[164:165],v34 offset:0
ds_read_b64_tr_b16 a[166:167],v34 offset:1024
v_mfma_f32_16x16x32_bf16 v[52:55],a[168:171],v[180:183],v[112:115]
s_add_u32 m0,s85,8192
s_xor_b32 s58,s11,2121728
v_mfma_f32_16x16x32_bf16 v[52:55],a[172:175],v[184:187],v[52:55]
ds_read_b64_tr_b16 a[160:161],v35 offset:0
ds_read_b64_tr_b16 a[162:163],v35 offset:1024
v_mfma_f32_16x16x32_bf16 v[60:63],a[172:175],v[200:203],v[116:119]
v_exp_f32 v91,v91
v_mfma_f32_16x16x32_bf16 v[60:63],a[168:171],v[196:199],v[60:63]
v_exp_f32 v92,v92
v_mfma_f32_16x16x32_bf16 v[68:71],a[168:171],v[212:215],v[120:123]
v_exp_f32 v93,v93
v_mfma_f32_16x16x32_bf16 v[68:71],a[172:175],v[216:219],v[68:71]
buffer_load_dwordx4 v12,s[28:31],s58 offen nt lds
v_mfma_f32_16x16x32_bf16 v[76:79],a[172:175],v[232:235],v[124:127]
ds_read_b64_tr_b16 a[172:173],v36 offset:0
ds_read_b64_tr_b16 a[174:175],v36 offset:1024
v_mfma_f32_16x16x32_bf16 v[76:79],a[168:171],v[228:231],v[76:79]
v_exp_f32 v94,v94
v_mfma_f32_16x16x32_bf16 v[72:75],a[176:179],v[236:239],v[72:75]
ds_read_b64_tr_b16 a[168:169],v37 offset:0
ds_read_b64_tr_b16 a[170:171],v37 offset:1024
v_mfma_f32_16x16x32_bf16 v[72:75],a[180:183],v[240:243],v[72:75]
v_exp_f32 v95,v95
v_mfma_f32_16x16x32_bf16 v[64:67],a[180:183],v[224:227],v[64:67]
v_cvt_pk_bf16_f32 v88,v88,v89
v_cvt_pk_bf16_f32 v89,v90,v91
v_mfma_f32_16x16x32_bf16 v[64:67],a[176:179],v[220:223],v[64:67]
v_cvt_pk_bf16_f32 v90,v92,v93
v_cvt_pk_bf16_f32 v91,v94,v95
v_mfma_f32_16x16x32_bf16 v[56:59],a[176:179],v[204:207],v[56:59]
buffer_load_dwordx4 v12,s[28:31],s58 offen offset:1024 nt lds
v_mfma_f32_16x16x32_bf16 v[56:59],a[180:183],v[208:211],v[56:59]
s_add_u32 m0,s85,12288
s_xor_b32 s58,s11,2154496
v_mfma_f32_16x16x32_bf16 v[48:51],a[180:183],v[192:195],v[48:51]
ds_read_b64_tr_b16 a[180:181],v38 offset:0
ds_read_b64_tr_b16 a[182:183],v38 offset:1024
v_mfma_f32_16x16x32_bf16 v[48:51],a[176:179],v[188:191],v[48:51]
v_exp_f32 v96,v96
v_mfma_f32_16x16x32_bf16 v[52:55],a[184:187],v[188:191],v[52:55]
ds_read_b64_tr_b16 a[176:177],v39 offset:0
ds_read_b64_tr_b16 a[178:179],v39 offset:1024
v_mfma_f32_16x16x32_bf16 v[52:55],a[188:191],v[192:195],v[52:55]
v_exp_f32 v97,v97
v_mfma_f32_16x16x32_bf16 v[60:63],a[188:191],v[208:211],v[60:63]
v_exp_f32 v98,v98
v_mfma_f32_16x16x32_bf16 v[60:63],a[184:187],v[204:207],v[60:63]
buffer_load_dwordx4 v13,s[28:31],s58 offen nt lds
v_mfma_f32_16x16x32_bf16 v[68:71],a[184:187],v[220:223],v[68:71]
v_exp_f32 v99,v99
v_mfma_f32_16x16x32_bf16 v[68:71],a[188:191],v[224:227],v[68:71]
v_exp_f32 v100,v100
v_mfma_f32_16x16x32_bf16 v[76:79],a[188:191],v[240:243],v[76:79]
v_exp_f32 v101,v101
v_mfma_f32_16x16x32_bf16 v[76:79],a[184:187],v[236:239],v[76:79]
v_exp_f32 v102,v102
v_mfma_f32_16x16x32_bf16 a[0:3],a[192:195],v[80:83],a[0:3]
v_exp_f32 v103,v103
v_mfma_f32_16x16x32_bf16 a[4:7],a[192:195],v[88:91],a[4:7]
v_cvt_pk_bf16_f32 v96,v96,v97
v_cvt_pk_bf16_f32 v97,v98,v99
v_cvt_pk_bf16_f32 v98,v100,v101
v_cvt_pk_bf16_f32 v99,v102,v103
s_nop 1
v_mfma_f32_16x16x32_bf16 a[8:11],a[192:195],v[96:99],a[8:11]
buffer_load_dwordx4 v13,s[28:31],s58 offen offset:1024 nt lds
v_exp_f32 v104,v104
v_exp_f32 v105,v105
v_exp_f32 v106,v106
v_exp_f32 v107,v107
v_exp_f32 v108,v108
v_exp_f32 v109,v109
v_exp_f32 v110,v110
v_exp_f32 v111,v111
v_cvt_pk_bf16_f32 v104,v104,v105
v_cvt_pk_bf16_f32 v105,v106,v107
v_cvt_pk_bf16_f32 v106,v108,v109
v_cvt_pk_bf16_f32 v107,v110,v111
s_nop 1
v_mfma_f32_16x16x32_bf16 a[12:15],a[192:195],v[104:107],a[12:15]
v_max3_f32 v3,v144,v145,v146
v_max3_f32 v3,v3,v147,v148
v_max3_f32 v3,v3,v149,v150
v_max_f32 v3,v3,v151
v_mov_b32 v4,v3
s_nop 1
v_permlane32_swap_b32 v3,v4
v_max_f32 v3,v3,v4
v_mov_b32 v4,v3
s_nop 1
v_permlane16_swap_b32 v3,v4
v_max_f32 v3,v3,v4
v_sub_f32 v152,0,v3
v_sub_f32 v153,0,v3
v_sub_f32 v154,0,v3
v_sub_f32 v155,0,v3
v_sub_f32 v144,v144,v3
v_sub_f32 v145,v145,v3
v_sub_f32 v146,v146,v3
v_sub_f32 v147,v147,v3
v_sub_f32 v148,v148,v3
v_sub_f32 v149,v149,v3
v_sub_f32 v150,v150,v3
v_sub_f32 v151,v151,v3
v_exp_f32 v144,v144
v_exp_f32 v145,v145
v_exp_f32 v146,v146
v_exp_f32 v147,v147
v_exp_f32 v148,v148
v_exp_f32 v149,v149
v_exp_f32 v150,v150
v_exp_f32 v151,v151
v_cvt_pk_bf16_f32 v144,v144,v145
v_cvt_pk_bf16_f32 v145,v146,v147
v_cvt_pk_bf16_f32 v146,v148,v149
v_cvt_pk_bf16_f32 v147,v150,v151
s_nop 1
v_mfma_f32_16x16x32_bf16 a[128:131],a[192:195],v[144:147],0
v_max3_f32 v1,v48,v49,v50
v_max3_f32 v1,v1,v51,v56
s_waitcnt lgkmcnt(0)
v_mfma_f32_16x16x32_bf16 a[132:135],a[196:199],v[144:147],0
ds_read_b128 a[188:191],v44 offset:32768
ds_read_b128 a[184:187],v45 offset:32768
v_mfma_f32_16x16x32_bf16 a[28:31],a[196:199],v[104:107],a[28:31]
ds_read_b128 a[192:195],v45 offset:33792
v_max3_f32 v1,v1,v57,v58
v_mfma_f32_16x16x32_bf16 a[24:27],a[196:199],v[96:99],a[24:27]
v_max3_f32 v1,v1,v59,v64
v_max3_f32 v1,v1,v65,v66
v_mfma_f32_16x16x32_bf16 a[20:23],a[196:199],v[88:91],a[20:23]
v_max3_f32 v1,v1,v67,v72
v_max3_f32 v1,v1,v73,v74
v_mfma_f32_16x16x32_bf16 a[16:19],a[196:199],v[80:83],a[16:19]
v_mov_b32 v9,1
s_cmp_eq_u32 s48,0
s_cbranch_scc0 L_fl0
s_mov_b64 exec,1
buffer_store_dword v9,off,s[40:43],s56 sc1
s_mov_b64 exec,-1
L_fl0:
v_mfma_f32_16x16x32_bf16 v[156:159],v[176:179],v[80:83],v[156:159]
ds_read_b128 a[196:199],v44 offset:33792
v_max3_f32 v1,v1,v75,v52
v_mfma_f32_16x16x32_bf16 a[32:35],a[164:167],v[80:83],a[32:35]
v_max3_f32 v1,v1,v53,v54
v_max3_f32 v1,v1,v55,v60
v_mfma_f32_16x16x32_bf16 a[36:39],a[164:167],v[88:91],a[36:39]
v_max3_f32 v1,v1,v61,v62
v_max3_f32 v1,v1,v63,v68
v_mfma_f32_16x16x32_bf16 a[40:43],a[164:167],v[96:99],a[40:43]
v_max3_f32 v1,v1,v69,v70
v_max3_f32 v1,v1,v71,v76
v_mfma_f32_16x16x32_bf16 a[44:47],a[164:167],v[104:107],a[44:47]
v_max3_f32 v1,v1,v77,v78
v_max_f32 v1,v1,v79
v_mfma_f32_16x16x32_bf16 a[136:139],a[164:167],v[144:147],0
ds_read_b128 a[164:167],v46 offset:32768
v_cmp_lt_f32 vcc,0x41000000,v1
v_mfma_f32_16x16x32_bf16 v[160:163],v[176:179],v[88:91],v[160:163]
v_mfma_f32_16x16x32_bf16 a[140:143],a[160:163],v[144:147],0
s_cbranch_vccnz L_noA2_1_o
L_noA2_1:
v_mfma_f32_16x16x32_bf16 a[60:63],a[160:163],v[104:107],a[60:63]
v_exp_f32 v48,v48
v_mfma_f32_16x16x32_bf16 a[56:59],a[160:163],v[96:99],a[56:59]
v_exp_f32 v49,v49
v_mfma_f32_16x16x32_bf16 a[52:55],a[160:163],v[88:91],a[52:55]
v_exp_f32 v50,v50
v_mfma_f32_16x16x32_bf16 a[48:51],a[160:163],v[80:83],a[48:51]
ds_read_b128 a[160:163],v47 offset:32768
v_mfma_f32_16x16x32_bf16 v[164:167],v[176:179],v[96:99],v[164:167]
v_exp_f32 v51,v51
v_mfma_f32_16x16x32_bf16 a[64:67],a[172:175],v[80:83],a[64:67]
v_exp_f32 v52,v52
v_mfma_f32_16x16x32_bf16 a[68:71],a[172:175],v[88:91],a[68:71]
v_exp_f32 v53,v53
v_mfma_f32_16x16x32_bf16 a[72:75],a[172:175],v[96:99],a[72:75]
v_exp_f32 v54,v54
v_mfma_f32_16x16x32_bf16 a[76:79],a[172:175],v[104:107],a[76:79]
v_exp_f32 v55,v55
v_mfma_f32_16x16x32_bf16 a[144:147],a[172:175],v[144:147],0
ds_read_b128 a[172:175],v47 offset:33792
v_cvt_pk_bf16_f32 v48,v48,v49
v_mfma_f32_16x16x32_bf16 v[168:171],v[176:179],v[104:107],v[168:171]
v_cvt_pk_bf16_f32 v49,v50,v51
v_cvt_pk_bf16_f32 v50,v52,v53
v_mfma_f32_16x16x32_bf16 a[148:151],a[168:171],v[144:147],0
v_cvt_pk_bf16_f32 v51,v54,v55
v_mfma_f32_16x16x32_bf16 a[92:95],a[168:171],v[104:107],a[92:95]
v_exp_f32 v56,v56
v_mfma_f32_16x16x32_bf16 a[88:91],a[168:171],v[96:99],a[88:91]
v_exp_f32 v57,v57
v_mfma_f32_16x16x32_bf16 a[84:87],a[168:171],v[88:91],a[84:87]
v_exp_f32 v58,v58
v_mfma_f32_16x16x32_bf16 a[80:83],a[168:171],v[80:83],a[80:83]
ds_read_b128 a[168:171],v46 offset:33792
v_mfma_f32_16x16x32_bf16 v[172:175],v[176:179],v[144:147],0
v_exp_f32 v59,v59
v_mfma_f32_16x16x32_bf16 a[96:99],a[180:183],v[80:83],a[96:99]
v_exp_f32 v60,v60
v_mfma_f32_16x16x32_bf16 a[100:103],a[180:183],v[88:91],a[100:103]
v_exp_f32 v61,v61
v_mfma_f32_16x16x32_bf16 a[104:107],a[180:183],v[96:99],a[104:107]
v_exp_f32 v62,v62
v_mfma_f32_16x16x32_bf16 a[108:111],a[180:183],v[104:107],a[108:111]
v_exp_f32 v63,v63
v_mfma_f32_16x16x32_bf16 a[152:155],a[180:183],v[144:147],0
s_waitcnt vmcnt(8) lgkmcnt(0)
s_barrier
s_cmp_eq_u32 s100,1
s_cbranch_scc1 L_qv1_1
s_waitcnt vmcnt(3)
L_qv1_1:
v_mfma_f32_16x16x32_bf16 a[156:159],a[176:179],v[144:147],0
s_add_u32 m0,s85,65536
s_xor_b32 s58,s11,2113536
v_mfma_f32_16x16x32_bf16 a[124:127],a[176:179],v[104:107],a[124:127]
buffer_load_dwordx4 v14,s[32:35],s58 offen nt lds
v_cvt_pk_bf16_f32 v56,v56,v57
v_mfma_f32_16x16x32_bf16 a[120:123],a[176:179],v[96:99],a[120:123]
ds_read_b64_tr_b16 a[180:181],v24 offset:32768
ds_read_b64_tr_b16 a[182:183],v24 offset:33792
v_mfma_f32_16x16x32_bf16 a[116:119],a[176:179],v[88:91],a[116:119]
v_cvt_pk_bf16_f32 v57,v58,v59
v_cvt_pk_bf16_f32 v58,v60,v61
v_mfma_f32_16x16x32_bf16 a[112:115],a[176:179],v[80:83],a[112:115]
ds_read_b64_tr_b16 a[176:177],v25 offset:32768
ds_read_b64_tr_b16 a[178:179],v25 offset:33792
v_mfma_f32_16x16x32_bf16 v[104:107],a[188:191],v[228:231],v[124:127]
v_cvt_pk_bf16_f32 v59,v62,v63
v_mfma_f32_16x16x32_bf16 v[104:107],a[184:187],v[232:235],v[104:107]
v_exp_f32 v64,v64
v_mfma_f32_16x16x32_bf16 v[96:99],a[184:187],v[216:219],v[120:123]
v_exp_f32 v65,v65
v_mfma_f32_16x16x32_bf16 v[96:99],a[188:191],v[212:215],v[96:99]
buffer_load_dwordx4 v14,s[32:35],s58 offen offset:1024 nt lds
v_mfma_f32_16x16x32_bf16 v[88:91],a[188:191],v[196:199],v[116:119]
s_add_u32 m0,s85,69632
s_xor_b32 s58,s11,2146304
v_mfma_f32_16x16x32_bf16 v[88:91],a[184:187],v[200:203],v[88:91]
v_exp_f32 v66,v66
v_mfma_f32_16x16x32_bf16 v[80:83],a[184:187],v[184:187],v[112:115]
s_cmp_eq_u32 s93,0
s_cbranch_scc0 L_noP2_1_o
L_noP2_1:
v_mfma_f32_16x16x32_bf16 v[80:83],a[188:191],v[180:183],v[80:83]
v_exp_f32 v67,v67
v_mfma_f32_16x16x32_bf16 v[144:147],a[188:191],v[128:131],v[152:155]
ds_read_b64_tr_b16 a[188:189],v26 offset:32768
ds_read_b64_tr_b16 a[190:191],v26 offset:33792
v_mfma_f32_16x16x32_bf16 v[144:147],a[184:187],v[136:139],v[144:147]
v_exp_f32 v68,v68
v_mfma_f32_16x16x32_bf16 v[148:151],a[192:195],v[136:139],v[152:155]
buffer_load_dwordx4 v14,s[32:35],s58 offen nt lds
v_mfma_f32_16x16x32_bf16 v[148:151],a[196:199],v[128:131],v[148:151]
ds_read_b64_tr_b16 a[184:185],v27 offset:32768
ds_read_b64_tr_b16 a[186:187],v27 offset:33792
v_mfma_f32_16x16x32_bf16 v[84:87],a[196:199],v[180:183],v[112:115]
v_exp_f32 v69,v69
v_mfma_f32_16x16x32_bf16 v[84:87],a[192:195],v[184:187],v[84:87]
v_exp_f32 v70,v70
v_mfma_f32_16x16x32_bf16 v[92:95],a[192:195],v[200:203],v[116:119]
v_exp_f32 v71,v71
v_mfma_f32_16x16x32_bf16 v[92:95],a[196:199],v[196:199],v[92:95]
v_cvt_pk_bf16_f32 v64,v64,v65
v_cvt_pk_bf16_f32 v65,v66,v67
v_mfma_f32_16x16x32_bf16 v[100:103],a[196:199],v[212:215],v[120:123]
v_cvt_pk_bf16_f32 v66,v68,v69
v_cvt_pk_bf16_f32 v67,v70,v71
v_mfma_f32_16x16x32_bf16 v[100:103],a[192:195],v[216:219],v[100:103]
buffer_load_dwordx4 v14,s[32:35],s58 offen offset:1024 nt lds
v_mfma_f32_16x16x32_bf16 v[108:111],a[192:195],v[232:235],v[124:127]
ds_read_b64_tr_b16 a[192:193],v28 offset:32768
ds_read_b64_tr_b16 a[194:195],v28 offset:33792
v_mfma_f32_16x16x32_bf16 v[108:111],a[196:199],v[228:231],v[108:111]
s_add_u32 m0,s85,73728
s_xor_b32 s58,s11,2121728
v_mfma_f32_16x16x32_bf16 v[104:107],a[164:167],v[236:239],v[104:107]
ds_read_b64_tr_b16 a[196:197],v29 offset:32768
ds_read_b64_tr_b16 a[198:199],v29 offset:33792
v_mfma_f32_16x16x32_bf16 v[104:107],a[160:163],v[240:243],v[104:107]
v_exp_f32 v72,v72
v_mfma_f32_16x16x32_bf16 v[96:99],a[160:163],v[224:227],v[96:99]
v_exp_f32 v73,v73
v_mfma_f32_16x16x32_bf16 v[96:99],a[164:167],v[220:223],v[96:99]
v_exp_f32 v74,v74
v_mfma_f32_16x16x32_bf16 v[88:91],a[164:167],v[204:207],v[88:91]
buffer_load_dwordx4 v14,s[32:35],s58 offen nt lds
v_mfma_f32_16x16x32_bf16 v[88:91],a[160:163],v[208:211],v[88:91]
v_exp_f32 v75,v75
v_mfma_f32_16x16x32_bf16 v[80:83],a[160:163],v[192:195],v[80:83]
v_exp_f32 v76,v76
v_mfma_f32_16x16x32_bf16 v[80:83],a[164:167],v[188:191],v[80:83]
v_exp_f32 v77,v77
v_mfma_f32_16x16x32_bf16 v[144:147],a[164:167],v[132:135],v[144:147]
ds_read_b64_tr_b16 a[164:165],v30 offset:32768
ds_read_b64_tr_b16 a[166:167],v30 offset:33792
v_mfma_f32_16x16x32_bf16 v[144:147],a[160:163],v[140:143],v[144:147]
v_exp_f32 v78,v78
v_mfma_f32_16x16x32_bf16 v[148:151],a[172:175],v[140:143],v[148:151]
v_exp_f32 v79,v79
v_mfma_f32_16x16x32_bf16 v[148:151],a[168:171],v[132:135],v[148:151]
buffer_load_dwordx4 v14,s[32:35],s58 offen offset:1024 nt lds
v_cvt_pk_bf16_f32 v72,v72,v73
v_mfma_f32_16x16x32_bf16 v[84:87],a[168:171],v[188:191],v[84:87]
s_add_u32 m0,s85,77824
s_xor_b32 s58,s11,2154496
v_mfma_f32_16x16x32_bf16 v[84:87],a[172:175],v[192:195],v[84:87]
v_cvt_pk_bf16_f32 v73,v74,v75
v_cvt_pk_bf16_f32 v74,v76,v77
v_mfma_f32_16x16x32_bf16 v[92:95],a[172:175],v[208:211],v[92:95]
v_cvt_pk_bf16_f32 v75,v78,v79
v_mfma_f32_16x16x32_bf16 v[92:95],a[168:171],v[204:207],v[92:95]
v_mfma_f32_16x16x32_bf16 v[100:103],a[168:171],v[220:223],v[100:103]
v_mfma_f32_16x16x32_bf16 v[100:103],a[172:175],v[224:227],v[100:103]
v_mfma_f32_16x16x32_bf16 v[108:111],a[172:175],v[240:243],v[108:111]
buffer_load_dwordx4 v14,s[32:35],s58 offen nt lds
v_mfma_f32_16x16x32_bf16 v[108:111],a[168:171],v[236:239],v[108:111]
v_max3_f32 v1,v144,v145,v146
v_max3_f32 v1,v1,v147,v148
s_waitcnt lgkmcnt(0)
v_mfma_f32_16x16x32_bf16 a[0:3],a[180:183],v[48:51],a[0:3]
ds_read_b64_tr_b16 a[160:161],v31 offset:32768
ds_read_b64_tr_b16 a[162:163],v31 offset:33792
v_mfma_f32_16x16x32_bf16 a[4:7],a[180:183],v[56:59],a[4:7]
v_max3_f32 v1,v1,v149,v150
v_max3_f32 v1,v1,v151,v80
v_mfma_f32_16x16x32_bf16 a[8:11],a[180:183],v[64:67],a[8:11]
v_max3_f32 v1,v1,v81,v82
v_max3_f32 v1,v1,v83,v88
v_mfma_f32_16x16x32_bf16 a[12:15],a[180:183],v[72:75],a[12:15]
v_max3_f32 v1,v1,v89,v90
v_max3_f32 v1,v1,v91,v96
v_mfma_f32_16x16x32_bf16 a[28:31],a[176:179],v[72:75],a[28:31]
v_max3_f32 v1,v1,v97,v98
v_max3_f32 v1,v1,v99,v104
v_mfma_f32_16x16x32_bf16 a[24:27],a[176:179],v[64:67],a[24:27]
buffer_load_dwordx4 v14,s[32:35],s58 offen offset:1024 nt lds
v_max3_f32 v1,v1,v105,v106
v_mfma_f32_16x16x32_bf16 a[20:23],a[176:179],v[56:59],a[20:23]
v_max3_f32 v1,v1,v107,v84
v_max3_f32 v1,v1,v85,v86
v_mfma_f32_16x16x32_bf16 a[16:19],a[176:179],v[48:51],a[16:19]
v_max3_f32 v1,v1,v87,v92
v_max3_f32 v1,v1,v93,v94
v_mfma_f32_16x16x32_bf16 v[156:159],v[176:179],v[48:51],v[156:159]
v_max3_f32 v1,v1,v95,v100
v_max3_f32 v1,v1,v101,v102
v_mfma_f32_16x16x32_bf16 a[32:35],a[188:191],v[48:51],a[32:35]
v_max3_f32 v1,v1,v103,v108
v_max3_f32 v1,v1,v109,v110
v_mfma_f32_16x16x32_bf16 a[36:39],a[188:191],v[56:59],a[36:39]
v_max_f32 v1,v1,v111
v_cmp_lt_f32 vcc,0x41000000,v1
v_mfma_f32_16x16x32_bf16 a[40:43],a[188:191],v[64:67],a[40:43]
v_mfma_f32_16x16x32_bf16 a[44:47],a[188:191],v[72:75],a[44:47]
s_cbranch_vccnz L_noA3_1_o
L_noA3_1:
v_mfma_f32_16x16x32_bf16 v[160:163],v[176:179],v[56:59],v[160:163]
v_exp_f32 v80,v80
v_mfma_f32_16x16x32_bf16 a[60:63],a[184:187],v[72:75],a[60:63]
v_exp_f32 v81,v81
v_mfma_f32_16x16x32_bf16 a[56:59],a[184:187],v[64:67],a[56:59]
v_exp_f32 v82,v82
v_mfma_f32_16x16x32_bf16 a[52:55],a[184:187],v[56:59],a[52:55]
v_exp_f32 v83,v83
v_mfma_f32_16x16x32_bf16 a[48:51],a[184:187],v[48:51],a[48:51]
v_exp_f32 v84,v84
v_mfma_f32_16x16x32_bf16 v[164:167],v[176:179],v[64:67],v[164:167]
v_exp_f32 v85,v85
v_mfma_f32_16x16x32_bf16 a[64:67],a[192:195],v[48:51],a[64:67]
s_waitcnt vmcnt(8) lgkmcnt(0)
s_barrier
s_cmp_eq_u32 s100,1
s_cbranch_scc1 L_qk2_1
s_waitcnt vmcnt(3)
L_qk2_1:
v_mfma_f32_16x16x32_bf16 a[68:71],a[192:195],v[56:59],a[68:71]
s_add_u32 m0,s85,32768
s_xor_b32 s58,s11,2117632
v_mfma_f32_16x16x32_bf16 a[72:75],a[192:195],v[64:67],a[72:75]
buffer_load_dwordx4 v12,s[28:31],s58 offen nt lds
v_mfma_f32_16x16x32_bf16 a[76:79],a[192:195],v[72:75],a[76:79]
ds_read_b128 a[172:175],v40 offset:0
ds_read_b128 a[168:171],v41 offset:0
v_mfma_f32_16x16x32_bf16 v[168:171],v[176:179],v[72:75],v[168:171]
ds_read_b128 a[180:183],v40 offset:1024
v_mfma_f32_16x16x32_bf16 a[92:95],a[196:199],v[72:75],a[92:95]
ds_read_b128 a[176:179],v41 offset:1024
ds_read_b128 a[188:191],v42 offset:0
v_mfma_f32_16x16x32_bf16 a[88:91],a[196:199],v[64:67],a[88:91]
ds_read_b128 a[184:187],v43 offset:0
v_mfma_f32_16x16x32_bf16 a[84:87],a[196:199],v[56:59],a[84:87]
ds_read_b128 a[192:195],v42 offset:1024
v_mfma_f32_16x16x32_bf16 a[80:83],a[196:199],v[48:51],a[80:83]
ds_read_b128 a[196:199],v43 offset:1024
v_mfma_f32_16x16x32_bf16 a[96:99],a[164:167],v[48:51],a[96:99]
buffer_load_dwordx4 v12,s[28:31],s58 offen offset:1024 nt lds
v_mfma_f32_16x16x32_bf16 a[100:103],a[164:167],v[56:59],a[100:103]
s_add_u32 m0,s85,36864
s_xor_b32 s58,s11,2150400
v_mfma_f32_16x16x32_bf16 a[104:107],a[164:167],v[64:67],a[104:107]
v_exp_f32 v86,v86
v_mfma_f32_16x16x32_bf16 a[108:111],a[164:167],v[72:75],a[108:111]
ds_read_b64_tr_b16 a[164:165],v32 offset:32768
ds_read_b64_tr_b16 a[166:167],v32 offset:33792
v_mfma_f32_16x16x32_bf16 a[124:127],a[160:163],v[72:75],a[124:127]
v_exp_f32 v87,v87
v_mfma_f32_16x16x32_bf16 a[120:123],a[160:163],v[64:67],a[120:123]
v_cvt_pk_bf16_f32 v80,v80,v81
v_cvt_pk_bf16_f32 v81,v82,v83
v_mfma_f32_16x16x32_bf16 a[116:119],a[160:163],v[56:59],a[116:119]
v_cvt_pk_bf16_f32 v82,v84,v85
v_cvt_pk_bf16_f32 v83,v86,v87
v_mfma_f32_16x16x32_bf16 a[112:115],a[160:163],v[48:51],a[112:115]
buffer_load_dwordx4 v13,s[28:31],s58 offen nt lds
s_waitcnt lgkmcnt(0)
v_mfma_f32_16x16x32_bf16 v[72:75],a[172:175],v[228:231],v[124:127]
ds_read_b64_tr_b16 a[160:161],v33 offset:32768
ds_read_b64_tr_b16 a[162:163],v33 offset:33792
v_mfma_f32_16x16x32_bf16 v[72:75],a[168:171],v[232:235],v[72:75]
v_exp_f32 v88,v88
v_mfma_f32_16x16x32_bf16 v[64:67],a[168:171],v[216:219],v[120:123]
v_exp_f32 v89,v89
v_mfma_f32_16x16x32_bf16 v[64:67],a[172:175],v[212:215],v[64:67]
v_exp_f32 v90,v90
v_mfma_f32_16x16x32_bf16 v[56:59],a[172:175],v[196:199],v[116:119]
s_cmp_eq_u32 s93,0
s_cbranch_scc0 L_noP3_1_o
L_noP3_1:
v_mfma_f32_16x16x32_bf16 v[56:59],a[168:171],v[200:203],v[56:59]
v_exp_f32 v91,v91
v_mfma_f32_16x16x32_bf16 v[48:51],a[168:171],v[184:187],v[112:115]
buffer_load_dwordx4 v13,s[28:31],s58 offen offset:1024 nt lds
v_mfma_f32_16x16x32_bf16 v[48:51],a[172:175],v[180:183],v[48:51]
ds_read_b64_tr_b16 a[168:169],v34 offset:32768
ds_read_b64_tr_b16 a[170:171],v34 offset:33792
v_mfma_f32_16x16x32_bf16 v[52:55],a[180:183],v[180:183],v[112:115]
s_add_u32 m0,s85,40960
s_xor_b32 s58,s11,2125824
v_mfma_f32_16x16x32_bf16 v[52:55],a[176:179],v[184:187],v[52:55]
ds_read_b64_tr_b16 a[172:173],v35 offset:32768
ds_read_b64_tr_b16 a[174:175],v35 offset:33792
v_mfma_f32_16x16x32_bf16 v[60:63],a[176:179],v[200:203],v[116:119]
v_exp_f32 v92,v92
v_mfma_f32_16x16x32_bf16 v[60:63],a[180:183],v[196:199],v[60:63]
v_exp_f32 v93,v93
v_mfma_f32_16x16x32_bf16 v[68:71],a[180:183],v[212:215],v[120:123]
v_exp_f32 v94,v94
v_mfma_f32_16x16x32_bf16 v[68:71],a[176:179],v[216:219],v[68:71]
buffer_load_dwordx4 v12,s[28:31],s58 offen nt lds
v_mfma_f32_16x16x32_bf16 v[76:79],a[176:179],v[232:235],v[124:127]
ds_read_b64_tr_b16 a[176:177],v36 offset:32768
ds_read_b64_tr_b16 a[178:179],v36 offset:33792
v_mfma_f32_16x16x32_bf16 v[76:79],a[180:183],v[228:231],v[76:79]
v_exp_f32 v95,v95
v_mfma_f32_16x16x32_bf16 v[72:75],a[188:191],v[236:239],v[72:75]
ds_read_b64_tr_b16 a[180:181],v37 offset:32768
ds_read_b64_tr_b16 a[182:183],v37 offset:33792
v_mfma_f32_16x16x32_bf16 v[72:75],a[184:187],v[240:243],v[72:75]
v_cvt_pk_bf16_f32 v88,v88,v89
v_cvt_pk_bf16_f32 v89,v90,v91
v_mfma_f32_16x16x32_bf16 v[64:67],a[184:187],v[224:227],v[64:67]
v_cvt_pk_bf16_f32 v90,v92,v93
v_cvt_pk_bf16_f32 v91,v94,v95
v_mfma_f32_16x16x32_bf16 v[64:67],a[188:191],v[220:223],v[64:67]
v_exp_f32 v96,v96
v_mfma_f32_16x16x32_bf16 v[56:59],a[188:191],v[204:207],v[56:59]
buffer_load_dwordx4 v12,s[28:31],s58 offen offset:1024 nt lds
v_mfma_f32_16x16x32_bf16 v[56:59],a[184:187],v[208:211],v[56:59]
s_add_u32 m0,s85,45056
s_xor_b32 s58,s11,2158592
v_mfma_f32_16x16x32_bf16 v[48:51],a[184:187],v[192:195],v[48:51]
ds_read_b64_tr_b16 a[184:185],v38 offset:32768
ds_read_b64_tr_b16 a[186:187],v38 offset:33792
v_mfma_f32_16x16x32_bf16 v[48:51],a[188:191],v[188:191],v[48:51]
v_exp_f32 v97,v97
v_mfma_f32_16x16x32_bf16 v[52:55],a[192:195],v[188:191],v[52:55]
ds_read_b64_tr_b16 a[188:189],v39 offset:32768
ds_read_b64_tr_b16 a[190:191],v39 offset:33792
v_mfma_f32_16x16x32_bf16 v[52:55],a[196:199],v[192:195],v[52:55]
v_exp_f32 v98,v98
v_mfma_f32_16x16x32_bf16 v[60:63],a[196:199],v[208:211],v[60:63]
v_exp_f32 v99,v99
v_mfma_f32_16x16x32_bf16 v[60:63],a[192:195],v[204:207],v[60:63]
buffer_load_dwordx4 v13,s[28:31],s58 offen nt lds
v_mfma_f32_16x16x32_bf16 v[68:71],a[192:195],v[220:223],v[68:71]
v_exp_f32 v100,v100
v_mfma_f32_16x16x32_bf16 v[68:71],a[196:199],v[224:227],v[68:71]
v_exp_f32 v101,v101
v_mfma_f32_16x16x32_bf16 v[76:79],a[196:199],v[240:243],v[76:79]
v_exp_f32 v102,v102
v_mfma_f32_16x16x32_bf16 v[76:79],a[192:195],v[236:239],v[76:79]
v_exp_f32 v103,v103
v_mfma_f32_16x16x32_bf16 a[0:3],a[164:167],v[80:83],a[0:3]
v_cvt_pk_bf16_f32 v96,v96,v97
v_cvt_pk_bf16_f32 v97,v98,v99
v_mfma_f32_16x16x32_bf16 a[4:7],a[164:167],v[88:91],a[4:7]
v_cvt_pk_bf16_f32 v98,v100,v101
v_cvt_pk_bf16_f32 v99,v102,v103
s_nop 1
v_mfma_f32_16x16x32_bf16 a[8:11],a[164:167],v[96:99],a[8:11]
buffer_load_dwordx4 v13,s[28:31],s58 offen offset:1024 nt lds
v_exp_f32 v104,v104
v_exp_f32 v105,v105
v_exp_f32 v106,v106
v_exp_f32 v107,v107
v_exp_f32 v108,v108
v_exp_f32 v109,v109
v_exp_f32 v110,v110
v_exp_f32 v111,v111
v_cvt_pk_bf16_f32 v104,v104,v105
v_cvt_pk_bf16_f32 v105,v106,v107
v_cvt_pk_bf16_f32 v106,v108,v109
v_cvt_pk_bf16_f32 v107,v110,v111
s_nop 1
v_mfma_f32_16x16x32_bf16 a[12:15],a[164:167],v[104:107],a[12:15]
v_exp_f32 v144,v144
v_exp_f32 v145,v145
v_exp_f32 v146,v146
v_exp_f32 v147,v147
v_exp_f32 v148,v148
v_exp_f32 v149,v149
v_exp_f32 v150,v150
v_exp_f32 v151,v151
v_cvt_pk_bf16_f32 v144,v144,v145
v_cvt_pk_bf16_f32 v145,v146,v147
v_cvt_pk_bf16_f32 v146,v148,v149
v_cvt_pk_bf16_f32 v147,v150,v151
s_nop 1
v_mfma_f32_16x16x32_bf16 a[128:131],a[164:167],v[144:147],a[128:131]
v_max3_f32 v1,v48,v49,v50
v_max3_f32 v1,v1,v51,v56
s_waitcnt lgkmcnt(0)
v_mfma_f32_16x16x32_bf16 a[132:135],a[160:163],v[144:147],a[132:135]
ds_read_b128 a[196:199],v44 offset:0
ds_read_b128 a[192:195],v45 offset:0
v_mfma_f32_16x16x32_bf16 a[28:31],a[160:163],v[104:107],a[28:31]
ds_read_b128 a[164:167],v45 offset:1024
v_max3_f32 v1,v1,v57,v58
v_mfma_f32_16x16x32_bf16 a[24:27],a[160:163],v[96:99],a[24:27]
v_max3_f32 v1,v1,v59,v64
v_max3_f32 v1,v1,v65,v66
v_mfma_f32_16x16x32_bf16 a[20:23],a[160:163],v[88:91],a[20:23]
v_max3_f32 v1,v1,v67,v72
v_max3_f32 v1,v1,v73,v74
v_mfma_f32_16x16x32_bf16 a[16:19],a[160:163],v[80:83],a[16:19]
ds_read_b128 a[160:163],v44 offset:1024
v_max3_f32 v1,v1,v75,v52
v_mfma_f32_16x16x32_bf16 v[156:159],v[176:179],v[80:83],v[156:159]
v_max3_f32 v1,v1,v53,v54
v_max3_f32 v1,v1,v55,v60
v_mfma_f32_16x16x32_bf16 a[32:35],a[168:171],v[80:83],a[32:35]
v_max3_f32 v1,v1,v61,v62
v_max3_f32 v1,v1,v63,v68
v_mfma_f32_16x16x32_bf16 a[36:39],a[168:171],v[88:91],a[36:39]
v_max3_f32 v1,v1,v69,v70
v_max3_f32 v1,v1,v71,v76
v_mfma_f32_16x16x32_bf16 a[40:43],a[168:171],v[96:99],a[40:43]
v_max3_f32 v1,v1,v77,v78
v_max_f32 v1,v1,v79
v_mfma_f32_16x16x32_bf16 a[44:47],a[168:171],v[104:107],a[44:47]
v_cmp_lt_f32 vcc,0x41000000,v1
v_mfma_f32_16x16x32_bf16 a[136:139],a[168:171],v[144:147],a[136:139]
ds_read_b128 a[168:171],v46 offset:0
v_mfma_f32_16x16x32_bf16 v[160:163],v[176:179],v[88:91],v[160:163]
v_mfma_f32_16x16x32_bf16 a[140:143],a[172:175],v[144:147],a[140:143]
s_cbranch_vccnz L_noA4_1_o
L_noA4_1:
v_mfma_f32_16x16x32_bf16 a[60:63],a[172:175],v[104:107],a[60:63]
v_exp_f32 v48,v48
v_mfma_f32_16x16x32_bf16 a[56:59],a[172:175],v[96:99],a[56:59]
v_exp_f32 v49,v49
v_mfma_f32_16x16x32_bf16 a[52:55],a[172:175],v[88:91],a[52:55]
v_exp_f32 v50,v50
v_mfma_f32_16x16x32_bf16 a[48:51],a[172:175],v[80:83],a[48:51]
ds_read_b128 a[172:175],v47 offset:0
v_mfma_f32_16x16x32_bf16 v[164:167],v[176:179],v[96:99],v[164:167]
v_exp_f32 v51,v51
v_mfma_f32_16x16x32_bf16 a[64:67],a[176:179],v[80:83],a[64:67]
v_exp_f32 v52,v52
v_mfma_f32_16x16x32_bf16 a[68:71],a[176:179],v[88:91],a[68:71]
v_exp_f32 v53,v53
v_mfma_f32_16x16x32_bf16 a[72:75],a[176:179],v[96:99],a[72:75]
v_exp_f32 v54,v54
v_mfma_f32_16x16x32_bf16 a[76:79],a[176:179],v[104:107],a[76:79]
v_exp_f32 v55,v55
v_mfma_f32_16x16x32_bf16 a[144:147],a[176:179],v[144:147],a[144:147]
ds_read_b128 a[176:179],v47 offset:1024
v_cvt_pk_bf16_f32 v48,v48,v49
v_mfma_f32_16x16x32_bf16 v[168:171],v[176:179],v[104:107],v[168:171]
v_cvt_pk_bf16_f32 v49,v50,v51
v_cvt_pk_bf16_f32 v50,v52,v53
v_mfma_f32_16x16x32_bf16 a[148:151],a[180:183],v[144:147],a[148:151]
v_cvt_pk_bf16_f32 v51,v54,v55
v_mfma_f32_16x16x32_bf16 a[92:95],a[180:183],v[104:107],a[92:95]
v_exp_f32 v56,v56
v_mfma_f32_16x16x32_bf16 a[88:91],a[180:183],v[96:99],a[88:91]
v_exp_f32 v57,v57
v_mfma_f32_16x16x32_bf16 a[84:87],a[180:183],v[88:91],a[84:87]
v_exp_f32 v58,v58
v_mfma_f32_16x16x32_bf16 a[80:83],a[180:183],v[80:83],a[80:83]
ds_read_b128 a[180:183],v46 offset:1024
v_mfma_f32_16x16x32_bf16 v[172:175],v[176:179],v[144:147],v[172:175]
v_exp_f32 v59,v59
v_mfma_f32_16x16x32_bf16 a[96:99],a[184:187],v[80:83],a[96:99]
v_exp_f32 v60,v60
v_mfma_f32_16x16x32_bf16 a[100:103],a[184:187],v[88:91],a[100:103]
v_exp_f32 v61,v61
v_mfma_f32_16x16x32_bf16 a[104:107],a[184:187],v[96:99],a[104:107]
v_exp_f32 v62,v62
v_mfma_f32_16x16x32_bf16 a[108:111],a[184:187],v[104:107],a[108:111]
v_exp_f32 v63,v63
v_mfma_f32_16x16x32_bf16 a[152:155],a[184:187],v[144:147],a[152:155]
s_waitcnt vmcnt(8) lgkmcnt(0)
s_barrier
s_cmp_eq_u32 s100,1
s_cbranch_scc1 L_qv2_1
s_waitcnt vmcnt(3)
L_qv2_1:
v_mfma_f32_16x16x32_bf16 a[156:159],a[188:191],v[144:147],a[156:159]
s_add_u32 m0,s85,98304
s_xor_b32 s58,s11,2117632
v_mfma_f32_16x16x32_bf16 a[124:127],a[188:191],v[104:107],a[124:127]
buffer_load_dwordx4 v14,s[32:35],s58 offen nt lds
v_cvt_pk_bf16_f32 v56,v56,v57
v_mfma_f32_16x16x32_bf16 a[120:123],a[188:191],v[96:99],a[120:123]
ds_read_b64_tr_b16 a[184:185],v24 offset:0
ds_read_b64_tr_b16 a[186:187],v24 offset:1024
v_mfma_f32_16x16x32_bf16 a[116:119],a[188:191],v[88:91],a[116:119]
v_cvt_pk_bf16_f32 v57,v58,v59
v_cvt_pk_bf16_f32 v58,v60,v61
v_mfma_f32_16x16x32_bf16 a[112:115],a[188:191],v[80:83],a[112:115]
ds_read_b64_tr_b16 a[188:189],v25 offset:0
ds_read_b64_tr_b16 a[190:191],v25 offset:1024
v_mfma_f32_16x16x32_bf16 v[104:107],a[196:199],v[228:231],v[124:127]
v_cvt_pk_bf16_f32 v59,v62,v63
v_mfma_f32_16x16x32_bf16 v[104:107],a[192:195],v[232:235],v[104:107]
v_exp_f32 v64,v64
v_mfma_f32_16x16x32_bf16 v[96:99],a[192:195],v[216:219],v[120:123]
v_exp_f32 v65,v65
v_mfma_f32_16x16x32_bf16 v[96:99],a[196:199],v[212:215],v[96:99]
buffer_load_dwordx4 v14,s[32:35],s58 offen offset:1024 nt lds
v_mfma_f32_16x16x32_bf16 v[88:91],a[196:199],v[196:199],v[116:119]
s_add_u32 m0,s85,102400
s_xor_b32 s58,s11,2150400
v_mfma_f32_16x16x32_bf16 v[88:91],a[192:195],v[200:203],v[88:91]
v_exp_f32 v66,v66
v_mfma_f32_16x16x32_bf16 v[80:83],a[192:195],v[184:187],v[112:115]
s_cmp_eq_u32 s93,0
s_cbranch_scc0 L_noP4_1_o
L_noP4_1:
v_mfma_f32_16x16x32_bf16 v[80:83],a[196:199],v[180:183],v[80:83]
v_exp_f32 v67,v67
v_mfma_f32_16x16x32_bf16 v[144:147],a[196:199],v[128:131],v[152:155]
ds_read_b64_tr_b16 a[196:197],v26 offset:0
ds_read_b64_tr_b16 a[198:199],v26 offset:1024
v_mfma_f32_16x16x32_bf16 v[144:147],a[192:195],v[136:139],v[144:147]
v_exp_f32 v68,v68
v_mfma_f32_16x16x32_bf16 v[148:151],a[164:167],v[136:139],v[152:155]
buffer_load_dwordx4 v14,s[32:35],s58 offen nt lds
v_mfma_f32_16x16x32_bf16 v[148:151],a[160:163],v[128:131],v[148:151]
ds_read_b64_tr_b16 a[192:193],v27 offset:0
ds_read_b64_tr_b16 a[194:195],v27 offset:1024
v_mfma_f32_16x16x32_bf16 v[84:87],a[160:163],v[180:183],v[112:115]
v_exp_f32 v69,v69
v_mfma_f32_16x16x32_bf16 v[84:87],a[164:167],v[184:187],v[84:87]
v_exp_f32 v70,v70
v_mfma_f32_16x16x32_bf16 v[92:95],a[164:167],v[200:203],v[116:119]
v_exp_f32 v71,v71
v_mfma_f32_16x16x32_bf16 v[92:95],a[160:163],v[196:199],v[92:95]
v_cvt_pk_bf16_f32 v64,v64,v65
v_cvt_pk_bf16_f32 v65,v66,v67
v_mfma_f32_16x16x32_bf16 v[100:103],a[160:163],v[212:215],v[120:123]
v_cvt_pk_bf16_f32 v66,v68,v69
v_cvt_pk_bf16_f32 v67,v70,v71
v_mfma_f32_16x16x32_bf16 v[100:103],a[164:167],v[216:219],v[100:103]
buffer_load_dwordx4 v14,s[32:35],s58 offen offset:1024 nt lds
v_mfma_f32_16x16x32_bf16 v[108:111],a[164:167],v[232:235],v[124:127]
ds_read_b64_tr_b16 a[164:165],v28 offset:0
ds_read_b64_tr_b16 a[166:167],v28 offset:1024
v_mfma_f32_16x16x32_bf16 v[108:111],a[160:163],v[228:231],v[108:111]
s_add_u32 m0,s85,106496
s_xor_b32 s58,s11,2125824
v_mfma_f32_16x16x32_bf16 v[104:107],a[168:171],v[236:239],v[104:107]
ds_read_b64_tr_b16 a[160:161],v29 offset:0
ds_read_b64_tr_b16 a[162:163],v29 offset:1024
v_mfma_f32_16x16x32_bf16 v[104:107],a[172:175],v[240:243],v[104:107]
v_exp_f32 v72,v72
v_mfma_f32_16x16x32_bf16 v[96:99],a[172:175],v[224:227],v[96:99]
v_exp_f32 v73,v73
v_mfma_f32_16x16x32_bf16 v[96:99],a[168:171],v[220:223],v[96:99]
v_exp_f32 v74,v74
v_mfma_f32_16x16x32_bf16 v[88:91],a[168:171],v[204:207],v[88:91]
buffer_load_dwordx4 v14,s[32:35],s58 offen nt lds
v_mfma_f32_16x16x32_bf16 v[88:91],a[172:175],v[208:211],v[88:91]
v_exp_f32 v75,v75
v_mfma_f32_16x16x32_bf16 v[80:83],a[172:175],v[192:195],v[80:83]
v_exp_f32 v76,v76
v_mfma_f32_16x16x32_bf16 v[80:83],a[168:171],v[188:191],v[80:83]
v_exp_f32 v77,v77
v_mfma_f32_16x16x32_bf16 v[144:147],a[168:171],v[132:135],v[144:147]
ds_read_b64_tr_b16 a[168:169],v30 offset:0
ds_read_b64_tr_b16 a[170:171],v30 offset:1024
v_mfma_f32_16x16x32_bf16 v[144:147],a[172:175],v[140:143],v[144:147]
v_exp_f32 v78,v78
v_mfma_f32_16x16x32_bf16 v[148:151],a[176:179],v[140:143],v[148:151]
v_exp_f32 v79,v79
v_mfma_f32_16x16x32_bf16 v[148:151],a[180:183],v[132:135],v[148:151]
buffer_load_dwordx4 v14,s[32:35],s58 offen offset:1024 nt lds
v_cvt_pk_bf16_f32 v72,v72,v73
v_mfma_f32_16x16x32_bf16 v[84:87],a[180:183],v[188:191],v[84:87]
s_add_u32 m0,s85,110592
s_xor_b32 s58,s11,2158592
v_mfma_f32_16x16x32_bf16 v[84:87],a[176:179],v[192:195],v[84:87]
v_cvt_pk_bf16_f32 v73,v74,v75
v_cvt_pk_bf16_f32 v74,v76,v77
v_mfma_f32_16x16x32_bf16 v[92:95],a[176:179],v[208:211],v[92:95]
v_cvt_pk_bf16_f32 v75,v78,v79
v_mfma_f32_16x16x32_bf16 v[92:95],a[180:183],v[204:207],v[92:95]
v_mfma_f32_16x16x32_bf16 v[100:103],a[180:183],v[220:223],v[100:103]
v_mfma_f32_16x16x32_bf16 v[100:103],a[176:179],v[224:227],v[100:103]
v_mfma_f32_16x16x32_bf16 v[108:111],a[176:179],v[240:243],v[108:111]
buffer_load_dwordx4 v14,s[32:35],s58 offen nt lds
v_mfma_f32_16x16x32_bf16 v[108:111],a[180:183],v[236:239],v[108:111]
v_max3_f32 v1,v144,v145,v146
v_max3_f32 v1,v1,v147,v148
s_waitcnt lgkmcnt(0)
v_mfma_f32_16x16x32_bf16 a[0:3],a[184:187],v[48:51],a[0:3]
ds_read_b64_tr_b16 a[172:173],v31 offset:0
ds_read_b64_tr_b16 a[174:175],v31 offset:1024
v_mfma_f32_16x16x32_bf16 a[4:7],a[184:187],v[56:59],a[4:7]
v_max3_f32 v1,v1,v149,v150
v_max3_f32 v1,v1,v151,v80
v_mfma_f32_16x16x32_bf16 a[8:11],a[184:187],v[64:67],a[8:11]
v_max3_f32 v1,v1,v81,v82
v_max3_f32 v1,v1,v83,v88
v_mfma_f32_16x16x32_bf16 a[12:15],a[184:187],v[72:75],a[12:15]
v_max3_f32 v1,v1,v89,v90
v_max3_f32 v1,v1,v91,v96
v_mfma_f32_16x16x32_bf16 a[28:31],a[188:191],v[72:75],a[28:31]
v_max3_f32 v1,v1,v97,v98
v_max3_f32 v1,v1,v99,v104
v_mfma_f32_16x16x32_bf16 a[24:27],a[188:191],v[64:67],a[24:27]
buffer_load_dwordx4 v14,s[32:35],s58 offen offset:1024 nt lds
v_max3_f32 v1,v1,v105,v106
v_mfma_f32_16x16x32_bf16 a[20:23],a[188:191],v[56:59],a[20:23]
v_max3_f32 v1,v1,v107,v84
v_max3_f32 v1,v1,v85,v86
v_mfma_f32_16x16x32_bf16 a[16:19],a[188:191],v[48:51],a[16:19]
v_max3_f32 v1,v1,v87,v92
v_max3_f32 v1,v1,v93,v94
v_mfma_f32_16x16x32_bf16 v[156:159],v[176:179],v[48:51],v[156:159]
v_max3_f32 v1,v1,v95,v100
v_max3_f32 v1,v1,v101,v102
v_mfma_f32_16x16x32_bf16 a[32:35],a[196:199],v[48:51],a[32:35]
v_max3_f32 v1,v1,v103,v108
v_max3_f32 v1,v1,v109,v110
v_mfma_f32_16x16x32_bf16 a[36:39],a[196:199],v[56:59],a[36:39]
v_max_f32 v1,v1,v111
v_cmp_lt_f32 vcc,0x41000000,v1
v_mfma_f32_16x16x32_bf16 a[40:43],a[196:199],v[64:67],a[40:43]
v_mfma_f32_16x16x32_bf16 a[44:47],a[196:199],v[72:75],a[44:47]
s_cbranch_vccnz L_noA5_1_o
L_noA5_1:
v_mfma_f32_16x16x32_bf16 v[160:163],v[176:179],v[56:59],v[160:163]
v_exp_f32 v80,v80
v_mfma_f32_16x16x32_bf16 a[60:63],a[192:195],v[72:75],a[60:63]
v_exp_f32 v81,v81
v_mfma_f32_16x16x32_bf16 a[56:59],a[192:195],v[64:67],a[56:59]
v_exp_f32 v82,v82
v_mfma_f32_16x16x32_bf16 a[52:55],a[192:195],v[56:59],a[52:55]
v_exp_f32 v83,v83
v_mfma_f32_16x16x32_bf16 a[48:51],a[192:195],v[48:51],a[48:51]
v_exp_f32 v84,v84
v_mfma_f32_16x16x32_bf16 v[164:167],v[176:179],v[64:67],v[164:167]
v_exp_f32 v85,v85
v_mfma_f32_16x16x32_bf16 a[64:67],a[164:167],v[48:51],a[64:67]
s_waitcnt vmcnt(8) lgkmcnt(0)
s_barrier
s_cmp_eq_u32 s100,1
s_cbranch_scc1 L_qk3_1
s_waitcnt vmcnt(3)
L_qk3_1:
v_mfma_f32_16x16x32_bf16 a[68:71],a[164:167],v[56:59],a[68:71]
s_add_u32 m0,s85,0
s_xor_b32 s58,s11,2162688
v_mfma_f32_16x16x32_bf16 a[72:75],a[164:167],v[64:67],a[72:75]
buffer_load_dwordx4 v12,s[28:31],s58 offen nt lds
v_mfma_f32_16x16x32_bf16 a[76:79],a[164:167],v[72:75],a[76:79]
ds_read_b128 a[176:179],v40 offset:32768
ds_read_b128 a[180:183],v41 offset:32768
v_mfma_f32_16x16x32_bf16 v[168:171],v[176:179],v[72:75],v[168:171]
ds_read_b128 a[184:187],v40 offset:33792
v_mfma_f32_16x16x32_bf16 a[92:95],a[160:163],v[72:75],a[92:95]
ds_read_b128 a[188:191],v41 offset:33792
ds_read_b128 a[196:199],v42 offset:32768
v_mfma_f32_16x16x32_bf16 a[88:91],a[160:163],v[64:67],a[88:91]
ds_read_b128 a[192:195],v43 offset:32768
v_mfma_f32_16x16x32_bf16 a[84:87],a[160:163],v[56:59],a[84:87]
ds_read_b128 a[164:167],v42 offset:33792
v_mfma_f32_16x16x32_bf16 a[80:83],a[160:163],v[48:51],a[80:83]
ds_read_b128 a[160:163],v43 offset:33792
v_mfma_f32_16x16x32_bf16 a[96:99],a[168:171],v[48:51],a[96:99]
buffer_load_dwordx4 v12,s[28:31],s58 offen offset:1024 nt lds
v_mfma_f32_16x16x32_bf16 a[100:103],a[168:171],v[56:59],a[100:103]
s_add_u32 m0,s85,4096
s_xor_b32 s58,s11,2195456
v_mfma_f32_16x16x32_bf16 a[104:107],a[168:171],v[64:67],a[104:107]
v_exp_f32 v86,v86
v_mfma_f32_16x16x32_bf16 a[108:111],a[168:171],v[72:75],a[108:111]
ds_read_b64_tr_b16 a[168:169],v32 offset:0
ds_read_b64_tr_b16 a[170:171],v32 offset:1024
v_mfma_f32_16x16x32_bf16 a[124:127],a[172:175],v[72:75],a[124:127]
v_exp_f32 v87,v87
v_mfma_f32_16x16x32_bf16 a[120:123],a[172:175],v[64:67],a[120:123]
v_cvt_pk_bf16_f32 v80,v80,v81
v_cvt_pk_bf16_f32 v81,v82,v83
v_mfma_f32_16x16x32_bf16 a[116:119],a[172:175],v[56:59],a[116:119]
v_cvt_pk_bf16_f32 v82,v84,v85
v_cvt_pk_bf16_f32 v83,v86,v87
v_mfma_f32_16x16x32_bf16 a[112:115],a[172:175],v[48:51],a[112:115]
buffer_load_dwordx4 v13,s[28:31],s58 offen nt lds
s_waitcnt lgkmcnt(0)
v_mfma_f32_16x16x32_bf16 v[72:75],a[176:179],v[228:231],v[124:127]
ds_read_b64_tr_b16 a[172:173],v33 offset:0
ds_read_b64_tr_b16 a[174:175],v33 offset:1024
v_mfma_f32_16x16x32_bf16 v[72:75],a[180:183],v[232:235],v[72:75]
v_exp_f32 v88,v88
v_mfma_f32_16x16x32_bf16 v[64:67],a[180:183],v[216:219],v[120:123]
v_exp_f32 v89,v89
v_mfma_f32_16x16x32_bf16 v[64:67],a[176:179],v[212:215],v[64:67]
v_exp_f32 v90,v90
v_mfma_f32_16x16x32_bf16 v[56:59],a[176:179],v[196:199],v[116:119]
s_cmp_eq_u32 s93,0
s_cbranch_scc0 L_noP5_1_o
L_noP5_1:
v_mfma_f32_16x16x32_bf16 v[56:59],a[180:183],v[200:203],v[56:59]
v_exp_f32 v91,v91
v_mfma_f32_16x16x32_bf16 v[48:51],a[180:183],v[184:187],v[112:115]
buffer_load_dwordx4 v13,s[28:31],s58 offen offset:1024 nt lds
v_mfma_f32_16x16x32_bf16 v[48:51],a[176:179],v[180:183],v[48:51]
ds_read_b64_tr_b16 a[180:181],v34 offset:0
ds_read_b64_tr_b16 a[182:183],v34 offset:1024
v_mfma_f32_16x16x32_bf16 v[52:55],a[184:187],v[180:183],v[112:115]
s_add_u32 m0,s85,8192
s_xor_b32 s58,s11,2170880
v_mfma_f32_16x16x32_bf16 v[52:55],a[188:191],v[184:187],v[52:55]
ds_read_b64_tr_b16 a[176:177],v35 offset:0
ds_read_b64_tr_b16 a[178:179],v35 offset:1024
v_mfma_f32_16x16x32_bf16 v[60:63],a[188:191],v[200:203],v[116:119]
v_exp_f32 v92,v92
v_mfma_f32_16x16x32_bf16 v[60:63],a[184:187],v[196:199],v[60:63]
v_exp_f32 v93,v93
v_mfma_f32_16x16x32_bf16 v[68:71],a[184:187],v[212:215],v[120:123]
v_exp_f32 v94,v94
v_mfma_f32_16x16x32_bf16 v[68:71],a[188:191],v[216:219],v[68:71]
buffer_load_dwordx4 v12,s[28:31],s58 offen nt lds
v_mfma_f32_16x16x32_bf16 v[76:79],a[188:191],v[232:235],v[124:127]
ds_read_b64_tr_b16 a[188:189],v36 offset:0
ds_read_b64_tr_b16 a[190:191],v36 offset:1024
v_mfma_f32_16x16x32_bf16 v[76:79],a[184:187],v[228:231],v[76:79]
v_exp_f32 v95,v95
v_mfma_f32_16x16x32_bf16 v[72:75],a[196:199],v[236:239],v[72:75]
ds_read_b64_tr_b16 a[184:185],v37 offset:0
ds_read_b64_tr_b16 a[186:187],v37 offset:1024
v_mfma_f32_16x16x32_bf16 v[72:75],a[192:195],v[240:243],v[72:75]
v_cvt_pk_bf16_f32 v88,v88,v89
v_cvt_pk_bf16_f32 v89,v90,v91
v_mfma_f32_16x16x32_bf16 v[64:67],a[192:195],v[224:227],v[64:67]
v_cvt_pk_bf16_f32 v90,v92,v93
v_cvt_pk_bf16_f32 v91,v94,v95
v_mfma_f32_16x16x32_bf16 v[64:67],a[196:199],v[220:223],v[64:67]
v_exp_f32 v96,v96
v_mfma_f32_16x16x32_bf16 v[56:59],a[196:199],v[204:207],v[56:59]
buffer_load_dwordx4 v12,s[28:31],s58 offen offset:1024 nt lds
v_mfma_f32_16x16x32_bf16 v[56:59],a[192:195],v[208:211],v[56:59]
s_add_u32 m0,s85,12288
s_xor_b32 s58,s11,2203648
v_mfma_f32_16x16x32_bf16 v[48:51],a[192:195],v[192:195],v[48:51]
ds_read_b64_tr_b16 a[192:193],v38 offset:0
ds_read_b64_tr_b16 a[194:195],v38 offset:1024
v_mfma_f32_16x16x32_bf16 v[48:51],a[196:199],v[188:191],v[48:51]
v_exp_f32 v97,v97
v_mfma_f32_16x16x32_bf16 v[52:55],a[164:167],v[188:191],v[52:55]
ds_read_b64_tr_b16 a[196:197],v39 offset:0
ds_read_b64_tr_b16 a[198:199],v39 offset:1024
v_mfma_f32_16x16x32_bf16 v[52:55],a[160:163],v[192:195],v[52:55]
v_exp_f32 v98,v98
v_mfma_f32_16x16x32_bf16 v[60:63],a[160:163],v[208:211],v[60:63]
v_exp_f32 v99,v99
v_mfma_f32_16x16x32_bf16 v[60:63],a[164:167],v[204:207],v[60:63]
buffer_load_dwordx4 v13,s[28:31],s58 offen nt lds
v_mfma_f32_16x16x32_bf16 v[68:71],a[164:167],v[220:223],v[68:71]
v_exp_f32 v100,v100
v_mfma_f32_16x16x32_bf16 v[68:71],a[160:163],v[224:227],v[68:71]
v_exp_f32 v101,v101
v_mfma_f32_16x16x32_bf16 v[76:79],a[160:163],v[240:243],v[76:79]
v_exp_f32 v102,v102
v_mfma_f32_16x16x32_bf16 v[76:79],a[164:167],v[236:239],v[76:79]
v_exp_f32 v103,v103
v_mfma_f32_16x16x32_bf16 a[0:3],a[168:171],v[80:83],a[0:3]
v_cvt_pk_bf16_f32 v96,v96,v97
v_cvt_pk_bf16_f32 v97,v98,v99
v_mfma_f32_16x16x32_bf16 a[4:7],a[168:171],v[88:91],a[4:7]
v_cvt_pk_bf16_f32 v98,v100,v101
v_cvt_pk_bf16_f32 v99,v102,v103
s_nop 1
v_mfma_f32_16x16x32_bf16 a[8:11],a[168:171],v[96:99],a[8:11]
buffer_load_dwordx4 v13,s[28:31],s58 offen offset:1024 nt lds
v_exp_f32 v104,v104
v_exp_f32 v105,v105
v_exp_f32 v106,v106
v_exp_f32 v107,v107
v_exp_f32 v108,v108
v_exp_f32 v109,v109
v_exp_f32 v110,v110
v_exp_f32 v111,v111
v_cvt_pk_bf16_f32 v104,v104,v105
v_cvt_pk_bf16_f32 v105,v106,v107
v_cvt_pk_bf16_f32 v106,v108,v109
v_cvt_pk_bf16_f32 v107,v110,v111
s_nop 1
v_mfma_f32_16x16x32_bf16 a[12:15],a[168:171],v[104:107],a[12:15]
v_exp_f32 v144,v144
v_exp_f32 v145,v145
v_exp_f32 v146,v146
v_exp_f32 v147,v147
v_exp_f32 v148,v148
v_exp_f32 v149,v149
v_exp_f32 v150,v150
v_exp_f32 v151,v151
v_cvt_pk_bf16_f32 v144,v144,v145
v_cvt_pk_bf16_f32 v145,v146,v147
v_cvt_pk_bf16_f32 v146,v148,v149
v_cvt_pk_bf16_f32 v147,v150,v151
s_nop 1
v_mfma_f32_16x16x32_bf16 a[128:131],a[168:171],v[144:147],a[128:131]
v_max3_f32 v1,v48,v49,v50
v_max3_f32 v1,v1,v51,v56
s_waitcnt lgkmcnt(0)
v_mfma_f32_16x16x32_bf16 a[132:135],a[172:175],v[144:147],a[132:135]
ds_read_b128 a[160:163],v44 offset:32768
ds_read_b128 a[164:167],v45 offset:32768
v_mfma_f32_16x16x32_bf16 a[28:31],a[172:175],v[104:107],a[28:31]
ds_read_b128 a[168:171],v45 offset:33792
v_max3_f32 v1,v1,v57,v58
v_mfma_f32_16x16x32_bf16 a[24:27],a[172:175],v[96:99],a[24:27]
v_max3_f32 v1,v1,v59,v64
v_max3_f32 v1,v1,v65,v66
v_mfma_f32_16x16x32_bf16 a[20:23],a[172:175],v[88:91],a[20:23]
v_max3_f32 v1,v1,v67,v72
v_max3_f32 v1,v1,v73,v74
v_mfma_f32_16x16x32_bf16 a[16:19],a[172:175],v[80:83],a[16:19]
ds_read_b128 a[172:175],v44 offset:33792
v_max3_f32 v1,v1,v75,v52
v_mfma_f32_16x16x32_bf16 v[156:159],v[176:179],v[80:83],v[156:159]
v_max3_f32 v1,v1,v53,v54
v_max3_f32 v1,v1,v55,v60
v_mfma_f32_16x16x32_bf16 a[32:35],a[180:183],v[80:83],a[32:35]
v_max3_f32 v1,v1,v61,v62
v_max3_f32 v1,v1,v63,v68
v_mfma_f32_16x16x32_bf16 a[36:39],a[180:183],v[88:91],a[36:39]
v_max3_f32 v1,v1,v69,v70
v_max3_f32 v1,v1,v71,v76
v_mfma_f32_16x16x32_bf16 a[40:43],a[180:183],v[96:99],a[40:43]
v_max3_f32 v1,v1,v77,v78
v_max_f32 v1,v1,v79
v_mfma_f32_16x16x32_bf16 a[44:47],a[180:183],v[104:107],a[44:47]
v_cmp_lt_f32 vcc,0x41000000,v1
v_mfma_f32_16x16x32_bf16 a[136:139],a[180:183],v[144:147],a[136:139]
ds_read_b128 a[180:183],v46 offset:32768
v_mfma_f32_16x16x32_bf16 v[160:163],v[176:179],v[88:91],v[160:163]
v_mfma_f32_16x16x32_bf16 a[140:143],a[176:179],v[144:147],a[140:143]
s_cbranch_vccnz L_noA6_1_o
L_noA6_1:
v_mfma_f32_16x16x32_bf16 a[60:63],a[176:179],v[104:107],a[60:63]
v_exp_f32 v48,v48
v_mfma_f32_16x16x32_bf16 a[56:59],a[176:179],v[96:99],a[56:59]
v_exp_f32 v49,v49
v_mfma_f32_16x16x32_bf16 a[52:55],a[176:179],v[88:91],a[52:55]
v_exp_f32 v50,v50
v_mfma_f32_16x16x32_bf16 a[48:51],a[176:179],v[80:83],a[48:51]
ds_read_b128 a[176:179],v47 offset:32768
v_mfma_f32_16x16x32_bf16 v[164:167],v[176:179],v[96:99],v[164:167]
v_exp_f32 v51,v51
v_mfma_f32_16x16x32_bf16 a[64:67],a[188:191],v[80:83],a[64:67]
v_exp_f32 v52,v52
v_mfma_f32_16x16x32_bf16 a[68:71],a[188:191],v[88:91],a[68:71]
v_exp_f32 v53,v53
v_mfma_f32_16x16x32_bf16 a[72:75],a[188:191],v[96:99],a[72:75]
v_exp_f32 v54,v54
v_mfma_f32_16x16x32_bf16 a[76:79],a[188:191],v[104:107],a[76:79]
v_exp_f32 v55,v55
v_mfma_f32_16x16x32_bf16 a[144:147],a[188:191],v[144:147],a[144:147]
ds_read_b128 a[188:191],v47 offset:33792
v_cvt_pk_bf16_f32 v48,v48,v49
v_mfma_f32_16x16x32_bf16 v[168:171],v[176:179],v[104:107],v[168:171]
v_cvt_pk_bf16_f32 v49,v50,v51
v_cvt_pk_bf16_f32 v50,v52,v53
v_mfma_f32_16x16x32_bf16 a[148:151],a[184:187],v[144:147],a[148:151]
v_cvt_pk_bf16_f32 v51,v54,v55
v_mfma_f32_16x16x32_bf16 a[92:95],a[184:187],v[104:107],a[92:95]
v_exp_f32 v56,v56
v_mfma_f32_16x16x32_bf16 a[88:91],a[184:187],v[96:99],a[88:91]
v_exp_f32 v57,v57
v_mfma_f32_16x16x32_bf16 a[84:87],a[184:187],v[88:91],a[84:87]
v_exp_f32 v58,v58
v_mfma_f32_16x16x32_bf16 a[80:83],a[184:187],v[80:83],a[80:83]
ds_read_b128 a[184:187],v46 offset:33792
v_mfma_f32_16x16x32_bf16 v[172:175],v[176:179],v[144:147],v[172:175]
v_exp_f32 v59,v59
v_mfma_f32_16x16x32_bf16 a[96:99],a[192:195],v[80:83],a[96:99]
v_exp_f32 v60,v60
v_mfma_f32_16x16x32_bf16 a[100:103],a[192:195],v[88:91],a[100:103]
v_exp_f32 v61,v61
v_mfma_f32_16x16x32_bf16 a[104:107],a[192:195],v[96:99],a[104:107]
v_exp_f32 v62,v62
v_mfma_f32_16x16x32_bf16 a[108:111],a[192:195],v[104:107],a[108:111]
v_exp_f32 v63,v63
v_mfma_f32_16x16x32_bf16 a[152:155],a[192:195],v[144:147],a[152:155]
s_waitcnt vmcnt(8) lgkmcnt(0)
s_barrier
s_cmp_eq_u32 s100,1
s_cbranch_scc1 L_qv3_1
s_waitcnt vmcnt(3)
L_qv3_1:
v_mfma_f32_16x16x32_bf16 a[156:159],a[196:199],v[144:147],a[156:159]
s_add_u32 m0,s85,65536
s_xor_b32 s58,s11,2162688
v_mfma_f32_16x16x32_bf16 a[124:127],a[196:199],v[104:107],a[124:127]
buffer_load_dwordx4 v14,s[32:35],s58 offen nt lds
v_cvt_pk_bf16_f32 v56,v56,v57
v_mfma_f32_16x16x32_bf16 a[120:123],a[196:199],v[96:99],a[120:123]
ds_read_b64_tr_b16 a[192:193],v24 offset:32768
ds_read_b64_tr_b16 a[194:195],v24 offset:33792
v_mfma_f32_16x16x32_bf16 a[116:119],a[196:199],v[88:91],a[116:119]
v_cvt_pk_bf16_f32 v57,v58,v59
v_cvt_pk_bf16_f32 v58,v60,v61
v_mfma_f32_16x16x32_bf16 a[112:115],a[196:199],v[80:83],a[112:115]
ds_read_b64_tr_b16 a[196:197],v25 offset:32768
ds_read_b64_tr_b16 a[198:199],v25 offset:33792
v_mfma_f32_16x16x32_bf16 v[104:107],a[160:163],v[228:231],v[124:127]
v_cvt_pk_bf16_f32 v59,v62,v63
v_mfma_f32_16x16x32_bf16 v[104:107],a[164:167],v[232:235],v[104:107]
v_exp_f32 v64,v64
v_mfma_f32_16x16x32_bf16 v[96:99],a[164:167],v[216:219],v[120:123]
v_exp_f32 v65,v65
v_mfma_f32_16x16x32_bf16 v[96:99],a[160:163],v[212:215],v[96:99]
buffer_load_dwordx4 v14,s[32:35],s58 offen offset:1024 nt lds
v_mfma_f32_16x16x32_bf16 v[88:91],a[160:163],v[196:199],v[116:119]
s_add_u32 m0,s85,69632
s_xor_b32 s58,s11,2195456
v_mfma_f32_16x16x32_bf16 v[88:91],a[164:167],v[200:203],v[88:91]
v_exp_f32 v66,v66
v_mfma_f32_16x16x32_bf16 v[80:83],a[164:167],v[184:187],v[112:115]
s_cmp_eq_u32 s93,0
s_cbranch_scc0 L_noP6_1_o
L_noP6_1:
v_mfma_f32_16x16x32_bf16 v[80:83],a[160:163],v[180:183],v[80:83]
v_exp_f32 v67,v67
v_mfma_f32_16x16x32_bf16 v[144:147],a[160:163],v[128:131],v[152:155]
ds_read_b64_tr_b16 a[160:161],v26 offset:32768
ds_read_b64_tr_b16 a[162:163],v26 offset:33792
v_mfma_f32_16x16x32_bf16 v[144:147],a[164:167],v[136:139],v[144:147]
v_exp_f32 v68,v68
v_mfma_f32_16x16x32_bf16 v[148:151],a[168:171],v[136:139],v[152:155]
buffer_load_dwordx4 v14,s[32:35],s58 offen nt lds
v_mfma_f32_16x16x32_bf16 v[148:151],a[172:175],v[128:131],v[148:151]
ds_read_b64_tr_b16 a[164:165],v27 offset:32768
ds_read_b64_tr_b16 a[166:167],v27 offset:33792
v_mfma_f32_16x16x32_bf16 v[84:87],a[172:175],v[180:183],v[112:115]
v_exp_f32 v69,v69
v_mfma_f32_16x16x32_bf16 v[84:87],a[168:171],v[184:187],v[84:87]
v_exp_f32 v70,v70
v_mfma_f32_16x16x32_bf16 v[92:95],a[168:171],v[200:203],v[116:119]
v_exp_f32 v71,v71
v_mfma_f32_16x16x32_bf16 v[92:95],a[172:175],v[196:199],v[92:95]
v_cvt_pk_bf16_f32 v64,v64,v65
v_cvt_pk_bf16_f32 v65,v66,v67
v_mfma_f32_16x16x32_bf16 v[100:103],a[172:175],v[212:215],v[120:123]
v_cvt_pk_bf16_f32 v66,v68,v69
v_cvt_pk_bf16_f32 v67,v70,v71
v_mfma_f32_16x16x32_bf16 v[100:103],a[168:171],v[216:219],v[100:103]
buffer_load_dwordx4 v14,s[32:35],s58 offen offset:1024 nt lds
v_mfma_f32_16x16x32_bf16 v[108:111],a[168:171],v[232:235],v[124:127]
ds_read_b64_tr_b16 a[168:169],v28 offset:32768
ds_read_b64_tr_b16 a[170:171],v28 offset:33792
v_mfma_f32_16x16x32_bf16 v[108:111],a[172:175],v[228:231],v[108:111]
s_add_u32 m0,s85,73728
s_xor_b32 s58,s11,2170880
v_mfma_f32_16x16x32_bf16 v[104:107],a[180:183],v[236:239],v[104:107]
ds_read_b64_tr_b16 a[172:173],v29 offset:32768
ds_read_b64_tr_b16 a[174:175],v29 offset:33792
v_mfma_f32_16x16x32_bf16 v[104:107],a[176:179],v[240:243],v[104:107]
v_exp_f32 v72,v72
v_mfma_f32_16x16x32_bf16 v[96:99],a[176:179],v[224:227],v[96:99]
v_exp_f32 v73,v73
v_mfma_f32_16x16x32_bf16 v[96:99],a[180:183],v[220:223],v[96:99]
v_exp_f32 v74,v74
v_mfma_f32_16x16x32_bf16 v[88:91],a[180:183],v[204:207],v[88:91]
buffer_load_dwordx4 v14,s[32:35],s58 offen nt lds
v_mfma_f32_16x16x32_bf16 v[88:91],a[176:179],v[208:211],v[88:91]
v_exp_f32 v75,v75
v_mfma_f32_16x16x32_bf16 v[80:83],a[176:179],v[192:195],v[80:83]
v_exp_f32 v76,v76
v_mfma_f32_16x16x32_bf16 v[80:83],a[180:183],v[188:191],v[80:83]
v_exp_f32 v77,v77
v_mfma_f32_16x16x32_bf16 v[144:147],a[180:183],v[132:135],v[144:147]
ds_read_b64_tr_b16 a[180:181],v30 offset:32768
ds_read_b64_tr_b16 a[182:183],v30 offset:33792
v_mfma_f32_16x16x32_bf16 v[144:147],a[176:179],v[140:143],v[144:147]
v_exp_f32 v78,v78
v_mfma_f32_16x16x32_bf16 v[148:151],a[188:191],v[140:143],v[148:151]
v_exp_f32 v79,v79
v_mfma_f32_16x16x32_bf16 v[148:151],a[184:187],v[132:135],v[148:151]
buffer_load_dwordx4 v14,s[32:35],s58 offen offset:1024 nt lds
v_cvt_pk_bf16_f32 v72,v72,v73
v_mfma_f32_16x16x32_bf16 v[84:87],a[184:187],v[188:191],v[84:87]
s_add_u32 m0,s85,77824
s_xor_b32 s58,s11,2203648
v_mfma_f32_16x16x32_bf16 v[84:87],a[188:191],v[192:195],v[84:87]
v_cvt_pk_bf16_f32 v73,v74,v75
v_cvt_pk_bf16_f32 v74,v76,v77
v_mfma_f32_16x16x32_bf16 v[92:95],a[188:191],v[208:211],v[92:95]
v_cvt_pk_bf16_f32 v75,v78,v79
v_mfma_f32_16x16x32_bf16 v[92:95],a[184:187],v[204:207],v[92:95]
v_mfma_f32_16x16x32_bf16 v[100:103],a[184:187],v[220:223],v[100:103]
v_mfma_f32_16x16x32_bf16 v[100:103],a[188:191],v[224:227],v[100:103]
v_mfma_f32_16x16x32_bf16 v[108:111],a[188:191],v[240:243],v[108:111]
buffer_load_dwordx4 v14,s[32:35],s58 offen nt lds
v_mfma_f32_16x16x32_bf16 v[108:111],a[184:187],v[236:239],v[108:111]
v_max3_f32 v1,v144,v145,v146
v_max3_f32 v1,v1,v147,v148
s_waitcnt lgkmcnt(0)
v_mfma_f32_16x16x32_bf16 a[0:3],a[192:195],v[48:51],a[0:3]
ds_read_b64_tr_b16 a[176:177],v31 offset:32768
ds_read_b64_tr_b16 a[178:179],v31 offset:33792
v_mfma_f32_16x16x32_bf16 a[4:7],a[192:195],v[56:59],a[4:7]
v_max3_f32 v1,v1,v149,v150
v_max3_f32 v1,v1,v151,v80
v_mfma_f32_16x16x32_bf16 a[8:11],a[192:195],v[64:67],a[8:11]
v_max3_f32 v1,v1,v81,v82
v_max3_f32 v1,v1,v83,v88
v_mfma_f32_16x16x32_bf16 a[12:15],a[192:195],v[72:75],a[12:15]
v_max3_f32 v1,v1,v89,v90
v_max3_f32 v1,v1,v91,v96
v_mfma_f32_16x16x32_bf16 a[28:31],a[196:199],v[72:75],a[28:31]
v_max3_f32 v1,v1,v97,v98
v_max3_f32 v1,v1,v99,v104
v_mfma_f32_16x16x32_bf16 a[24:27],a[196:199],v[64:67],a[24:27]
buffer_load_dwordx4 v14,s[32:35],s58 offen offset:1024 nt lds
v_max3_f32 v1,v1,v105,v106
v_mfma_f32_16x16x32_bf16 a[20:23],a[196:199],v[56:59],a[20:23]
v_max3_f32 v1,v1,v107,v84
v_max3_f32 v1,v1,v85,v86
v_mfma_f32_16x16x32_bf16 a[16:19],a[196:199],v[48:51],a[16:19]
v_max3_f32 v1,v1,v87,v92
v_max3_f32 v1,v1,v93,v94
v_mfma_f32_16x16x32_bf16 v[156:159],v[176:179],v[48:51],v[156:159]
v_max3_f32 v1,v1,v95,v100
v_max3_f32 v1,v1,v101,v102
v_mfma_f32_16x16x32_bf16 a[32:35],a[160:163],v[48:51],a[32:35]
v_max3_f32 v1,v1,v103,v108
v_max3_f32 v1,v1,v109,v110
v_mfma_f32_16x16x32_bf16 a[36:39],a[160:163],v[56:59],a[36:39]
v_max_f32 v1,v1,v111
v_cmp_lt_f32 vcc,0x41000000,v1
v_mfma_f32_16x16x32_bf16 a[40:43],a[160:163],v[64:67],a[40:43]
v_mfma_f32_16x16x32_bf16 a[44:47],a[160:163],v[72:75],a[44:47]
s_cbranch_vccnz L_noA7_1_o
L_noA7_1:
v_mfma_f32_16x16x32_bf16 v[160:163],v[176:179],v[56:59],v[160:163]
v_exp_f32 v80,v80
v_mfma_f32_16x16x32_bf16 a[60:63],a[164:167],v[72:75],a[60:63]
v_exp_f32 v81,v81
v_mfma_f32_16x16x32_bf16 a[56:59],a[164:167],v[64:67],a[56:59]
v_exp_f32 v82,v82
v_mfma_f32_16x16x32_bf16 a[52:55],a[164:167],v[56:59],a[52:55]
v_exp_f32 v83,v83
v_mfma_f32_16x16x32_bf16 a[48:51],a[164:167],v[48:51],a[48:51]
v_exp_f32 v84,v84
v_mfma_f32_16x16x32_bf16 v[164:167],v[176:179],v[64:67],v[164:167]
v_exp_f32 v85,v85
v_mfma_f32_16x16x32_bf16 a[64:67],a[168:171],v[48:51],a[64:67]
s_waitcnt vmcnt(8) lgkmcnt(0)
s_barrier
s_cmp_eq_u32 s100,1
s_cbranch_scc1 L_qk4_1
s_waitcnt vmcnt(3)
L_qk4_1:
v_mfma_f32_16x16x32_bf16 a[68:71],a[168:171],v[56:59],a[68:71]
s_add_u32 m0,s85,32768
s_xor_b32 s58,s11,2166784
v_mfma_f32_16x16x32_bf16 a[72:75],a[168:171],v[64:67],a[72:75]
buffer_load_dwordx4 v12,s[28:31],s58 offen nt lds
v_mfma_f32_16x16x32_bf16 a[76:79],a[168:171],v[72:75],a[76:79]
ds_read_b128 a[188:191],v40 offset:0
ds_read_b128 a[184:187],v41 offset:0
v_mfma_f32_16x16x32_bf16 v[168:171],v[176:179],v[72:75],v[168:171]
ds_read_b128 a[192:195],v40 offset:1024
v_mfma_f32_16x16x32_bf16 a[92:95],a[172:175],v[72:75],a[92:95]
ds_read_b128 a[196:199],v41 offset:1024
ds_read_b128 a[160:163],v42 offset:0
v_mfma_f32_16x16x32_bf16 a[88:91],a[172:175],v[64:67],a[88:91]
ds_read_b128 a[164:167],v43 offset:0
v_mfma_f32_16x16x32_bf16 a[84:87],a[172:175],v[56:59],a[84:87]
ds_read_b128 a[168:171],v42 offset:1024
v_mfma_f32_16x16x32_bf16 a[80:83],a[172:175],v[48:51],a[80:83]
ds_read_b128 a[172:175],v43 offset:1024
v_mfma_f32_16x16x32_bf16 a[96:99],a[180:183],v[48:51],a[96:99]
buffer_load_dwordx4 v12,s[28:31],s58 offen offset:1024 nt lds
v_mfma_f32_16x16x32_bf16 a[100:103],a[180:183],v[56:59],a[100:103]
s_add_u32 m0,s85,36864
s_xor_b32 s58,s11,2199552
v_mfma_f32_16x16x32_bf16 a[104:107],a[180:183],v[64:67],a[104:107]
v_exp_f32 v86,v86
v_mfma_f32_16x16x32_bf16 a[108:111],a[180:183],v[72:75],a[108:111]
ds_read_b64_tr_b16 a[180:181],v32 offset:32768
ds_read_b64_tr_b16 a[182:183],v32 offset:33792
v_mfma_f32_16x16x32_bf16 a[124:127],a[176:179],v[72:75],a[124:127]
v_exp_f32 v87,v87
v_mfma_f32_16x16x32_bf16 a[120:123],a[176:179],v[64:67],a[120:123]
v_cvt_pk_bf16_f32 v80,v80,v81
v_cvt_pk_bf16_f32 v81,v82,v83
v_mfma_f32_16x16x32_bf16 a[116:119],a[176:179],v[56:59],a[116:119]
v_cvt_pk_bf16_f32 v82,v84,v85
v_cvt_pk_bf16_f32 v83,v86,v87
v_mfma_f32_16x16x32_bf16 a[112:115],a[176:179],v[48:51],a[112:115]
buffer_load_dwordx4 v13,s[28:31],s58 offen nt lds
s_waitcnt lgkmcnt(0)
v_mfma_f32_16x16x32_bf16 v[72:75],a[188:191],v[228:231],v[124:127]
ds_read_b64_tr_b16 a[176:177],v33 offset:32768
ds_read_b64_tr_b16 a[178:179],v33 offset:33792
v_mfma_f32_16x16x32_bf16 v[72:75],a[184:187],v[232:235],v[72:75]
v_exp_f32 v88,v88
v_mfma_f32_16x16x32_bf16 v[64:67],a[184:187],v[216:219],v[120:123]
v_exp_f32 v89,v89
v_mfma_f32_16x16x32_bf16 v[64:67],a[188:191],v[212:215],v[64:67]
v_exp_f32 v90,v90
v_mfma_f32_16x16x32_bf16 v[56:59],a[188:191],v[196:199],v[116:119]
s_cmp_eq_u32 s93,0
s_cbranch_scc0 L_noP7_1_o
L_noP7_1:
v_mfma_f32_16x16x32_bf16 v[56:59],a[184:187],v[200:203],v[56:59]
v_exp_f32 v91,v91
v_mfma_f32_16x16x32_bf16 v[48:51],a[184:187],v[184:187],v[112:115]
buffer_load_dwordx4 v13,s[28:31],s58 offen offset:1024 nt lds
v_mfma_f32_16x16x32_bf16 v[48:51],a[188:191],v[180:183],v[48:51]
ds_read_b64_tr_b16 a[184:185],v34 offset:32768
ds_read_b64_tr_b16 a[186:187],v34 offset:33792
v_mfma_f32_16x16x32_bf16 v[52:55],a[192:195],v[180:183],v[112:115]
s_add_u32 m0,s85,40960
s_xor_b32 s58,s11,2174976
v_mfma_f32_16x16x32_bf16 v[52:55],a[196:199],v[184:187],v[52:55]
ds_read_b64_tr_b16 a[188:189],v35 offset:32768
ds_read_b64_tr_b16 a[190:191],v35 offset:33792
v_mfma_f32_16x16x32_bf16 v[60:63],a[196:199],v[200:203],v[116:119]
v_exp_f32 v92,v92
v_mfma_f32_16x16x32_bf16 v[60:63],a[192:195],v[196:199],v[60:63]
v_exp_f32 v93,v93
v_mfma_f32_16x16x32_bf16 v[68:71],a[192:195],v[212:215],v[120:123]
v_exp_f32 v94,v94
v_mfma_f32_16x16x32_bf16 v[68:71],a[196:199],v[216:219],v[68:71]
buffer_load_dwordx4 v12,s[28:31],s58 offen nt lds
v_mfma_f32_16x16x32_bf16 v[76:79],a[196:199],v[232:235],v[124:127]
ds_read_b64_tr_b16 a[196:197],v36 offset:32768
ds_read_b64_tr_b16 a[198:199],v36 offset:33792
v_mfma_f32_16x16x32_bf16 v[76:79],a[192:195],v[228:231],v[76:79]
v_exp_f32 v95,v95
v_mfma_f32_16x16x32_bf16 v[72:75],a[160:163],v[236:239],v[72:75]
ds_read_b64_tr_b16 a[192:193],v37 offset:32768
ds_read_b64_tr_b16 a[194:195],v37 offset:33792
v_mfma_f32_16x16x32_bf16 v[72:75],a[164:167],v[240:243],v[72:75]
v_cvt_pk_bf16_f32 v88,v88,v89
v_cvt_pk_bf16_f32 v89,v90,v91
v_mfma_f32_16x16x32_bf16 v[64:67],a[164:167],v[224:227],v[64:67]
v_cvt_pk_bf16_f32 v90,v92,v93
v_cvt_pk_bf16_f32 v91,v94,v95
v_mfma_f32_16x16x32_bf16 v[64:67],a[160:163],v[220:223],v[64:67]
v_exp_f32 v96,v96
v_mfma_f32_16x16x32_bf16 v[56:59],a[160:163],v[204:207],v[56:59]
buffer_load_dwordx4 v12,s[28:31],s58 offen offset:1024 nt lds
v_mfma_f32_16x16x32_bf16 v[56:59],a[164:167],v[208:211],v[56:59]
s_add_u32 m0,s85,45056
s_xor_b32 s58,s11,2207744
v_mfma_f32_16x16x32_bf16 v[48:51],a[164:167],v[192:195],v[48:51]
ds_read_b64_tr_b16 a[164:165],v38 offset:32768
ds_read_b64_tr_b16 a[166:167],v38 offset:33792
v_mfma_f32_16x16x32_bf16 v[48:51],a[160:163],v[188:191],v[48:51]
v_exp_f32 v97,v97
v_mfma_f32_16x16x32_bf16 v[52:55],a[168:171],v[188:191],v[52:55]
ds_read_b64_tr_b16 a[160:161],v39 offset:32768
ds_read_b64_tr_b16 a[162:163],v39 offset:33792
v_mfma_f32_16x16x32_bf16 v[52:55],a[172:175],v[192:195],v[52:55]
v_exp_f32 v98,v98
v_mfma_f32_16x16x32_bf16 v[60:63],a[172:175],v[208:211],v[60:63]
v_exp_f32 v99,v99
v_mfma_f32_16x16x32_bf16 v[60:63],a[168:171],v[204:207],v[60:63]
buffer_load_dwordx4 v13,s[28:31],s58 offen nt lds
v_mfma_f32_16x16x32_bf16 v[68:71],a[168:171],v[220:223],v[68:71]
v_exp_f32 v100,v100
v_mfma_f32_16x16x32_bf16 v[68:71],a[172:175],v[224:227],v[68:71]
v_exp_f32 v101,v101
v_mfma_f32_16x16x32_bf16 v[76:79],a[172:175],v[240:243],v[76:79]
v_exp_f32 v102,v102
v_mfma_f32_16x16x32_bf16 v[76:79],a[168:171],v[236:239],v[76:79]
v_exp_f32 v103,v103
v_mfma_f32_16x16x32_bf16 a[0:3],a[180:183],v[80:83],a[0:3]
v_cvt_pk_bf16_f32 v96,v96,v97
v_cvt_pk_bf16_f32 v97,v98,v99
v_mfma_f32_16x16x32_bf16 a[4:7],a[180:183],v[88:91],a[4:7]
v_cvt_pk_bf16_f32 v98,v100,v101
v_cvt_pk_bf16_f32 v99,v102,v103
s_nop 1
v_mfma_f32_16x16x32_bf16 a[8:11],a[180:183],v[96:99],a[8:11]
buffer_load_dwordx4 v13,s[28:31],s58 offen offset:1024 nt lds
v_exp_f32 v104,v104
v_exp_f32 v105,v105
v_exp_f32 v106,v106
v_exp_f32 v107,v107
v_exp_f32 v108,v108
v_exp_f32 v109,v109
v_exp_f32 v110,v110
v_exp_f32 v111,v111
v_cvt_pk_bf16_f32 v104,v104,v105
v_cvt_pk_bf16_f32 v105,v106,v107
v_cvt_pk_bf16_f32 v106,v108,v109
v_cvt_pk_bf16_f32 v107,v110,v111
s_nop 1
v_mfma_f32_16x16x32_bf16 a[12:15],a[180:183],v[104:107],a[12:15]
v_exp_f32 v144,v144
v_exp_f32 v145,v145
v_exp_f32 v146,v146
v_exp_f32 v147,v147
v_exp_f32 v148,v148
v_exp_f32 v149,v149
v_exp_f32 v150,v150
v_exp_f32 v151,v151
v_cvt_pk_bf16_f32 v144,v144,v145
v_cvt_pk_bf16_f32 v145,v146,v147
v_cvt_pk_bf16_f32 v146,v148,v149
v_cvt_pk_bf16_f32 v147,v150,v151
s_nop 1
v_mfma_f32_16x16x32_bf16 a[128:131],a[180:183],v[144:147],a[128:131]
v_max3_f32 v1,v48,v49,v50
v_max3_f32 v1,v1,v51,v56
s_waitcnt lgkmcnt(0)
v_mfma_f32_16x16x32_bf16 a[132:135],a[176:179],v[144:147],a[132:135]
ds_read_b128 a[172:175],v44 offset:0
ds_read_b128 a[168:171],v45 offset:0
v_mfma_f32_16x16x32_bf16 a[28:31],a[176:179],v[104:107],a[28:31]
ds_read_b128 a[180:183],v45 offset:1024
v_max3_f32 v1,v1,v57,v58
v_mfma_f32_16x16x32_bf16 a[24:27],a[176:179],v[96:99],a[24:27]
v_max3_f32 v1,v1,v59,v64
v_max3_f32 v1,v1,v65,v66
v_mfma_f32_16x16x32_bf16 a[20:23],a[176:179],v[88:91],a[20:23]
v_max3_f32 v1,v1,v67,v72
v_max3_f32 v1,v1,v73,v74
v_mfma_f32_16x16x32_bf16 a[16:19],a[176:179],v[80:83],a[16:19]
ds_read_b128 a[176:179],v44 offset:1024
v_max3_f32 v1,v1,v75,v52
v_mfma_f32_16x16x32_bf16 v[156:159],v[176:179],v[80:83],v[156:159]
v_max3_f32 v1,v1,v53,v54
v_max3_f32 v1,v1,v55,v60
v_mfma_f32_16x16x32_bf16 a[32:35],a[184:187],v[80:83],a[32:35]
v_max3_f32 v1,v1,v61,v62
v_max3_f32 v1,v1,v63,v68
v_mfma_f32_16x16x32_bf16 a[36:39],a[184:187],v[88:91],a[36:39]
v_max3_f32 v1,v1,v69,v70
v_max3_f32 v1,v1,v71,v76
v_mfma_f32_16x16x32_bf16 a[40:43],a[184:187],v[96:99],a[40:43]
v_max3_f32 v1,v1,v77,v78
v_max_f32 v1,v1,v79
v_mfma_f32_16x16x32_bf16 a[44:47],a[184:187],v[104:107],a[44:47]
v_cmp_lt_f32 vcc,0x41000000,v1
v_mfma_f32_16x16x32_bf16 a[136:139],a[184:187],v[144:147],a[136:139]
ds_read_b128 a[184:187],v46 offset:0
v_mfma_f32_16x16x32_bf16 v[160:163],v[176:179],v[88:91],v[160:163]
v_mfma_f32_16x16x32_bf16 a[140:143],a[188:191],v[144:147],a[140:143]
s_cbranch_vccnz L_noA8_1_o
L_noA8_1:
v_mfma_f32_16x16x32_bf16 a[60:63],a[188:191],v[104:107],a[60:63]
v_exp_f32 v48,v48
v_mfma_f32_16x16x32_bf16 a[56:59],a[188:191],v[96:99],a[56:59]
v_exp_f32 v49,v49
v_mfma_f32_16x16x32_bf16 a[52:55],a[188:191],v[88:91],a[52:55]
v_exp_f32 v50,v50
v_mfma_f32_16x16x32_bf16 a[48:51],a[188:191],v[80:83],a[48:51]
ds_read_b128 a[188:191],v47 offset:0
v_mfma_f32_16x16x32_bf16 v[164:167],v[176:179],v[96:99],v[164:167]
v_exp_f32 v51,v51
v_mfma_f32_16x16x32_bf16 a[64:67],a[196:199],v[80:83],a[64:67]
v_exp_f32 v52,v52
v_mfma_f32_16x16x32_bf16 a[68:71],a[196:199],v[88:91],a[68:71]
v_exp_f32 v53,v53
v_mfma_f32_16x16x32_bf16 a[72:75],a[196:199],v[96:99],a[72:75]
v_exp_f32 v54,v54
v_mfma_f32_16x16x32_bf16 a[76:79],a[196:199],v[104:107],a[76:79]
v_exp_f32 v55,v55
v_mfma_f32_16x16x32_bf16 a[144:147],a[196:199],v[144:147],a[144:147]
ds_read_b128 a[196:199],v47 offset:1024
v_cvt_pk_bf16_f32 v48,v48,v49
v_mfma_f32_16x16x32_bf16 v[168:171],v[176:179],v[104:107],v[168:171]
v_cvt_pk_bf16_f32 v49,v50,v51
v_cvt_pk_bf16_f32 v50,v52,v53
v_mfma_f32_16x16x32_bf16 a[148:151],a[192:195],v[144:147],a[148:151]
v_cvt_pk_bf16_f32 v51,v54,v55
v_mfma_f32_16x16x32_bf16 a[92:95],a[192:195],v[104:107],a[92:95]
v_exp_f32 v56,v56
v_mfma_f32_16x16x32_bf16 a[88:91],a[192:195],v[96:99],a[88:91]
v_exp_f32 v57,v57
v_mfma_f32_16x16x32_bf16 a[84:87],a[192:195],v[88:91],a[84:87]
v_exp_f32 v58,v58
v_mfma_f32_16x16x32_bf16 a[80:83],a[192:195],v[80:83],a[80:83]
ds_read_b128 a[192:195],v46 offset:1024
v_mfma_f32_16x16x32_bf16 v[172:175],v[176:179],v[144:147],v[172:175]
v_exp_f32 v59,v59
v_mfma_f32_16x16x32_bf16 a[96:99],a[164:167],v[80:83],a[96:99]
v_exp_f32 v60,v60
v_mfma_f32_16x16x32_bf16 a[100:103],a[164:167],v[88:91],a[100:103]
v_exp_f32 v61,v61
v_mfma_f32_16x16x32_bf16 a[104:107],a[164:167],v[96:99],a[104:107]
v_exp_f32 v62,v62
v_mfma_f32_16x16x32_bf16 a[108:111],a[164:167],v[104:107],a[108:111]
v_exp_f32 v63,v63
v_mfma_f32_16x16x32_bf16 a[152:155],a[164:167],v[144:147],a[152:155]
s_waitcnt vmcnt(8) lgkmcnt(0)
s_barrier
s_cmp_eq_u32 s100,1
s_cbranch_scc1 L_qv4_1
s_waitcnt vmcnt(3)
L_qv4_1:
v_mfma_f32_16x16x32_bf16 a[156:159],a[160:163],v[144:147],a[156:159]
s_add_u32 m0,s85,98304
s_xor_b32 s58,s11,2166784
v_mfma_f32_16x16x32_bf16 a[124:127],a[160:163],v[104:107],a[124:127]
buffer_load_dwordx4 v14,s[32:35],s58 offen nt lds
v_cvt_pk_bf16_f32 v56,v56,v57
v_mfma_f32_16x16x32_bf16 a[120:123],a[160:163],v[96:99],a[120:123]
ds_read_b64_tr_b16 a[164:165],v24 offset:0
ds_read_b64_tr_b16 a[166:167],v24 offset:1024
v_mfma_f32_16x16x32_bf16 a[116:119],a[160:163],v[88:91],a[116:119]
v_cvt_pk_bf16_f32 v57,v58,v59
v_cvt_pk_bf16_f32 v58,v60,v61
v_mfma_f32_16x16x32_bf16 a[112:115],a[160:163],v[80:83],a[112:115]
ds_read_b64_tr_b16 a[160:161],v25 offset:0
ds_read_b64_tr_b16 a[162:163],v25 offset:1024
v_mfma_f32_16x16x32_bf16 v[104:107],a[172:175],v[228:231],v[124:127]
v_cvt_pk_bf16_f32 v59,v62,v63
v_mfma_f32_16x16x32_bf16 v[104:107],a[168:171],v[232:235],v[104:107]
v_exp_f32 v64,v64
v_mfma_f32_16x16x32_bf16 v[96:99],a[168:171],v[216:219],v[120:123]
v_exp_f32 v65,v65
v_mfma_f32_16x16x32_bf16 v[96:99],a[172:175],v[212:215],v[96:99]
buffer_load_dwordx4 v14,s[32:35],s58 offen offset:1024 nt lds
v_mfma_f32_16x16x32_bf16 v[88:91],a[172:175],v[196:199],v[116:119]
s_add_u32 m0,s85,102400
s_xor_b32 s58,s11,2199552
v_mfma_f32_16x16x32_bf16 v[88:91],a[168:171],v[200:203],v[88:91]
v_exp_f32 v66,v66
v_mfma_f32_16x16x32_bf16 v[80:83],a[168:171],v[184:187],v[112:115]
s_cmp_eq_u32 s93,0
s_cbranch_scc0 L_noP8_1_o
L_noP8_1:
v_mfma_f32_16x16x32_bf16 v[80:83],a[172:175],v[180:183],v[80:83]
v_exp_f32 v67,v67
v_mfma_f32_16x16x32_bf16 v[144:147],a[172:175],v[128:131],v[152:155]
ds_read_b64_tr_b16 a[172:173],v26 offset:0
ds_read_b64_tr_b16 a[174:175],v26 offset:1024
v_mfma_f32_16x16x32_bf16 v[144:147],a[168:171],v[136:139],v[144:147]
v_exp_f32 v68,v68
v_mfma_f32_16x16x32_bf16 v[148:151],a[180:183],v[136:139],v[152:155]
buffer_load_dwordx4 v14,s[32:35],s58 offen nt lds
v_mfma_f32_16x16x32_bf16 v[148:151],a[176:179],v[128:131],v[148:151]
ds_read_b64_tr_b16 a[168:169],v27 offset:0
ds_read_b64_tr_b16 a[170:171],v27 offset:1024
v_mfma_f32_16x16x32_bf16 v[84:87],a[176:179],v[180:183],v[112:115]
v_exp_f32 v69,v69
v_mfma_f32_16x16x32_bf16 v[84:87],a[180:183],v[184:187],v[84:87]
v_exp_f32 v70,v70
v_mfma_f32_16x16x32_bf16 v[92:95],a[180:183],v[200:203],v[116:119]
v_exp_f32 v71,v71
v_mfma_f32_16x16x32_bf16 v[92:95],a[176:179],v[196:199],v[92:95]
v_cvt_pk_bf16_f32 v64,v64,v65
v_cvt_pk_bf16_f32 v65,v66,v67
v_mfma_f32_16x16x32_bf16 v[100:103],a[176:179],v[212:215],v[120:123]
v_cvt_pk_bf16_f32 v66,v68,v69
v_cvt_pk_bf16_f32 v67,v70,v71
v_mfma_f32_16x16x32_bf16 v[100:103],a[180:183],v[216:219],v[100:103]
buffer_load_dwordx4 v14,s[32:35],s58 offen offset:1024 nt lds
v_mfma_f32_16x16x32_bf16 v[108:111],a[180:183],v[232:235],v[124:127]
ds_read_b64_tr_b16 a[180:181],v28 offset:0
ds_read_b64_tr_b16 a[182:183],v28 offset:1024
v_mfma_f32_16x16x32_bf16 v[108:111],a[176:179],v[228:231],v[108:111]
s_add_u32 m0,s85,106496
s_xor_b32 s58,s11,2174976
v_mfma_f32_16x16x32_bf16 v[104:107],a[184:187],v[236:239],v[104:107]
ds_read_b64_tr_b16 a[176:177],v29 offset:0
ds_read_b64_tr_b16 a[178:179],v29 offset:1024
v_mfma_f32_16x16x32_bf16 v[104:107],a[188:191],v[240:243],v[104:107]
v_exp_f32 v72,v72
v_mfma_f32_16x16x32_bf16 v[96:99],a[188:191],v[224:227],v[96:99]
v_exp_f32 v73,v73
v_mfma_f32_16x16x32_bf16 v[96:99],a[184:187],v[220:223],v[96:99]
v_exp_f32 v74,v74
v_mfma_f32_16x16x32_bf16 v[88:91],a[184:187],v[204:207],v[88:91]
buffer_load_dwordx4 v14,s[32:35],s58 offen nt lds
v_mfma_f32_16x16x32_bf16 v[88:91],a[188:191],v[208:211],v[88:91]
v_exp_f32 v75,v75
v_mfma_f32_16x16x32_bf16 v[80:83],a[188:191],v[192:195],v[80:83]
v_exp_f32 v76,v76
v_mfma_f32_16x16x32_bf16 v[80:83],a[184:187],v[188:191],v[80:83]
v_exp_f32 v77,v77
v_mfma_f32_16x16x32_bf16 v[144:147],a[184:187],v[132:135],v[144:147]
ds_read_b64_tr_b16 a[184:185],v30 offset:0
ds_read_b64_tr_b16 a[186:187],v30 offset:1024
v_mfma_f32_16x16x32_bf16 v[144:147],a[188:191],v[140:143],v[144:147]
v_exp_f32 v78,v78
v_mfma_f32_16x16x32_bf16 v[148:151],a[196:199],v[140:143],v[148:151]
v_exp_f32 v79,v79
v_mfma_f32_16x16x32_bf16 v[148:151],a[192:195],v[132:135],v[148:151]
buffer_load_dwordx4 v14,s[32:35],s58 offen offset:1024 nt lds
v_cvt_pk_bf16_f32 v72,v72,v73
v_mfma_f32_16x16x32_bf16 v[84:87],a[192:195],v[188:191],v[84:87]
s_add_u32 m0,s85,110592
s_xor_b32 s58,s11,2207744
v_mfma_f32_16x16x32_bf16 v[84:87],a[196:199],v[192:195],v[84:87]
v_cvt_pk_bf16_f32 v73,v74,v75
v_cvt_pk_bf16_f32 v74,v76,v77
v_mfma_f32_16x16x32_bf16 v[92:95],a[196:199],v[208:211],v[92:95]
v_cvt_pk_bf16_f32 v75,v78,v79
v_mfma_f32_16x16x32_bf16 v[92:95],a[192:195],v[204:207],v[92:95]
v_mfma_f32_16x16x32_bf16 v[100:103],a[192:195],v[220:223],v[100:103]
v_mfma_f32_16x16x32_bf16 v[100:103],a[196:199],v[224:227],v[100:103]
v_mfma_f32_16x16x32_bf16 v[108:111],a[196:199],v[240:243],v[108:111]
buffer_load_dwordx4 v14,s[32:35],s58 offen nt lds
v_mfma_f32_16x16x32_bf16 v[108:111],a[192:195],v[236:239],v[108:111]
v_max3_f32 v1,v144,v145,v146
v_max3_f32 v1,v1,v147,v148
s_waitcnt lgkmcnt(0)
v_mfma_f32_16x16x32_bf16 a[0:3],a[164:167],v[48:51],a[0:3]
ds_read_b64_tr_b16 a[188:189],v31 offset:0
ds_read_b64_tr_b16 a[190:191],v31 offset:1024
v_mfma_f32_16x16x32_bf16 a[4:7],a[164:167],v[56:59],a[4:7]
v_max3_f32 v1,v1,v149,v150
v_max3_f32 v1,v1,v151,v80
v_mfma_f32_16x16x32_bf16 a[8:11],a[164:167],v[64:67],a[8:11]
v_max3_f32 v1,v1,v81,v82
v_max3_f32 v1,v1,v83,v88
v_mfma_f32_16x16x32_bf16 a[12:15],a[164:167],v[72:75],a[12:15]
v_max3_f32 v1,v1,v89,v90
v_max3_f32 v1,v1,v91,v96
v_mfma_f32_16x16x32_bf16 a[28:31],a[160:163],v[72:75],a[28:31]
v_max3_f32 v1,v1,v97,v98
v_max3_f32 v1,v1,v99,v104
v_mfma_f32_16x16x32_bf16 a[24:27],a[160:163],v[64:67],a[24:27]
buffer_load_dwordx4 v14,s[32:35],s58 offen offset:1024 nt lds
v_max3_f32 v1,v1,v105,v106
v_mfma_f32_16x16x32_bf16 a[20:23],a[160:163],v[56:59],a[20:23]
v_max3_f32 v1,v1,v107,v84
v_max3_f32 v1,v1,v85,v86
v_mfma_f32_16x16x32_bf16 a[16:19],a[160:163],v[48:51],a[16:19]
v_max3_f32 v1,v1,v87,v92
v_max3_f32 v1,v1,v93,v94
v_mfma_f32_16x16x32_bf16 v[156:159],v[176:179],v[48:51],v[156:159]
v_max3_f32 v1,v1,v95,v100
v_max3_f32 v1,v1,v101,v102
v_mfma_f32_16x16x32_bf16 a[32:35],a[172:175],v[48:51],a[32:35]
v_max3_f32 v1,v1,v103,v108
v_max3_f32 v1,v1,v109,v110
v_mfma_f32_16x16x32_bf16 a[36:39],a[172:175],v[56:59],a[36:39]
v_max_f32 v1,v1,v111
v_cmp_lt_f32 vcc,0x41000000,v1
v_mfma_f32_16x16x32_bf16 a[40:43],a[172:175],v[64:67],a[40:43]
v_mfma_f32_16x16x32_bf16 a[44:47],a[172:175],v[72:75],a[44:47]
s_cbranch_vccnz L_noA9_1_o
L_noA9_1:
v_mfma_f32_16x16x32_bf16 v[160:163],v[176:179],v[56:59],v[160:163]
v_exp_f32 v80,v80
v_mfma_f32_16x16x32_bf16 a[60:63],a[168:171],v[72:75],a[60:63]
v_exp_f32 v81,v81
v_mfma_f32_16x16x32_bf16 a[56:59],a[168:171],v[64:67],a[56:59]
v_exp_f32 v82,v82
v_mfma_f32_16x16x32_bf16 a[52:55],a[168:171],v[56:59],a[52:55]
v_exp_f32 v83,v83
v_mfma_f32_16x16x32_bf16 a[48:51],a[168:171],v[48:51],a[48:51]
v_exp_f32 v84,v84
v_mfma_f32_16x16x32_bf16 v[164:167],v[176:179],v[64:67],v[164:167]
v_exp_f32 v85,v85
v_mfma_f32_16x16x32_bf16 a[64:67],a[180:183],v[48:51],a[64:67]
s_waitcnt vmcnt(8) lgkmcnt(0)
s_barrier
s_cmp_eq_u32 s100,1
s_cbranch_scc1 L_qk5_1
s_waitcnt vmcnt(3)
L_qk5_1:
v_mfma_f32_16x16x32_bf16 a[68:71],a[180:183],v[56:59],a[68:71]
s_add_u32 m0,s85,0
s_xor_b32 s58,s11,2179072
v_mfma_f32_16x16x32_bf16 a[72:75],a[180:183],v[64:67],a[72:75]
buffer_load_dwordx4 v12,s[28:31],s58 offen nt lds
v_mfma_f32_16x16x32_bf16 a[76:79],a[180:183],v[72:75],a[76:79]
ds_read_b128 a[196:199],v40 offset:32768
ds_read_b128 a[192:195],v41 offset:32768
v_mfma_f32_16x16x32_bf16 v[168:171],v[176:179],v[72:75],v[168:171]
ds_read_b128 a[164:167],v40 offset:33792
v_mfma_f32_16x16x32_bf16 a[92:95],a[176:179],v[72:75],a[92:95]
ds_read_b128 a[160:163],v41 offset:33792
ds_read_b128 a[172:175],v42 offset:32768
v_mfma_f32_16x16x32_bf16 a[88:91],a[176:179],v[64:67],a[88:91]
ds_read_b128 a[168:171],v43 offset:32768
v_mfma_f32_16x16x32_bf16 a[84:87],a[176:179],v[56:59],a[84:87]
ds_read_b128 a[180:183],v42 offset:33792
v_mfma_f32_16x16x32_bf16 a[80:83],a[176:179],v[48:51],a[80:83]
ds_read_b128 a[176:179],v43 offset:33792
v_mfma_f32_16x16x32_bf16 a[96:99],a[184:187],v[48:51],a[96:99]
buffer_load_dwordx4 v12,s[28:31],s58 offen offset:1024 nt lds
v_mfma_f32_16x16x32_bf16 a[100:103],a[184:187],v[56:59],a[100:103]
s_add_u32 m0,s85,4096
s_xor_b32 s58,s11,2211840
v_mfma_f32_16x16x32_bf16 a[104:107],a[184:187],v[64:67],a[104:107]
v_exp_f32 v86,v86
v_mfma_f32_16x16x32_bf16 a[108:111],a[184:187],v[72:75],a[108:111]
ds_read_b64_tr_b16 a[184:185],v32 offset:0
ds_read_b64_tr_b16 a[186:187],v32 offset:1024
v_mfma_f32_16x16x32_bf16 a[124:127],a[188:191],v[72:75],a[124:127]
v_exp_f32 v87,v87
v_mfma_f32_16x16x32_bf16 a[120:123],a[188:191],v[64:67],a[120:123]
v_cvt_pk_bf16_f32 v80,v80,v81
v_cvt_pk_bf16_f32 v81,v82,v83
v_mfma_f32_16x16x32_bf16 a[116:119],a[188:191],v[56:59],a[116:119]
v_cvt_pk_bf16_f32 v82,v84,v85
v_cvt_pk_bf16_f32 v83,v86,v87
v_mfma_f32_16x16x32_bf16 a[112:115],a[188:191],v[48:51],a[112:115]
buffer_load_dwordx4 v13,s[28:31],s58 offen nt lds
s_waitcnt lgkmcnt(0)
v_mfma_f32_16x16x32_bf16 v[72:75],a[196:199],v[228:231],v[124:127]
ds_read_b64_tr_b16 a[188:189],v33 offset:0
ds_read_b64_tr_b16 a[190:191],v33 offset:1024
v_mfma_f32_16x16x32_bf16 v[72:75],a[192:195],v[232:235],v[72:75]
v_exp_f32 v88,v88
v_mfma_f32_16x16x32_bf16 v[64:67],a[192:195],v[216:219],v[120:123]
v_exp_f32 v89,v89
v_mfma_f32_16x16x32_bf16 v[64:67],a[196:199],v[212:215],v[64:67]
v_exp_f32 v90,v90
v_mfma_f32_16x16x32_bf16 v[56:59],a[196:199],v[196:199],v[116:119]
s_cmp_eq_u32 s93,0
s_cbranch_scc0 L_noP9_1_o
L_noP9_1:
v_mfma_f32_16x16x32_bf16 v[56:59],a[192:195],v[200:203],v[56:59]
v_exp_f32 v91,v91
v_mfma_f32_16x16x32_bf16 v[48:51],a[192:195],v[184:187],v[112:115]
buffer_load_dwordx4 v13,s[28:31],s58 offen offset:1024 nt lds
v_mfma_f32_16x16x32_bf16 v[48:51],a[196:199],v[180:183],v[48:51]
ds_read_b64_tr_b16 a[192:193],v34 offset:0
ds_read_b64_tr_b16 a[194:195],v34 offset:1024
v_mfma_f32_16x16x32_bf16 v[52:55],a[164:167],v[180:183],v[112:115]
s_add_u32 m0,s85,8192
s_xor_b32 s58,s11,2187264
v_mfma_f32_16x16x32_bf16 v[52:55],a[160:163],v[184:187],v[52:55]
ds_read_b64_tr_b16 a[196:197],v35 offset:0
ds_read_b64_tr_b16 a[198:199],v35 offset:1024
v_mfma_f32_16x16x32_bf16 v[60:63],a[160:163],v[200:203],v[116:119]
v_exp_f32 v92,v92
v_mfma_f32_16x16x32_bf16 v[60:63],a[164:167],v[196:199],v[60:63]
v_exp_f32 v93,v93
v_mfma_f32_16x16x32_bf16 v[68:71],a[164:167],v[212:215],v[120:123]
v_exp_f32 v94,v94
v_mfma_f32_16x16x32_bf16 v[68:71],a[160:163],v[216:219],v[68:71]
buffer_load_dwordx4 v12,s[28:31],s58 offen nt lds
v_mfma_f32_16x16x32_bf16 v[76:79],a[160:163],v[232:235],v[124:127]
ds_read_b64_tr_b16 a[160:161],v36 offset:0
ds_read_b64_tr_b16 a[162:163],v36 offset:1024
v_mfma_f32_16x16x32_bf16 v[76:79],a[164:167],v[228:231],v[76:79]
v_exp_f32 v95,v95
v_mfma_f32_16x16x32_bf16 v[72:75],a[172:175],v[236:239],v[72:75]
ds_read_b64_tr_b16 a[164:165],v37 offset:0
ds_read_b64_tr_b16 a[166:167],v37 offset:1024
v_mfma_f32_16x16x32_bf16 v[72:75],a[168:171],v[240:243],v[72:75]
v_cvt_pk_bf16_f32 v88,v88,v89
v_cvt_pk_bf16_f32 v89,v90,v91
v_mfma_f32_16x16x32_bf16 v[64:67],a[168:171],v[224:227],v[64:67]
v_cvt_pk_bf16_f32 v90,v92,v93
v_cvt_pk_bf16_f32 v91,v94,v95
v_mfma_f32_16x16x32_bf16 v[64:67],a[172:175],v[220:223],v[64:67]
v_exp_f32 v96,v96
v_mfma_f32_16x16x32_bf16 v[56:59],a[172:175],v[204:207],v[56:59]
buffer_load_dwordx4 v12,s[28:31],s58 offen offset:1024 nt lds
v_mfma_f32_16x16x32_bf16 v[56:59],a[168:171],v[208:211],v[56:59]
s_add_u32 m0,s85,12288
s_xor_b32 s58,s11,2220032
v_mfma_f32_16x16x32_bf16 v[48:51],a[168:171],v[192:195],v[48:51]
ds_read_b64_tr_b16 a[168:169],v38 offset:0
ds_read_b64_tr_b16 a[170:171],v38 offset:1024
v_mfma_f32_16x16x32_bf16 v[48:51],a[172:175],v[188:191],v[48:51]
v_exp_f32 v97,v97
v_mfma_f32_16x16x32_bf16 v[52:55],a[180:183],v[188:191],v[52:55]
ds_read_b64_tr_b16 a[172:173],v39 offset:0
ds_read_b64_tr_b16 a[174:175],v39 offset:1024
v_mfma_f32_16x16x32_bf16 v[52:55],a[176:179],v[192:195],v[52:55]
v_exp_f32 v98,v98
v_mfma_f32_16x16x32_bf16 v[60:63],a[176:179],v[208:211],v[60:63]
v_exp_f32 v99,v99
v_mfma_f32_16x16x32_bf16 v[60:63],a[180:183],v[204:207],v[60:63]
buffer_load_dwordx4 v13,s[28:31],s58 offen nt lds
v_mfma_f32_16x16x32_bf16 v[68:71],a[180:183],v[220:223],v[68:71]
v_exp_f32 v100,v100
v_mfma_f32_16x16x32_bf16 v[68:71],a[176:179],v[224:227],v[68:71]
v_exp_f32 v101,v101
v_mfma_f32_16x16x32_bf16 v[76:79],a[176:179],v[240:243],v[76:79]
v_exp_f32 v102,v102
v_mfma_f32_16x16x32_bf16 v[76:79],a[180:183],v[236:239],v[76:79]
v_exp_f32 v103,v103
v_mfma_f32_16x16x32_bf16 a[0:3],a[184:187],v[80:83],a[0:3]
v_cvt_pk_bf16_f32 v96,v96,v97
v_cvt_pk_bf16_f32 v97,v98,v99
v_mfma_f32_16x16x32_bf16 a[4:7],a[184:187],v[88:91],a[4:7]
v_cvt_pk_bf16_f32 v98,v100,v101
v_cvt_pk_bf16_f32 v99,v102,v103
s_nop 1
v_mfma_f32_16x16x32_bf16 a[8:11],a[184:187],v[96:99],a[8:11]
buffer_load_dwordx4 v13,s[28:31],s58 offen offset:1024 nt lds
v_exp_f32 v104,v104
v_exp_f32 v105,v105
v_exp_f32 v106,v106
v_exp_f32 v107,v107
v_exp_f32 v108,v108
v_exp_f32 v109,v109
v_exp_f32 v110,v110
v_exp_f32 v111,v111
v_cvt_pk_bf16_f32 v104,v104,v105
v_cvt_pk_bf16_f32 v105,v106,v107
v_cvt_pk_bf16_f32 v106,v108,v109
v_cvt_pk_bf16_f32 v107,v110,v111
s_nop 1
v_mfma_f32_16x16x32_bf16 a[12:15],a[184:187],v[104:107],a[12:15]
v_exp_f32 v144,v144
v_exp_f32 v145,v145
v_exp_f32 v146,v146
v_exp_f32 v147,v147
v_exp_f32 v148,v148
v_exp_f32 v149,v149
v_exp_f32 v150,v150
v_exp_f32 v151,v151
v_cvt_pk_bf16_f32 v144,v144,v145
v_cvt_pk_bf16_f32 v145,v146,v147
v_cvt_pk_bf16_f32 v146,v148,v149
v_cvt_pk_bf16_f32 v147,v150,v151
s_nop 1
v_mfma_f32_16x16x32_bf16 a[128:131],a[184:187],v[144:147],a[128:131]
v_max3_f32 v1,v48,v49,v50
v_max3_f32 v1,v1,v51,v56
s_waitcnt lgkmcnt(0)
v_mfma_f32_16x16x32_bf16 a[132:135],a[188:191],v[144:147],a[132:135]
ds_read_b128 a[176:179],v44 offset:32768
ds_read_b128 a[180:183],v45 offset:32768
v_mfma_f32_16x16x32_bf16 a[28:31],a[188:191],v[104:107],a[28:31]
ds_read_b128 a[184:187],v45 offset:33792
v_max3_f32 v1,v1,v57,v58
v_mfma_f32_16x16x32_bf16 a[24:27],a[188:191],v[96:99],a[24:27]
v_max3_f32 v1,v1,v59,v64
v_max3_f32 v1,v1,v65,v66
v_mfma_f32_16x16x32_bf16 a[20:23],a[188:191],v[88:91],a[20:23]
v_max3_f32 v1,v1,v67,v72
v_max3_f32 v1,v1,v73,v74
v_mfma_f32_16x16x32_bf16 a[16:19],a[188:191],v[80:83],a[16:19]
v_lshrrev_b32 v8,2,v10
buffer_load_dword v254,v8,s[96:99],0 offen sc1
v_mfma_f32_16x16x32_bf16 v[156:159],v[176:179],v[80:83],v[156:159]
ds_read_b128 a[188:191],v44 offset:33792
v_max3_f32 v1,v1,v75,v52
v_mfma_f32_16x16x32_bf16 a[32:35],a[192:195],v[80:83],a[32:35]
v_max3_f32 v1,v1,v53,v54
v_max3_f32 v1,v1,v55,v60
v_mfma_f32_16x16x32_bf16 a[36:39],a[192:195],v[88:91],a[36:39]
v_max3_f32 v1,v1,v61,v62
v_max3_f32 v1,v1,v63,v68
v_mfma_f32_16x16x32_bf16 a[40:43],a[192:195],v[96:99],a[40:43]
v_max3_f32 v1,v1,v69,v70
v_max3_f32 v1,v1,v71,v76
v_mfma_f32_16x16x32_bf16 a[44:47],a[192:195],v[104:107],a[44:47]
v_max3_f32 v1,v1,v77,v78
v_max_f32 v1,v1,v79
v_mfma_f32_16x16x32_bf16 a[136:139],a[192:195],v[144:147],a[136:139]
ds_read_b128 a[192:195],v46 offset:32768
v_cmp_lt_f32 vcc,0x41000000,v1
v_mfma_f32_16x16x32_bf16 v[160:163],v[176:179],v[88:91],v[160:163]
v_mfma_f32_16x16x32_bf16 a[140:143],a[196:199],v[144:147],a[140:143]
s_cbranch_vccnz L_noA10_1_o
L_noA10_1:
v_mfma_f32_16x16x32_bf16 a[60:63],a[196:199],v[104:107],a[60:63]
v_exp_f32 v48,v48
v_mfma_f32_16x16x32_bf16 a[56:59],a[196:199],v[96:99],a[56:59]
v_exp_f32 v49,v49
v_mfma_f32_16x16x32_bf16 a[52:55],a[196:199],v[88:91],a[52:55]
v_exp_f32 v50,v50
v_mfma_f32_16x16x32_bf16 a[48:51],a[196:199],v[80:83],a[48:51]
ds_read_b128 a[196:199],v47 offset:32768
v_mfma_f32_16x16x32_bf16 v[164:167],v[176:179],v[96:99],v[164:167]
v_exp_f32 v51,v51
v_mfma_f32_16x16x32_bf16 a[64:67],a[160:163],v[80:83],a[64:67]
v_exp_f32 v52,v52
v_mfma_f32_16x16x32_bf16 a[68:71],a[160:163],v[88:91],a[68:71]
v_exp_f32 v53,v53
v_mfma_f32_16x16x32_bf16 a[72:75],a[160:163],v[96:99],a[72:75]
v_exp_f32 v54,v54
v_mfma_f32_16x16x32_bf16 a[76:79],a[160:163],v[104:107],a[76:79]
v_exp_f32 v55,v55
v_mfma_f32_16x16x32_bf16 a[144:147],a[160:163],v[144:147],a[144:147]
ds_read_b128 a[160:163],v47 offset:33792
v_cvt_pk_bf16_f32 v48,v48,v49
v_mfma_f32_16x16x32_bf16 v[168:171],v[176:179],v[104:107],v[168:171]
v_cvt_pk_bf16_f32 v49,v50,v51
v_cvt_pk_bf16_f32 v50,v52,v53
v_mfma_f32_16x16x32_bf16 a[148:151],a[164:167],v[144:147],a[148:151]
v_cvt_pk_bf16_f32 v51,v54,v55
v_mfma_f32_16x16x32_bf16 a[92:95],a[164:167],v[104:107],a[92:95]
v_exp_f32 v56,v56
v_mfma_f32_16x16x32_bf16 a[88:91],a[164:167],v[96:99],a[88:91]
v_exp_f32 v57,v57
v_mfma_f32_16x16x32_bf16 a[84:87],a[164:167],v[88:91],a[84:87]
v_exp_f32 v58,v58
v_mfma_f32_16x16x32_bf16 a[80:83],a[164:167],v[80:83],a[80:83]
ds_read_b128 a[164:167],v46 offset:33792
v_mfma_f32_16x16x32_bf16 v[172:175],v[176:179],v[144:147],v[172:175]
v_exp_f32 v59,v59
v_mfma_f32_16x16x32_bf16 a[96:99],a[168:171],v[80:83],a[96:99]
v_exp_f32 v60,v60
v_mfma_f32_16x16x32_bf16 a[100:103],a[168:171],v[88:91],a[100:103]
v_exp_f32 v61,v61
v_mfma_f32_16x16x32_bf16 a[104:107],a[168:171],v[96:99],a[104:107]
v_exp_f32 v62,v62
v_mfma_f32_16x16x32_bf16 a[108:111],a[168:171],v[104:107],a[108:111]
v_exp_f32 v63,v63
v_mfma_f32_16x16x32_bf16 a[152:155],a[168:171],v[144:147],a[152:155]
s_waitcnt vmcnt(9) lgkmcnt(0)
s_barrier
s_cmp_eq_u32 s100,1
s_cbranch_scc1 L_qv5_1
s_waitcnt vmcnt(3)
L_qv5_1:
v_mfma_f32_16x16x32_bf16 a[156:159],a[172:175],v[144:147],a[156:159]
s_add_u32 m0,s85,65536
s_xor_b32 s58,s11,2179072
v_mfma_f32_16x16x32_bf16 a[124:127],a[172:175],v[104:107],a[124:127]
buffer_load_dwordx4 v14,s[32:35],s58 offen nt lds
v_cvt_pk_bf16_f32 v56,v56,v57
v_mfma_f32_16x16x32_bf16 a[120:123],a[172:175],v[96:99],a[120:123]
ds_read_b64_tr_b16 a[168:169],v24 offset:32768
ds_read_b64_tr_b16 a[170:171],v24 offset:33792
v_mfma_f32_16x16x32_bf16 a[116:119],a[172:175],v[88:91],a[116:119]
v_cvt_pk_bf16_f32 v57,v58,v59
v_cvt_pk_bf16_f32 v58,v60,v61
v_mfma_f32_16x16x32_bf16 a[112:115],a[172:175],v[80:83],a[112:115]
ds_read_b64_tr_b16 a[172:173],v25 offset:32768
ds_read_b64_tr_b16 a[174:175],v25 offset:33792
v_mfma_f32_16x16x32_bf16 v[104:107],a[176:179],v[228:231],v[124:127]
v_cvt_pk_bf16_f32 v59,v62,v63
v_mfma_f32_16x16x32_bf16 v[104:107],a[180:183],v[232:235],v[104:107]
v_exp_f32 v64,v64
v_mfma_f32_16x16x32_bf16 v[96:99],a[180:183],v[216:219],v[120:123]
v_exp_f32 v65,v65
v_mfma_f32_16x16x32_bf16 v[96:99],a[176:179],v[212:215],v[96:99]
buffer_load_dwordx4 v14,s[32:35],s58 offen offset:1024 nt lds
v_mfma_f32_16x16x32_bf16 v[88:91],a[176:179],v[196:199],v[116:119]
s_add_u32 m0,s85,69632
s_xor_b32 s58,s11,2211840
v_mfma_f32_16x16x32_bf16 v[88:91],a[180:183],v[200:203],v[88:91]
v_exp_f32 v66,v66
v_mfma_f32_16x16x32_bf16 v[80:83],a[180:183],v[184:187],v[112:115]
s_cmp_eq_u32 s93,0
s_cbranch_scc0 L_noP10_1_o
L_noP10_1:
v_mfma_f32_16x16x32_bf16 v[80:83],a[176:179],v[180:183],v[80:83]
v_exp_f32 v67,v67
v_mfma_f32_16x16x32_bf16 v[144:147],a[176:179],v[128:131],v[152:155]
ds_read_b64_tr_b16 a[176:177],v26 offset:32768
ds_read_b64_tr_b16 a[178:179],v26 offset:33792
v_mfma_f32_16x16x32_bf16 v[144:147],a[180:183],v[136:139],v[144:147]
v_exp_f32 v68,v68
v_mfma_f32_16x16x32_bf16 v[148:151],a[184:187],v[136:139],v[152:155]
buffer_load_dwordx4 v14,s[32:35],s58 offen nt lds
v_mfma_f32_16x16x32_bf16 v[148:151],a[188:191],v[128:131],v[148:151]
ds_read_b64_tr_b16 a[180:181],v27 offset:32768
ds_read_b64_tr_b16 a[182:183],v27 offset:33792
v_mfma_f32_16x16x32_bf16 v[84:87],a[188:191],v[180:183],v[112:115]
v_exp_f32 v69,v69
v_mfma_f32_16x16x32_bf16 v[84:87],a[184:187],v[184:187],v[84:87]
v_exp_f32 v70,v70
v_mfma_f32_16x16x32_bf16 v[92:95],a[184:187],v[200:203],v[116:119]
v_exp_f32 v71,v71
v_mfma_f32_16x16x32_bf16 v[92:95],a[188:191],v[196:199],v[92:95]
v_cvt_pk_bf16_f32 v64,v64,v65
v_cvt_pk_bf16_f32 v65,v66,v67
v_mfma_f32_16x16x32_bf16 v[100:103],a[188:191],v[212:215],v[120:123]
v_cvt_pk_bf16_f32 v66,v68,v69
v_cvt_pk_bf16_f32 v67,v70,v71
v_mfma_f32_16x16x32_bf16 v[100:103],a[184:187],v[216:219],v[100:103]
buffer_load_dwordx4 v14,s[32:35],s58 offen offset:1024 nt lds
v_mfma_f32_16x16x32_bf16 v[108:111],a[184:187],v[232:235],v[124:127]
ds_read_b64_tr_b16 a[184:185],v28 offset:32768
ds_read_b64_tr_b16 a[186:187],v28 offset:33792
v_mfma_f32_16x16x32_bf16 v[108:111],a[188:191],v[228:231],v[108:111]
s_add_u32 m0,s85,73728
s_xor_b32 s58,s11,2187264
v_mfma_f32_16x16x32_bf16 v[104:107],a[192:195],v[236:239],v[104:107]
ds_read_b64_tr_b16 a[188:189],v29 offset:32768
ds_read_b64_tr_b16 a[190:191],v29 offset:33792
v_mfma_f32_16x16x32_bf16 v[104:107],a[196:199],v[240:243],v[104:107]
v_exp_f32 v72,v72
v_mfma_f32_16x16x32_bf16 v[96:99],a[196:199],v[224:227],v[96:99]
v_exp_f32 v73,v73
v_mfma_f32_16x16x32_bf16 v[96:99],a[192:195],v[220:223],v[96:99]
v_exp_f32 v74,v74
v_mfma_f32_16x16x32_bf16 v[88:91],a[192:195],v[204:207],v[88:91]
buffer_load_dwordx4 v14,s[32:35],s58 offen nt lds
v_mfma_f32_16x16x32_bf16 v[88:91],a[196:199],v[208:211],v[88:91]
v_exp_f32 v75,v75
v_mfma_f32_16x16x32_bf16 v[80:83],a[196:199],v[192:195],v[80:83]
v_exp_f32 v76,v76
v_mfma_f32_16x16x32_bf16 v[80:83],a[192:195],v[188:191],v[80:83]
v_exp_f32 v77,v77
v_mfma_f32_16x16x32_bf16 v[144:147],a[192:195],v[132:135],v[144:147]
ds_read_b64_tr_b16 a[192:193],v30 offset:32768
ds_read_b64_tr_b16 a[194:195],v30 offset:33792
v_mfma_f32_16x16x32_bf16 v[144:147],a[196:199],v[140:143],v[144:147]
v_exp_f32 v78,v78
v_mfma_f32_16x16x32_bf16 v[148:151],a[160:163],v[140:143],v[148:151]
v_exp_f32 v79,v79
v_mfma_f32_16x16x32_bf16 v[148:151],a[164:167],v[132:135],v[148:151]
buffer_load_dwordx4 v14,s[32:35],s58 offen offset:1024 nt lds
v_cvt_pk_bf16_f32 v72,v72,v73
v_mfma_f32_16x16x32_bf16 v[84:87],a[164:167],v[188:191],v[84:87]
s_add_u32 m0,s85,77824
s_xor_b32 s58,s11,2220032
v_mfma_f32_16x16x32_bf16 v[84:87],a[160:163],v[192:195],v[84:87]
v_cvt_pk_bf16_f32 v73,v74,v75
v_cvt_pk_bf16_f32 v74,v76,v77
v_mfma_f32_16x16x32_bf16 v[92:95],a[160:163],v[208:211],v[92:95]
v_cvt_pk_bf16_f32 v75,v78,v79
v_mfma_f32_16x16x32_bf16 v[92:95],a[164:167],v[204:207],v[92:95]
v_mfma_f32_16x16x32_bf16 v[100:103],a[164:167],v[220:223],v[100:103]
v_mfma_f32_16x16x32_bf16 v[100:103],a[160:163],v[224:227],v[100:103]
v_mfma_f32_16x16x32_bf16 v[108:111],a[160:163],v[240:243],v[108:111]
buffer_load_dwordx4 v14,s[32:35],s58 offen nt lds
v_mfma_f32_16x16x32_bf16 v[108:111],a[164:167],v[236:239],v[108:111]
v_max3_f32 v1,v144,v145,v146
v_max3_f32 v1,v1,v147,v148
s_waitcnt lgkmcnt(0)
v_mfma_f32_16x16x32_bf16 a[0:3],a[168:171],v[48:51],a[0:3]
ds_read_b64_tr_b16 a[196:197],v31 offset:32768
ds_read_b64_tr_b16 a[198:199],v31 offset:33792
v_mfma_f32_16x16x32_bf16 a[4:7],a[168:171],v[56:59],a[4:7]
v_max3_f32 v1,v1,v149,v150
v_max3_f32 v1,v1,v151,v80
v_mfma_f32_16x16x32_bf16 a[8:11],a[168:171],v[64:67],a[8:11]
v_max3_f32 v1,v1,v81,v82
v_max3_f32 v1,v1,v83,v88
v_mfma_f32_16x16x32_bf16 a[12:15],a[168:171],v[72:75],a[12:15]
v_max3_f32 v1,v1,v89,v90
v_max3_f32 v1,v1,v91,v96
v_mfma_f32_16x16x32_bf16 a[28:31],a[172:175],v[72:75],a[28:31]
v_max3_f32 v1,v1,v97,v98
v_max3_f32 v1,v1,v99,v104
v_mfma_f32_16x16x32_bf16 a[24:27],a[172:175],v[64:67],a[24:27]
buffer_load_dwordx4 v14,s[32:35],s58 offen offset:1024 nt lds
v_max3_f32 v1,v1,v105,v106
v_mfma_f32_16x16x32_bf16 a[20:23],a[172:175],v[56:59],a[20:23]
v_max3_f32 v1,v1,v107,v84
v_max3_f32 v1,v1,v85,v86
v_mfma_f32_16x16x32_bf16 a[16:19],a[172:175],v[48:51],a[16:19]
v_max3_f32 v1,v1,v87,v92
v_max3_f32 v1,v1,v93,v94
v_mfma_f32_16x16x32_bf16 v[156:159],v[176:179],v[48:51],v[156:159]
v_max3_f32 v1,v1,v95,v100
v_max3_f32 v1,v1,v101,v102
v_mfma_f32_16x16x32_bf16 a[32:35],a[176:179],v[48:51],a[32:35]
v_max3_f32 v1,v1,v103,v108
v_max3_f32 v1,v1,v109,v110
v_mfma_f32_16x16x32_bf16 a[36:39],a[176:179],v[56:59],a[36:39]
v_max_f32 v1,v1,v111
v_cmp_lt_f32 vcc,0x41000000,v1
v_mfma_f32_16x16x32_bf16 a[40:43],a[176:179],v[64:67],a[40:43]
v_mfma_f32_16x16x32_bf16 a[44:47],a[176:179],v[72:75],a[44:47]
s_cbranch_vccnz L_noA11_1_o
L_noA11_1:
v_mfma_f32_16x16x32_bf16 v[160:163],v[176:179],v[56:59],v[160:163]
v_exp_f32 v80,v80
v_mfma_f32_16x16x32_bf16 a[60:63],a[180:183],v[72:75],a[60:63]
v_exp_f32 v81,v81
v_mfma_f32_16x16x32_bf16 a[56:59],a[180:183],v[64:67],a[56:59]
v_exp_f32 v82,v82
v_mfma_f32_16x16x32_bf16 a[52:55],a[180:183],v[56:59],a[52:55]
v_exp_f32 v83,v83
v_mfma_f32_16x16x32_bf16 a[48:51],a[180:183],v[48:51],a[48:51]
v_exp_f32 v84,v84
v_mfma_f32_16x16x32_bf16 v[164:167],v[176:179],v[64:67],v[164:167]
v_exp_f32 v85,v85
v_mfma_f32_16x16x32_bf16 a[64:67],a[184:187],v[48:51],a[64:67]
s_waitcnt vmcnt(9) lgkmcnt(0)
s_barrier
s_cmp_eq_u32 s100,1
s_cbranch_scc1 L_qk6_1
s_waitcnt vmcnt(3)
L_qk6_1:
v_mfma_f32_16x16x32_bf16 a[68:71],a[184:187],v[56:59],a[68:71]
s_add_u32 m0,s85,32768
s_xor_b32 s58,s11,2183168
v_mfma_f32_16x16x32_bf16 a[72:75],a[184:187],v[64:67],a[72:75]
buffer_load_dwordx4 v12,s[28:31],s58 offen nt lds
v_mfma_f32_16x16x32_bf16 a[76:79],a[184:187],v[72:75],a[76:79]
ds_read_b128 a[160:163],v40 offset:0
ds_read_b128 a[164:167],v41 offset:0
v_mfma_f32_16x16x32_bf16 v[168:171],v[176:179],v[72:75],v[168:171]
ds_read_b128 a[168:171],v40 offset:1024
v_mfma_f32_16x16x32_bf16 a[92:95],a[188:191],v[72:75],a[92:95]
ds_read_b128 a[172:175],v41 offset:1024
ds_read_b128 a[176:179],v42 offset:0
v_mfma_f32_16x16x32_bf16 a[88:91],a[188:191],v[64:67],a[88:91]
ds_read_b128 a[180:183],v43 offset:0
v_mfma_f32_16x16x32_bf16 a[84:87],a[188:191],v[56:59],a[84:87]
ds_read_b128 a[184:187],v42 offset:1024
v_mfma_f32_16x16x32_bf16 a[80:83],a[188:191],v[48:51],a[80:83]
ds_read_b128 a[188:191],v43 offset:1024
v_mfma_f32_16x16x32_bf16 a[96:99],a[192:195],v[48:51],a[96:99]
buffer_load_dwordx4 v12,s[28:31],s58 offen offset:1024 nt lds
v_mfma_f32_16x16x32_bf16 a[100:103],a[192:195],v[56:59],a[100:103]
s_add_u32 m0,s85,36864
s_xor_b32 s58,s11,2215936
v_mfma_f32_16x16x32_bf16 a[104:107],a[192:195],v[64:67],a[104:107]
v_exp_f32 v86,v86
v_mfma_f32_16x16x32_bf16 a[108:111],a[192:195],v[72:75],a[108:111]
ds_read_b64_tr_b16 a[192:193],v32 offset:32768
ds_read_b64_tr_b16 a[194:195],v32 offset:33792
v_mfma_f32_16x16x32_bf16 a[124:127],a[196:199],v[72:75],a[124:127]
v_exp_f32 v87,v87
v_mfma_f32_16x16x32_bf16 a[120:123],a[196:199],v[64:67],a[120:123]
v_cvt_pk_bf16_f32 v80,v80,v81
v_cvt_pk_bf16_f32 v81,v82,v83
v_mfma_f32_16x16x32_bf16 a[116:119],a[196:199],v[56:59],a[116:119]
v_cvt_pk_bf16_f32 v82,v84,v85
v_cvt_pk_bf16_f32 v83,v86,v87
v_mfma_f32_16x16x32_bf16 a[112:115],a[196:199],v[48:51],a[112:115]
buffer_load_dwordx4 v13,s[28:31],s58 offen nt lds
s_waitcnt lgkmcnt(0)
v_mfma_f32_16x16x32_bf16 v[72:75],a[160:163],v[228:231],v[124:127]
ds_read_b64_tr_b16 a[196:197],v33 offset:32768
ds_read_b64_tr_b16 a[198:199],v33 offset:33792
v_mfma_f32_16x16x32_bf16 v[72:75],a[164:167],v[232:235],v[72:75]
v_exp_f32 v88,v88
v_mfma_f32_16x16x32_bf16 v[64:67],a[164:167],v[216:219],v[120:123]
v_exp_f32 v89,v89
v_mfma_f32_16x16x32_bf16 v[64:67],a[160:163],v[212:215],v[64:67]
v_exp_f32 v90,v90
v_mfma_f32_16x16x32_bf16 v[56:59],a[160:163],v[196:199],v[116:119]
s_cmp_eq_u32 s93,0
s_cbranch_scc0 L_noP11_1_o
L_noP11_1:
v_mfma_f32_16x16x32_bf16 v[56:59],a[164:167],v[200:203],v[56:59]
v_exp_f32 v91,v91
v_mfma_f32_16x16x32_bf16 v[48:51],a[164:167],v[184:187],v[112:115]
buffer_load_dwordx4 v13,s[28:31],s58 offen offset:1024 nt lds
v_mfma_f32_16x16x32_bf16 v[48:51],a[160:163],v[180:183],v[48:51]
ds_read_b64_tr_b16 a[164:165],v34 offset:32768
ds_read_b64_tr_b16 a[166:167],v34 offset:33792
v_mfma_f32_16x16x32_bf16 v[52:55],a[168:171],v[180:183],v[112:115]
s_add_u32 m0,s85,40960
s_xor_b32 s58,s11,2191360
v_mfma_f32_16x16x32_bf16 v[52:55],a[172:175],v[184:187],v[52:55]
ds_read_b64_tr_b16 a[160:161],v35 offset:32768
ds_read_b64_tr_b16 a[162:163],v35 offset:33792
v_mfma_f32_16x16x32_bf16 v[60:63],a[172:175],v[200:203],v[116:119]
v_exp_f32 v92,v92
v_mfma_f32_16x16x32_bf16 v[60:63],a[168:171],v[196:199],v[60:63]
v_exp_f32 v93,v93
v_mfma_f32_16x16x32_bf16 v[68:71],a[168:171],v[212:215],v[120:123]
v_exp_f32 v94,v94
v_mfma_f32_16x16x32_bf16 v[68:71],a[172:175],v[216:219],v[68:71]
buffer_load_dwordx4 v12,s[28:31],s58 offen nt lds
v_mfma_f32_16x16x32_bf16 v[76:79],a[172:175],v[232:235],v[124:127]
ds_read_b64_tr_b16 a[172:173],v36 offset:32768
ds_read_b64_tr_b16 a[174:175],v36 offset:33792
v_mfma_f32_16x16x32_bf16 v[76:79],a[168:171],v[228:231],v[76:79]
v_exp_f32 v95,v95
v_mfma_f32_16x16x32_bf16 v[72:75],a[176:179],v[236:239],v[72:75]
ds_read_b64_tr_b16 a[168:169],v37 offset:32768
ds_read_b64_tr_b16 a[170:171],v37 offset:33792
v_mfma_f32_16x16x32_bf16 v[72:75],a[180:183],v[240:243],v[72:75]
v_cvt_pk_bf16_f32 v88,v88,v89
v_cvt_pk_bf16_f32 v89,v90,v91
v_mfma_f32_16x16x32_bf16 v[64:67],a[180:183],v[224:227],v[64:67]
v_cvt_pk_bf16_f32 v90,v92,v93
v_cvt_pk_bf16_f32 v91,v94,v95
v_mfma_f32_16x16x32_bf16 v[64:67],a[176:179],v[220:223],v[64:67]
v_exp_f32 v96,v96
v_mfma_f32_16x16x32_bf16 v[56:59],a[176:179],v[204:207],v[56:59]
buffer_load_dwordx4 v12,s[28:31],s58 offen offset:1024 nt lds
v_mfma_f32_16x16x32_bf16 v[56:59],a[180:183],v[208:211],v[56:59]
s_add_u32 m0,s85,45056
s_xor_b32 s58,s11,2224128
v_mfma_f32_16x16x32_bf16 v[48:51],a[180:183],v[192:195],v[48:51]
ds_read_b64_tr_b16 a[180:181],v38 offset:32768
ds_read_b64_tr_b16 a[182:183],v38 offset:33792
v_mfma_f32_16x16x32_bf16 v[48:51],a[176:179],v[188:191],v[48:51]
v_exp_f32 v97,v97
v_mfma_f32_16x16x32_bf16 v[52:55],a[184:187],v[188:191],v[52:55]
ds_read_b64_tr_b16 a[176:177],v39 offset:32768
ds_read_b64_tr_b16 a[178:179],v39 offset:33792
v_mfma_f32_16x16x32_bf16 v[52:55],a[188:191],v[192:195],v[52:55]
v_exp_f32 v98,v98
v_mfma_f32_16x16x32_bf16 v[60:63],a[188:191],v[208:211],v[60:63]
v_exp_f32 v99,v99
v_mfma_f32_16x16x32_bf16 v[60:63],a[184:187],v[204:207],v[60:63]
buffer_load_dwordx4 v13,s[28:31],s58 offen nt lds
v_mfma_f32_16x16x32_bf16 v[68:71],a[184:187],v[220:223],v[68:71]
v_exp_f32 v100,v100
v_mfma_f32_16x16x32_bf16 v[68:71],a[188:191],v[224:227],v[68:71]
v_exp_f32 v101,v101
v_mfma_f32_16x16x32_bf16 v[76:79],a[188:191],v[240:243],v[76:79]
v_exp_f32 v102,v102
v_mfma_f32_16x16x32_bf16 v[76:79],a[184:187],v[236:239],v[76:79]
v_exp_f32 v103,v103
v_mfma_f32_16x16x32_bf16 a[0:3],a[192:195],v[80:83],a[0:3]
v_cvt_pk_bf16_f32 v96,v96,v97
v_cvt_pk_bf16_f32 v97,v98,v99
v_mfma_f32_16x16x32_bf16 a[4:7],a[192:195],v[88:91],a[4:7]
v_cvt_pk_bf16_f32 v98,v100,v101
v_cvt_pk_bf16_f32 v99,v102,v103
s_nop 1
v_mfma_f32_16x16x32_bf16 a[8:11],a[192:195],v[96:99],a[8:11]
buffer_load_dwordx4 v13,s[28:31],s58 offen offset:1024 nt lds
v_exp_f32 v104,v104
v_exp_f32 v105,v105
v_exp_f32 v106,v106
v_exp_f32 v107,v107
v_exp_f32 v108,v108
v_exp_f32 v109,v109
v_exp_f32 v110,v110
v_exp_f32 v111,v111
v_cvt_pk_bf16_f32 v104,v104,v105
v_cvt_pk_bf16_f32 v105,v106,v107
v_cvt_pk_bf16_f32 v106,v108,v109
v_cvt_pk_bf16_f32 v107,v110,v111
s_nop 1
v_mfma_f32_16x16x32_bf16 a[12:15],a[192:195],v[104:107],a[12:15]
v_exp_f32 v144,v144
v_exp_f32 v145,v145
v_exp_f32 v146,v146
v_exp_f32 v147,v147
v_exp_f32 v148,v148
v_exp_f32 v149,v149
v_exp_f32 v150,v150
v_exp_f32 v151,v151
v_cvt_pk_bf16_f32 v144,v144,v145
v_cvt_pk_bf16_f32 v145,v146,v147
v_cvt_pk_bf16_f32 v146,v148,v149
v_cvt_pk_bf16_f32 v147,v150,v151
s_nop 1
v_mfma_f32_16x16x32_bf16 a[128:131],a[192:195],v[144:147],a[128:131]
v_max3_f32 v1,v48,v49,v50
v_max3_f32 v1,v1,v51,v56
s_waitcnt lgkmcnt(0)
v_mfma_f32_16x16x32_bf16 a[132:135],a[196:199],v[144:147],a[132:135]
ds_read_b128 a[188:191],v44 offset:0
ds_read_b128 a[184:187],v45 offset:0
v_mfma_f32_16x16x32_bf16 a[28:31],a[196:199],v[104:107],a[28:31]
ds_read_b128 a[192:195],v45 offset:1024
v_max3_f32 v1,v1,v57,v58
v_mfma_f32_16x16x32_bf16 a[24:27],a[196:199],v[96:99],a[24:27]
v_max3_f32 v1,v1,v59,v64
v_max3_f32 v1,v1,v65,v66
v_mfma_f32_16x16x32_bf16 a[20:23],a[196:199],v[88:91],a[20:23]
v_max3_f32 v1,v1,v67,v72
v_max3_f32 v1,v1,v73,v74
v_mfma_f32_16x16x32_bf16 a[16:19],a[196:199],v[80:83],a[16:19]
s_mov_b32 s101,0x80808080
s_waitcnt vmcnt(16)
v_and_b32 v255,0x80808080,v254
v_cmp_ne_u32 s[70:71],s101,v255
s_nop 3
s_cmp_eq_u64 s[70:71],0
s_cbranch_scc1 L_gw
s_mov_b32 s72,0
L_gw_spin:
s_sleep 8
buffer_load_dword v254,v8,s[96:99],0 offen sc1
s_waitcnt vmcnt(0)
s_add_u32 s72,s72,1
s_cmp_ge_u32 s72,0x40000
s_cbranch_scc1 L_gw
v_and_b32 v255,0x80808080,v254
v_cmp_ne_u32 s[70:71],s101,v255
s_nop 3
s_cmp_eq_u64 s[70:71],0
s_cbranch_scc0 L_gw_spin
L_gw:
s_lshl_b32 s70,s49,1
s_add_u32 s71,s70,1
s_nop 3
v_readlane_b32 s101,v254,s70
v_readlane_b32 s3,v254,s71
s_nop 0
s_xor_b32 s101,s101,s53
s_xor_b32 s3,s3,s53
s_or_b32 s3,s3,s101
s_cmp_eq_u32 s3,0
s_cselect_b32 s95,1,0
s_lshl_b32 s71,s48,3
buffer_load_dwordx2 v[254:255],off,s[40:43],s71 sc1
v_mfma_f32_16x16x32_bf16 v[156:159],v[176:179],v[80:83],v[156:159]
ds_read_b128 a[196:199],v44 offset:1024
v_max3_f32 v1,v1,v75,v52
v_mfma_f32_16x16x32_bf16 a[32:35],a[164:167],v[80:83],a[32:35]
v_max3_f32 v1,v1,v53,v54
v_max3_f32 v1,v1,v55,v60
v_mfma_f32_16x16x32_bf16 a[36:39],a[164:167],v[88:91],a[36:39]
v_max3_f32 v1,v1,v61,v62
v_max3_f32 v1,v1,v63,v68
v_mfma_f32_16x16x32_bf16 a[40:43],a[164:167],v[96:99],a[40:43]
v_max3_f32 v1,v1,v69,v70
v_max3_f32 v1,v1,v71,v76
v_mfma_f32_16x16x32_bf16 a[44:47],a[164:167],v[104:107],a[44:47]
v_max3_f32 v1,v1,v77,v78
v_max_f32 v1,v1,v79
v_mfma_f32_16x16x32_bf16 a[136:139],a[164:167],v[144:147],a[136:139]
ds_read_b128 a[164:167],v46 offset:0
v_cmp_lt_f32 vcc,0x41000000,v1
v_mfma_f32_16x16x32_bf16 v[160:163],v[176:179],v[88:91],v[160:163]
v_mfma_f32_16x16x32_bf16 a[140:143],a[160:163],v[144:147],a[140:143]
s_cbranch_vccnz L_noA12_1_o
L_noA12_1:
v_mfma_f32_16x16x32_bf16 a[60:63],a[160:163],v[104:107],a[60:63]
v_exp_f32 v48,v48
v_mfma_f32_16x16x32_bf16 a[56:59],a[160:163],v[96:99],a[56:59]
v_exp_f32 v49,v49
v_mfma_f32_16x16x32_bf16 a[52:55],a[160:163],v[88:91],a[52:55]
v_exp_f32 v50,v50
v_mfma_f32_16x16x32_bf16 a[48:51],a[160:163],v[80:83],a[48:51]
ds_read_b128 a[160:163],v47 offset:0
v_mfma_f32_16x16x32_bf16 v[164:167],v[176:179],v[96:99],v[164:167]
v_exp_f32 v51,v51
v_mfma_f32_16x16x32_bf16 a[64:67],a[172:175],v[80:83],a[64:67]
v_exp_f32 v52,v52
v_mfma_f32_16x16x32_bf16 a[68:71],a[172:175],v[88:91],a[68:71]
v_exp_f32 v53,v53
v_mfma_f32_16x16x32_bf16 a[72:75],a[172:175],v[96:99],a[72:75]
v_exp_f32 v54,v54
v_mfma_f32_16x16x32_bf16 a[76:79],a[172:175],v[104:107],a[76:79]
v_exp_f32 v55,v55
v_mfma_f32_16x16x32_bf16 a[144:147],a[172:175],v[144:147],a[144:147]
ds_read_b128 a[172:175],v47 offset:1024
v_cvt_pk_bf16_f32 v48,v48,v49
v_mfma_f32_16x16x32_bf16 v[168:171],v[176:179],v[104:107],v[168:171]
v_cvt_pk_bf16_f32 v49,v50,v51
v_cvt_pk_bf16_f32 v50,v52,v53
v_mfma_f32_16x16x32_bf16 a[148:151],a[168:171],v[144:147],a[148:151]
v_cvt_pk_bf16_f32 v51,v54,v55
v_mfma_f32_16x16x32_bf16 a[92:95],a[168:171],v[104:107],a[92:95]
v_exp_f32 v56,v56
v_mfma_f32_16x16x32_bf16 a[88:91],a[168:171],v[96:99],a[88:91]
v_exp_f32 v57,v57
v_mfma_f32_16x16x32_bf16 a[84:87],a[168:171],v[88:91],a[84:87]
v_exp_f32 v58,v58
v_mfma_f32_16x16x32_bf16 a[80:83],a[168:171],v[80:83],a[80:83]
ds_read_b128 a[168:171],v46 offset:1024
v_mfma_f32_16x16x32_bf16 v[172:175],v[176:179],v[144:147],v[172:175]
v_exp_f32 v59,v59
v_mfma_f32_16x16x32_bf16 a[96:99],a[180:183],v[80:83],a[96:99]
v_exp_f32 v60,v60
v_mfma_f32_16x16x32_bf16 a[100:103],a[180:183],v[88:91],a[100:103]
v_exp_f32 v61,v61
v_mfma_f32_16x16x32_bf16 a[104:107],a[180:183],v[96:99],a[104:107]
v_exp_f32 v62,v62
v_mfma_f32_16x16x32_bf16 a[108:111],a[180:183],v[104:107],a[108:111]
v_exp_f32 v63,v63
v_mfma_f32_16x16x32_bf16 a[152:155],a[180:183],v[144:147],a[152:155]
s_waitcnt vmcnt(9) lgkmcnt(0)
s_barrier
s_cmp_eq_u32 s100,1
s_cbranch_scc1 L_qv6_1
s_waitcnt vmcnt(3)
L_qv6_1:
v_mfma_f32_16x16x32_bf16 a[156:159],a[176:179],v[144:147],a[156:159]
s_add_u32 m0,s85,98304
s_xor_b32 s58,s11,2183168
v_mfma_f32_16x16x32_bf16 a[124:127],a[176:179],v[104:107],a[124:127]
buffer_load_dwordx4 v14,s[32:35],s58 offen nt lds
v_cvt_pk_bf16_f32 v56,v56,v57
v_mfma_f32_16x16x32_bf16 a[120:123],a[176:179],v[96:99],a[120:123]
ds_read_b64_tr_b16 a[180:181],v24 offset:0
ds_read_b64_tr_b16 a[182:183],v24 offset:1024
v_mfma_f32_16x16x32_bf16 a[116:119],a[176:179],v[88:91],a[116:119]
v_cvt_pk_bf16_f32 v57,v58,v59
v_cvt_pk_bf16_f32 v58,v60,v61
v_mfma_f32_16x16x32_bf16 a[112:115],a[176:179],v[80:83],a[112:115]
ds_read_b64_tr_b16 a[176:177],v25 offset:0
ds_read_b64_tr_b16 a[178:179],v25 offset:1024
v_mfma_f32_16x16x32_bf16 v[104:107],a[188:191],v[228:231],v[124:127]
v_cvt_pk_bf16_f32 v59,v62,v63
v_mfma_f32_16x16x32_bf16 v[104:107],a[184:187],v[232:235],v[104:107]
v_exp_f32 v64,v64
v_mfma_f32_16x16x32_bf16 v[96:99],a[184:187],v[216:219],v[120:123]
v_exp_f32 v65,v65
v_mfma_f32_16x16x32_bf16 v[96:99],a[188:191],v[212:215],v[96:99]
buffer_load_dwordx4 v14,s[32:35],s58 offen offset:1024 nt lds
v_mfma_f32_16x16x32_bf16 v[88:91],a[188:191],v[196:199],v[116:119]
s_add_u32 m0,s85,102400
s_xor_b32 s58,s11,2215936
v_mfma_f32_16x16x32_bf16 v[88:91],a[184:187],v[200:203],v[88:91]
v_exp_f32 v66,v66
v_mfma_f32_16x16x32_bf16 v[80:83],a[184:187],v[184:187],v[112:115]
s_cmp_eq_u32 s93,0
s_cbranch_scc0 L_noP12_1_o
L_noP12_1:
v_mfma_f32_16x16x32_bf16 v[80:83],a[188:191],v[180:183],v[80:83]
v_exp_f32 v67,v67
v_mfma_f32_16x16x32_bf16 v[144:147],a[188:191],v[128:131],v[152:155]
ds_read_b64_tr_b16 a[188:189],v26 offset:0
ds_read_b64_tr_b16 a[190:191],v26 offset:1024
v_mfma_f32_16x16x32_bf16 v[144:147],a[184:187],v[136:139],v[144:147]
v_exp_f32 v68,v68
v_mfma_f32_16x16x32_bf16 v[148:151],a[192:195],v[136:139],v[152:155]
buffer_load_dwordx4 v14,s[32:35],s58 offen nt lds
v_mfma_f32_16x16x32_bf16 v[148:151],a[196:199],v[128:131],v[148:151]
ds_read_b64_tr_b16 a[184:185],v27 offset:0
ds_read_b64_tr_b16 a[186:187],v27 offset:1024
v_mfma_f32_16x16x32_bf16 v[84:87],a[196:199],v[180:183],v[112:115]
v_exp_f32 v69,v69
v_mfma_f32_16x16x32_bf16 v[84:87],a[192:195],v[184:187],v[84:87]
v_exp_f32 v70,v70
v_mfma_f32_16x16x32_bf16 v[92:95],a[192:195],v[200:203],v[116:119]
v_exp_f32 v71,v71
v_mfma_f32_16x16x32_bf16 v[92:95],a[196:199],v[196:199],v[92:95]
v_cvt_pk_bf16_f32 v64,v64,v65
v_cvt_pk_bf16_f32 v65,v66,v67
v_mfma_f32_16x16x32_bf16 v[100:103],a[196:199],v[212:215],v[120:123]
v_cvt_pk_bf16_f32 v66,v68,v69
v_cvt_pk_bf16_f32 v67,v70,v71
v_mfma_f32_16x16x32_bf16 v[100:103],a[192:195],v[216:219],v[100:103]
buffer_load_dwordx4 v14,s[32:35],s58 offen offset:1024 nt lds
v_mfma_f32_16x16x32_bf16 v[108:111],a[192:195],v[232:235],v[124:127]
ds_read_b64_tr_b16 a[192:193],v28 offset:0
ds_read_b64_tr_b16 a[194:195],v28 offset:1024
v_mfma_f32_16x16x32_bf16 v[108:111],a[196:199],v[228:231],v[108:111]
s_add_u32 m0,s85,106496
s_xor_b32 s58,s11,2191360
v_mfma_f32_16x16x32_bf16 v[104:107],a[164:167],v[236:239],v[104:107]
ds_read_b64_tr_b16 a[196:197],v29 offset:0
ds_read_b64_tr_b16 a[198:199],v29 offset:1024
v_mfma_f32_16x16x32_bf16 v[104:107],a[160:163],v[240:243],v[104:107]
v_exp_f32 v72,v72
v_mfma_f32_16x16x32_bf16 v[96:99],a[160:163],v[224:227],v[96:99]
v_exp_f32 v73,v73
v_mfma_f32_16x16x32_bf16 v[96:99],a[164:167],v[220:223],v[96:99]
v_exp_f32 v74,v74
v_mfma_f32_16x16x32_bf16 v[88:91],a[164:167],v[204:207],v[88:91]
buffer_load_dwordx4 v14,s[32:35],s58 offen nt lds
v_mfma_f32_16x16x32_bf16 v[88:91],a[160:163],v[208:211],v[88:91]
v_exp_f32 v75,v75
v_mfma_f32_16x16x32_bf16 v[80:83],a[160:163],v[192:195],v[80:83]
v_exp_f32 v76,v76
v_mfma_f32_16x16x32_bf16 v[80:83],a[164:167],v[188:191],v[80:83]
v_exp_f32 v77,v77
v_mfma_f32_16x16x32_bf16 v[144:147],a[164:167],v[132:135],v[144:147]
ds_read_b64_tr_b16 a[164:165],v30 offset:0
ds_read_b64_tr_b16 a[166:167],v30 offset:1024
v_mfma_f32_16x16x32_bf16 v[144:147],a[160:163],v[140:143],v[144:147]
v_exp_f32 v78,v78
v_mfma_f32_16x16x32_bf16 v[148:151],a[172:175],v[140:143],v[148:151]
v_exp_f32 v79,v79
v_mfma_f32_16x16x32_bf16 v[148:151],a[168:171],v[132:135],v[148:151]
buffer_load_dwordx4 v14,s[32:35],s58 offen offset:1024 nt lds
v_cvt_pk_bf16_f32 v72,v72,v73
v_mfma_f32_16x16x32_bf16 v[84:87],a[168:171],v[188:191],v[84:87]
s_add_u32 m0,s85,110592
s_xor_b32 s58,s11,2224128
v_mfma_f32_16x16x32_bf16 v[84:87],a[172:175],v[192:195],v[84:87]
v_cvt_pk_bf16_f32 v73,v74,v75
v_cvt_pk_bf16_f32 v74,v76,v77
v_mfma_f32_16x16x32_bf16 v[92:95],a[172:175],v[208:211],v[92:95]
v_cvt_pk_bf16_f32 v75,v78,v79
v_mfma_f32_16x16x32_bf16 v[92:95],a[168:171],v[204:207],v[92:95]
v_mfma_f32_16x16x32_bf16 v[100:103],a[168:171],v[220:223],v[100:103]
v_mfma_f32_16x16x32_bf16 v[100:103],a[172:175],v[224:227],v[100:103]
v_mfma_f32_16x16x32_bf16 v[108:111],a[172:175],v[240:243],v[108:111]
buffer_load_dwordx4 v14,s[32:35],s58 offen nt lds
v_mfma_f32_16x16x32_bf16 v[108:111],a[168:171],v[236:239],v[108:111]
v_max3_f32 v1,v144,v145,v146
v_max3_f32 v1,v1,v147,v148
s_waitcnt lgkmcnt(0)
v_mfma_f32_16x16x32_bf16 a[0:3],a[180:183],v[48:51],a[0:3]
ds_read_b64_tr_b16 a[160:161],v31 offset:0
ds_read_b64_tr_b16 a[162:163],v31 offset:1024
v_mfma_f32_16x16x32_bf16 a[4:7],a[180:183],v[56:59],a[4:7]
v_max3_f32 v1,v1,v149,v150
v_max3_f32 v1,v1,v151,v80
v_mfma_f32_16x16x32_bf16 a[8:11],a[180:183],v[64:67],a[8:11]
v_max3_f32 v1,v1,v81,v82
v_max3_f32 v1,v1,v83,v88
v_mfma_f32_16x16x32_bf16 a[12:15],a[180:183],v[72:75],a[12:15]
v_max3_f32 v1,v1,v89,v90
v_max3_f32 v1,v1,v91,v96
v_mfma_f32_16x16x32_bf16 a[28:31],a[176:179],v[72:75],a[28:31]
v_max3_f32 v1,v1,v97,v98
v_max3_f32 v1,v1,v99,v104
v_mfma_f32_16x16x32_bf16 a[24:27],a[176:179],v[64:67],a[24:27]
buffer_load_dwordx4 v14,s[32:35],s58 offen offset:1024 nt lds
v_max3_f32 v1,v1,v105,v106
v_mfma_f32_16x16x32_bf16 a[20:23],a[176:179],v[56:59],a[20:23]
v_max3_f32 v1,v1,v107,v84
v_max3_f32 v1,v1,v85,v86
v_mfma_f32_16x16x32_bf16 a[16:19],a[176:179],v[48:51],a[16:19]
v_max3_f32 v1,v1,v87,v92
v_max3_f32 v1,v1,v93,v94
v_mfma_f32_16x16x32_bf16 v[156:159],v[176:179],v[48:51],v[156:159]
v_max3_f32 v1,v1,v95,v100
v_max3_f32 v1,v1,v101,v102
v_mfma_f32_16x16x32_bf16 a[32:35],a[188:191],v[48:51],a[32:35]
v_max3_f32 v1,v1,v103,v108
v_max3_f32 v1,v1,v109,v110
v_mfma_f32_16x16x32_bf16 a[36:39],a[188:191],v[56:59],a[36:39]
v_max_f32 v1,v1,v111
v_cmp_lt_f32 vcc,0x41000000,v1
v_mfma_f32_16x16x32_bf16 a[40:43],a[188:191],v[64:67],a[40:43]
v_mfma_f32_16x16x32_bf16 a[44:47],a[188:191],v[72:75],a[44:47]
s_cbranch_vccnz L_noA13_1_o
L_noA13_1:
v_mfma_f32_16x16x32_bf16 v[160:163],v[176:179],v[56:59],v[160:163]
v_exp_f32 v80,v80
v_mfma_f32_16x16x32_bf16 a[60:63],a[184:187],v[72:75],a[60:63]
v_exp_f32 v81,v81
v_mfma_f32_16x16x32_bf16 a[56:59],a[184:187],v[64:67],a[56:59]
v_exp_f32 v82,v82
v_mfma_f32_16x16x32_bf16 a[52:55],a[184:187],v[56:59],a[52:55]
v_exp_f32 v83,v83
v_mfma_f32_16x16x32_bf16 a[48:51],a[184:187],v[48:51],a[48:51]
v_exp_f32 v84,v84
v_mfma_f32_16x16x32_bf16 v[164:167],v[176:179],v[64:67],v[164:167]
v_exp_f32 v85,v85
v_mfma_f32_16x16x32_bf16 a[64:67],a[192:195],v[48:51],a[64:67]
s_waitcnt vmcnt(9) lgkmcnt(0)
s_barrier
v_mfma_f32_16x16x32_bf16 a[68:71],a[192:195],v[56:59],a[68:71]
s_waitcnt vmcnt(8)
v_readfirstlane_b32 s101,v254
v_readfirstlane_b32 s3,v255
s_nop 0
s_and_b32 s101,s101,s3
s_cmp_eq_u32 s101,1
s_cbranch_scc1 L_f0
s_mov_b32 s72,0
L_f0_spin:
s_sleep 8
buffer_load_dwordx2 v[254:255],off,s[40:43],s71 sc1
s_waitcnt vmcnt(0)
s_add_u32 s72,s72,1
s_cmp_ge_u32 s72,0x40000
s_cbranch_scc1 L_f0
v_readfirstlane_b32 s101,v254
v_readfirstlane_b32 s3,v255
s_nop 0
s_and_b32 s101,s101,s3
s_cmp_eq_u32 s101,1
s_cbranch_scc0 L_f0_spin
L_f0:
v_mfma_f32_16x16x32_bf16 a[72:75],a[192:195],v[64:67],a[72:75]
s_mul_i32 s59,s48,147456
v_add_u32 v252,s59,v10
s_mul_i32 s59,s48,81920
v_add_u32 v253,s59,v10
v_mfma_f32_16x16x32_bf16 a[76:79],a[192:195],v[72:75],a[76:79]
s_mul_i32 s59,s51,655360
s_add_u32 s24,s44,s59
s_addc_u32 s25,s45,0
s_mov_b32 s26,655360
s_mov_b32 s68,4096
v_mfma_f32_16x16x32_bf16 v[168:171],v[176:179],v[72:75],v[168:171]
s_mul_i32 s59,s49,1179648
s_add_u32 s20,s18,s59
s_addc_u32 s21,s19,0
s_mov_b32 s22,1179648
s_mov_b32 s69,8192
v_mfma_f32_16x16x32_bf16 a[92:95],a[196:199],v[72:75],a[92:95]
s_xor_b32 s52,s48,0
s_lshl_b32 s52,s52,11
s_xor_b32 s53,s48,1
s_lshl_b32 s53,s53,11
s_xor_b32 s54,s48,2
s_lshl_b32 s54,s54,11
s_xor_b32 s55,s48,3
s_lshl_b32 s55,s55,11
s_lshl_b32 s91,s48,13
v_add_u32 v12,s91,v10
v_mfma_f32_16x16x32_bf16 a[88:91],a[196:199],v[64:67],a[88:91]
buffer_load_dwordx4 a[200:203],v253,s[24:27],0 offen sc1
v_mfma_f32_16x16x32_bf16 a[84:87],a[196:199],v[56:59],a[84:87]
ds_read_b128 a[172:175],v40 offset:32768
ds_read_b128 a[168:171],v41 offset:32768
v_mfma_f32_16x16x32_bf16 a[80:83],a[196:199],v[48:51],a[80:83]
ds_read_b128 a[180:183],v40 offset:33792
v_mfma_f32_16x16x32_bf16 a[96:99],a[164:167],v[48:51],a[96:99]
ds_read_b128 a[176:179],v41 offset:33792
ds_read_b128 a[188:191],v42 offset:32768
v_mfma_f32_16x16x32_bf16 a[100:103],a[164:167],v[56:59],a[100:103]
ds_read_b128 a[184:187],v43 offset:32768
v_mfma_f32_16x16x32_bf16 a[104:107],a[164:167],v[64:67],a[104:107]
ds_read_b128 a[192:195],v42 offset:33792
ds_read_b128 a[196:199],v43 offset:33792
v_mfma_f32_16x16x32_bf16 a[108:111],a[164:167],v[72:75],a[108:111]
v_exp_f32 v86,v86
v_mfma_f32_16x16x32_bf16 a[124:127],a[160:163],v[72:75],a[124:127]
buffer_load_dwordx4 a[204:207],v253,s[24:27],0 offen offset:1024 sc1
v_mfma_f32_16x16x32_bf16 a[120:123],a[160:163],v[64:67],a[120:123]
ds_read_b64_tr_b16 a[164:165],v32 offset:0
ds_read_b64_tr_b16 a[166:167],v32 offset:1024
v_mfma_f32_16x16x32_bf16 a[116:119],a[160:163],v[56:59],a[116:119]
v_exp_f32 v87,v87
v_mfma_f32_16x16x32_bf16 a[112:115],a[160:163],v[48:51],a[112:115]
ds_read_b64_tr_b16 a[160:161],v33 offset:0
ds_read_b64_tr_b16 a[162:163],v33 offset:1024
s_waitcnt lgkmcnt(4)
v_mfma_f32_16x16x32_bf16 v[72:75],a[172:175],v[228:231],v[124:127]
v_cvt_pk_bf16_f32 v80,v80,v81
v_cvt_pk_bf16_f32 v81,v82,v83
v_mfma_f32_16x16x32_bf16 v[72:75],a[168:171],v[232:235],v[72:75]
v_cvt_pk_bf16_f32 v82,v84,v85
v_cvt_pk_bf16_f32 v83,v86,v87
v_mfma_f32_16x16x32_bf16 v[64:67],a[168:171],v[216:219],v[120:123]
v_exp_f32 v88,v88
v_mfma_f32_16x16x32_bf16 v[64:67],a[172:175],v[212:215],v[64:67]
buffer_load_dwordx4 a[208:211],v253,s[24:27],0 offen offset:2048 sc1
v_mfma_f32_16x16x32_bf16 v[56:59],a[172:175],v[196:199],v[116:119]
s_cmp_eq_u32 s93,0
s_cbranch_scc0 L_noP13_1_o
L_noP13_1:
v_mfma_f32_16x16x32_bf16 v[56:59],a[168:171],v[200:203],v[56:59]
v_exp_f32 v89,v89
v_mfma_f32_16x16x32_bf16 v[48:51],a[168:171],v[184:187],v[112:115]
ds_read_b64_tr_b16 a[168:169],v34 offset:0
ds_read_b64_tr_b16 a[170:171],v34 offset:1024
v_mfma_f32_16x16x32_bf16 v[48:51],a[172:175],v[180:183],v[48:51]
v_exp_f32 v90,v90
v_mfma_f32_16x16x32_bf16 v[52:55],a[180:183],v[180:183],v[112:115]
ds_read_b64_tr_b16 a[172:173],v35 offset:0
ds_read_b64_tr_b16 a[174:175],v35 offset:1024
v_mfma_f32_16x16x32_bf16 v[52:55],a[176:179],v[184:187],v[52:55]
v_exp_f32 v91,v91
v_mfma_f32_16x16x32_bf16 v[60:63],a[176:179],v[200:203],v[116:119]
buffer_load_dwordx4 a[212:215],v253,s[24:27],0 offen offset:3072 sc1
v_mfma_f32_16x16x32_bf16 v[60:63],a[180:183],v[196:199],v[60:63]
v_exp_f32 v92,v92
v_mfma_f32_16x16x32_bf16 v[68:71],a[180:183],v[212:215],v[120:123]
v_exp_f32 v93,v93
v_mfma_f32_16x16x32_bf16 v[68:71],a[176:179],v[216:219],v[68:71]
v_exp_f32 v94,v94
v_mfma_f32_16x16x32_bf16 v[76:79],a[176:179],v[232:235],v[124:127]
ds_read_b64_tr_b16 a[176:177],v36 offset:0
ds_read_b64_tr_b16 a[178:179],v36 offset:1024
v_mfma_f32_16x16x32_bf16 v[76:79],a[180:183],v[228:231],v[76:79]
v_exp_f32 v95,v95
v_mfma_f32_16x16x32_bf16 v[72:75],a[188:191],v[236:239],v[72:75]
ds_read_b64_tr_b16 a[180:181],v37 offset:0
ds_read_b64_tr_b16 a[182:183],v37 offset:1024
v_mfma_f32_16x16x32_bf16 v[72:75],a[184:187],v[240:243],v[72:75]
buffer_load_dwordx4 a[216:219],v253,s[24:27],s68 offen sc1
v_mfma_f32_16x16x32_bf16 v[64:67],a[184:187],v[224:227],v[64:67]
v_cvt_pk_bf16_f32 v88,v88,v89
v_cvt_pk_bf16_f32 v89,v90,v91
v_mfma_f32_16x16x32_bf16 v[64:67],a[188:191],v[220:223],v[64:67]
v_cvt_pk_bf16_f32 v90,v92,v93
v_cvt_pk_bf16_f32 v91,v94,v95
v_mfma_f32_16x16x32_bf16 v[56:59],a[188:191],v[204:207],v[56:59]
v_exp_f32 v96,v96
v_mfma_f32_16x16x32_bf16 v[56:59],a[184:187],v[208:211],v[56:59]
v_exp_f32 v97,v97
v_mfma_f32_16x16x32_bf16 v[48:51],a[184:187],v[192:195],v[48:51]
ds_read_b64_tr_b16 a[184:185],v38 offset:0
ds_read_b64_tr_b16 a[186:187],v38 offset:1024
v_mfma_f32_16x16x32_bf16 v[48:51],a[188:191],v[188:191],v[48:51]
v_exp_f32 v98,v98
v_mfma_f32_16x16x32_bf16 v[52:55],a[192:195],v[188:191],v[52:55]
buffer_load_dwordx4 a[220:223],v252,s[20:23],s52 offen sc1
v_mfma_f32_16x16x32_bf16 v[52:55],a[196:199],v[192:195],v[52:55]
v_exp_f32 v99,v99
v_mfma_f32_16x16x32_bf16 v[60:63],a[196:199],v[208:211],v[60:63]
v_exp_f32 v100,v100
v_mfma_f32_16x16x32_bf16 v[60:63],a[192:195],v[204:207],v[60:63]
v_exp_f32 v101,v101
v_mfma_f32_16x16x32_bf16 v[68:71],a[192:195],v[220:223],v[68:71]
v_exp_f32 v102,v102
v_mfma_f32_16x16x32_bf16 v[68:71],a[196:199],v[224:227],v[68:71]
v_exp_f32 v103,v103
v_mfma_f32_16x16x32_bf16 v[76:79],a[196:199],v[240:243],v[76:79]
v_cvt_pk_bf16_f32 v96,v96,v97
v_cvt_pk_bf16_f32 v97,v98,v99
v_mfma_f32_16x16x32_bf16 v[76:79],a[192:195],v[236:239],v[76:79]
buffer_load_dwordx4 a[224:227],v252,s[20:23],s52 offen offset:1024 sc1
s_waitcnt lgkmcnt(0)
v_mfma_f32_16x16x32_bf16 a[0:3],a[164:167],v[80:83],a[0:3]
ds_read_b64_tr_b16 a[188:189],v39 offset:0
ds_read_b64_tr_b16 a[190:191],v39 offset:1024
v_mfma_f32_16x16x32_bf16 a[4:7],a[164:167],v[88:91],a[4:7]
ds_read_b128 a[196:199],v44 offset:32768
v_cvt_pk_bf16_f32 v98,v100,v101
v_cvt_pk_bf16_f32 v99,v102,v103
s_nop 1
v_mfma_f32_16x16x32_bf16 a[8:11],a[164:167],v[96:99],a[8:11]
ds_read_b128 a[192:195],v45 offset:32768
v_exp_f32 v104,v104
v_exp_f32 v105,v105
v_exp_f32 v106,v106
v_exp_f32 v107,v107
v_exp_f32 v108,v108
v_exp_f32 v109,v109
v_exp_f32 v110,v110
v_exp_f32 v111,v111
v_cvt_pk_bf16_f32 v104,v104,v105
v_cvt_pk_bf16_f32 v105,v106,v107
v_cvt_pk_bf16_f32 v106,v108,v109
v_cvt_pk_bf16_f32 v107,v110,v111
s_nop 1
v_mfma_f32_16x16x32_bf16 a[12:15],a[164:167],v[104:107],a[12:15]
v_exp_f32 v144,v144
v_exp_f32 v145,v145
v_exp_f32 v146,v146
v_exp_f32 v147,v147
v_exp_f32 v148,v148
v_exp_f32 v149,v149
v_exp_f32 v150,v150
v_exp_f32 v151,v151
v_cvt_pk_bf16_f32 v144,v144,v145
v_cvt_pk_bf16_f32 v145,v146,v147
v_cvt_pk_bf16_f32 v146,v148,v149
v_cvt_pk_bf16_f32 v147,v150,v151
s_nop 1
v_mfma_f32_16x16x32_bf16 a[128:131],a[164:167],v[144:147],a[128:131]
ds_read_b128 a[164:167],v45 offset:33792
v_max3_f32 v1,v48,v49,v50
v_mfma_f32_16x16x32_bf16 a[132:135],a[160:163],v[144:147],a[132:135]
v_max3_f32 v1,v1,v51,v56
v_max3_f32 v1,v1,v57,v58
v_mfma_f32_16x16x32_bf16 a[28:31],a[160:163],v[104:107],a[28:31]
buffer_load_dwordx4 a[228:231],v252,s[20:23],s53 offen sc1
v_mfma_f32_16x16x32_bf16 a[24:27],a[160:163],v[96:99],a[24:27]
v_max3_f32 v1,v1,v59,v64
v_max3_f32 v1,v1,v65,v66
v_mfma_f32_16x16x32_bf16 a[20:23],a[160:163],v[88:91],a[20:23]
v_max3_f32 v1,v1,v67,v72
v_max3_f32 v1,v1,v73,v74
v_mfma_f32_16x16x32_bf16 a[16:19],a[160:163],v[80:83],a[16:19]
ds_read_b128 a[160:163],v44 offset:33792
v_max3_f32 v1,v1,v75,v52
v_mfma_f32_16x16x32_bf16 v[156:159],v[176:179],v[80:83],v[156:159]
v_max3_f32 v1,v1,v53,v54
v_max3_f32 v1,v1,v55,v60
v_mfma_f32_16x16x32_bf16 a[32:35],a[168:171],v[80:83],a[32:35]
v_max3_f32 v1,v1,v61,v62
v_max3_f32 v1,v1,v63,v68
v_mfma_f32_16x16x32_bf16 a[36:39],a[168:171],v[88:91],a[36:39]
v_max3_f32 v1,v1,v69,v70
v_max3_f32 v1,v1,v71,v76
v_mfma_f32_16x16x32_bf16 a[40:43],a[168:171],v[96:99],a[40:43]
buffer_load_dwordx4 a[232:235],v252,s[20:23],s53 offen offset:1024 sc1
v_mfma_f32_16x16x32_bf16 a[44:47],a[168:171],v[104:107],a[44:47]
v_max3_f32 v1,v1,v77,v78
v_max_f32 v1,v1,v79
v_mfma_f32_16x16x32_bf16 a[136:139],a[168:171],v[144:147],a[136:139]
ds_read_b128 a[168:171],v46 offset:32768
v_cmp_lt_f32 vcc,0x41000000,v1
v_mfma_f32_16x16x32_bf16 v[160:163],v[176:179],v[88:91],v[160:163]
v_mfma_f32_16x16x32_bf16 a[140:143],a[172:175],v[144:147],a[140:143]
s_cbranch_vccnz L_noA14_1_o
L_noA14_1:
v_mfma_f32_16x16x32_bf16 a[60:63],a[172:175],v[104:107],a[60:63]
v_exp_f32 v48,v48
v_mfma_f32_16x16x32_bf16 a[56:59],a[172:175],v[96:99],a[56:59]
v_exp_f32 v49,v49
v_mfma_f32_16x16x32_bf16 a[52:55],a[172:175],v[88:91],a[52:55]
buffer_load_dwordx4 a[236:239],v252,s[20:23],s54 offen sc1
v_mfma_f32_16x16x32_bf16 a[48:51],a[172:175],v[80:83],a[48:51]
ds_read_b128 a[172:175],v47 offset:32768
v_mfma_f32_16x16x32_bf16 v[164:167],v[176:179],v[96:99],v[164:167]
v_exp_f32 v50,v50
v_mfma_f32_16x16x32_bf16 a[64:67],a[176:179],v[80:83],a[64:67]
v_exp_f32 v51,v51
v_mfma_f32_16x16x32_bf16 a[68:71],a[176:179],v[88:91],a[68:71]
v_exp_f32 v52,v52
v_mfma_f32_16x16x32_bf16 a[72:75],a[176:179],v[96:99],a[72:75]
v_exp_f32 v53,v53
v_mfma_f32_16x16x32_bf16 a[76:79],a[176:179],v[104:107],a[76:79]
v_exp_f32 v54,v54
v_mfma_f32_16x16x32_bf16 a[144:147],a[176:179],v[144:147],a[144:147]
buffer_load_dwordx4 a[240:243],v252,s[20:23],s54 offen offset:1024 sc1
v_mfma_f32_16x16x32_bf16 v[168:171],v[176:179],v[104:107],v[168:171]
ds_read_b128 a[176:179],v47 offset:33792
v_mfma_f32_16x16x32_bf16 a[148:151],a[180:183],v[144:147],a[148:151]
v_exp_f32 v55,v55
v_mfma_f32_16x16x32_bf16 a[92:95],a[180:183],v[104:107],a[92:95]
v_cvt_pk_bf16_f32 v48,v48,v49
v_cvt_pk_bf16_f32 v49,v50,v51
v_mfma_f32_16x16x32_bf16 a[88:91],a[180:183],v[96:99],a[88:91]
v_cvt_pk_bf16_f32 v50,v52,v53
v_cvt_pk_bf16_f32 v51,v54,v55
v_mfma_f32_16x16x32_bf16 a[84:87],a[180:183],v[88:91],a[84:87]
v_exp_f32 v56,v56
v_mfma_f32_16x16x32_bf16 a[80:83],a[180:183],v[80:83],a[80:83]
ds_read_b128 a[180:183],v46 offset:33792
v_mfma_f32_16x16x32_bf16 v[172:175],v[176:179],v[144:147],v[172:175]
buffer_load_dwordx4 a[244:247],v252,s[20:23],s55 offen sc1
v_mfma_f32_16x16x32_bf16 a[96:99],a[184:187],v[80:83],a[96:99]
v_exp_f32 v57,v57
v_mfma_f32_16x16x32_bf16 a[100:103],a[184:187],v[88:91],a[100:103]
v_exp_f32 v58,v58
v_mfma_f32_16x16x32_bf16 a[104:107],a[184:187],v[96:99],a[104:107]
v_exp_f32 v59,v59
v_mfma_f32_16x16x32_bf16 a[108:111],a[184:187],v[104:107],a[108:111]
v_exp_f32 v60,v60
v_mfma_f32_16x16x32_bf16 a[152:155],a[184:187],v[144:147],a[152:155]
buffer_load_dwordx4 a[248:251],v252,s[20:23],s55 offen offset:1024 sc1
buffer_load_dwordx4 a[252:255],v252,s[20:23],s69 offen sc1
s_waitcnt vmcnt(14) lgkmcnt(0)
s_barrier
v_mfma_f32_16x16x32_bf16 a[156:159],a[188:191],v[144:147],a[156:159]
v_add_u32 v16,9216,v252
v_add_u32 v17,5120,v253
s_add_u32 m0,s91,0
s_nop 0
buffer_load_dwordx4 v17,s[24:27],0 offen sc1 lds
v_mfma_f32_16x16x32_bf16 a[124:127],a[188:191],v[104:107],a[124:127]
ds_read_b64_tr_b16 a[184:185],v24 offset:32768
ds_read_b64_tr_b16 a[186:187],v24 offset:33792
v_mfma_f32_16x16x32_bf16 a[120:123],a[188:191],v[96:99],a[120:123]
v_exp_f32 v61,v61
v_mfma_f32_16x16x32_bf16 a[116:119],a[188:191],v[88:91],a[116:119]
v_exp_f32 v62,v62
v_mfma_f32_16x16x32_bf16 a[112:115],a[188:191],v[80:83],a[112:115]
ds_read_b64_tr_b16 a[188:189],v25 offset:32768
ds_read_b64_tr_b16 a[190:191],v25 offset:33792
v_mfma_f32_16x16x32_bf16 v[104:107],a[196:199],v[228:231],v[124:127]
s_add_u32 m0,s91,0
s_nop 0
buffer_load_dwordx4 v17,s[24:27],0 offen offset:1024 sc1 lds
v_mfma_f32_16x16x32_bf16 v[104:107],a[192:195],v[232:235],v[104:107]
v_exp_f32 v63,v63
v_mfma_f32_16x16x32_bf16 v[96:99],a[192:195],v[216:219],v[120:123]
v_cvt_pk_bf16_f32 v56,v56,v57
v_cvt_pk_bf16_f32 v57,v58,v59
v_mfma_f32_16x16x32_bf16 v[96:99],a[196:199],v[212:215],v[96:99]
v_cvt_pk_bf16_f32 v58,v60,v61
v_cvt_pk_bf16_f32 v59,v62,v63
v_mfma_f32_16x16x32_bf16 v[88:91],a[196:199],v[196:199],v[116:119]
v_exp_f32 v64,v64
v_mfma_f32_16x16x32_bf16 v[88:91],a[192:195],v[200:203],v[88:91]
s_add_u32 m0,s91,0
s_nop 0
buffer_load_dwordx4 v17,s[24:27],0 offen offset:2048 sc1 lds
v_mfma_f32_16x16x32_bf16 v[80:83],a[192:195],v[184:187],v[112:115]
s_cmp_eq_u32 s93,0
s_cbranch_scc0 L_noP14_1_o
L_noP14_1:
v_mfma_f32_16x16x32_bf16 v[80:83],a[196:199],v[180:183],v[80:83]
v_exp_f32 v65,v65
v_mfma_f32_16x16x32_bf16 v[144:147],a[196:199],v[128:131],v[152:155]
ds_read_b64_tr_b16 a[196:197],v26 offset:32768
ds_read_b64_tr_b16 a[198:199],v26 offset:33792
v_mfma_f32_16x16x32_bf16 v[144:147],a[192:195],v[136:139],v[144:147]
v_exp_f32 v66,v66
v_mfma_f32_16x16x32_bf16 v[148:151],a[164:167],v[136:139],v[152:155]
s_add_u32 m0,s91,0
s_nop 0
buffer_load_dwordx4 v17,s[24:27],0 offen offset:3072 sc1 lds
v_mfma_f32_16x16x32_bf16 v[148:151],a[160:163],v[128:131],v[148:151]
ds_read_b64_tr_b16 a[192:193],v27 offset:32768
ds_read_b64_tr_b16 a[194:195],v27 offset:33792
v_mfma_f32_16x16x32_bf16 v[84:87],a[160:163],v[180:183],v[112:115]
v_exp_f32 v67,v67
v_mfma_f32_16x16x32_bf16 v[84:87],a[164:167],v[184:187],v[84:87]
v_exp_f32 v68,v68
v_mfma_f32_16x16x32_bf16 v[92:95],a[164:167],v[200:203],v[116:119]
v_exp_f32 v69,v69
v_mfma_f32_16x16x32_bf16 v[92:95],a[160:163],v[196:199],v[92:95]
s_add_u32 m0,s91,4096
s_nop 0
buffer_load_dwordx4 v17,s[24:27],s68 offen sc1 lds
v_mfma_f32_16x16x32_bf16 v[100:103],a[160:163],v[212:215],v[120:123]
v_exp_f32 v70,v70
v_mfma_f32_16x16x32_bf16 v[100:103],a[164:167],v[216:219],v[100:103]
v_exp_f32 v71,v71
v_mfma_f32_16x16x32_bf16 v[108:111],a[164:167],v[232:235],v[124:127]
ds_read_b64_tr_b16 a[164:165],v28 offset:32768
ds_read_b64_tr_b16 a[166:167],v28 offset:33792
v_mfma_f32_16x16x32_bf16 v[108:111],a[160:163],v[228:231],v[108:111]
v_cvt_pk_bf16_f32 v64,v64,v65
v_cvt_pk_bf16_f32 v65,v66,v67
v_mfma_f32_16x16x32_bf16 v[104:107],a[168:171],v[236:239],v[104:107]
s_add_u32 m0,s91,5120
s_nop 0
buffer_load_dwordx4 v16,s[20:23],s52 offen sc1 lds
v_mfma_f32_16x16x32_bf16 v[104:107],a[172:175],v[240:243],v[104:107]
ds_read_b64_tr_b16 a[160:161],v29 offset:32768
ds_read_b64_tr_b16 a[162:163],v29 offset:33792
v_mfma_f32_16x16x32_bf16 v[96:99],a[172:175],v[224:227],v[96:99]
v_cvt_pk_bf16_f32 v66,v68,v69
v_cvt_pk_bf16_f32 v67,v70,v71
v_mfma_f32_16x16x32_bf16 v[96:99],a[168:171],v[220:223],v[96:99]
v_exp_f32 v72,v72
v_mfma_f32_16x16x32_bf16 v[88:91],a[168:171],v[204:207],v[88:91]
v_exp_f32 v73,v73
v_mfma_f32_16x16x32_bf16 v[88:91],a[172:175],v[208:211],v[88:91]
s_add_u32 m0,s91,5120
s_nop 0
buffer_load_dwordx4 v16,s[20:23],s52 offen offset:1024 sc1 lds
v_mfma_f32_16x16x32_bf16 v[80:83],a[172:175],v[192:195],v[80:83]
v_exp_f32 v74,v74
v_mfma_f32_16x16x32_bf16 v[80:83],a[168:171],v[188:191],v[80:83]
v_exp_f32 v75,v75
v_mfma_f32_16x16x32_bf16 v[144:147],a[168:171],v[132:135],v[144:147]
ds_read_b64_tr_b16 a[168:169],v30 offset:32768
ds_read_b64_tr_b16 a[170:171],v30 offset:33792
v_mfma_f32_16x16x32_bf16 v[144:147],a[172:175],v[140:143],v[144:147]
v_exp_f32 v76,v76
v_mfma_f32_16x16x32_bf16 v[148:151],a[176:179],v[140:143],v[148:151]
s_add_u32 m0,s91,7168
s_nop 0
buffer_load_dwordx4 v16,s[20:23],s53 offen sc1 lds
v_mfma_f32_16x16x32_bf16 v[148:151],a[180:183],v[132:135],v[148:151]
v_exp_f32 v77,v77
v_mfma_f32_16x16x32_bf16 v[84:87],a[180:183],v[188:191],v[84:87]
v_exp_f32 v78,v78
v_mfma_f32_16x16x32_bf16 v[84:87],a[176:179],v[192:195],v[84:87]
v_exp_f32 v79,v79
v_mfma_f32_16x16x32_bf16 v[92:95],a[176:179],v[208:211],v[92:95]
v_cvt_pk_bf16_f32 v72,v72,v73
v_cvt_pk_bf16_f32 v73,v74,v75
v_mfma_f32_16x16x32_bf16 v[92:95],a[180:183],v[204:207],v[92:95]
s_add_u32 m0,s91,31744
s_nop 0
buffer_load_dwordx4 v16,s[20:23],s53 offen offset:1024 sc1 lds
v_mfma_f32_16x16x32_bf16 v[100:103],a[180:183],v[220:223],v[100:103]
v_cvt_pk_bf16_f32 v74,v76,v77
v_cvt_pk_bf16_f32 v75,v78,v79
v_mfma_f32_16x16x32_bf16 v[100:103],a[176:179],v[224:227],v[100:103]
v_mfma_f32_16x16x32_bf16 v[108:111],a[176:179],v[240:243],v[108:111]
v_mfma_f32_16x16x32_bf16 v[108:111],a[180:183],v[236:239],v[108:111]
v_max3_f32 v1,v144,v145,v146
v_max3_f32 v1,v1,v147,v148
s_waitcnt lgkmcnt(0)
v_mfma_f32_16x16x32_bf16 a[0:3],a[184:187],v[48:51],a[0:3]
s_add_u32 m0,s91,33792
s_nop 0
buffer_load_dwordx4 v16,s[20:23],s54 offen sc1 lds
v_mfma_f32_16x16x32_bf16 a[4:7],a[184:187],v[56:59],a[4:7]
ds_read_b64_tr_b16 a[172:173],v31 offset:32768
ds_read_b64_tr_b16 a[174:175],v31 offset:33792
v_mfma_f32_16x16x32_bf16 a[8:11],a[184:187],v[64:67],a[8:11]
v_max3_f32 v1,v1,v149,v150
v_max3_f32 v1,v1,v151,v80
v_mfma_f32_16x16x32_bf16 a[12:15],a[184:187],v[72:75],a[12:15]
ds_read_b64_tr_b16 a[176:177],v32 offset:32768
ds_read_b64_tr_b16 a[178:179],v32 offset:33792
v_mfma_f32_16x16x32_bf16 a[28:31],a[188:191],v[72:75],a[28:31]
v_max3_f32 v1,v1,v81,v82
v_max3_f32 v1,v1,v83,v88
v_mfma_f32_16x16x32_bf16 a[24:27],a[188:191],v[64:67],a[24:27]
s_add_u32 m0,s91,33792
s_nop 0
buffer_load_dwordx4 v16,s[20:23],s54 offen offset:1024 sc1 lds
v_mfma_f32_16x16x32_bf16 a[20:23],a[188:191],v[56:59],a[20:23]
ds_read_b64_tr_b16 a[180:181],v33 offset:32768
ds_read_b64_tr_b16 a[182:183],v33 offset:33792
v_mfma_f32_16x16x32_bf16 a[16:19],a[188:191],v[48:51],a[16:19]
v_max3_f32 v1,v1,v89,v90
v_max3_f32 v1,v1,v91,v96
v_mfma_f32_16x16x32_bf16 v[156:159],v[176:179],v[48:51],v[156:159]
ds_read_b64_tr_b16 a[184:185],v34 offset:32768
ds_read_b64_tr_b16 a[186:187],v34 offset:33792
v_mfma_f32_16x16x32_bf16 a[32:35],a[196:199],v[48:51],a[32:35]
v_max3_f32 v1,v1,v97,v98
v_max3_f32 v1,v1,v99,v104
v_mfma_f32_16x16x32_bf16 a[36:39],a[196:199],v[56:59],a[36:39]
s_add_u32 m0,s91,35840
s_nop 0
buffer_load_dwordx4 v16,s[20:23],s55 offen sc1 lds
v_mfma_f32_16x16x32_bf16 a[40:43],a[196:199],v[64:67],a[40:43]
ds_read_b64_tr_b16 a[188:189],v35 offset:32768
ds_read_b64_tr_b16 a[190:191],v35 offset:33792
v_mfma_f32_16x16x32_bf16 a[44:47],a[196:199],v[72:75],a[44:47]
v_max3_f32 v1,v1,v105,v106
v_max3_f32 v1,v1,v107,v84
v_mfma_f32_16x16x32_bf16 v[160:163],v[176:179],v[56:59],v[160:163]
ds_read_b64_tr_b16 a[196:197],v36 offset:32768
ds_read_b64_tr_b16 a[198:199],v36 offset:33792
v_mfma_f32_16x16x32_bf16 a[60:63],a[192:195],v[72:75],a[60:63]
v_max3_f32 v1,v1,v85,v86
v_max3_f32 v1,v1,v87,v92
v_mfma_f32_16x16x32_bf16 a[56:59],a[192:195],v[64:67],a[56:59]
s_add_u32 m0,s91,35840
s_nop 0
buffer_load_dwordx4 v16,s[20:23],s55 offen offset:1024 sc1 lds
v_mfma_f32_16x16x32_bf16 a[52:55],a[192:195],v[56:59],a[52:55]
v_max3_f32 v1,v1,v93,v94
v_max3_f32 v1,v1,v95,v100
v_mfma_f32_16x16x32_bf16 a[48:51],a[192:195],v[48:51],a[48:51]
ds_read_b64_tr_b16 a[192:193],v37 offset:32768
ds_read_b64_tr_b16 a[194:195],v37 offset:33792
v_mfma_f32_16x16x32_bf16 v[164:167],v[176:179],v[64:67],v[164:167]
v_max3_f32 v1,v1,v101,v102
v_max3_f32 v1,v1,v103,v108
v_mfma_f32_16x16x32_bf16 a[64:67],a[164:167],v[48:51],a[64:67]
v_max3_f32 v1,v1,v109,v110
v_max_f32 v1,v1,v111
v_mfma_f32_16x16x32_bf16 a[68:71],a[164:167],v[56:59],a[68:71]
s_add_u32 m0,s91,37888
s_nop 0
buffer_load_dwordx4 v16,s[20:23],s69 offen sc1 lds
v_mfma_f32_16x16x32_bf16 a[72:75],a[164:167],v[64:67],a[72:75]
v_cmp_lt_f32 vcc,0x41000000,v1
v_mfma_f32_16x16x32_bf16 a[76:79],a[164:167],v[72:75],a[76:79]
v_mfma_f32_16x16x32_bf16 v[168:171],v[176:179],v[72:75],v[168:171]
s_cbranch_vccnz L_noA15_1_o
L_noA15_1:
v_mfma_f32_16x16x32_bf16 a[92:95],a[160:163],v[72:75],a[92:95]
v_exp_f32 v80,v80
v_mfma_f32_16x16x32_bf16 a[88:91],a[160:163],v[64:67],a[88:91]
v_add_u32 v18,9216,v16
v_add_u32 v15,5120,v17
s_add_u32 m0,s91,38912
s_nop 0
buffer_load_dwordx4 v15,s[24:27],0 offen sc1 lds
v_mfma_f32_16x16x32_bf16 a[84:87],a[160:163],v[56:59],a[84:87]
v_exp_f32 v81,v81
v_mfma_f32_16x16x32_bf16 a[80:83],a[160:163],v[48:51],a[80:83]
v_exp_f32 v82,v82
v_mfma_f32_16x16x32_bf16 a[96:99],a[168:171],v[48:51],a[96:99]
v_exp_f32 v83,v83
v_mfma_f32_16x16x32_bf16 a[100:103],a[168:171],v[56:59],a[100:103]
v_exp_f32 v84,v84
v_mfma_f32_16x16x32_bf16 a[104:107],a[168:171],v[64:67],a[104:107]
s_add_u32 m0,s91,38912
s_nop 0
buffer_load_dwordx4 v15,s[24:27],0 offen offset:1024 sc1 lds
v_mfma_f32_16x16x32_bf16 a[108:111],a[168:171],v[72:75],a[108:111]
v_exp_f32 v85,v85
s_waitcnt lgkmcnt(0)
v_mfma_f32_16x16x32_bf16 a[124:127],a[172:175],v[72:75],a[124:127]
ds_read_b64_tr_b16 a[164:165],v38 offset:32768
ds_read_b64_tr_b16 a[166:167],v38 offset:33792
v_mfma_f32_16x16x32_bf16 a[120:123],a[172:175],v[64:67],a[120:123]
v_exp_f32 v86,v86
v_mfma_f32_16x16x32_bf16 a[116:119],a[172:175],v[56:59],a[116:119]
ds_read_b64_tr_b16 a[160:161],v39 offset:32768
ds_read_b64_tr_b16 a[162:163],v39 offset:33792
v_mfma_f32_16x16x32_bf16 a[112:115],a[172:175],v[48:51],a[112:115]
v_exp_f32 v87,v87
s_nop 1
s_cmp_eq_u32 s93,0
s_cbranch_scc0 L_noP15_1_o
L_noP15_1:
v_cvt_pk_bf16_f32 v80,v80,v81
v_cvt_pk_bf16_f32 v81,v82,v83
v_cvt_pk_bf16_f32 v82,v84,v85
v_cvt_pk_bf16_f32 v83,v86,v87
s_nop 1
v_mfma_f32_16x16x32_bf16 v[156:159],v[176:179],v[80:83],v[156:159]
v_exp_f32 v144,v144
v_mfma_f32_16x16x32_bf16 a[0:3],a[176:179],v[80:83],a[0:3]
v_exp_f32 v145,v145
v_mfma_f32_16x16x32_bf16 a[16:19],a[180:183],v[80:83],a[16:19]
v_exp_f32 v146,v146
v_mfma_f32_16x16x32_bf16 a[32:35],a[184:187],v[80:83],a[32:35]
v_exp_f32 v147,v147
v_mfma_f32_16x16x32_bf16 a[48:51],a[188:191],v[80:83],a[48:51]
v_exp_f32 v148,v148
v_mfma_f32_16x16x32_bf16 a[64:67],a[196:199],v[80:83],a[64:67]
v_exp_f32 v149,v149
v_mfma_f32_16x16x32_bf16 a[80:83],a[192:195],v[80:83],a[80:83]
v_exp_f32 v150,v150
s_waitcnt lgkmcnt(0)
v_mfma_f32_16x16x32_bf16 a[96:99],a[164:167],v[80:83],a[96:99]
v_exp_f32 v151,v151
v_mfma_f32_16x16x32_bf16 a[112:115],a[160:163],v[80:83],a[112:115]
v_cvt_pk_bf16_f32 v144,v144,v145
v_cvt_pk_bf16_f32 v145,v146,v147
v_cvt_pk_bf16_f32 v146,v148,v149
v_cvt_pk_bf16_f32 v147,v150,v151
s_nop 1
v_mfma_f32_16x16x32_bf16 v[172:175],v[176:179],v[144:147],v[172:175]
v_exp_f32 v88,v88
v_mfma_f32_16x16x32_bf16 a[144:147],a[196:199],v[144:147],a[144:147]
v_exp_f32 v89,v89
v_mfma_f32_16x16x32_bf16 a[148:151],a[192:195],v[144:147],a[148:151]
v_exp_f32 v90,v90
v_mfma_f32_16x16x32_bf16 a[152:155],a[164:167],v[144:147],a[152:155]
v_exp_f32 v91,v91
v_mfma_f32_16x16x32_bf16 a[156:159],a[160:163],v[144:147],a[156:159]
v_exp_f32 v92,v92
v_mfma_f32_16x16x32_bf16 a[128:131],a[176:179],v[144:147],a[128:131]
v_exp_f32 v93,v93
v_mfma_f32_16x16x32_bf16 a[132:135],a[180:183],v[144:147],a[132:135]
v_exp_f32 v94,v94
v_mfma_f32_16x16x32_bf16 a[136:139],a[184:187],v[144:147],a[136:139]
v_exp_f32 v95,v95
v_mfma_f32_16x16x32_bf16 a[140:143],a[188:191],v[144:147],a[140:143]
v_cvt_pk_bf16_f32 v88,v88,v89
v_cvt_pk_bf16_f32 v89,v90,v91
v_cvt_pk_bf16_f32 v90,v92,v93
v_cvt_pk_bf16_f32 v91,v94,v95
s_nop 1
v_mfma_f32_16x16x32_bf16 v[160:163],v[176:179],v[88:91],v[160:163]
v_exp_f32 v96,v96
v_mfma_f32_16x16x32_bf16 a[4:7],a[176:179],v[88:91],a[4:7]
v_exp_f32 v97,v97
v_mfma_f32_16x16x32_bf16 a[20:23],a[180:183],v[88:91],a[20:23]
v_exp_f32 v98,v98
v_mfma_f32_16x16x32_bf16 a[36:39],a[184:187],v[88:91],a[36:39]
v_exp_f32 v99,v99
v_mfma_f32_16x16x32_bf16 a[52:55],a[188:191],v[88:91],a[52:55]
v_exp_f32 v100,v100
v_mfma_f32_16x16x32_bf16 a[68:71],a[196:199],v[88:91],a[68:71]
v_exp_f32 v101,v101
v_mfma_f32_16x16x32_bf16 a[84:87],a[192:195],v[88:91],a[84:87]
v_exp_f32 v102,v102
v_mfma_f32_16x16x32_bf16 a[100:103],a[164:167],v[88:91],a[100:103]
v_exp_f32 v103,v103
v_mfma_f32_16x16x32_bf16 a[116:119],a[160:163],v[88:91],a[116:119]
v_cvt_pk_bf16_f32 v96,v96,v97
v_cvt_pk_bf16_f32 v97,v98,v99
v_cvt_pk_bf16_f32 v98,v100,v101
v_cvt_pk_bf16_f32 v99,v102,v103
s_nop 1
v_mfma_f32_16x16x32_bf16 v[164:167],v[176:179],v[96:99],v[164:167]
v_exp_f32 v104,v104
v_mfma_f32_16x16x32_bf16 a[8:11],a[176:179],v[96:99],a[8:11]
v_exp_f32 v105,v105
v_mfma_f32_16x16x32_bf16 a[24:27],a[180:183],v[96:99],a[24:27]
v_exp_f32 v106,v106
v_mfma_f32_16x16x32_bf16 a[40:43],a[184:187],v[96:99],a[40:43]
v_exp_f32 v107,v107
v_mfma_f32_16x16x32_bf16 a[56:59],a[188:191],v[96:99],a[56:59]
v_exp_f32 v108,v108
v_mfma_f32_16x16x32_bf16 a[72:75],a[196:199],v[96:99],a[72:75]
v_exp_f32 v109,v109
v_mfma_f32_16x16x32_bf16 a[88:91],a[192:195],v[96:99],a[88:91]
v_exp_f32 v110,v110
v_mfma_f32_16x16x32_bf16 a[104:107],a[164:167],v[96:99],a[104:107]
v_exp_f32 v111,v111
v_mfma_f32_16x16x32_bf16 a[120:123],a[160:163],v[96:99],a[120:123]
v_cvt_pk_bf16_f32 v104,v104,v105
v_cvt_pk_bf16_f32 v105,v106,v107
v_cvt_pk_bf16_f32 v106,v108,v109
v_cvt_pk_bf16_f32 v107,v110,v111
s_nop 1
v_mfma_f32_16x16x32_bf16 v[168:171],v[176:179],v[104:107],v[168:171]
v_lshrrev_b32 v1,1,v10
s_add_u32 s59,s88,143360
v_add_u32 v1,s59,v1
v_mfma_f32_16x16x32_bf16 a[12:15],a[176:179],v[104:107],a[12:15]
v_mov_b32 v153,v172
ds_write_b64 v1,v[152:153] offset:0
v_mfma_f32_16x16x32_bf16 a[28:31],a[180:183],v[104:107],a[28:31]
s_add_u32 s59,s87,147456
v_add_u32 v6,s59,v10
ds_write_b128 v6,a[144:147] offset:0
v_mfma_f32_16x16x32_bf16 a[44:47],a[184:187],v[104:107],a[44:47]
ds_write_b128 v6,a[148:151] offset:1024
ds_write_b128 v6,a[152:155] offset:2048
v_mfma_f32_16x16x32_bf16 a[60:63],a[188:191],v[104:107],a[60:63]
ds_write_b128 v6,a[156:159] offset:3072
v_xor_b32 v1,512,v1
v_mfma_f32_16x16x32_bf16 a[76:79],a[196:199],v[104:107],a[76:79]
v_xor_b32 v6,4096,v6
v_accvgpr_read_b32 v136,a128
v_mfma_f32_16x16x32_bf16 a[92:95],a[192:195],v[104:107],a[92:95]
v_accvgpr_read_b32 v137,a129
v_accvgpr_read_b32 v138,a130
v_mfma_f32_16x16x32_bf16 a[108:111],a[164:167],v[104:107],a[108:111]
v_accvgpr_read_b32 v139,a131
v_accvgpr_read_b32 v140,a132
v_mfma_f32_16x16x32_bf16 a[124:127],a[160:163],v[104:107],a[124:127]
v_accvgpr_read_b32 v141,a133
v_accvgpr_read_b32 v142,a134
v_accvgpr_read_b32 v143,a135
v_accvgpr_read_b32 v144,a136
v_accvgpr_read_b32 v145,a137
v_accvgpr_read_b32 v146,a138
v_accvgpr_read_b32 v147,a139
v_accvgpr_read_b32 v148,a140
v_accvgpr_read_b32 v149,a141
v_accvgpr_read_b32 v150,a142
v_accvgpr_read_b32 v151,a143
v_rcp_f32 v156,v156
v_rcp_f32 v160,v160
v_rcp_f32 v164,v164
v_rcp_f32 v168,v168
buffer_load_dwordx4 v[20:23],v15,s[24:27],0 offen offset:2048 sc1
buffer_load_dwordx4 v[24:27],v15,s[24:27],0 offen offset:3072 sc1
buffer_load_dwordx4 v[28:31],v15,s[24:27],s68 offen sc1
v_add_u32 v252,9216,v18
v_add_u32 v253,5120,v15
buffer_load_dwordx4 v[32:35],v253,s[24:27],0 offen sc1
buffer_load_dwordx4 v[36:39],v253,s[24:27],0 offen offset:1024 sc1
buffer_load_dwordx4 v[40:43],v253,s[24:27],0 offen offset:2048 sc1
buffer_load_dwordx4 v[44:47],v253,s[24:27],0 offen offset:3072 sc1
buffer_load_dwordx4 v[48:51],v253,s[24:27],s68 offen sc1
s_waitcnt lgkmcnt(0)
s_barrier
ds_read_b64 v[174:175],v1 offset:0
ds_read_b128 v[112:115],v6 offset:0
ds_read_b128 v[116:119],v6 offset:1024
ds_read_b128 v[120:123],v6 offset:2048
ds_read_b128 v[124:127],v6 offset:3072
v_accvgpr_read_b32 v180,a0
v_accvgpr_read_b32 v181,a1
v_accvgpr_read_b32 v182,a2
v_accvgpr_read_b32 v183,a3
v_accvgpr_read_b32 v128,a16
v_accvgpr_read_b32 v129,a17
v_accvgpr_read_b32 v130,a18
v_accvgpr_read_b32 v131,a19
buffer_load_dwordx4 v[52:55],v18,s[20:23],s52 offen sc1
v_pk_mul_f32 v[180:181],v[180:181],v[156:157] op_sel_hi:[1,0]
v_pk_mul_f32 v[182:183],v[182:183],v[156:157] op_sel_hi:[1,0]
v_pk_mul_f32 v[128:129],v[128:129],v[156:157] op_sel_hi:[1,0]
v_pk_mul_f32 v[130:131],v[130:131],v[156:157] op_sel_hi:[1,0]
v_cvt_pk_bf16_f32 v180,v180,v181
v_cvt_pk_bf16_f32 v181,v182,v183
v_cvt_pk_bf16_f32 v182,v128,v129
v_cvt_pk_bf16_f32 v183,v130,v131
buffer_load_dwordx4 v[56:59],v252,s[20:23],s52 offen sc1
v_accvgpr_read_b32 v184,a4
v_accvgpr_read_b32 v185,a5
v_accvgpr_read_b32 v186,a6
v_accvgpr_read_b32 v187,a7
v_accvgpr_read_b32 v132,a20
v_accvgpr_read_b32 v133,a21
v_accvgpr_read_b32 v134,a22
v_accvgpr_read_b32 v135,a23
buffer_load_dwordx4 v[60:63],v18,s[20:23],s52 offen offset:1024 sc1
v_pk_mul_f32 v[184:185],v[184:185],v[160:161] op_sel_hi:[1,0]
v_pk_mul_f32 v[186:187],v[186:187],v[160:161] op_sel_hi:[1,0]
v_pk_mul_f32 v[132:133],v[132:133],v[160:161] op_sel_hi:[1,0]
v_pk_mul_f32 v[134:135],v[134:135],v[160:161] op_sel_hi:[1,0]
v_cvt_pk_bf16_f32 v184,v184,v185
v_cvt_pk_bf16_f32 v185,v186,v187
v_cvt_pk_bf16_f32 v186,v132,v133
v_cvt_pk_bf16_f32 v187,v134,v135
buffer_load_dwordx4 v[64:67],v252,s[20:23],s52 offen offset:1024 sc1
v_accvgpr_read_b32 v188,a8
v_accvgpr_read_b32 v189,a9
v_accvgpr_read_b32 v190,a10
v_accvgpr_read_b32 v191,a11
v_accvgpr_read_b32 v128,a24
v_accvgpr_read_b32 v129,a25
v_accvgpr_read_b32 v130,a26
v_accvgpr_read_b32 v131,a27
buffer_load_dwordx4 v[68:71],v18,s[20:23],s53 offen sc1
v_pk_mul_f32 v[188:189],v[188:189],v[164:165] op_sel_hi:[1,0]
v_pk_mul_f32 v[190:191],v[190:191],v[164:165] op_sel_hi:[1,0]
v_pk_mul_f32 v[128:129],v[128:129],v[164:165] op_sel_hi:[1,0]
v_pk_mul_f32 v[130:131],v[130:131],v[164:165] op_sel_hi:[1,0]
v_cvt_pk_bf16_f32 v188,v188,v189
v_cvt_pk_bf16_f32 v189,v190,v191
v_cvt_pk_bf16_f32 v190,v128,v129
v_cvt_pk_bf16_f32 v191,v130,v131
buffer_load_dwordx4 v[72:75],v252,s[20:23],s53 offen sc1
v_accvgpr_read_b32 v192,a12
v_accvgpr_read_b32 v193,a13
v_accvgpr_read_b32 v194,a14
v_accvgpr_read_b32 v195,a15
v_accvgpr_read_b32 v132,a28
v_accvgpr_read_b32 v133,a29
v_accvgpr_read_b32 v134,a30
v_accvgpr_read_b32 v135,a31
buffer_load_dwordx4 v[76:79],v18,s[20:23],s53 offen offset:1024 sc1
v_pk_mul_f32 v[192:193],v[192:193],v[168:169] op_sel_hi:[1,0]
v_pk_mul_f32 v[194:195],v[194:195],v[168:169] op_sel_hi:[1,0]
v_pk_mul_f32 v[132:133],v[132:133],v[168:169] op_sel_hi:[1,0]
v_pk_mul_f32 v[134:135],v[134:135],v[168:169] op_sel_hi:[1,0]
v_cvt_pk_bf16_f32 v192,v192,v193
v_cvt_pk_bf16_f32 v193,v194,v195
v_cvt_pk_bf16_f32 v194,v132,v133
v_cvt_pk_bf16_f32 v195,v134,v135
buffer_load_dwordx4 v[80:83],v252,s[20:23],s53 offen offset:1024 sc1
v_accvgpr_read_b32 v196,a32
v_accvgpr_read_b32 v197,a33
v_accvgpr_read_b32 v198,a34
v_accvgpr_read_b32 v199,a35
v_accvgpr_read_b32 v128,a48
v_accvgpr_read_b32 v129,a49
v_accvgpr_read_b32 v130,a50
v_accvgpr_read_b32 v131,a51
buffer_load_dwordx4 v[84:87],v18,s[20:23],s54 offen sc1
v_pk_mul_f32 v[196:197],v[196:197],v[156:157] op_sel_hi:[1,0]
v_pk_mul_f32 v[198:199],v[198:199],v[156:157] op_sel_hi:[1,0]
v_pk_mul_f32 v[128:129],v[128:129],v[156:157] op_sel_hi:[1,0]
v_pk_mul_f32 v[130:131],v[130:131],v[156:157] op_sel_hi:[1,0]
v_cvt_pk_bf16_f32 v196,v196,v197
v_cvt_pk_bf16_f32 v197,v198,v199
v_cvt_pk_bf16_f32 v198,v128,v129
v_cvt_pk_bf16_f32 v199,v130,v131
buffer_load_dwordx4 v[88:91],v252,s[20:23],s54 offen sc1
v_accvgpr_read_b32 v200,a36
v_accvgpr_read_b32 v201,a37
v_accvgpr_read_b32 v202,a38
v_accvgpr_read_b32 v203,a39
v_accvgpr_read_b32 v132,a52
v_accvgpr_read_b32 v133,a53
v_accvgpr_read_b32 v134,a54
v_accvgpr_read_b32 v135,a55
buffer_load_dwordx4 v[92:95],v18,s[20:23],s54 offen offset:1024 sc1
v_pk_mul_f32 v[200:201],v[200:201],v[160:161] op_sel_hi:[1,0]
v_pk_mul_f32 v[202:203],v[202:203],v[160:161] op_sel_hi:[1,0]
v_pk_mul_f32 v[132:133],v[132:133],v[160:161] op_sel_hi:[1,0]
v_pk_mul_f32 v[134:135],v[134:135],v[160:161] op_sel_hi:[1,0]
v_cvt_pk_bf16_f32 v200,v200,v201
v_cvt_pk_bf16_f32 v201,v202,v203
v_cvt_pk_bf16_f32 v202,v132,v133
v_cvt_pk_bf16_f32 v203,v134,v135
buffer_load_dwordx4 v[96:99],v252,s[20:23],s54 offen offset:1024 sc1
v_accvgpr_read_b32 v204,a40
v_accvgpr_read_b32 v205,a41
v_accvgpr_read_b32 v206,a42
v_accvgpr_read_b32 v207,a43
v_accvgpr_read_b32 v128,a56
v_accvgpr_read_b32 v129,a57
v_accvgpr_read_b32 v130,a58
v_accvgpr_read_b32 v131,a59
buffer_load_dwordx4 v[100:103],v18,s[20:23],s55 offen sc1
v_pk_mul_f32 v[204:205],v[204:205],v[164:165] op_sel_hi:[1,0]
v_pk_mul_f32 v[206:207],v[206:207],v[164:165] op_sel_hi:[1,0]
v_pk_mul_f32 v[128:129],v[128:129],v[164:165] op_sel_hi:[1,0]
v_pk_mul_f32 v[130:131],v[130:131],v[164:165] op_sel_hi:[1,0]
v_cvt_pk_bf16_f32 v204,v204,v205
v_cvt_pk_bf16_f32 v205,v206,v207
v_cvt_pk_bf16_f32 v206,v128,v129
v_cvt_pk_bf16_f32 v207,v130,v131
buffer_load_dwordx4 v[104:107],v252,s[20:23],s55 offen sc1
v_accvgpr_read_b32 v208,a44
v_accvgpr_read_b32 v209,a45
v_accvgpr_read_b32 v210,a46
v_accvgpr_read_b32 v211,a47
v_accvgpr_read_b32 v132,a60
v_accvgpr_read_b32 v133,a61
v_accvgpr_read_b32 v134,a62
v_accvgpr_read_b32 v135,a63
buffer_load_dwordx4 v[108:111],v18,s[20:23],s55 offen offset:1024 sc1
v_pk_mul_f32 v[208:209],v[208:209],v[168:169] op_sel_hi:[1,0]
v_pk_mul_f32 v[210:211],v[210:211],v[168:169] op_sel_hi:[1,0]
v_pk_mul_f32 v[132:133],v[132:133],v[168:169] op_sel_hi:[1,0]
v_pk_mul_f32 v[134:135],v[134:135],v[168:169] op_sel_hi:[1,0]
v_cvt_pk_bf16_f32 v208,v208,v209
v_cvt_pk_bf16_f32 v209,v210,v211
v_cvt_pk_bf16_f32 v210,v132,v133
v_cvt_pk_bf16_f32 v211,v134,v135
buffer_load_dwordx4 a[180:183],v252,s[20:23],s55 offen offset:1024 sc1
v_accvgpr_read_b32 v212,a64
v_accvgpr_read_b32 v213,a65
v_accvgpr_read_b32 v214,a66
v_accvgpr_read_b32 v215,a67
v_accvgpr_read_b32 v128,a80
v_accvgpr_read_b32 v129,a81
v_accvgpr_read_b32 v130,a82
v_accvgpr_read_b32 v131,a83
buffer_load_dwordx4 a[184:187],v18,s[20:23],s69 offen sc1
v_pk_mul_f32 v[212:213],v[212:213],v[156:157] op_sel_hi:[1,0]
v_pk_mul_f32 v[214:215],v[214:215],v[156:157] op_sel_hi:[1,0]
v_pk_mul_f32 v[128:129],v[128:129],v[156:157] op_sel_hi:[1,0]
v_pk_mul_f32 v[130:131],v[130:131],v[156:157] op_sel_hi:[1,0]
v_cvt_pk_bf16_f32 v212,v212,v213
v_cvt_pk_bf16_f32 v213,v214,v215
v_cvt_pk_bf16_f32 v214,v128,v129
v_cvt_pk_bf16_f32 v215,v130,v131
buffer_load_dwordx4 a[188:191],v252,s[20:23],s69 offen sc1
v_accvgpr_read_b32 v216,a68
v_accvgpr_read_b32 v217,a69
v_accvgpr_read_b32 v218,a70
v_accvgpr_read_b32 v219,a71
v_accvgpr_read_b32 v132,a84
v_accvgpr_read_b32 v133,a85
v_accvgpr_read_b32 v134,a86
v_accvgpr_read_b32 v135,a87
v_add_u32 v16,9216,v252
v_add_u32 v17,5120,v253
buffer_load_dwordx4 a[192:195],v17,s[24:27],0 offen sc1
v_pk_mul_f32 v[216:217],v[216:217],v[160:161] op_sel_hi:[1,0]
v_pk_mul_f32 v[218:219],v[218:219],v[160:161] op_sel_hi:[1,0]
v_pk_mul_f32 v[132:133],v[132:133],v[160:161] op_sel_hi:[1,0]
v_pk_mul_f32 v[134:135],v[134:135],v[160:161] op_sel_hi:[1,0]
v_cvt_pk_bf16_f32 v216,v216,v217
v_cvt_pk_bf16_f32 v217,v218,v219
v_cvt_pk_bf16_f32 v218,v132,v133
v_cvt_pk_bf16_f32 v219,v134,v135
buffer_load_dwordx4 a[196:199],v17,s[24:27],0 offen offset:1024 sc1
v_accvgpr_read_b32 v220,a72
v_accvgpr_read_b32 v221,a73
v_accvgpr_read_b32 v222,a74
v_accvgpr_read_b32 v223,a75
v_accvgpr_read_b32 v128,a88
v_accvgpr_read_b32 v129,a89
v_accvgpr_read_b32 v130,a90
v_accvgpr_read_b32 v131,a91
v_pk_mul_f32 v[220:221],v[220:221],v[164:165] op_sel_hi:[1,0]
v_pk_mul_f32 v[222:223],v[222:223],v[164:165] op_sel_hi:[1,0]
v_pk_mul_f32 v[128:129],v[128:129],v[164:165] op_sel_hi:[1,0]
v_pk_mul_f32 v[130:131],v[130:131],v[164:165] op_sel_hi:[1,0]
v_cvt_pk_bf16_f32 v220,v220,v221
v_cvt_pk_bf16_f32 v221,v222,v223
v_cvt_pk_bf16_f32 v222,v128,v129
v_cvt_pk_bf16_f32 v223,v130,v131
v_accvgpr_read_b32 v224,a76
v_accvgpr_read_b32 v225,a77
v_accvgpr_read_b32 v226,a78
v_accvgpr_read_b32 v227,a79
v_accvgpr_read_b32 v132,a92
v_accvgpr_read_b32 v133,a93
v_accvgpr_read_b32 v134,a94
v_accvgpr_read_b32 v135,a95
v_pk_mul_f32 v[224:225],v[224:225],v[168:169] op_sel_hi:[1,0]
v_pk_mul_f32 v[226:227],v[226:227],v[168:169] op_sel_hi:[1,0]
v_pk_mul_f32 v[132:133],v[132:133],v[168:169] op_sel_hi:[1,0]
v_pk_mul_f32 v[134:135],v[134:135],v[168:169] op_sel_hi:[1,0]
v_cvt_pk_bf16_f32 v224,v224,v225
v_cvt_pk_bf16_f32 v225,v226,v227
v_cvt_pk_bf16_f32 v226,v132,v133
v_cvt_pk_bf16_f32 v227,v134,v135
v_accvgpr_read_b32 v228,a96
v_accvgpr_read_b32 v229,a97
v_accvgpr_read_b32 v230,a98
v_accvgpr_read_b32 v231,a99
v_accvgpr_read_b32 v128,a112
v_accvgpr_read_b32 v129,a113
v_accvgpr_read_b32 v130,a114
v_accvgpr_read_b32 v131,a115
v_pk_mul_f32 v[228:229],v[228:229],v[156:157] op_sel_hi:[1,0]
v_pk_mul_f32 v[230:231],v[230:231],v[156:157] op_sel_hi:[1,0]
v_pk_mul_f32 v[128:129],v[128:129],v[156:157] op_sel_hi:[1,0]
v_pk_mul_f32 v[130:131],v[130:131],v[156:157] op_sel_hi:[1,0]
v_cvt_pk_bf16_f32 v228,v228,v229
v_cvt_pk_bf16_f32 v229,v230,v231
v_cvt_pk_bf16_f32 v230,v128,v129
v_cvt_pk_bf16_f32 v231,v130,v131
v_accvgpr_read_b32 v232,a100
v_accvgpr_read_b32 v233,a101
v_accvgpr_read_b32 v234,a102
v_accvgpr_read_b32 v235,a103
v_accvgpr_read_b32 v132,a116
v_accvgpr_read_b32 v133,a117
v_accvgpr_read_b32 v134,a118
v_accvgpr_read_b32 v135,a119
v_pk_mul_f32 v[232:233],v[232:233],v[160:161] op_sel_hi:[1,0]
v_pk_mul_f32 v[234:235],v[234:235],v[160:161] op_sel_hi:[1,0]
v_pk_mul_f32 v[132:133],v[132:133],v[160:161] op_sel_hi:[1,0]
v_pk_mul_f32 v[134:135],v[134:135],v[160:161] op_sel_hi:[1,0]
v_cvt_pk_bf16_f32 v232,v232,v233
v_cvt_pk_bf16_f32 v233,v234,v235
v_cvt_pk_bf16_f32 v234,v132,v133
v_cvt_pk_bf16_f32 v235,v134,v135
v_accvgpr_read_b32 v236,a104
v_accvgpr_read_b32 v237,a105
v_accvgpr_read_b32 v238,a106
v_accvgpr_read_b32 v239,a107
v_accvgpr_read_b32 v128,a120
v_accvgpr_read_b32 v129,a121
v_accvgpr_read_b32 v130,a122
v_accvgpr_read_b32 v131,a123
v_pk_mul_f32 v[236:237],v[236:237],v[164:165] op_sel_hi:[1,0]
v_pk_mul_f32 v[238:239],v[238:239],v[164:165] op_sel_hi:[1,0]
v_pk_mul_f32 v[128:129],v[128:129],v[164:165] op_sel_hi:[1,0]
v_pk_mul_f32 v[130:131],v[130:131],v[164:165] op_sel_hi:[1,0]
v_cvt_pk_bf16_f32 v236,v236,v237
v_cvt_pk_bf16_f32 v237,v238,v239
v_cvt_pk_bf16_f32 v238,v128,v129
v_cvt_pk_bf16_f32 v239,v130,v131
v_accvgpr_read_b32 v240,a108
v_accvgpr_read_b32 v241,a109
v_accvgpr_read_b32 v242,a110
v_accvgpr_read_b32 v243,a111
v_accvgpr_read_b32 v132,a124
v_accvgpr_read_b32 v133,a125
v_accvgpr_read_b32 v134,a126
v_accvgpr_read_b32 v135,a127
v_pk_mul_f32 v[240:241],v[240:241],v[168:169] op_sel_hi:[1,0]
v_pk_mul_f32 v[242:243],v[242:243],v[168:169] op_sel_hi:[1,0]
v_pk_mul_f32 v[132:133],v[132:133],v[168:169] op_sel_hi:[1,0]
v_pk_mul_f32 v[134:135],v[134:135],v[168:169] op_sel_hi:[1,0]
v_cvt_pk_bf16_f32 v240,v240,v241
v_cvt_pk_bf16_f32 v241,v242,v243
v_cvt_pk_bf16_f32 v242,v132,v133
v_cvt_pk_bf16_f32 v243,v134,v135
s_waitcnt lgkmcnt(4)
v_min_f32 v4,v152,v174
v_sub_f32 v152,v4,v152
v_sub_f32 v174,v4,v174
v_exp_f32 v152,v152
v_exp_f32 v174,v174
v_mul_f32 v5,v152,v153
v_fmac_f32 v5,v174,v175
v_rcp_f32 v5,v5
s_nop 0
v_mul_f32 v152,v152,v5
v_mul_f32 v174,v174,v5
v_mul_f32 v136,v136,v152
v_mul_f32 v137,v137,v152
v_mul_f32 v138,v138,v152
v_mul_f32 v139,v139,v152
v_mul_f32 v140,v140,v152
v_mul_f32 v141,v141,v152
v_mul_f32 v142,v142,v152
v_mul_f32 v143,v143,v152
v_mul_f32 v144,v144,v152
v_mul_f32 v145,v145,v152
v_mul_f32 v146,v146,v152
v_mul_f32 v147,v147,v152
v_mul_f32 v148,v148,v152
v_mul_f32 v149,v149,v152
v_mul_f32 v150,v150,v152
v_mul_f32 v151,v151,v152
s_waitcnt lgkmcnt(3)
v_fmac_f32 v136,v112,v174
v_fmac_f32 v137,v113,v174
v_fmac_f32 v138,v114,v174
v_fmac_f32 v139,v115,v174
s_waitcnt lgkmcnt(2)
v_fmac_f32 v140,v116,v174
v_fmac_f32 v141,v117,v174
v_fmac_f32 v142,v118,v174
v_fmac_f32 v143,v119,v174
s_waitcnt lgkmcnt(1)
v_fmac_f32 v144,v120,v174
v_fmac_f32 v145,v121,v174
v_fmac_f32 v146,v122,v174
v_fmac_f32 v147,v123,v174
s_waitcnt lgkmcnt(0)
v_fmac_f32 v148,v124,v174
v_fmac_f32 v149,v125,v174
v_fmac_f32 v150,v126,v174
v_fmac_f32 v151,v127,v174
v_cvt_pk_bf16_f32 v244,v136,v137
v_cvt_pk_bf16_f32 v245,v138,v139
v_cvt_pk_bf16_f32 v246,v140,v141
v_cvt_pk_bf16_f32 v247,v142,v143
v_cvt_pk_bf16_f32 v248,v144,v145
v_cvt_pk_bf16_f32 v249,v146,v147
v_cvt_pk_bf16_f32 v250,v148,v149
v_cvt_pk_bf16_f32 v251,v150,v151
s_mul_i32 s57,s82,36864
s_add_u32 s57,s57,65536
s_add_u32 s59,s57,s90
v_add_u32 v6,s59,v10
s_add_u32 s59,s57,s86
v_add_u32 v7,s59,v10
s_add_u32 s59,s57,s89
v_add_u32 v8,s59,v10
s_mul_i32 s59,s49,184320
s_add_u32 s28,s14,s59
s_addc_u32 s29,s15,0
s_mov_b32 s30,184320
s_waitcnt vmcnt(52)
v_mfma_f32_16x16x32_bf16 a[0:3],a[200:203],a[220:223],0
v_mfma_f32_16x16x32_bf16 a[4:7],a[204:207],a[220:223],0
s_add_u32 s58,s90,589824
buffer_store_dwordx4 v[180:183],v10,s[36:39],s58 offen offset:0
ds_write_b128 v6,v[180:183] offset:0
v_mfma_f32_16x16x32_bf16 a[8:11],a[208:211],a[220:223],0
v_mfma_f32_16x16x32_bf16 a[12:15],a[212:215],a[220:223],0
s_add_u32 s58,s90,589824
buffer_store_dwordx4 v[184:187],v10,s[36:39],s58 offen offset:1024
ds_write_b128 v6,v[184:187] offset:1024
v_mfma_f32_16x16x32_bf16 a[16:19],a[216:219],a[220:223],0
s_waitcnt vmcnt(53)
v_mfma_f32_16x16x32_bf16 a[36:39],a[216:219],a[224:227],0
s_waitcnt vmcnt(45)
ds_read_b128 v[112:115],v12 offset:0
s_add_u32 s58,s90,589824
buffer_store_dwordx4 v[188:191],v10,s[36:39],s58 offen offset:2048
ds_write_b128 v6,v[188:191] offset:2048
v_mfma_f32_16x16x32_bf16 a[32:35],a[212:215],a[224:227],0
v_mfma_f32_16x16x32_bf16 a[28:31],a[208:211],a[224:227],0
s_add_u32 s58,s90,589824
buffer_store_dwordx4 v[192:195],v10,s[36:39],s58 offen offset:3072
ds_write_b128 v6,v[192:195] offset:3072
v_mfma_f32_16x16x32_bf16 a[24:27],a[204:207],a[224:227],0
v_mfma_f32_16x16x32_bf16 a[20:23],a[200:203],a[224:227],0
s_add_u32 s58,s90,599040
buffer_store_dwordx4 v[196:199],v10,s[36:39],s58 offen offset:0
ds_write_b128 v6,v[196:199] offset:9216
v_mfma_f32_16x16x32_bf16 a[40:43],a[200:203],a[228:231],0
s_waitcnt vmcnt(47)
ds_read_b128 v[116:119],v12 offset:1024
v_mfma_f32_16x16x32_bf16 a[44:47],a[204:207],a[228:231],0
s_add_u32 s58,s90,599040
buffer_store_dwordx4 v[200:203],v10,s[36:39],s58 offen offset:1024
ds_write_b128 v6,v[200:203] offset:10240
v_mfma_f32_16x16x32_bf16 a[48:51],a[208:211],a[228:231],0
v_mfma_f32_16x16x32_bf16 a[52:55],a[212:215],a[228:231],0
buffer_load_dwordx4 v[120:123],v17,s[24:27],0 offen offset:2048 sc1
v_mfma_f32_16x16x32_bf16 a[56:59],a[216:219],a[228:231],0
v_mfma_f32_16x16x32_bf16 a[76:79],a[216:219],a[232:235],0
s_waitcnt vmcnt(48)
ds_read_b128 v[124:127],v12 offset:2048
buffer_load_dwordx4 v[128:131],v17,s[24:27],0 offen offset:3072 sc1
v_mfma_f32_16x16x32_bf16 a[72:75],a[212:215],a[232:235],0
v_mfma_f32_16x16x32_bf16 a[68:71],a[208:211],a[232:235],0
buffer_load_dwordx4 v[132:135],v17,s[24:27],s68 offen sc1
v_mfma_f32_16x16x32_bf16 a[64:67],a[204:207],a[232:235],0
v_mfma_f32_16x16x32_bf16 a[60:63],a[200:203],a[232:235],0
v_add_u32 v18,9216,v16
v_add_u32 v15,5120,v17
buffer_load_dwordx4 v[136:139],v15,s[24:27],0 offen sc1
v_mfma_f32_16x16x32_bf16 a[80:83],a[200:203],a[236:239],0
s_waitcnt vmcnt(50)
ds_read_b128 v[140:143],v12 offset:3072
v_mfma_f32_16x16x32_bf16 a[84:87],a[204:207],a[236:239],0
buffer_load_dwordx4 v[144:147],v15,s[24:27],0 offen offset:1024 sc1
v_mfma_f32_16x16x32_bf16 a[88:91],a[208:211],a[236:239],0
v_mfma_f32_16x16x32_bf16 a[92:95],a[212:215],a[236:239],0
buffer_load_dwordx4 v[148:151],v15,s[24:27],0 offen offset:2048 sc1
v_mfma_f32_16x16x32_bf16 a[96:99],a[216:219],a[236:239],0
v_mfma_f32_16x16x32_bf16 a[116:119],a[216:219],a[240:243],0
s_waitcnt vmcnt(51)
ds_read_b128 v[152:155],v12 offset:4096
buffer_load_dwordx4 v[156:159],v15,s[24:27],0 offen offset:3072 sc1
v_mfma_f32_16x16x32_bf16 a[112:115],a[212:215],a[240:243],0
v_mfma_f32_16x16x32_bf16 a[108:111],a[208:211],a[240:243],0
buffer_load_dwordx4 v[160:163],v15,s[24:27],s68 offen sc1
v_mfma_f32_16x16x32_bf16 a[104:107],a[204:207],a[240:243],0
v_mfma_f32_16x16x32_bf16 a[100:103],a[200:203],a[240:243],0
buffer_load_dwordx4 v[164:167],v16,s[20:23],s52 offen sc1
v_mfma_f32_16x16x32_bf16 a[120:123],a[200:203],a[244:247],0
s_waitcnt vmcnt(53)
ds_read_b128 v[168:171],v12 offset:5120
v_mfma_f32_16x16x32_bf16 a[124:127],a[204:207],a[244:247],0
v_mfma_f32_16x16x32_bf16 a[128:131],a[208:211],a[244:247],0
v_mfma_f32_16x16x32_bf16 a[132:135],a[212:215],a[244:247],0
v_mfma_f32_16x16x32_bf16 a[136:139],a[216:219],a[244:247],0
buffer_load_dwordx4 v[172:175],v18,s[20:23],s52 offen sc1
v_mfma_f32_16x16x32_bf16 a[156:159],a[216:219],a[248:251],0
s_waitcnt vmcnt(53)
ds_read_b128 v[176:179],v12 offset:6144
v_mfma_f32_16x16x32_bf16 a[152:155],a[212:215],a[248:251],0
v_mfma_f32_16x16x32_bf16 a[148:151],a[208:211],a[248:251],0
v_mfma_f32_16x16x32_bf16 a[144:147],a[204:207],a[248:251],0
v_mfma_f32_16x16x32_bf16 a[140:143],a[200:203],a[248:251],0
v_mfma_f32_16x16x32_bf16 a[160:163],a[200:203],a[252:255],0
s_waitcnt vmcnt(52)
ds_read_b128 a[220:223],v12 offset:7168
v_mfma_f32_16x16x32_bf16 a[164:167],a[204:207],a[252:255],0
buffer_load_dwordx4 a[224:227],v16,s[20:23],s52 offen offset:1024 sc1
v_mfma_f32_16x16x32_bf16 a[168:171],a[208:211],a[252:255],0
v_mfma_f32_16x16x32_bf16 a[172:175],a[212:215],a[252:255],0
buffer_load_dwordx4 a[228:231],v18,s[20:23],s52 offen offset:1024 sc1
v_mfma_f32_16x16x32_bf16 a[176:179],a[216:219],a[252:255],0
s_waitcnt lgkmcnt(2)
v_mfma_f32_16x16x32_bf16 a[0:3],v[112:115],v[168:171],a[0:3]
s_waitcnt vmcnt(53)
ds_read_b128 a[232:235],v12 offset:32768
s_add_u32 s58,s90,599040
buffer_store_dwordx4 v[204:207],v10,s[36:39],s58 offen offset:2048
ds_write_b128 v6,v[204:207] offset:11264
v_mfma_f32_16x16x32_bf16 a[4:7],v[116:119],v[168:171],a[4:7]
s_waitcnt vmcnt(53)
ds_read_b128 a[236:239],v12 offset:33792
v_mfma_f32_16x16x32_bf16 a[8:11],v[124:127],v[168:171],a[8:11]
s_waitcnt vmcnt(52)
ds_read_b128 a[240:243],v12 offset:34816
s_add_u32 s58,s90,599040
buffer_store_dwordx4 v[208:211],v10,s[36:39],s58 offen offset:3072
ds_write_b128 v6,v[208:211] offset:12288
v_mfma_f32_16x16x32_bf16 a[12:15],v[140:143],v[168:171],a[12:15]
s_waitcnt vmcnt(52)
ds_read_b128 a[244:247],v12 offset:35840
v_mfma_f32_16x16x32_bf16 a[16:19],v[152:155],v[168:171],a[16:19]
s_waitcnt vmcnt(51)
ds_read_b128 a[248:251],v12 offset:36864
s_add_u32 s58,s86,589824
buffer_store_dwordx4 v[212:215],v10,s[36:39],s58 offen offset:0
ds_write_b128 v7,v[212:215] offset:0
s_waitcnt lgkmcnt(9)
v_mfma_f32_16x16x32_bf16 a[36:39],v[152:155],v[176:179],a[36:39]
s_waitcnt vmcnt(51)
ds_read_b128 a[200:203],v12 offset:37888
v_mfma_f32_16x16x32_bf16 a[32:35],v[140:143],v[176:179],a[32:35]
s_waitcnt vmcnt(50)
ds_read_b128 a[204:207],v12 offset:38912
s_add_u32 s58,s86,589824
buffer_store_dwordx4 v[216:219],v10,s[36:39],s58 offen offset:1024
ds_write_b128 v7,v[216:219] offset:1024
v_mfma_f32_16x16x32_bf16 a[28:31],v[124:127],v[176:179],a[28:31]
v_mfma_f32_16x16x32_bf16 a[24:27],v[116:119],v[176:179],a[24:27]
s_add_u32 s58,s86,589824
buffer_store_dwordx4 v[220:223],v10,s[36:39],s58 offen offset:2048
ds_write_b128 v7,v[220:223] offset:2048
v_mfma_f32_16x16x32_bf16 a[20:23],v[112:115],v[176:179],a[20:23]
s_waitcnt lgkmcnt(12)
v_mfma_f32_16x16x32_bf16 a[40:43],v[112:115],a[220:223],a[40:43]
s_waitcnt vmcnt(51)
ds_read_b128 a[208:211],v12 offset:39936
s_add_u32 s58,s86,589824
buffer_store_dwordx4 v[224:227],v10,s[36:39],s58 offen offset:3072
ds_write_b128 v7,v[224:227] offset:3072
v_mfma_f32_16x16x32_bf16 a[44:47],v[116:119],a[220:223],a[44:47]
v_mfma_f32_16x16x32_bf16 a[48:51],v[124:127],a[220:223],a[48:51]
buffer_load_dwordx4 a[212:215],v16,s[20:23],s53 offen sc1
v_mfma_f32_16x16x32_bf16 a[52:55],v[140:143],a[220:223],a[52:55]
v_mfma_f32_16x16x32_bf16 a[56:59],v[152:155],a[220:223],a[56:59]
buffer_load_dwordx4 a[216:219],v18,s[20:23],s53 offen sc1
s_waitcnt lgkmcnt(13)
v_mfma_f32_16x16x32_bf16 a[76:79],v[152:155],a[232:235],a[76:79]
v_mfma_f32_16x16x32_bf16 a[72:75],v[140:143],a[232:235],a[72:75]
buffer_load_dwordx4 a[252:255],v16,s[20:23],s53 offen offset:1024 sc1
v_mfma_f32_16x16x32_bf16 a[68:71],v[124:127],a[232:235],a[68:71]
v_mfma_f32_16x16x32_bf16 a[64:67],v[116:119],a[232:235],a[64:67]
buffer_load_dwordx4 v[168:171],v18,s[20:23],s53 offen offset:1024 sc1
v_mfma_f32_16x16x32_bf16 a[60:63],v[112:115],a[232:235],a[60:63]
s_waitcnt lgkmcnt(11)
v_mfma_f32_16x16x32_bf16 a[80:83],v[112:115],a[236:239],a[80:83]
buffer_load_dwordx4 v[176:179],v16,s[20:23],s54 offen sc1
v_mfma_f32_16x16x32_bf16 a[84:87],v[116:119],a[236:239],a[84:87]
v_mfma_f32_16x16x32_bf16 a[88:91],v[124:127],a[236:239],a[88:91]
buffer_load_dwordx4 a[220:223],v18,s[20:23],s54 offen sc1
v_mfma_f32_16x16x32_bf16 a[92:95],v[140:143],a[236:239],a[92:95]
v_mfma_f32_16x16x32_bf16 a[96:99],v[152:155],a[236:239],a[96:99]
buffer_load_dwordx4 a[232:235],v16,s[20:23],s54 offen offset:1024 sc1
s_waitcnt lgkmcnt(10)
v_mfma_f32_16x16x32_bf16 a[116:119],v[152:155],a[240:243],a[116:119]
v_mfma_f32_16x16x32_bf16 a[112:115],v[140:143],a[240:243],a[112:115]
buffer_load_dwordx4 a[236:239],v18,s[20:23],s54 offen offset:1024 sc1
v_mfma_f32_16x16x32_bf16 a[108:111],v[124:127],a[240:243],a[108:111]
v_mfma_f32_16x16x32_bf16 a[104:107],v[116:119],a[240:243],a[104:107]
v_mfma_f32_16x16x32_bf16 a[100:103],v[112:115],a[240:243],a[100:103]
s_waitcnt lgkmcnt(8)
v_mfma_f32_16x16x32_bf16 a[120:123],v[112:115],a[244:247],a[120:123]
v_mfma_f32_16x16x32_bf16 a[124:127],v[116:119],a[244:247],a[124:127]
v_mfma_f32_16x16x32_bf16 a[128:131],v[124:127],a[244:247],a[128:131]
v_mfma_f32_16x16x32_bf16 a[132:135],v[140:143],a[244:247],a[132:135]
v_mfma_f32_16x16x32_bf16 a[136:139],v[152:155],a[244:247],a[136:139]
s_waitcnt lgkmcnt(7)
v_mfma_f32_16x16x32_bf16 a[156:159],v[152:155],a[248:251],a[156:159]
v_mfma_f32_16x16x32_bf16 a[152:155],v[140:143],a[248:251],a[152:155]
v_mfma_f32_16x16x32_bf16 a[148:151],v[124:127],a[248:251],a[148:151]
v_mfma_f32_16x16x32_bf16 a[144:147],v[116:119],a[248:251],a[144:147]
v_mfma_f32_16x16x32_bf16 a[140:143],v[112:115],a[248:251],a[140:143]
s_waitcnt lgkmcnt(5)
v_mfma_f32_16x16x32_bf16 a[160:163],v[112:115],a[200:203],a[160:163]
v_mfma_f32_16x16x32_bf16 a[164:167],v[116:119],a[200:203],a[164:167]
v_mfma_f32_16x16x32_bf16 a[168:171],v[124:127],a[200:203],a[168:171]
v_mfma_f32_16x16x32_bf16 a[172:175],v[140:143],a[200:203],a[172:175]
v_mfma_f32_16x16x32_bf16 a[176:179],v[152:155],a[200:203],a[176:179]
s_waitcnt vmcnt(51) lgkmcnt(4)
v_mfma_f32_16x16x32_bf16 a[0:3],a[204:207],v[52:55],a[0:3]
s_add_u32 s58,s86,599040
buffer_store_dwordx4 v[228:231],v10,s[36:39],s58 offen offset:0
ds_write_b128 v7,v[228:231] offset:9216
s_waitcnt vmcnt(51)
v_mfma_f32_16x16x32_bf16 a[0:3],v[32:35],v[56:59],a[0:3]
v_mfma_f32_16x16x32_bf16 a[4:7],v[36:39],v[56:59],a[4:7]
s_add_u32 s58,s86,599040
buffer_store_dwordx4 v[232:235],v10,s[36:39],s58 offen offset:1024
ds_write_b128 v7,v[232:235] offset:10240
s_waitcnt lgkmcnt(3)
v_mfma_f32_16x16x32_bf16 a[4:7],a[208:211],v[52:55],a[4:7]
v_mfma_f32_16x16x32_bf16 a[8:11],v[20:23],v[52:55],a[8:11]
s_add_u32 s58,s86,599040
buffer_store_dwordx4 v[236:239],v10,s[36:39],s58 offen offset:2048
ds_write_b128 v7,v[236:239] offset:11264
v_mfma_f32_16x16x32_bf16 a[8:11],v[40:43],v[56:59],a[8:11]
v_mfma_f32_16x16x32_bf16 a[12:15],v[44:47],v[56:59],a[12:15]
s_add_u32 s58,s86,599040
buffer_store_dwordx4 v[240:243],v10,s[36:39],s58 offen offset:3072
ds_write_b128 v7,v[240:243] offset:12288
v_mfma_f32_16x16x32_bf16 a[12:15],v[24:27],v[52:55],a[12:15]
v_mfma_f32_16x16x32_bf16 a[16:19],v[28:31],v[52:55],a[16:19]
s_add_u32 s58,s89,589824
buffer_store_dwordx4 v[244:247],v10,s[36:39],s58 offen offset:0
ds_write_b128 v8,v[244:247] offset:0
v_mfma_f32_16x16x32_bf16 a[16:19],v[48:51],v[56:59],a[16:19]
s_waitcnt vmcnt(53)
v_mfma_f32_16x16x32_bf16 a[36:39],v[48:51],v[64:67],a[36:39]
s_add_u32 s58,s89,599040
buffer_store_dwordx4 v[248:251],v10,s[36:39],s58 offen offset:0
ds_write_b128 v8,v[248:251] offset:9216
v_mfma_f32_16x16x32_bf16 a[36:39],v[28:31],v[60:63],a[36:39]
v_mfma_f32_16x16x32_bf16 a[32:35],v[24:27],v[60:63],a[32:35]
buffer_load_dwordx4 a[240:243],v16,s[20:23],s55 offen sc1
v_mfma_f32_16x16x32_bf16 a[32:35],v[44:47],v[64:67],a[32:35]
v_mfma_f32_16x16x32_bf16 a[28:31],v[40:43],v[64:67],a[28:31]
buffer_load_dwordx4 a[244:247],v18,s[20:23],s55 offen sc1
v_mfma_f32_16x16x32_bf16 a[28:31],v[20:23],v[60:63],a[28:31]
v_mfma_f32_16x16x32_bf16 a[24:27],a[208:211],v[60:63],a[24:27]
buffer_load_dwordx4 a[248:251],v16,s[20:23],s55 offen offset:1024 sc1
v_mfma_f32_16x16x32_bf16 a[24:27],v[36:39],v[64:67],a[24:27]
v_mfma_f32_16x16x32_bf16 a[20:23],v[32:35],v[64:67],a[20:23]
buffer_load_dwordx4 v[112:115],v18,s[20:23],s55 offen offset:1024 sc1
v_mfma_f32_16x16x32_bf16 a[20:23],a[204:207],v[60:63],a[20:23]
s_waitcnt vmcnt(57)
v_mfma_f32_16x16x32_bf16 a[40:43],a[204:207],v[68:71],a[40:43]
buffer_load_dwordx4 v[116:119],v16,s[20:23],s69 offen sc1
s_waitcnt vmcnt(57)
v_mfma_f32_16x16x32_bf16 a[40:43],v[32:35],v[72:75],a[40:43]
v_mfma_f32_16x16x32_bf16 a[44:47],v[36:39],v[72:75],a[44:47]
buffer_load_dwordx4 v[124:127],v18,s[20:23],s69 offen sc1
v_mfma_f32_16x16x32_bf16 a[44:47],a[208:211],v[68:71],a[44:47]
v_mfma_f32_16x16x32_bf16 a[48:51],v[20:23],v[68:71],a[48:51]
v_add_u32 v252,9216,v18
v_add_u32 v253,5120,v15
buffer_load_dwordx4 v[140:143],v253,s[24:27],0 offen sc1
v_mfma_f32_16x16x32_bf16 a[48:51],v[40:43],v[72:75],a[48:51]
v_mfma_f32_16x16x32_bf16 a[52:55],v[44:47],v[72:75],a[52:55]
buffer_load_dwordx4 v[152:155],v253,s[24:27],0 offen offset:1024 sc1
v_mfma_f32_16x16x32_bf16 a[52:55],v[24:27],v[68:71],a[52:55]
v_mfma_f32_16x16x32_bf16 a[56:59],v[28:31],v[68:71],a[56:59]
v_mfma_f32_16x16x32_bf16 a[56:59],v[48:51],v[72:75],a[56:59]
s_waitcnt vmcnt(58)
v_mfma_f32_16x16x32_bf16 a[76:79],v[48:51],v[80:83],a[76:79]
buffer_load_dwordx4 a[200:203],v253,s[24:27],0 offen offset:2048 sc1
v_mfma_f32_16x16x32_bf16 a[76:79],v[28:31],v[76:79],a[76:79]
v_mfma_f32_16x16x32_bf16 a[72:75],v[24:27],v[76:79],a[72:75]
buffer_load_dwordx4 v[52:55],v253,s[24:27],0 offen offset:3072 sc1
v_mfma_f32_16x16x32_bf16 a[72:75],v[44:47],v[80:83],a[72:75]
v_mfma_f32_16x16x32_bf16 a[68:71],v[40:43],v[80:83],a[68:71]
v_mfma_f32_16x16x32_bf16 a[68:71],v[20:23],v[76:79],a[68:71]
v_mfma_f32_16x16x32_bf16 a[64:67],a[208:211],v[76:79],a[64:67]
v_mfma_f32_16x16x32_bf16 a[64:67],v[36:39],v[80:83],a[64:67]
v_mfma_f32_16x16x32_bf16 a[60:63],v[32:35],v[80:83],a[60:63]
v_mfma_f32_16x16x32_bf16 a[60:63],a[204:207],v[76:79],a[60:63]
s_waitcnt vmcnt(59)
v_mfma_f32_16x16x32_bf16 a[80:83],a[204:207],v[84:87],a[80:83]
buffer_load_dwordx4 v[56:59],v253,s[24:27],s68 offen sc1
s_waitcnt vmcnt(59)
v_mfma_f32_16x16x32_bf16 a[80:83],v[32:35],v[88:91],a[80:83]
v_mfma_f32_16x16x32_bf16 a[84:87],v[36:39],v[88:91],a[84:87]
v_add_u32 v16,9216,v252
v_add_u32 v17,5120,v253
buffer_load_dwordx4 v[64:67],v17,s[24:27],0 offen sc1
v_mfma_f32_16x16x32_bf16 a[84:87],a[208:211],v[84:87],a[84:87]
v_mfma_f32_16x16x32_bf16 a[88:91],v[20:23],v[84:87],a[88:91]
v_mfma_f32_16x16x32_bf16 a[88:91],v[40:43],v[88:91],a[88:91]
v_mfma_f32_16x16x32_bf16 a[92:95],v[44:47],v[88:91],a[92:95]
v_mfma_f32_16x16x32_bf16 a[92:95],v[24:27],v[84:87],a[92:95]
v_mfma_f32_16x16x32_bf16 a[96:99],v[28:31],v[84:87],a[96:99]
v_mfma_f32_16x16x32_bf16 a[96:99],v[48:51],v[88:91],a[96:99]
s_waitcnt vmcnt(58)
v_mfma_f32_16x16x32_bf16 a[116:119],v[48:51],v[96:99],a[116:119]
buffer_load_dwordx4 v[60:63],v17,s[24:27],0 offen offset:1024 sc1
v_mfma_f32_16x16x32_bf16 a[116:119],v[28:31],v[92:95],a[116:119]
v_mfma_f32_16x16x32_bf16 a[112:115],v[24:27],v[92:95],a[112:115]
buffer_load_dwordx4 v[68:71],v17,s[24:27],0 offen offset:2048 sc1
v_mfma_f32_16x16x32_bf16 a[112:115],v[44:47],v[96:99],a[112:115]
v_mfma_f32_16x16x32_bf16 a[108:111],v[40:43],v[96:99],a[108:111]
v_mfma_f32_16x16x32_bf16 a[108:111],v[20:23],v[92:95],a[108:111]
v_mfma_f32_16x16x32_bf16 a[104:107],a[208:211],v[92:95],a[104:107]
v_mfma_f32_16x16x32_bf16 a[104:107],v[36:39],v[96:99],a[104:107]
v_mfma_f32_16x16x32_bf16 a[100:103],v[32:35],v[96:99],a[100:103]
v_mfma_f32_16x16x32_bf16 a[100:103],a[204:207],v[92:95],a[100:103]
s_waitcnt vmcnt(59)
v_mfma_f32_16x16x32_bf16 a[120:123],a[204:207],v[100:103],a[120:123]
buffer_load_dwordx4 v[72:75],v17,s[24:27],0 offen offset:3072 sc1
s_waitcnt vmcnt(59)
v_mfma_f32_16x16x32_bf16 a[120:123],v[32:35],v[104:107],a[120:123]
v_mfma_f32_16x16x32_bf16 a[124:127],v[36:39],v[104:107],a[124:127]
buffer_load_dwordx4 v[80:83],v17,s[24:27],s68 offen sc1
v_mfma_f32_16x16x32_bf16 a[124:127],a[208:211],v[100:103],a[124:127]
v_mfma_f32_16x16x32_bf16 a[128:131],v[20:23],v[100:103],a[128:131]
v_mfma_f32_16x16x32_bf16 a[128:131],v[40:43],v[104:107],a[128:131]
v_mfma_f32_16x16x32_bf16 a[132:135],v[44:47],v[104:107],a[132:135]
v_mfma_f32_16x16x32_bf16 a[132:135],v[24:27],v[100:103],a[132:135]
v_mfma_f32_16x16x32_bf16 a[136:139],v[28:31],v[100:103],a[136:139]
v_mfma_f32_16x16x32_bf16 a[136:139],v[48:51],v[104:107],a[136:139]
s_waitcnt vmcnt(58)
v_mfma_f32_16x16x32_bf16 a[156:159],v[48:51],a[180:183],a[156:159]
buffer_load_dwordx4 v[76:79],v252,s[20:23],s52 offen sc1
v_mfma_f32_16x16x32_bf16 a[156:159],v[28:31],v[108:111],a[156:159]
v_mfma_f32_16x16x32_bf16 a[152:155],v[24:27],v[108:111],a[152:155]
buffer_load_dwordx4 v[84:87],v16,s[20:23],s52 offen sc1
v_mfma_f32_16x16x32_bf16 a[152:155],v[44:47],a[180:183],a[152:155]
v_mfma_f32_16x16x32_bf16 a[148:151],v[40:43],a[180:183],a[148:151]
v_mfma_f32_16x16x32_bf16 a[148:151],v[20:23],v[108:111],a[148:151]
v_mfma_f32_16x16x32_bf16 a[144:147],a[208:211],v[108:111],a[144:147]
v_mfma_f32_16x16x32_bf16 a[144:147],v[36:39],a[180:183],a[144:147]
v_mfma_f32_16x16x32_bf16 a[140:143],v[32:35],a[180:183],a[140:143]
v_mfma_f32_16x16x32_bf16 a[140:143],a[204:207],v[108:111],a[140:143]
s_waitcnt vmcnt(59)
v_mfma_f32_16x16x32_bf16 a[160:163],a[204:207],a[184:187],a[160:163]
buffer_load_dwordx4 v[88:91],v252,s[20:23],s52 offen offset:1024 sc1
s_waitcnt vmcnt(59)
v_mfma_f32_16x16x32_bf16 a[160:163],v[32:35],a[188:191],a[160:163]
v_mfma_f32_16x16x32_bf16 a[164:167],v[36:39],a[188:191],a[164:167]
buffer_load_dwordx4 v[96:99],v16,s[20:23],s52 offen offset:1024 sc1
v_mfma_f32_16x16x32_bf16 a[164:167],a[208:211],a[184:187],a[164:167]
v_mfma_f32_16x16x32_bf16 a[168:171],v[20:23],a[184:187],a[168:171]
v_mfma_f32_16x16x32_bf16 a[168:171],v[40:43],a[188:191],a[168:171]
v_mfma_f32_16x16x32_bf16 a[172:175],v[44:47],a[188:191],a[172:175]
v_mfma_f32_16x16x32_bf16 a[172:175],v[24:27],a[184:187],a[172:175]
v_mfma_f32_16x16x32_bf16 a[176:179],v[28:31],a[184:187],a[176:179]
v_mfma_f32_16x16x32_bf16 a[176:179],v[48:51],a[188:191],a[176:179]
s_waitcnt vmcnt(43)
v_mfma_f32_16x16x32_bf16 a[0:3],a[192:195],v[164:167],a[0:3]
buffer_load_dwordx4 v[92:95],v252,s[20:23],s53 offen sc1
s_waitcnt vmcnt(43)
v_mfma_f32_16x16x32_bf16 a[0:3],v[136:139],v[172:175],a[0:3]
v_mfma_f32_16x16x32_bf16 a[4:7],v[144:147],v[172:175],a[4:7]
buffer_load_dwordx4 v[100:103],v16,s[20:23],s53 offen sc1
v_mfma_f32_16x16x32_bf16 a[4:7],a[196:199],v[164:167],a[4:7]
v_mfma_f32_16x16x32_bf16 a[8:11],v[120:123],v[164:167],a[8:11]
buffer_load_dwordx4 v[104:107],v252,s[20:23],s53 offen offset:1024 sc1
v_mfma_f32_16x16x32_bf16 a[8:11],v[148:151],v[172:175],a[8:11]
v_mfma_f32_16x16x32_bf16 a[12:15],v[156:159],v[172:175],a[12:15]
buffer_load_dwordx4 a[180:183],v16,s[20:23],s53 offen offset:1024 sc1
v_mfma_f32_16x16x32_bf16 a[12:15],v[128:131],v[164:167],a[12:15]
v_mfma_f32_16x16x32_bf16 a[16:19],v[132:135],v[164:167],a[16:19]
buffer_load_dwordx4 v[108:111],v252,s[20:23],s54 offen sc1
v_mfma_f32_16x16x32_bf16 a[16:19],v[160:163],v[172:175],a[16:19]
s_waitcnt vmcnt(45)
v_mfma_f32_16x16x32_bf16 a[36:39],v[160:163],a[228:231],a[36:39]
buffer_load_dwordx4 a[204:207],v16,s[20:23],s54 offen sc1
v_mfma_f32_16x16x32_bf16 a[36:39],v[132:135],a[224:227],a[36:39]
v_mfma_f32_16x16x32_bf16 a[32:35],v[128:131],a[224:227],a[32:35]
buffer_load_dwordx4 v[32:35],v252,s[20:23],s54 offen offset:1024 sc1
v_mfma_f32_16x16x32_bf16 a[32:35],v[156:159],a[228:231],a[32:35]
v_mfma_f32_16x16x32_bf16 a[28:31],v[148:151],a[228:231],a[28:31]
buffer_load_dwordx4 v[36:39],v16,s[20:23],s54 offen offset:1024 sc1
v_mfma_f32_16x16x32_bf16 a[28:31],v[120:123],a[224:227],a[28:31]
v_mfma_f32_16x16x32_bf16 a[24:27],a[196:199],a[224:227],a[24:27]
buffer_load_dwordx4 a[208:211],v252,s[20:23],s55 offen sc1
v_mfma_f32_16x16x32_bf16 a[24:27],v[144:147],a[228:231],a[24:27]
v_mfma_f32_16x16x32_bf16 a[20:23],v[136:139],a[228:231],a[20:23]
buffer_load_dwordx4 v[20:23],v16,s[20:23],s55 offen sc1
v_mfma_f32_16x16x32_bf16 a[20:23],a[192:195],a[224:227],a[20:23]
s_waitcnt vmcnt(43)
v_mfma_f32_16x16x32_bf16 a[40:43],a[192:195],a[212:215],a[40:43]
buffer_load_dwordx4 v[40:43],v252,s[20:23],s55 offen offset:1024 sc1
s_waitcnt vmcnt(43)
v_mfma_f32_16x16x32_bf16 a[40:43],v[136:139],a[216:219],a[40:43]
v_mfma_f32_16x16x32_bf16 a[44:47],v[144:147],a[216:219],a[44:47]
buffer_load_dwordx4 v[44:47],v16,s[20:23],s55 offen offset:1024 sc1
v_mfma_f32_16x16x32_bf16 a[44:47],a[196:199],a[212:215],a[44:47]
v_mfma_f32_16x16x32_bf16 a[48:51],v[120:123],a[212:215],a[48:51]
buffer_load_dwordx4 v[24:27],v252,s[20:23],s69 offen sc1
v_mfma_f32_16x16x32_bf16 a[48:51],v[148:151],a[216:219],a[48:51]
v_mfma_f32_16x16x32_bf16 a[52:55],v[156:159],a[216:219],a[52:55]
buffer_load_dwordx4 v[28:31],v16,s[20:23],s69 offen sc1
v_mfma_f32_16x16x32_bf16 a[52:55],v[128:131],a[212:215],a[52:55]
v_mfma_f32_16x16x32_bf16 a[56:59],v[132:135],a[212:215],a[56:59]
v_add_u32 v18,9216,v16
v_add_u32 v15,5120,v17
buffer_load_dwordx4 a[184:187],v15,s[24:27],0 offen sc1
v_mfma_f32_16x16x32_bf16 a[56:59],v[160:163],a[216:219],a[56:59]
s_waitcnt vmcnt(45)
v_mfma_f32_16x16x32_bf16 a[76:79],v[160:163],v[168:171],a[76:79]
buffer_load_dwordx4 v[48:51],v15,s[24:27],0 offen offset:1024 sc1
v_mfma_f32_16x16x32_bf16 a[76:79],v[132:135],a[252:255],a[76:79]
v_mfma_f32_16x16x32_bf16 a[72:75],v[128:131],a[252:255],a[72:75]
buffer_load_dwordx4 a[188:191],v15,s[24:27],0 offen offset:2048 sc1
v_mfma_f32_16x16x32_bf16 a[72:75],v[156:159],v[168:171],a[72:75]
v_mfma_f32_16x16x32_bf16 a[68:71],v[148:151],v[168:171],a[68:71]
buffer_load_dwordx4 v[164:167],v15,s[24:27],0 offen offset:3072 sc1
v_mfma_f32_16x16x32_bf16 a[68:71],v[120:123],a[252:255],a[68:71]
v_mfma_f32_16x16x32_bf16 a[64:67],a[196:199],a[252:255],a[64:67]
buffer_load_dwordx4 v[172:175],v15,s[24:27],s68 offen sc1
v_mfma_f32_16x16x32_bf16 a[64:67],v[144:147],v[168:171],a[64:67]
v_mfma_f32_16x16x32_bf16 a[60:63],v[136:139],v[168:171],a[60:63]
v_mfma_f32_16x16x32_bf16 a[60:63],a[192:195],a[252:255],a[60:63]
s_waitcnt vmcnt(48)
v_mfma_f32_16x16x32_bf16 a[80:83],a[192:195],v[176:179],a[80:83]
v_add_u32 v252,9216,v18
v_add_u32 v253,5120,v15
buffer_load_dwordx4 a[228:231],v253,s[24:27],0 offen sc1
s_waitcnt vmcnt(48)
v_mfma_f32_16x16x32_bf16 a[80:83],v[136:139],a[220:223],a[80:83]
v_mfma_f32_16x16x32_bf16 a[84:87],v[144:147],a[220:223],a[84:87]
v_mfma_f32_16x16x32_bf16 a[84:87],a[196:199],v[176:179],a[84:87]
v_mfma_f32_16x16x32_bf16 a[88:91],v[120:123],v[176:179],a[88:91]
buffer_load_dwordx4 a[224:227],v253,s[24:27],0 offen offset:1024 sc1
s_waitcnt vmcnt(41) lgkmcnt(0)
s_barrier
v_mov_b32 v9,1
s_cmp_eq_u32 s48,0
s_cbranch_scc0 L_fl1
s_mov_b64 exec,1
s_cmp_eq_u32 s95,1
s_cbranch_scc1 L_fl1_s
buffer_wbl2 sc1
s_waitcnt vmcnt(0)
L_fl1_s:
buffer_store_dword v9,off,s[40:43],s56 offset:32 sc1
s_mov_b64 exec,-1
L_fl1:
v_mfma_f32_16x16x32_bf16 a[88:91],v[148:151],a[220:223],a[88:91]
v_mfma_f32_16x16x32_bf16 a[92:95],v[156:159],a[220:223],a[92:95]
v_mfma_f32_16x16x32_bf16 a[92:95],v[128:131],v[176:179],a[92:95]
buffer_load_dwordx4 a[212:215],v253,s[24:27],0 offen offset:2048 sc1
v_mfma_f32_16x16x32_bf16 a[96:99],v[132:135],v[176:179],a[96:99]
v_mfma_f32_16x16x32_bf16 a[96:99],v[160:163],a[220:223],a[96:99]
v_mfma_f32_16x16x32_bf16 a[116:119],v[160:163],a[236:239],a[116:119]
v_mfma_f32_16x16x32_bf16 a[116:119],v[132:135],a[232:235],a[116:119]
buffer_load_dwordx4 a[216:219],v253,s[24:27],0 offen offset:3072 sc1
v_mfma_f32_16x16x32_bf16 a[112:115],v[128:131],a[232:235],a[112:115]
v_mfma_f32_16x16x32_bf16 a[112:115],v[156:159],a[236:239],a[112:115]
v_mfma_f32_16x16x32_bf16 a[108:111],v[148:151],a[236:239],a[108:111]
v_mfma_f32_16x16x32_bf16 a[108:111],v[120:123],a[232:235],a[108:111]
buffer_load_dwordx4 v[168:171],v253,s[24:27],s68 offen sc1
v_mfma_f32_16x16x32_bf16 a[104:107],a[196:199],a[232:235],a[104:107]
v_mfma_f32_16x16x32_bf16 a[104:107],v[144:147],a[236:239],a[104:107]
v_mfma_f32_16x16x32_bf16 a[100:103],v[136:139],a[236:239],a[100:103]
v_mfma_f32_16x16x32_bf16 a[100:103],a[192:195],a[232:235],a[100:103]
buffer_load_dwordx4 a[252:255],v18,s[20:23],s52 offen sc1
s_waitcnt vmcnt(44)
v_mfma_f32_16x16x32_bf16 a[120:123],a[192:195],a[240:243],a[120:123]
s_waitcnt vmcnt(43)
v_mfma_f32_16x16x32_bf16 a[120:123],v[136:139],a[244:247],a[120:123]
v_mfma_f32_16x16x32_bf16 a[124:127],v[144:147],a[244:247],a[124:127]
buffer_load_dwordx4 v[220:223],v252,s[20:23],s52 offen sc1
v_mfma_f32_16x16x32_bf16 a[124:127],a[196:199],a[240:243],a[124:127]
v_mfma_f32_16x16x32_bf16 a[128:131],v[120:123],a[240:243],a[128:131]
v_mfma_f32_16x16x32_bf16 a[128:131],v[148:151],a[244:247],a[128:131]
v_mfma_f32_16x16x32_bf16 a[132:135],v[156:159],a[244:247],a[132:135]
buffer_load_dwordx4 v[224:227],v18,s[20:23],s52 offen offset:1024 sc1
v_mfma_f32_16x16x32_bf16 a[132:135],v[128:131],a[240:243],a[132:135]
v_mfma_f32_16x16x32_bf16 a[136:139],v[132:135],a[240:243],a[136:139]
v_mfma_f32_16x16x32_bf16 a[136:139],v[160:163],a[244:247],a[136:139]
s_waitcnt vmcnt(43)
v_mfma_f32_16x16x32_bf16 a[156:159],v[160:163],v[112:115],a[156:159]
buffer_load_dwordx4 v[228:231],v252,s[20:23],s52 offen offset:1024 sc1
v_mfma_f32_16x16x32_bf16 a[156:159],v[132:135],a[248:251],a[156:159]
v_mfma_f32_16x16x32_bf16 a[152:155],v[128:131],a[248:251],a[152:155]
v_mfma_f32_16x16x32_bf16 a[152:155],v[156:159],v[112:115],a[152:155]
v_mfma_f32_16x16x32_bf16 a[148:151],v[148:151],v[112:115],a[148:151]
buffer_load_dwordx4 v[232:235],v18,s[20:23],s53 offen sc1
v_mfma_f32_16x16x32_bf16 a[148:151],v[120:123],a[248:251],a[148:151]
v_mfma_f32_16x16x32_bf16 a[144:147],a[196:199],a[248:251],a[144:147]
v_mfma_f32_16x16x32_bf16 a[144:147],v[144:147],v[112:115],a[144:147]
buffer_load_dwordx4 v[236:239],v252,s[20:23],s53 offen sc1
v_mfma_f32_16x16x32_bf16 a[140:143],v[136:139],v[112:115],a[140:143]
v_mfma_f32_16x16x32_bf16 a[140:143],a[192:195],a[248:251],a[140:143]
s_waitcnt vmcnt(45)
v_mfma_f32_16x16x32_bf16 a[160:163],a[192:195],v[116:119],a[160:163]
s_waitcnt vmcnt(44)
v_mfma_f32_16x16x32_bf16 a[160:163],v[136:139],v[124:127],a[160:163]
buffer_load_dwordx4 v[240:243],v18,s[20:23],s53 offen offset:1024 sc1
v_mfma_f32_16x16x32_bf16 a[164:167],v[144:147],v[124:127],a[164:167]
v_mfma_f32_16x16x32_bf16 a[164:167],a[196:199],v[116:119],a[164:167]
v_mfma_f32_16x16x32_bf16 a[168:171],v[120:123],v[116:119],a[168:171]
v_mfma_f32_16x16x32_bf16 a[168:171],v[148:151],v[124:127],a[168:171]
buffer_load_dwordx4 v[244:247],v252,s[20:23],s53 offen offset:1024 sc1
v_mfma_f32_16x16x32_bf16 a[172:175],v[156:159],v[124:127],a[172:175]
v_mfma_f32_16x16x32_bf16 a[172:175],v[128:131],v[116:119],a[172:175]
v_mfma_f32_16x16x32_bf16 a[176:179],v[132:135],v[116:119],a[176:179]
v_mfma_f32_16x16x32_bf16 a[176:179],v[160:163],v[124:127],a[176:179]
buffer_load_dwordx4 v[248:251],v18,s[20:23],s54 offen sc1
s_waitcnt vmcnt(36)
v_mfma_f32_16x16x32_bf16 a[0:3],v[140:143],v[76:79],a[0:3]
s_waitcnt vmcnt(35)
v_mfma_f32_16x16x32_bf16 a[0:3],v[64:67],v[84:87],a[0:3]
v_mfma_f32_16x16x32_bf16 a[4:7],v[60:63],v[84:87],a[4:7]
buffer_load_dwordx4 v[176:179],v252,s[20:23],s54 offen sc1
v_mfma_f32_16x16x32_bf16 a[4:7],v[152:155],v[76:79],a[4:7]
v_mfma_f32_16x16x32_bf16 a[8:11],a[200:203],v[76:79],a[8:11]
v_mfma_f32_16x16x32_bf16 a[8:11],v[68:71],v[84:87],a[8:11]
v_mfma_f32_16x16x32_bf16 a[12:15],v[72:75],v[84:87],a[12:15]
buffer_load_dwordx4 a[220:223],v18,s[20:23],s54 offen offset:1024 sc1
v_mfma_f32_16x16x32_bf16 a[12:15],v[52:55],v[76:79],a[12:15]
v_mfma_f32_16x16x32_bf16 a[16:19],v[56:59],v[76:79],a[16:19]
v_mfma_f32_16x16x32_bf16 a[16:19],v[80:83],v[84:87],a[16:19]
s_waitcnt vmcnt(35)
v_mfma_f32_16x16x32_bf16 a[36:39],v[80:83],v[96:99],a[36:39]
buffer_load_dwordx4 a[236:239],v252,s[20:23],s54 offen offset:1024 sc1
v_mfma_f32_16x16x32_bf16 a[36:39],v[56:59],v[88:91],a[36:39]
v_mfma_f32_16x16x32_bf16 a[32:35],v[52:55],v[88:91],a[32:35]
v_mfma_f32_16x16x32_bf16 a[32:35],v[72:75],v[96:99],a[32:35]
buffer_load_dwordx4 a[232:235],v18,s[20:23],s55 offen sc1
v_mfma_f32_16x16x32_bf16 a[28:31],v[68:71],v[96:99],a[28:31]
v_mfma_f32_16x16x32_bf16 a[28:31],a[200:203],v[88:91],a[28:31]
v_mfma_f32_16x16x32_bf16 a[24:27],v[152:155],v[88:91],a[24:27]
v_mfma_f32_16x16x32_bf16 a[24:27],v[60:63],v[96:99],a[24:27]
buffer_load_dwordx4 a[240:243],v252,s[20:23],s55 offen sc1
v_mfma_f32_16x16x32_bf16 a[20:23],v[64:67],v[96:99],a[20:23]
v_mfma_f32_16x16x32_bf16 a[20:23],v[140:143],v[88:91],a[20:23]
s_waitcnt vmcnt(37)
v_mfma_f32_16x16x32_bf16 a[40:43],v[140:143],v[92:95],a[40:43]
s_waitcnt vmcnt(36)
v_mfma_f32_16x16x32_bf16 a[40:43],v[64:67],v[100:103],a[40:43]
buffer_load_dwordx4 a[244:247],v18,s[20:23],s55 offen offset:1024 sc1
v_mfma_f32_16x16x32_bf16 a[44:47],v[60:63],v[100:103],a[44:47]
v_mfma_f32_16x16x32_bf16 a[44:47],v[152:155],v[92:95],a[44:47]
v_mfma_f32_16x16x32_bf16 a[48:51],a[200:203],v[92:95],a[48:51]
v_mfma_f32_16x16x32_bf16 a[48:51],v[68:71],v[100:103],a[48:51]
buffer_load_dwordx4 v[112:115],v252,s[20:23],s55 offen offset:1024 sc1
v_mfma_f32_16x16x32_bf16 a[52:55],v[72:75],v[100:103],a[52:55]
v_mfma_f32_16x16x32_bf16 a[52:55],v[52:55],v[92:95],a[52:55]
v_mfma_f32_16x16x32_bf16 a[56:59],v[56:59],v[92:95],a[56:59]
buffer_load_dwordx4 a[248:251],v18,s[20:23],s69 offen sc1
v_mfma_f32_16x16x32_bf16 a[56:59],v[80:83],v[100:103],a[56:59]
s_waitcnt vmcnt(37)
v_mfma_f32_16x16x32_bf16 a[76:79],v[80:83],a[180:183],a[76:79]
v_mfma_f32_16x16x32_bf16 a[76:79],v[56:59],v[104:107],a[76:79]
v_mfma_f32_16x16x32_bf16 a[72:75],v[52:55],v[104:107],a[72:75]
buffer_load_dwordx4 a[192:195],v252,s[20:23],s69 offen sc1
v_mfma_f32_16x16x32_bf16 a[72:75],v[72:75],a[180:183],a[72:75]
v_mfma_f32_16x16x32_bf16 a[68:71],v[68:71],a[180:183],a[68:71]
v_mfma_f32_16x16x32_bf16 a[68:71],a[200:203],v[104:107],a[68:71]
v_mfma_f32_16x16x32_bf16 a[64:67],v[152:155],v[104:107],a[64:67]
v_add_u32 v16,9216,v252
v_add_u32 v17,5120,v253
buffer_load_dwordx4 v[136:139],v17,s[24:27],0 offen sc1
v_mfma_f32_16x16x32_bf16 a[64:67],v[60:63],a[180:183],a[64:67]
v_mfma_f32_16x16x32_bf16 a[60:63],v[64:67],a[180:183],a[60:63]
v_mfma_f32_16x16x32_bf16 a[60:63],v[140:143],v[104:107],a[60:63]
s_waitcnt vmcnt(38)
v_mfma_f32_16x16x32_bf16 a[80:83],v[140:143],v[108:111],a[80:83]
buffer_load_dwordx4 v[144:147],v17,s[24:27],0 offen offset:1024 sc1
s_waitcnt vmcnt(38)
v_mfma_f32_16x16x32_bf16 a[80:83],v[64:67],a[204:207],a[80:83]
v_mfma_f32_16x16x32_bf16 a[84:87],v[60:63],a[204:207],a[84:87]
v_mfma_f32_16x16x32_bf16 a[84:87],v[152:155],v[108:111],a[84:87]
buffer_load_dwordx4 a[196:199],v17,s[24:27],0 offen offset:2048 sc1
v_mfma_f32_16x16x32_bf16 a[88:91],a[200:203],v[108:111],a[88:91]
v_mfma_f32_16x16x32_bf16 a[88:91],v[68:71],a[204:207],a[88:91]
v_mfma_f32_16x16x32_bf16 a[92:95],v[72:75],a[204:207],a[92:95]
v_mfma_f32_16x16x32_bf16 a[92:95],v[52:55],v[108:111],a[92:95]
buffer_load_dwordx4 v[120:123],v17,s[24:27],0 offen offset:3072 sc1
v_mfma_f32_16x16x32_bf16 a[96:99],v[56:59],v[108:111],a[96:99]
v_mfma_f32_16x16x32_bf16 a[96:99],v[80:83],a[204:207],a[96:99]
s_waitcnt vmcnt(38)
v_mfma_f32_16x16x32_bf16 a[116:119],v[80:83],v[36:39],a[116:119]
v_mfma_f32_16x16x32_bf16 a[116:119],v[56:59],v[32:35],a[116:119]
buffer_load_dwordx4 v[148:151],v17,s[24:27],s68 offen sc1
v_mfma_f32_16x16x32_bf16 a[112:115],v[52:55],v[32:35],a[112:115]
v_mfma_f32_16x16x32_bf16 a[112:115],v[72:75],v[36:39],a[112:115]
v_mfma_f32_16x16x32_bf16 a[108:111],v[68:71],v[36:39],a[108:111]
v_mfma_f32_16x16x32_bf16 a[108:111],a[200:203],v[32:35],a[108:111]
v_add_u32 v18,9216,v16
v_add_u32 v15,5120,v17
buffer_load_dwordx4 v[156:159],v15,s[24:27],0 offen sc1
v_mfma_f32_16x16x32_bf16 a[104:107],v[152:155],v[32:35],a[104:107]
v_mfma_f32_16x16x32_bf16 a[104:107],v[60:63],v[36:39],a[104:107]
v_mfma_f32_16x16x32_bf16 a[100:103],v[64:67],v[36:39],a[100:103]
buffer_load_dwordx4 v[128:131],v15,s[24:27],0 offen offset:1024 sc1
v_mfma_f32_16x16x32_bf16 a[100:103],v[140:143],v[32:35],a[100:103]
s_waitcnt vmcnt(40)
v_mfma_f32_16x16x32_bf16 a[120:123],v[140:143],a[208:211],a[120:123]
s_waitcnt vmcnt(39)
v_mfma_f32_16x16x32_bf16 a[120:123],v[64:67],v[20:23],a[120:123]
v_mfma_f32_16x16x32_bf16 a[124:127],v[60:63],v[20:23],a[124:127]
buffer_load_dwordx4 v[132:135],v15,s[24:27],0 offen offset:2048 sc1
v_mfma_f32_16x16x32_bf16 a[124:127],v[152:155],a[208:211],a[124:127]
v_mfma_f32_16x16x32_bf16 a[128:131],a[200:203],a[208:211],a[128:131]
v_mfma_f32_16x16x32_bf16 a[128:131],v[68:71],v[20:23],a[128:131]
v_mfma_f32_16x16x32_bf16 a[132:135],v[72:75],v[20:23],a[132:135]
buffer_load_dwordx4 v[116:119],v15,s[24:27],0 offen offset:3072 sc1
v_mfma_f32_16x16x32_bf16 a[132:135],v[52:55],a[208:211],a[132:135]
v_mfma_f32_16x16x32_bf16 a[136:139],v[56:59],a[208:211],a[136:139]
v_mfma_f32_16x16x32_bf16 a[136:139],v[80:83],v[20:23],a[136:139]
s_waitcnt vmcnt(39)
v_mfma_f32_16x16x32_bf16 a[156:159],v[80:83],v[44:47],a[156:159]
buffer_load_dwordx4 v[160:163],v15,s[24:27],s68 offen sc1
v_mfma_f32_16x16x32_bf16 a[156:159],v[56:59],v[40:43],a[156:159]
v_mfma_f32_16x16x32_bf16 a[152:155],v[52:55],v[40:43],a[152:155]
v_mfma_f32_16x16x32_bf16 a[152:155],v[72:75],v[44:47],a[152:155]
buffer_load_dwordx4 v[124:127],v16,s[20:23],s52 offen sc1
v_mfma_f32_16x16x32_bf16 a[148:151],v[68:71],v[44:47],a[148:151]
v_mfma_f32_16x16x32_bf16 a[148:151],a[200:203],v[40:43],a[148:151]
v_mfma_f32_16x16x32_bf16 a[144:147],v[152:155],v[40:43],a[144:147]
v_mfma_f32_16x16x32_bf16 a[144:147],v[60:63],v[44:47],a[144:147]
buffer_load_dwordx4 v[76:79],v18,s[20:23],s52 offen sc1
v_mfma_f32_16x16x32_bf16 a[140:143],v[64:67],v[44:47],a[140:143]
v_mfma_f32_16x16x32_bf16 a[140:143],v[140:143],v[40:43],a[140:143]
s_waitcnt vmcnt(41)
v_mfma_f32_16x16x32_bf16 a[160:163],v[140:143],v[24:27],a[160:163]
s_waitcnt vmcnt(40)
v_mfma_f32_16x16x32_bf16 a[160:163],v[64:67],v[28:31],a[160:163]
buffer_load_dwordx4 v[84:87],v16,s[20:23],s52 offen offset:1024 sc1
v_mfma_f32_16x16x32_bf16 a[164:167],v[60:63],v[28:31],a[164:167]
v_mfma_f32_16x16x32_bf16 a[164:167],v[152:155],v[24:27],a[164:167]
v_mfma_f32_16x16x32_bf16 a[168:171],a[200:203],v[24:27],a[168:171]
buffer_load_dwordx4 v[96:99],v18,s[20:23],s52 offen offset:1024 sc1
v_mfma_f32_16x16x32_bf16 a[168:171],v[68:71],v[28:31],a[168:171]
v_mfma_f32_16x16x32_bf16 a[172:175],v[72:75],v[28:31],a[172:175]
v_mfma_f32_16x16x32_bf16 a[172:175],v[52:55],v[24:27],a[172:175]
v_mfma_f32_16x16x32_bf16 a[176:179],v[56:59],v[24:27],a[176:179]
buffer_load_dwordx4 v[88:91],v16,s[20:23],s53 offen sc1
v_mfma_f32_16x16x32_bf16 a[176:179],v[80:83],v[28:31],a[176:179]
s_waitcnt vmcnt(32)
v_mfma_f32_16x16x32_bf16 a[0:3],a[184:187],a[252:255],a[0:3]
s_waitcnt vmcnt(31)
v_mfma_f32_16x16x32_bf16 a[0:3],a[228:231],v[220:223],a[0:3]
v_mfma_f32_16x16x32_bf16 a[4:7],a[224:227],v[220:223],a[4:7]
buffer_load_dwordx4 v[92:95],v18,s[20:23],s53 offen sc1
v_mfma_f32_16x16x32_bf16 a[4:7],v[48:51],a[252:255],a[4:7]
v_mfma_f32_16x16x32_bf16 a[8:11],a[188:191],a[252:255],a[8:11]
v_mfma_f32_16x16x32_bf16 a[8:11],a[212:215],v[220:223],a[8:11]
v_mfma_f32_16x16x32_bf16 a[12:15],a[216:219],v[220:223],a[12:15]
buffer_load_dwordx4 v[100:103],v16,s[20:23],s53 offen offset:1024 sc1
v_mfma_f32_16x16x32_bf16 a[12:15],v[164:167],a[252:255],a[12:15]
v_mfma_f32_16x16x32_bf16 a[16:19],v[172:175],a[252:255],a[16:19]
v_mfma_f32_16x16x32_bf16 a[16:19],v[168:171],v[220:223],a[16:19]
buffer_load_dwordx4 a[180:183],v18,s[20:23],s53 offen offset:1024 sc1
s_waitcnt vmcnt(32)
v_mfma_f32_16x16x32_bf16 a[36:39],v[168:171],v[228:231],a[36:39]
v_mfma_f32_16x16x32_bf16 a[36:39],v[172:175],v[224:227],a[36:39]
v_mfma_f32_16x16x32_bf16 a[32:35],v[164:167],v[224:227],a[32:35]
v_mfma_f32_16x16x32_bf16 a[32:35],a[216:219],v[228:231],a[32:35]
buffer_load_dwordx4 v[104:107],v16,s[20:23],s54 offen sc1
v_mfma_f32_16x16x32_bf16 a[28:31],a[212:215],v[228:231],a[28:31]
v_mfma_f32_16x16x32_bf16 a[28:31],a[188:191],v[224:227],a[28:31]
v_mfma_f32_16x16x32_bf16 a[24:27],v[48:51],v[224:227],a[24:27]
v_mfma_f32_16x16x32_bf16 a[24:27],a[224:227],v[228:231],a[24:27]
buffer_load_dwordx4 v[108:111],v18,s[20:23],s54 offen sc1
v_mfma_f32_16x16x32_bf16 a[20:23],a[228:231],v[228:231],a[20:23]
v_mfma_f32_16x16x32_bf16 a[20:23],a[184:187],v[224:227],a[20:23]
s_waitcnt vmcnt(33)
v_mfma_f32_16x16x32_bf16 a[40:43],a[184:187],v[232:235],a[40:43]
s_waitcnt vmcnt(32)
v_mfma_f32_16x16x32_bf16 a[40:43],a[228:231],v[236:239],a[40:43]
buffer_load_dwordx4 a[204:207],v16,s[20:23],s54 offen offset:1024 sc1
v_mfma_f32_16x16x32_bf16 a[44:47],a[224:227],v[236:239],a[44:47]
v_mfma_f32_16x16x32_bf16 a[44:47],v[48:51],v[232:235],a[44:47]
v_mfma_f32_16x16x32_bf16 a[48:51],a[188:191],v[232:235],a[48:51]
buffer_load_dwordx4 v[36:39],v18,s[20:23],s54 offen offset:1024 sc1
v_mfma_f32_16x16x32_bf16 a[48:51],a[212:215],v[236:239],a[48:51]
v_mfma_f32_16x16x32_bf16 a[52:55],a[216:219],v[236:239],a[52:55]
v_mfma_f32_16x16x32_bf16 a[52:55],v[164:167],v[232:235],a[52:55]
v_mfma_f32_16x16x32_bf16 a[56:59],v[172:175],v[232:235],a[56:59]
buffer_load_dwordx4 v[32:35],v16,s[20:23],s55 offen sc1
v_mfma_f32_16x16x32_bf16 a[56:59],v[168:171],v[236:239],a[56:59]
s_waitcnt vmcnt(33)
v_mfma_f32_16x16x32_bf16 a[76:79],v[168:171],v[244:247],a[76:79]
v_mfma_f32_16x16x32_bf16 a[76:79],v[172:175],v[240:243],a[76:79]
v_mfma_f32_16x16x32_bf16 a[72:75],v[164:167],v[240:243],a[72:75]
buffer_load_dwordx4 a[208:211],v18,s[20:23],s55 offen sc1
v_mfma_f32_16x16x32_bf16 a[72:75],a[216:219],v[244:247],a[72:75]
v_mfma_f32_16x16x32_bf16 a[68:71],a[212:215],v[244:247],a[68:71]
v_mfma_f32_16x16x32_bf16 a[68:71],a[188:191],v[240:243],a[68:71]
v_mfma_f32_16x16x32_bf16 a[64:67],v[48:51],v[240:243],a[64:67]
buffer_load_dwordx4 v[20:23],v16,s[20:23],s55 offen offset:1024 sc1
v_mfma_f32_16x16x32_bf16 a[64:67],a[224:227],v[244:247],a[64:67]
v_mfma_f32_16x16x32_bf16 a[60:63],a[228:231],v[244:247],a[60:63]
v_mfma_f32_16x16x32_bf16 a[60:63],a[184:187],v[240:243],a[60:63]
buffer_load_dwordx4 v[44:47],v18,s[20:23],s55 offen offset:1024 sc1
s_waitcnt vmcnt(35)
v_mfma_f32_16x16x32_bf16 a[80:83],a[184:187],v[248:251],a[80:83]
s_waitcnt vmcnt(34)
v_mfma_f32_16x16x32_bf16 a[80:83],a[228:231],v[176:179],a[80:83]
v_mfma_f32_16x16x32_bf16 a[84:87],a[224:227],v[176:179],a[84:87]
v_mfma_f32_16x16x32_bf16 a[84:87],v[48:51],v[248:251],a[84:87]
buffer_load_dwordx4 v[40:43],v16,s[20:23],s69 offen sc1
v_mfma_f32_16x16x32_bf16 a[88:91],a[188:191],v[248:251],a[88:91]
v_mfma_f32_16x16x32_bf16 a[88:91],a[212:215],v[176:179],a[88:91]
v_mfma_f32_16x16x32_bf16 a[92:95],a[216:219],v[176:179],a[92:95]
v_mfma_f32_16x16x32_bf16 a[92:95],v[164:167],v[248:251],a[92:95]
buffer_load_dwordx4 v[140:143],v18,s[20:23],s69 offen sc1
v_mfma_f32_16x16x32_bf16 a[96:99],v[172:175],v[248:251],a[96:99]
v_mfma_f32_16x16x32_bf16 a[96:99],v[168:171],v[176:179],a[96:99]
s_waitcnt vmcnt(34)
v_mfma_f32_16x16x32_bf16 a[116:119],v[168:171],a[236:239],a[116:119]
v_mfma_f32_16x16x32_bf16 a[116:119],v[172:175],a[220:223],a[116:119]
v_add_u32 v252,9216,v18
v_add_u32 v253,5120,v15
buffer_load_dwordx4 v[64:67],v253,s[24:27],0 offen sc1
v_mfma_f32_16x16x32_bf16 a[112:115],v[164:167],a[220:223],a[112:115]
v_mfma_f32_16x16x32_bf16 a[112:115],a[216:219],a[236:239],a[112:115]
v_mfma_f32_16x16x32_bf16 a[108:111],a[212:215],a[236:239],a[108:111]
buffer_load_dwordx4 v[60:63],v253,s[24:27],0 offen offset:1024 sc1
v_mfma_f32_16x16x32_bf16 a[108:111],a[188:191],a[220:223],a[108:111]
v_mfma_f32_16x16x32_bf16 a[104:107],v[48:51],a[220:223],a[104:107]
v_mfma_f32_16x16x32_bf16 a[104:107],a[224:227],a[236:239],a[104:107]
v_mfma_f32_16x16x32_bf16 a[100:103],a[228:231],a[236:239],a[100:103]
buffer_load_dwordx4 v[152:155],v253,s[24:27],0 offen offset:2048 sc1
v_mfma_f32_16x16x32_bf16 a[100:103],a[184:187],a[220:223],a[100:103]
s_waitcnt vmcnt(36)
v_mfma_f32_16x16x32_bf16 a[120:123],a[184:187],a[232:235],a[120:123]
s_waitcnt vmcnt(35)
v_mfma_f32_16x16x32_bf16 a[120:123],a[228:231],a[240:243],a[120:123]
v_mfma_f32_16x16x32_bf16 a[124:127],a[224:227],a[240:243],a[124:127]
buffer_load_dwordx4 a[200:203],v253,s[24:27],0 offen offset:3072 sc1
v_mfma_f32_16x16x32_bf16 a[124:127],v[48:51],a[232:235],a[124:127]
v_mfma_f32_16x16x32_bf16 a[128:131],a[188:191],a[232:235],a[128:131]
v_mfma_f32_16x16x32_bf16 a[128:131],a[212:215],a[240:243],a[128:131]
buffer_load_dwordx4 v[68:71],v253,s[24:27],s68 offen sc1
v_mfma_f32_16x16x32_bf16 a[132:135],a[216:219],a[240:243],a[132:135]
v_mfma_f32_16x16x32_bf16 a[132:135],v[164:167],a[232:235],a[132:135]
v_mfma_f32_16x16x32_bf16 a[136:139],v[172:175],a[232:235],a[136:139]
v_mfma_f32_16x16x32_bf16 a[136:139],v[168:171],a[240:243],a[136:139]
v_add_u32 v16,9216,v252
v_add_u32 v17,5120,v253
buffer_load_dwordx4 v[72:75],v17,s[24:27],0 offen sc1
s_waitcnt vmcnt(36)
v_mfma_f32_16x16x32_bf16 a[156:159],v[168:171],v[112:115],a[156:159]
v_mfma_f32_16x16x32_bf16 a[156:159],v[172:175],a[244:247],a[156:159]
v_mfma_f32_16x16x32_bf16 a[152:155],v[164:167],a[244:247],a[152:155]
v_mfma_f32_16x16x32_bf16 a[152:155],a[216:219],v[112:115],a[152:155]
buffer_load_dwordx4 v[52:55],v17,s[24:27],0 offen offset:1024 sc1
v_mfma_f32_16x16x32_bf16 a[148:151],a[212:215],v[112:115],a[148:151]
v_mfma_f32_16x16x32_bf16 a[148:151],a[188:191],a[244:247],a[148:151]
v_mfma_f32_16x16x32_bf16 a[144:147],v[48:51],a[244:247],a[144:147]
v_mfma_f32_16x16x32_bf16 a[144:147],a[224:227],v[112:115],a[144:147]
buffer_load_dwordx4 v[56:59],v17,s[24:27],0 offen offset:2048 sc1
v_mfma_f32_16x16x32_bf16 a[140:143],a[228:231],v[112:115],a[140:143]
v_mfma_f32_16x16x32_bf16 a[140:143],a[184:187],a[244:247],a[140:143]
s_waitcnt vmcnt(37)
v_mfma_f32_16x16x32_bf16 a[160:163],a[184:187],a[248:251],a[160:163]
buffer_load_dwordx4 v[24:27],v17,s[24:27],0 offen offset:3072 sc1
s_waitcnt vmcnt(37)
v_mfma_f32_16x16x32_bf16 a[160:163],a[228:231],a[192:195],a[160:163]
v_mfma_f32_16x16x32_bf16 a[164:167],a[224:227],a[192:195],a[164:167]
v_mfma_f32_16x16x32_bf16 a[164:167],v[48:51],a[248:251],a[164:167]
v_mfma_f32_16x16x32_bf16 a[168:171],a[188:191],a[248:251],a[168:171]
buffer_load_dwordx4 v[80:83],v17,s[24:27],s68 offen sc1
v_mfma_f32_16x16x32_bf16 a[168:171],a[212:215],a[192:195],a[168:171]
v_mfma_f32_16x16x32_bf16 a[172:175],a[216:219],a[192:195],a[172:175]
v_mfma_f32_16x16x32_bf16 a[172:175],v[164:167],a[248:251],a[172:175]
v_mfma_f32_16x16x32_bf16 a[176:179],v[172:175],a[248:251],a[176:179]
buffer_load_dwordx4 v[28:31],v252,s[20:23],s52 offen sc1
v_mfma_f32_16x16x32_bf16 a[176:179],v[168:171],a[192:195],a[176:179]
s_waitcnt vmcnt(28)
v_mfma_f32_16x16x32_bf16 a[0:3],v[136:139],v[124:127],a[0:3]
s_waitcnt vmcnt(27)
v_mfma_f32_16x16x32_bf16 a[0:3],v[156:159],v[76:79],a[0:3]
v_mfma_f32_16x16x32_bf16 a[4:7],v[128:131],v[76:79],a[4:7]
buffer_load_dwordx4 a[252:255],v16,s[20:23],s52 offen sc1
v_mfma_f32_16x16x32_bf16 a[4:7],v[144:147],v[124:127],a[4:7]
v_mfma_f32_16x16x32_bf16 a[8:11],a[196:199],v[124:127],a[8:11]
v_mfma_f32_16x16x32_bf16 a[8:11],v[132:135],v[76:79],a[8:11]
buffer_load_dwordx4 v[220:223],v252,s[20:23],s52 offen offset:1024 sc1
v_mfma_f32_16x16x32_bf16 a[12:15],v[116:119],v[76:79],a[12:15]
v_mfma_f32_16x16x32_bf16 a[12:15],v[120:123],v[124:127],a[12:15]
v_mfma_f32_16x16x32_bf16 a[16:19],v[148:151],v[124:127],a[16:19]
v_mfma_f32_16x16x32_bf16 a[16:19],v[160:163],v[76:79],a[16:19]
buffer_load_dwordx4 v[228:231],v16,s[20:23],s52 offen offset:1024 sc1
s_waitcnt vmcnt(28)
v_mfma_f32_16x16x32_bf16 a[36:39],v[160:163],v[96:99],a[36:39]
v_mfma_f32_16x16x32_bf16 a[36:39],v[148:151],v[84:87],a[36:39]
v_mfma_f32_16x16x32_bf16 a[32:35],v[120:123],v[84:87],a[32:35]
v_mfma_f32_16x16x32_bf16 a[32:35],v[116:119],v[96:99],a[32:35]
buffer_load_dwordx4 v[224:227],v252,s[20:23],s53 offen sc1
v_mfma_f32_16x16x32_bf16 a[28:31],v[132:135],v[96:99],a[28:31]
v_mfma_f32_16x16x32_bf16 a[28:31],a[196:199],v[84:87],a[28:31]
v_mfma_f32_16x16x32_bf16 a[24:27],v[144:147],v[84:87],a[24:27]
v_mfma_f32_16x16x32_bf16 a[24:27],v[128:131],v[96:99],a[24:27]
buffer_load_dwordx4 v[232:235],v16,s[20:23],s53 offen sc1
v_mfma_f32_16x16x32_bf16 a[20:23],v[156:159],v[96:99],a[20:23]
v_mfma_f32_16x16x32_bf16 a[20:23],v[136:139],v[84:87],a[20:23]
s_waitcnt vmcnt(29)
v_mfma_f32_16x16x32_bf16 a[40:43],v[136:139],v[88:91],a[40:43]
buffer_load_dwordx4 v[236:239],v252,s[20:23],s53 offen offset:1024 sc1
s_waitcnt vmcnt(29)
v_mfma_f32_16x16x32_bf16 a[40:43],v[156:159],v[92:95],a[40:43]
v_mfma_f32_16x16x32_bf16 a[44:47],v[128:131],v[92:95],a[44:47]
v_mfma_f32_16x16x32_bf16 a[44:47],v[144:147],v[88:91],a[44:47]
v_mfma_f32_16x16x32_bf16 a[48:51],a[196:199],v[88:91],a[48:51]
buffer_load_dwordx4 v[244:247],v16,s[20:23],s53 offen offset:1024 sc1
v_mfma_f32_16x16x32_bf16 a[48:51],v[132:135],v[92:95],a[48:51]
v_mfma_f32_16x16x32_bf16 a[52:55],v[116:119],v[92:95],a[52:55]
v_mfma_f32_16x16x32_bf16 a[52:55],v[120:123],v[88:91],a[52:55]
v_mfma_f32_16x16x32_bf16 a[56:59],v[148:151],v[88:91],a[56:59]
buffer_load_dwordx4 v[240:243],v252,s[20:23],s54 offen sc1
v_mfma_f32_16x16x32_bf16 a[56:59],v[160:163],v[92:95],a[56:59]
s_waitcnt vmcnt(29)
v_mfma_f32_16x16x32_bf16 a[76:79],v[160:163],a[180:183],a[76:79]
v_mfma_f32_16x16x32_bf16 a[76:79],v[148:151],v[100:103],a[76:79]
v_mfma_f32_16x16x32_bf16 a[72:75],v[120:123],v[100:103],a[72:75]
buffer_load_dwordx4 v[248:251],v16,s[20:23],s54 offen sc1
v_mfma_f32_16x16x32_bf16 a[72:75],v[116:119],a[180:183],a[72:75]
v_mfma_f32_16x16x32_bf16 a[68:71],v[132:135],a[180:183],a[68:71]
v_mfma_f32_16x16x32_bf16 a[68:71],a[196:199],v[100:103],a[68:71]
buffer_load_dwordx4 v[176:179],v252,s[20:23],s54 offen offset:1024 sc1
v_mfma_f32_16x16x32_bf16 a[64:67],v[144:147],v[100:103],a[64:67]
v_mfma_f32_16x16x32_bf16 a[64:67],v[128:131],a[180:183],a[64:67]
v_mfma_f32_16x16x32_bf16 a[60:63],v[156:159],a[180:183],a[60:63]
v_mfma_f32_16x16x32_bf16 a[60:63],v[136:139],v[100:103],a[60:63]
buffer_load_dwordx4 a[236:239],v16,s[20:23],s54 offen offset:1024 sc1
s_waitcnt vmcnt(31)
v_mfma_f32_16x16x32_bf16 a[80:83],v[136:139],v[104:107],a[80:83]
s_waitcnt vmcnt(30)
v_mfma_f32_16x16x32_bf16 a[80:83],v[156:159],v[108:111],a[80:83]
v_mfma_f32_16x16x32_bf16 a[84:87],v[128:131],v[108:111],a[84:87]
v_mfma_f32_16x16x32_bf16 a[84:87],v[144:147],v[104:107],a[84:87]
buffer_load_dwordx4 a[220:223],v252,s[20:23],s55 offen sc1
v_mfma_f32_16x16x32_bf16 a[88:91],a[196:199],v[104:107],a[88:91]
v_mfma_f32_16x16x32_bf16 a[88:91],v[132:135],v[108:111],a[88:91]
v_mfma_f32_16x16x32_bf16 a[92:95],v[116:119],v[108:111],a[92:95]
buffer_load_dwordx4 a[232:235],v16,s[20:23],s55 offen sc1
v_mfma_f32_16x16x32_bf16 a[92:95],v[120:123],v[104:107],a[92:95]
v_mfma_f32_16x16x32_bf16 a[96:99],v[148:151],v[104:107],a[96:99]
v_mfma_f32_16x16x32_bf16 a[96:99],v[160:163],v[108:111],a[96:99]
s_waitcnt vmcnt(30)
v_mfma_f32_16x16x32_bf16 a[116:119],v[160:163],v[36:39],a[116:119]
buffer_load_dwordx4 a[240:243],v252,s[20:23],s55 offen offset:1024 sc1
v_mfma_f32_16x16x32_bf16 a[116:119],v[148:151],a[204:207],a[116:119]
v_mfma_f32_16x16x32_bf16 a[112:115],v[120:123],a[204:207],a[112:115]
v_mfma_f32_16x16x32_bf16 a[112:115],v[116:119],v[36:39],a[112:115]
v_mfma_f32_16x16x32_bf16 a[108:111],v[132:135],v[36:39],a[108:111]
buffer_load_dwordx4 v[112:115],v16,s[20:23],s55 offen offset:1024 sc1
v_mfma_f32_16x16x32_bf16 a[108:111],a[196:199],a[204:207],a[108:111]
v_mfma_f32_16x16x32_bf16 a[104:107],v[144:147],a[204:207],a[104:107]
v_mfma_f32_16x16x32_bf16 a[104:107],v[128:131],v[36:39],a[104:107]
v_mfma_f32_16x16x32_bf16 a[100:103],v[156:159],v[36:39],a[100:103]
buffer_load_dwordx4 a[244:247],v252,s[20:23],s69 offen sc1
v_mfma_f32_16x16x32_bf16 a[100:103],v[136:139],a[204:207],a[100:103]
s_waitcnt vmcnt(32)
v_mfma_f32_16x16x32_bf16 a[120:123],v[136:139],v[32:35],a[120:123]
s_waitcnt vmcnt(31)
v_mfma_f32_16x16x32_bf16 a[120:123],v[156:159],a[208:211],a[120:123]
buffer_load_dwordx4 a[184:187],v16,s[20:23],s69 offen sc1
v_mfma_f32_16x16x32_bf16 a[124:127],v[128:131],a[208:211],a[124:127]
v_mfma_f32_16x16x32_bf16 a[124:127],v[144:147],v[32:35],a[124:127]
v_mfma_f32_16x16x32_bf16 a[128:131],a[196:199],v[32:35],a[128:131]
v_mfma_f32_16x16x32_bf16 a[128:131],v[132:135],a[208:211],a[128:131]
v_add_u32 v18,9216,v16
v_add_u32 v15,5120,v17
buffer_load_dwordx4 a[228:231],v15,s[24:27],0 offen sc1
v_mfma_f32_16x16x32_bf16 a[132:135],v[116:119],a[208:211],a[132:135]
v_mfma_f32_16x16x32_bf16 a[132:135],v[120:123],v[32:35],a[132:135]
v_mfma_f32_16x16x32_bf16 a[136:139],v[148:151],v[32:35],a[136:139]
v_mfma_f32_16x16x32_bf16 a[136:139],v[160:163],a[208:211],a[136:139]
buffer_load_dwordx4 a[224:227],v15,s[24:27],0 offen offset:1024 sc1
s_waitcnt vmcnt(32)
v_mfma_f32_16x16x32_bf16 a[156:159],v[160:163],v[44:47],a[156:159]
v_mfma_f32_16x16x32_bf16 a[156:159],v[148:151],v[20:23],a[156:159]
v_mfma_f32_16x16x32_bf16 a[152:155],v[120:123],v[20:23],a[152:155]
v_mfma_f32_16x16x32_bf16 a[152:155],v[116:119],v[44:47],a[152:155]
buffer_load_dwordx4 v[48:51],v15,s[24:27],0 offen offset:2048 sc1
v_mfma_f32_16x16x32_bf16 a[148:151],v[132:135],v[44:47],a[148:151]
v_mfma_f32_16x16x32_bf16 a[148:151],a[196:199],v[20:23],a[148:151]
v_mfma_f32_16x16x32_bf16 a[144:147],v[144:147],v[20:23],a[144:147]
buffer_load_dwordx4 a[188:191],v15,s[24:27],0 offen offset:3072 sc1
v_mfma_f32_16x16x32_bf16 a[144:147],v[128:131],v[44:47],a[144:147]
v_mfma_f32_16x16x32_bf16 a[140:143],v[156:159],v[44:47],a[140:143]
v_mfma_f32_16x16x32_bf16 a[140:143],v[136:139],v[20:23],a[140:143]
s_waitcnt vmcnt(33)
v_mfma_f32_16x16x32_bf16 a[160:163],v[136:139],v[40:43],a[160:163]
buffer_load_dwordx4 a[212:215],v15,s[24:27],s68 offen sc1
s_waitcnt vmcnt(33)
v_mfma_f32_16x16x32_bf16 a[160:163],v[156:159],v[140:143],a[160:163]
v_mfma_f32_16x16x32_bf16 a[164:167],v[128:131],v[140:143],a[164:167]
v_mfma_f32_16x16x32_bf16 a[164:167],v[144:147],v[40:43],a[164:167]
v_mfma_f32_16x16x32_bf16 a[168:171],a[196:199],v[40:43],a[168:171]
v_lshrrev_b32 v255,2,v10
buffer_load_dword v254,v255,s[40:43],0 offen offset:32 sc1
v_add_u32 v252,9216,v18
v_add_u32 v253,5120,v15
buffer_load_dwordx4 a[216:219],v253,s[24:27],0 offen sc1
v_mfma_f32_16x16x32_bf16 a[168:171],v[132:135],v[140:143],a[168:171]
v_mfma_f32_16x16x32_bf16 a[172:175],v[116:119],v[140:143],a[172:175]
v_mfma_f32_16x16x32_bf16 a[172:175],v[120:123],v[40:43],a[172:175]
v_mfma_f32_16x16x32_bf16 a[176:179],v[148:151],v[40:43],a[176:179]
buffer_load_dwordx4 v[164:167],v253,s[24:27],0 offen offset:1024 sc1
v_mfma_f32_16x16x32_bf16 a[176:179],v[160:163],v[140:143],a[176:179]
s_waitcnt vmcnt(25)
v_mfma_f32_16x16x32_bf16 a[0:3],v[64:67],v[28:31],a[0:3]
s_waitcnt vmcnt(24)
v_mfma_f32_16x16x32_bf16 a[0:3],v[72:75],a[252:255],a[0:3]
buffer_load_dwordx4 v[172:175],v253,s[24:27],0 offen offset:2048 sc1
v_mfma_f32_16x16x32_bf16 a[4:7],v[52:55],a[252:255],a[4:7]
v_mfma_f32_16x16x32_bf16 a[4:7],v[60:63],v[28:31],a[4:7]
v_mfma_f32_16x16x32_bf16 a[8:11],v[152:155],v[28:31],a[8:11]
v_mfma_f32_16x16x32_bf16 a[8:11],v[56:59],a[252:255],a[8:11]
buffer_load_dwordx4 a[248:251],v253,s[24:27],0 offen offset:3072 sc1
v_mfma_f32_16x16x32_bf16 a[12:15],v[24:27],a[252:255],a[12:15]
v_mfma_f32_16x16x32_bf16 a[12:15],a[200:203],v[28:31],a[12:15]
v_mfma_f32_16x16x32_bf16 a[16:19],v[68:71],v[28:31],a[16:19]
v_mfma_f32_16x16x32_bf16 a[16:19],v[80:83],a[252:255],a[16:19]
buffer_load_dwordx4 v[168:171],v253,s[24:27],s68 offen sc1
s_waitcnt vmcnt(25)
v_mfma_f32_16x16x32_bf16 a[36:39],v[80:83],v[228:231],a[36:39]
v_mfma_f32_16x16x32_bf16 a[36:39],v[68:71],v[220:223],a[36:39]
v_mfma_f32_16x16x32_bf16 a[32:35],a[200:203],v[220:223],a[32:35]
v_mfma_f32_16x16x32_bf16 a[32:35],v[24:27],v[228:231],a[32:35]
buffer_load_dwordx4 a[192:195],v18,s[20:23],s52 offen sc1
v_mfma_f32_16x16x32_bf16 a[28:31],v[56:59],v[228:231],a[28:31]
v_mfma_f32_16x16x32_bf16 a[28:31],v[152:155],v[220:223],a[28:31]
v_mfma_f32_16x16x32_bf16 a[24:27],v[60:63],v[220:223],a[24:27]
buffer_load_dwordx4 v[124:127],v252,s[20:23],s52 offen sc1
v_mfma_f32_16x16x32_bf16 a[24:27],v[52:55],v[228:231],a[24:27]
v_mfma_f32_16x16x32_bf16 a[20:23],v[72:75],v[228:231],a[20:23]
v_mfma_f32_16x16x32_bf16 a[20:23],v[64:67],v[220:223],a[20:23]
s_waitcnt vmcnt(26)
v_mfma_f32_16x16x32_bf16 a[40:43],v[64:67],v[224:227],a[40:43]
buffer_load_dwordx4 v[76:79],v18,s[20:23],s52 offen offset:1024 sc1
s_waitcnt vmcnt(26)
v_mfma_f32_16x16x32_bf16 a[40:43],v[72:75],v[232:235],a[40:43]
v_mfma_f32_16x16x32_bf16 a[44:47],v[52:55],v[232:235],a[44:47]
v_mfma_f32_16x16x32_bf16 a[44:47],v[60:63],v[224:227],a[44:47]
v_mfma_f32_16x16x32_bf16 a[48:51],v[152:155],v[224:227],a[48:51]
buffer_load_dwordx4 v[96:99],v252,s[20:23],s52 offen offset:1024 sc1
v_mfma_f32_16x16x32_bf16 a[48:51],v[56:59],v[232:235],a[48:51]
v_mfma_f32_16x16x32_bf16 a[52:55],v[24:27],v[232:235],a[52:55]
v_mfma_f32_16x16x32_bf16 a[52:55],a[200:203],v[224:227],a[52:55]
buffer_load_dwordx4 v[84:87],v18,s[20:23],s53 offen sc1
v_mfma_f32_16x16x32_bf16 a[56:59],v[68:71],v[224:227],a[56:59]
v_mfma_f32_16x16x32_bf16 a[56:59],v[80:83],v[232:235],a[56:59]
s_waitcnt vmcnt(26)
v_mfma_f32_16x16x32_bf16 a[76:79],v[80:83],v[244:247],a[76:79]
v_mfma_f32_16x16x32_bf16 a[76:79],v[68:71],v[236:239],a[76:79]
buffer_load_dwordx4 v[88:91],v252,s[20:23],s53 offen sc1
v_mfma_f32_16x16x32_bf16 a[72:75],a[200:203],v[236:239],a[72:75]
v_mfma_f32_16x16x32_bf16 a[72:75],v[24:27],v[244:247],a[72:75]
v_mfma_f32_16x16x32_bf16 a[68:71],v[56:59],v[244:247],a[68:71]
v_mfma_f32_16x16x32_bf16 a[68:71],v[152:155],v[236:239],a[68:71]
buffer_load_dwordx4 v[92:95],v18,s[20:23],s53 offen offset:1024 sc1
v_mfma_f32_16x16x32_bf16 a[64:67],v[60:63],v[236:239],a[64:67]
v_mfma_f32_16x16x32_bf16 a[64:67],v[52:55],v[244:247],a[64:67]
v_mfma_f32_16x16x32_bf16 a[60:63],v[72:75],v[244:247],a[60:63]
v_mfma_f32_16x16x32_bf16 a[60:63],v[64:67],v[236:239],a[60:63]
buffer_load_dwordx4 a[180:183],v252,s[20:23],s53 offen offset:1024 sc1
s_waitcnt vmcnt(28)
v_mfma_f32_16x16x32_bf16 a[80:83],v[64:67],v[240:243],a[80:83]
s_waitcnt vmcnt(27)
v_mfma_f32_16x16x32_bf16 a[80:83],v[72:75],v[248:251],a[80:83]
v_mfma_f32_16x16x32_bf16 a[84:87],v[52:55],v[248:251],a[84:87]
buffer_load_dwordx4 v[100:103],v18,s[20:23],s54 offen sc1
v_mfma_f32_16x16x32_bf16 a[84:87],v[60:63],v[240:243],a[84:87]
v_mfma_f32_16x16x32_bf16 a[88:91],v[152:155],v[240:243],a[88:91]
v_mfma_f32_16x16x32_bf16 a[88:91],v[56:59],v[248:251],a[88:91]
v_mfma_f32_16x16x32_bf16 a[92:95],v[24:27],v[248:251],a[92:95]
buffer_load_dwordx4 v[104:107],v252,s[20:23],s54 offen sc1
v_mfma_f32_16x16x32_bf16 a[92:95],a[200:203],v[240:243],a[92:95]
v_mfma_f32_16x16x32_bf16 a[96:99],v[68:71],v[240:243],a[96:99]
v_mfma_f32_16x16x32_bf16 a[96:99],v[80:83],v[248:251],a[96:99]
s_waitcnt vmcnt(27)
v_mfma_f32_16x16x32_bf16 a[116:119],v[80:83],a[236:239],a[116:119]
buffer_load_dwordx4 v[108:111],v18,s[20:23],s54 offen offset:1024 sc1
v_mfma_f32_16x16x32_bf16 a[116:119],v[68:71],v[176:179],a[116:119]
v_mfma_f32_16x16x32_bf16 a[112:115],a[200:203],v[176:179],a[112:115]
v_mfma_f32_16x16x32_bf16 a[112:115],v[24:27],a[236:239],a[112:115]
v_mfma_f32_16x16x32_bf16 a[108:111],v[56:59],a[236:239],a[108:111]
buffer_load_dwordx4 v[36:39],v252,s[20:23],s54 offen offset:1024 sc1
v_mfma_f32_16x16x32_bf16 a[108:111],v[152:155],v[176:179],a[108:111]
v_mfma_f32_16x16x32_bf16 a[104:107],v[60:63],v[176:179],a[104:107]
v_mfma_f32_16x16x32_bf16 a[104:107],v[52:55],a[236:239],a[104:107]
buffer_load_dwordx4 a[204:207],v18,s[20:23],s55 offen sc1
v_mfma_f32_16x16x32_bf16 a[100:103],v[72:75],a[236:239],a[100:103]
v_mfma_f32_16x16x32_bf16 a[100:103],v[64:67],v[176:179],a[100:103]
s_waitcnt vmcnt(29)
v_mfma_f32_16x16x32_bf16 a[120:123],v[64:67],a[220:223],a[120:123]
s_waitcnt vmcnt(28)
v_mfma_f32_16x16x32_bf16 a[120:123],v[72:75],a[232:235],a[120:123]
buffer_load_dwordx4 v[32:35],v252,s[20:23],s55 offen sc1
v_mfma_f32_16x16x32_bf16 a[124:127],v[52:55],a[232:235],a[124:127]
v_mfma_f32_16x16x32_bf16 a[124:127],v[60:63],a[220:223],a[124:127]
v_mfma_f32_16x16x32_bf16 a[128:131],v[152:155],a[220:223],a[128:131]
v_mfma_f32_16x16x32_bf16 a[128:131],v[56:59],a[232:235],a[128:131]
buffer_load_dwordx4 a[208:211],v18,s[20:23],s55 offen offset:1024 sc1
v_mfma_f32_16x16x32_bf16 a[132:135],v[24:27],a[232:235],a[132:135]
v_mfma_f32_16x16x32_bf16 a[132:135],a[200:203],a[220:223],a[132:135]
v_mfma_f32_16x16x32_bf16 a[136:139],v[68:71],a[220:223],a[136:139]
v_mfma_f32_16x16x32_bf16 a[136:139],v[80:83],a[232:235],a[136:139]
buffer_load_dwordx4 v[44:47],v252,s[20:23],s55 offen offset:1024 sc1
s_waitcnt vmcnt(29)
v_mfma_f32_16x16x32_bf16 a[156:159],v[80:83],v[112:115],a[156:159]
v_mfma_f32_16x16x32_bf16 a[156:159],v[68:71],a[240:243],a[156:159]
v_mfma_f32_16x16x32_bf16 a[152:155],a[200:203],a[240:243],a[152:155]
buffer_load_dwordx4 v[20:23],v18,s[20:23],s69 offen sc1
v_mfma_f32_16x16x32_bf16 a[152:155],v[24:27],v[112:115],a[152:155]
v_mfma_f32_16x16x32_bf16 a[148:151],v[56:59],v[112:115],a[148:151]
v_mfma_f32_16x16x32_bf16 a[148:151],v[152:155],a[240:243],a[148:151]
v_mfma_f32_16x16x32_bf16 a[144:147],v[60:63],a[240:243],a[144:147]
buffer_load_dwordx4 v[136:139],v252,s[20:23],s69 offen sc1
v_mfma_f32_16x16x32_bf16 a[144:147],v[52:55],v[112:115],a[144:147]
v_mfma_f32_16x16x32_bf16 a[140:143],v[72:75],v[112:115],a[140:143]
v_mfma_f32_16x16x32_bf16 a[140:143],v[64:67],a[240:243],a[140:143]
s_waitcnt vmcnt(30)
v_mfma_f32_16x16x32_bf16 a[160:163],v[64:67],a[244:247],a[160:163]
s_lshl_b32 s59,s51,3
s_add_u32 s59,s59,s48
s_add_u32 s59,s59,64
s_mul_i32 s57,s59,5120
v_add_u32 v17,s57,v10
buffer_load_dwordx4 v[156:159],v17,s[24:27],0 offen sc1
s_waitcnt vmcnt(30)
v_mfma_f32_16x16x32_bf16 a[160:163],v[72:75],a[184:187],a[160:163]
v_mfma_f32_16x16x32_bf16 a[164:167],v[52:55],a[184:187],a[164:167]
v_mfma_f32_16x16x32_bf16 a[164:167],v[60:63],a[244:247],a[164:167]
v_mfma_f32_16x16x32_bf16 a[168:171],v[152:155],a[244:247],a[168:171]
buffer_load_dwordx4 v[128:131],v17,s[24:27],0 offen offset:1024 sc1
v_mfma_f32_16x16x32_bf16 a[168:171],v[56:59],a[184:187],a[168:171]
v_mfma_f32_16x16x32_bf16 a[172:175],v[24:27],a[184:187],a[172:175]
v_mfma_f32_16x16x32_bf16 a[172:175],a[200:203],a[244:247],a[172:175]
buffer_load_dwordx4 v[144:147],v17,s[24:27],0 offen offset:2048 sc1
v_mfma_f32_16x16x32_bf16 a[176:179],v[68:71],a[244:247],a[176:179]
v_mfma_f32_16x16x32_bf16 a[176:179],v[80:83],a[184:187],a[176:179]
s_waitcnt vmcnt(20)
v_mfma_f32_16x16x32_bf16 a[0:3],a[228:231],a[192:195],a[0:3]
s_waitcnt vmcnt(19)
v_mfma_f32_16x16x32_bf16 a[0:3],a[216:219],v[124:127],a[0:3]
buffer_load_dwordx4 a[196:199],v17,s[24:27],0 offen offset:3072 sc1
v_mfma_f32_16x16x32_bf16 a[4:7],v[164:167],v[124:127],a[4:7]
v_mfma_f32_16x16x32_bf16 a[4:7],a[224:227],a[192:195],a[4:7]
v_mfma_f32_16x16x32_bf16 a[8:11],v[48:51],a[192:195],a[8:11]
v_mfma_f32_16x16x32_bf16 a[8:11],v[172:175],v[124:127],a[8:11]
buffer_load_dwordx4 v[132:135],v17,s[24:27],s68 offen sc1
v_mfma_f32_16x16x32_bf16 a[12:15],a[248:251],v[124:127],a[12:15]
v_mfma_f32_16x16x32_bf16 a[12:15],a[188:191],a[192:195],a[12:15]
v_mfma_f32_16x16x32_bf16 a[16:19],a[212:215],a[192:195],a[16:19]
s_lshl_b32 s59,s51,3
s_add_u32 s59,s59,s48
s_add_u32 s59,s59,68
s_mul_i32 s57,s59,5120
v_add_u32 v15,s57,v10
buffer_load_dwordx4 v[116:119],v15,s[24:27],0 offen sc1
v_mfma_f32_16x16x32_bf16 a[16:19],v[168:171],v[124:127],a[16:19]
s_waitcnt vmcnt(20)
v_mfma_f32_16x16x32_bf16 a[36:39],v[168:171],v[96:99],a[36:39]
v_mfma_f32_16x16x32_bf16 a[36:39],a[212:215],v[76:79],a[36:39]
v_mfma_f32_16x16x32_bf16 a[32:35],a[188:191],v[76:79],a[32:35]
buffer_load_dwordx4 v[120:123],v15,s[24:27],0 offen offset:1024 sc1
v_mfma_f32_16x16x32_bf16 a[32:35],a[248:251],v[96:99],a[32:35]
v_mfma_f32_16x16x32_bf16 a[28:31],v[172:175],v[96:99],a[28:31]
v_mfma_f32_16x16x32_bf16 a[28:31],v[48:51],v[76:79],a[28:31]
v_mfma_f32_16x16x32_bf16 a[24:27],a[224:227],v[76:79],a[24:27]
buffer_load_dwordx4 v[148:151],v15,s[24:27],0 offen offset:2048 sc1
v_mfma_f32_16x16x32_bf16 a[24:27],v[164:167],v[96:99],a[24:27]
v_mfma_f32_16x16x32_bf16 a[20:23],a[216:219],v[96:99],a[20:23]
v_mfma_f32_16x16x32_bf16 a[20:23],a[228:231],v[76:79],a[20:23]
s_waitcnt vmcnt(21)
v_mfma_f32_16x16x32_bf16 a[40:43],a[228:231],v[84:87],a[40:43]
buffer_load_dwordx4 v[40:43],v15,s[24:27],0 offen offset:3072 sc1
s_waitcnt vmcnt(21)
v_mfma_f32_16x16x32_bf16 a[40:43],a[216:219],v[88:91],a[40:43]
v_mfma_f32_16x16x32_bf16 a[44:47],v[164:167],v[88:91],a[44:47]
v_mfma_f32_16x16x32_bf16 a[44:47],a[224:227],v[84:87],a[44:47]
buffer_load_dwordx4 v[160:163],v15,s[24:27],s68 offen sc1
v_mfma_f32_16x16x32_bf16 a[48:51],v[48:51],v[84:87],a[48:51]
v_mfma_f32_16x16x32_bf16 a[48:51],v[172:175],v[88:91],a[48:51]
v_mfma_f32_16x16x32_bf16 a[52:55],a[248:251],v[88:91],a[52:55]
v_mfma_f32_16x16x32_bf16 a[52:55],a[188:191],v[84:87],a[52:55]
v_cmp_eq_u32 vcc,1,v254
s_nop 3
s_and_b32 s101,vcc_lo,0xff
s_cmp_eq_u32 s101,0xff
s_cbranch_scc1 L_f1a
s_mov_b32 s72,0
L_f1a_spin:
s_sleep 8
buffer_load_dword v254,v255,s[40:43],0 offen offset:32 sc1
s_waitcnt vmcnt(0)
s_add_u32 s72,s72,1
s_cmp_ge_u32 s72,0x40000
s_cbranch_scc1 L_f1a
v_cmp_eq_u32 vcc,1,v254
s_nop 3
s_and_b32 s101,vcc_lo,0xff
s_cmp_eq_u32 s101,0xff
s_cbranch_scc0 L_f1a_spin
L_f1a:
s_cmp_eq_u32 s95,1
s_cbranch_scc1 L_aqa
buffer_inv sc1
L_aqa:
s_cmp_le_u32 s51,0
s_cselect_b32 s59,8,0
s_add_u32 s59,s59,s48
s_add_u32 s59,s59,64
s_mul_i32 s57,s59,9216
v_add_u32 v252,s57,v10
s_mul_i32 s57,s59,5120
v_add_u32 v253,s57,v10
buffer_load_dwordx4 v[140:143],v253,s[24:27],0 offen sc1
v_mfma_f32_16x16x32_bf16 a[56:59],a[212:215],v[84:87],a[56:59]
v_mfma_f32_16x16x32_bf16 a[56:59],v[168:171],v[88:91],a[56:59]
s_waitcnt vmcnt(21)
v_mfma_f32_16x16x32_bf16 a[76:79],v[168:171],a[180:183],a[76:79]
v_mfma_f32_16x16x32_bf16 a[76:79],a[212:215],v[92:95],a[76:79]
buffer_load_dwordx4 v[28:31],v253,s[24:27],0 offen offset:1024 sc1
v_mfma_f32_16x16x32_bf16 a[72:75],a[188:191],v[92:95],a[72:75]
v_mfma_f32_16x16x32_bf16 a[72:75],a[248:251],a[180:183],a[72:75]
v_mfma_f32_16x16x32_bf16 a[68:71],v[172:175],a[180:183],a[68:71]
v_mfma_f32_16x16x32_bf16 a[68:71],v[48:51],v[92:95],a[68:71]
buffer_load_dwordx4 a[252:255],v253,s[24:27],0 offen offset:2048 sc1
v_mfma_f32_16x16x32_bf16 a[64:67],a[224:227],v[92:95],a[64:67]
v_mfma_f32_16x16x32_bf16 a[64:67],v[164:167],a[180:183],a[64:67]
v_mfma_f32_16x16x32_bf16 a[60:63],a[216:219],a[180:183],a[60:63]
buffer_load_dwordx4 v[228:231],v253,s[24:27],0 offen offset:3072 sc1
v_mfma_f32_16x16x32_bf16 a[60:63],a[228:231],v[92:95],a[60:63]
s_waitcnt vmcnt(23)
v_mfma_f32_16x16x32_bf16 a[80:83],a[228:231],v[100:103],a[80:83]
s_waitcnt vmcnt(22)
v_mfma_f32_16x16x32_bf16 a[80:83],a[216:219],v[104:107],a[80:83]
v_mfma_f32_16x16x32_bf16 a[84:87],v[164:167],v[104:107],a[84:87]
buffer_load_dwordx4 v[220:223],v253,s[24:27],s68 offen sc1
v_mfma_f32_16x16x32_bf16 a[84:87],a[224:227],v[100:103],a[84:87]
v_mfma_f32_16x16x32_bf16 a[88:91],v[48:51],v[100:103],a[88:91]
v_mfma_f32_16x16x32_bf16 a[88:91],v[172:175],v[104:107],a[88:91]
v_mfma_f32_16x16x32_bf16 a[92:95],a[248:251],v[104:107],a[92:95]
s_cmp_le_u32 s51,0
s_cselect_b32 s59,8,0
s_add_u32 s59,s59,s48
s_add_u32 s59,s59,68
s_mul_i32 s57,s59,9216
v_add_u32 v16,s57,v10
s_mul_i32 s57,s59,5120
v_add_u32 v17,s57,v10
buffer_load_dwordx4 v[224:227],v17,s[24:27],0 offen sc1
v_mfma_f32_16x16x32_bf16 a[92:95],a[188:191],v[100:103],a[92:95]
v_mfma_f32_16x16x32_bf16 a[96:99],a[212:215],v[100:103],a[96:99]
v_mfma_f32_16x16x32_bf16 a[96:99],v[168:171],v[104:107],a[96:99]
s_waitcnt vmcnt(22)
v_mfma_f32_16x16x32_bf16 a[116:119],v[168:171],v[36:39],a[116:119]
buffer_load_dwordx4 v[232:235],v17,s[24:27],0 offen offset:1024 sc1
v_mfma_f32_16x16x32_bf16 a[116:119],a[212:215],v[108:111],a[116:119]
v_mfma_f32_16x16x32_bf16 a[112:115],a[188:191],v[108:111],a[112:115]
v_mfma_f32_16x16x32_bf16 a[112:115],a[248:251],v[36:39],a[112:115]
buffer_load_dwordx4 v[244:247],v17,s[24:27],0 offen offset:2048 sc1
v_mfma_f32_16x16x32_bf16 a[108:111],v[172:175],v[36:39],a[108:111]
v_mfma_f32_16x16x32_bf16 a[108:111],v[48:51],v[108:111],a[108:111]
v_mfma_f32_16x16x32_bf16 a[104:107],a[224:227],v[108:111],a[104:107]
v_mfma_f32_16x16x32_bf16 a[104:107],v[164:167],v[36:39],a[104:107]
buffer_load_dwordx4 v[236:239],v17,s[24:27],0 offen offset:3072 sc1
v_mfma_f32_16x16x32_bf16 a[100:103],a[216:219],v[36:39],a[100:103]
v_mfma_f32_16x16x32_bf16 a[100:103],a[228:231],v[108:111],a[100:103]
s_waitcnt vmcnt(24)
v_mfma_f32_16x16x32_bf16 a[120:123],a[228:231],a[204:207],a[120:123]
s_waitcnt vmcnt(23)
v_mfma_f32_16x16x32_bf16 a[120:123],a[216:219],v[32:35],a[120:123]
buffer_load_dwordx4 v[240:243],v17,s[24:27],s68 offen sc1
v_mfma_f32_16x16x32_bf16 a[124:127],v[164:167],v[32:35],a[124:127]
v_mfma_f32_16x16x32_bf16 a[124:127],a[224:227],a[204:207],a[124:127]
v_mfma_f32_16x16x32_bf16 a[128:131],v[48:51],a[204:207],a[128:131]
v_mfma_f32_16x16x32_bf16 a[128:131],v[172:175],v[32:35],a[128:131]
buffer_load_dwordx4 v[248:251],v252,s[20:23],s52 offen sc1
v_mfma_f32_16x16x32_bf16 a[132:135],a[248:251],v[32:35],a[132:135]
v_mfma_f32_16x16x32_bf16 a[132:135],a[188:191],a[204:207],a[132:135]
v_mfma_f32_16x16x32_bf16 a[136:139],a[212:215],a[204:207],a[136:139]
buffer_load_dwordx4 a[236:239],v16,s[20:23],s52 offen sc1
v_mfma_f32_16x16x32_bf16 a[136:139],v[168:171],v[32:35],a[136:139]
s_waitcnt vmcnt(24)
v_mfma_f32_16x16x32_bf16 a[156:159],v[168:171],v[44:47],a[156:159]
v_mfma_f32_16x16x32_bf16 a[156:159],a[212:215],a[208:211],a[156:159]
v_mfma_f32_16x16x32_bf16 a[152:155],a[188:191],a[208:211],a[152:155]
buffer_load_dwordx4 v[176:179],v252,s[20:23],s52 offen offset:1024 sc1
v_mfma_f32_16x16x32_bf16 a[152:155],a[248:251],v[44:47],a[152:155]
v_mfma_f32_16x16x32_bf16 a[148:151],v[172:175],v[44:47],a[148:151]
v_mfma_f32_16x16x32_bf16 a[148:151],v[48:51],a[208:211],a[148:151]
v_mfma_f32_16x16x32_bf16 a[144:147],a[224:227],a[208:211],a[144:147]
buffer_load_dwordx4 a[220:223],v16,s[20:23],s52 offen offset:1024 sc1
v_mfma_f32_16x16x32_bf16 a[144:147],v[164:167],v[44:47],a[144:147]
v_mfma_f32_16x16x32_bf16 a[140:143],a[216:219],v[44:47],a[140:143]
v_mfma_f32_16x16x32_bf16 a[140:143],a[228:231],a[208:211],a[140:143]
buffer_load_dwordx4 a[232:235],v252,s[20:23],s53 offen sc1
s_waitcnt vmcnt(26)
v_mfma_f32_16x16x32_bf16 a[160:163],a[228:231],v[20:23],a[160:163]
s_waitcnt vmcnt(25)
v_mfma_f32_16x16x32_bf16 a[160:163],a[216:219],v[136:139],a[160:163]
v_mfma_f32_16x16x32_bf16 a[164:167],v[164:167],v[136:139],a[164:167]
v_mfma_f32_16x16x32_bf16 a[164:167],a[224:227],v[20:23],a[164:167]
buffer_load_dwordx4 v[112:115],v16,s[20:23],s53 offen sc1
v_mfma_f32_16x16x32_bf16 a[168:171],v[48:51],v[20:23],a[168:171]
v_mfma_f32_16x16x32_bf16 a[168:171],v[172:175],v[136:139],a[168:171]
v_mfma_f32_16x16x32_bf16 a[172:175],a[248:251],v[136:139],a[172:175]
v_mfma_f32_16x16x32_bf16 a[172:175],a[188:191],v[20:23],a[172:175]
buffer_load_dwordx4 a[240:243],v252,s[20:23],s53 offen offset:1024 sc1
v_mfma_f32_16x16x32_bf16 a[176:179],a[212:215],v[20:23],a[176:179]
v_mfma_f32_16x16x32_bf16 a[176:179],v[168:171],v[136:139],a[176:179]
s_mul_i32 s59,s48,9216
s_add_u32 s59,s59,65536
v_add_u32 v5,s59,v10
v_add_u32 v1,s52,v5
v_add_u32 v2,s53,v5
v_add_u32 v3,s54,v5
v_add_u32 v4,s55,v5
ds_read_b128 v[64:67],v1 offset:0
s_waitcnt vmcnt(26) lgkmcnt(0)
v_mfma_f32_16x16x32_bf16 a[0:3],v[156:159],v[64:67],a[0:3]
ds_read_b128 v[72:75],v1 offset:36864
s_waitcnt vmcnt(21) lgkmcnt(0)
v_mfma_f32_16x16x32_bf16 a[0:3],v[116:119],v[72:75],a[0:3]
ds_read_b128 v[52:55],v1 offset:1024
buffer_load_dwordx4 v[60:63],v16,s[20:23],s53 offen offset:1024 sc1
s_waitcnt vmcnt(21)
v_mfma_f32_16x16x32_bf16 a[4:7],v[120:123],v[72:75],a[4:7]
ds_read_b128 v[152:155],v1 offset:37888
v_mfma_f32_16x16x32_bf16 a[4:7],v[128:131],v[64:67],a[4:7]
ds_read_b128 v[56:59],v2 offset:0
v_mfma_f32_16x16x32_bf16 a[8:11],v[144:147],v[64:67],a[8:11]
ds_read_b128 v[24:27],v2 offset:36864
buffer_load_dwordx4 a[200:203],v252,s[20:23],s54 offen sc1
s_waitcnt vmcnt(21)
v_mfma_f32_16x16x32_bf16 a[8:11],v[148:151],v[72:75],a[8:11]
ds_read_b128 v[68:71],v2 offset:1024
s_waitcnt vmcnt(20)
v_mfma_f32_16x16x32_bf16 a[12:15],v[40:43],v[72:75],a[12:15]
ds_read_b128 a[244:247],v2 offset:37888
v_mfma_f32_16x16x32_bf16 a[12:15],a[196:199],v[64:67],a[12:15]
ds_read_b128 v[80:83],v3 offset:0
v_mfma_f32_16x16x32_bf16 a[16:19],v[132:135],v[64:67],a[16:19]
buffer_load_dwordx4 a[184:187],v16,s[20:23],s54 offen sc1
s_waitcnt vmcnt(20)
v_mfma_f32_16x16x32_bf16 a[16:19],v[160:163],v[72:75],a[16:19]
ds_read_b128 a[192:195],v3 offset:36864
s_waitcnt lgkmcnt(6)
v_mfma_f32_16x16x32_bf16 a[36:39],v[160:163],v[152:155],a[36:39]
ds_read_b128 v[124:127],v3 offset:1024
v_mfma_f32_16x16x32_bf16 a[36:39],v[132:135],v[52:55],a[36:39]
v_mfma_f32_16x16x32_bf16 a[32:35],a[196:199],v[52:55],a[32:35]
buffer_load_dwordx4 v[96:99],v252,s[20:23],s54 offen offset:1024 sc1
v_mfma_f32_16x16x32_bf16 a[32:35],v[40:43],v[152:155],a[32:35]
ds_read_b128 v[76:79],v3 offset:37888
v_mfma_f32_16x16x32_bf16 a[28:31],v[148:151],v[152:155],a[28:31]
v_mfma_f32_16x16x32_bf16 a[28:31],v[144:147],v[52:55],a[28:31]
v_mfma_f32_16x16x32_bf16 a[24:27],v[128:131],v[52:55],a[24:27]
buffer_load_dwordx4 v[84:87],v16,s[20:23],s54 offen offset:1024 sc1
v_mfma_f32_16x16x32_bf16 a[24:27],v[120:123],v[152:155],a[24:27]
v_mfma_f32_16x16x32_bf16 a[20:23],v[116:119],v[152:155],a[20:23]
v_mfma_f32_16x16x32_bf16 a[20:23],v[156:159],v[52:55],a[20:23]
buffer_load_dwordx4 v[88:91],v252,s[20:23],s55 offen sc1
s_waitcnt lgkmcnt(7)
v_mfma_f32_16x16x32_bf16 a[40:43],v[156:159],v[56:59],a[40:43]
ds_read_b128 a[180:183],v4 offset:0
s_waitcnt lgkmcnt(7)
v_mfma_f32_16x16x32_bf16 a[40:43],v[116:119],v[24:27],a[40:43]
ds_read_b128 v[92:95],v4 offset:36864
v_mfma_f32_16x16x32_bf16 a[44:47],v[120:123],v[24:27],a[44:47]
v_mfma_f32_16x16x32_bf16 a[44:47],v[128:131],v[56:59],a[44:47]
buffer_load_dwordx4 v[100:103],v16,s[20:23],s55 offen sc1
v_mfma_f32_16x16x32_bf16 a[48:51],v[144:147],v[56:59],a[48:51]
v_mfma_f32_16x16x32_bf16 a[48:51],v[148:151],v[24:27],a[48:51]
v_mfma_f32_16x16x32_bf16 a[52:55],v[40:43],v[24:27],a[52:55]
v_mfma_f32_16x16x32_bf16 a[52:55],a[196:199],v[56:59],a[52:55]
buffer_load_dwordx4 v[104:107],v252,s[20:23],s55 offen offset:1024 sc1
v_mfma_f32_16x16x32_bf16 a[56:59],v[132:135],v[56:59],a[56:59]
v_mfma_f32_16x16x32_bf16 a[56:59],v[160:163],v[24:27],a[56:59]
s_waitcnt lgkmcnt(6)
v_mfma_f32_16x16x32_bf16 a[76:79],v[160:163],a[244:247],a[76:79]
ds_read_b128 v[36:39],v4 offset:1024
v_mfma_f32_16x16x32_bf16 a[76:79],v[132:135],v[68:71],a[76:79]
buffer_load_dwordx4 v[108:111],v16,s[20:23],s55 offen offset:1024 sc1
v_mfma_f32_16x16x32_bf16 a[72:75],a[196:199],v[68:71],a[72:75]
v_mfma_f32_16x16x32_bf16 a[72:75],v[40:43],a[244:247],a[72:75]
ds_read_b128 a[204:207],v4 offset:37888
v_mfma_f32_16x16x32_bf16 a[68:71],v[148:151],a[244:247],a[68:71]
buffer_load_dwordx4 v[32:35],v252,s[20:23],s69 offen sc1
v_mfma_f32_16x16x32_bf16 a[68:71],v[144:147],v[68:71],a[68:71]
v_mfma_f32_16x16x32_bf16 a[64:67],v[128:131],v[68:71],a[64:67]
v_mfma_f32_16x16x32_bf16 a[64:67],v[120:123],a[244:247],a[64:67]
v_mfma_f32_16x16x32_bf16 a[60:63],v[116:119],a[244:247],a[60:63]
buffer_load_dwordx4 v[44:47],v16,s[20:23],s69 offen sc1
v_mfma_f32_16x16x32_bf16 a[60:63],v[156:159],v[68:71],a[60:63]
s_waitcnt lgkmcnt(7)
v_mfma_f32_16x16x32_bf16 a[80:83],v[156:159],v[80:83],a[80:83]
ds_read_b128 a[208:211],v5 offset:8192
s_waitcnt lgkmcnt(7)
v_mfma_f32_16x16x32_bf16 a[80:83],v[116:119],a[192:195],a[80:83]
ds_read_b128 a[228:231],v5 offset:45056
v_mfma_f32_16x16x32_bf16 a[84:87],v[120:123],a[192:195],a[84:87]
s_cmp_le_u32 s51,1
s_cselect_b32 s59,8,0
s_add_u32 s59,s59,s48
s_add_u32 s59,s59,72
s_mul_i32 s57,s59,9216
v_add_u32 v18,s57,v10
s_mul_i32 s57,s59,5120
v_add_u32 v15,s57,v10
buffer_load_dwordx4 a[216:219],v15,s[24:27],0 offen sc1
v_mfma_f32_16x16x32_bf16 a[84:87],v[128:131],v[80:83],a[84:87]
v_mfma_f32_16x16x32_bf16 a[88:91],v[144:147],v[80:83],a[88:91]
v_mfma_f32_16x16x32_bf16 a[88:91],v[148:151],a[192:195],a[88:91]
buffer_load_dwordx4 v[164:167],v15,s[24:27],0 offen offset:1024 sc1
v_mfma_f32_16x16x32_bf16 a[92:95],v[40:43],a[192:195],a[92:95]
v_mfma_f32_16x16x32_bf16 a[92:95],a[196:199],v[80:83],a[92:95]
v_mfma_f32_16x16x32_bf16 a[96:99],v[132:135],v[80:83],a[96:99]
v_mfma_f32_16x16x32_bf16 a[96:99],v[160:163],a[192:195],a[96:99]
buffer_load_dwordx4 a[224:227],v15,s[24:27],0 offen offset:2048 sc1
s_waitcnt lgkmcnt(6)
v_mfma_f32_16x16x32_bf16 a[116:119],v[160:163],v[76:79],a[116:119]
v_mfma_f32_16x16x32_bf16 a[116:119],v[132:135],v[124:127],a[116:119]
v_mfma_f32_16x16x32_bf16 a[112:115],a[196:199],v[124:127],a[112:115]
v_mfma_f32_16x16x32_bf16 a[112:115],v[40:43],v[76:79],a[112:115]
buffer_load_dwordx4 v[48:51],v15,s[24:27],0 offen offset:3072 sc1
v_mfma_f32_16x16x32_bf16 a[108:111],v[148:151],v[76:79],a[108:111]
v_mfma_f32_16x16x32_bf16 a[108:111],v[144:147],v[124:127],a[108:111]
v_mfma_f32_16x16x32_bf16 a[104:107],v[128:131],v[124:127],a[104:107]
v_mfma_f32_16x16x32_bf16 a[104:107],v[120:123],v[76:79],a[104:107]
buffer_load_dwordx4 v[172:175],v15,s[24:27],s68 offen sc1
v_mfma_f32_16x16x32_bf16 a[100:103],v[116:119],v[76:79],a[100:103]
v_mfma_f32_16x16x32_bf16 a[100:103],v[156:159],v[124:127],a[100:103]
s_waitcnt lgkmcnt(5)
v_mfma_f32_16x16x32_bf16 a[120:123],v[156:159],a[180:183],a[120:123]
s_cmp_le_u32 s51,1
s_cselect_b32 s59,8,0
s_add_u32 s59,s59,s48
s_add_u32 s59,s59,76
s_mul_i32 s57,s59,9216
v_add_u32 v252,s57,v10
s_mul_i32 s57,s59,5120
v_add_u32 v253,s57,v10
buffer_load_dwordx4 a[248:251],v253,s[24:27],0 offen sc1
s_waitcnt lgkmcnt(4)
v_mfma_f32_16x16x32_bf16 a[120:123],v[116:119],v[92:95],a[120:123]
v_mfma_f32_16x16x32_bf16 a[124:127],v[120:123],v[92:95],a[124:127]
v_mfma_f32_16x16x32_bf16 a[124:127],v[128:131],a[180:183],a[124:127]
v_mfma_f32_16x16x32_bf16 a[128:131],v[144:147],a[180:183],a[128:131]
buffer_load_dwordx4 a[188:191],v253,s[24:27],0 offen offset:1024 sc1
v_mfma_f32_16x16x32_bf16 a[128:131],v[148:151],v[92:95],a[128:131]
v_mfma_f32_16x16x32_bf16 a[132:135],v[40:43],v[92:95],a[132:135]
v_mfma_f32_16x16x32_bf16 a[132:135],a[196:199],a[180:183],a[132:135]
v_mfma_f32_16x16x32_bf16 a[136:139],v[132:135],a[180:183],a[136:139]
buffer_load_dwordx4 a[212:215],v253,s[24:27],0 offen offset:2048 sc1
v_mfma_f32_16x16x32_bf16 a[136:139],v[160:163],v[92:95],a[136:139]
s_waitcnt lgkmcnt(2)
v_mfma_f32_16x16x32_bf16 a[156:159],v[160:163],a[204:207],a[156:159]
v_mfma_f32_16x16x32_bf16 a[156:159],v[132:135],v[36:39],a[156:159]
v_mfma_f32_16x16x32_bf16 a[152:155],a[196:199],v[36:39],a[152:155]
buffer_load_dwordx4 v[20:23],v253,s[24:27],0 offen offset:3072 sc1
v_mfma_f32_16x16x32_bf16 a[152:155],v[40:43],a[204:207],a[152:155]
v_mfma_f32_16x16x32_bf16 a[148:151],v[148:151],a[204:207],a[148:151]
v_mfma_f32_16x16x32_bf16 a[148:151],v[144:147],v[36:39],a[148:151]
buffer_load_dwordx4 v[168:171],v253,s[24:27],s68 offen sc1
v_mfma_f32_16x16x32_bf16 a[144:147],v[128:131],v[36:39],a[144:147]
v_mfma_f32_16x16x32_bf16 a[144:147],v[120:123],a[204:207],a[144:147]
v_mfma_f32_16x16x32_bf16 a[140:143],v[116:119],a[204:207],a[140:143]
v_mfma_f32_16x16x32_bf16 a[140:143],v[156:159],v[36:39],a[140:143]
buffer_load_dwordx4 v[136:139],v18,s[20:23],s52 offen sc1
s_waitcnt lgkmcnt(1)
v_mfma_f32_16x16x32_bf16 a[160:163],v[156:159],a[208:211],a[160:163]
s_waitcnt lgkmcnt(0)
v_mfma_f32_16x16x32_bf16 a[160:163],v[116:119],a[228:231],a[160:163]
v_mfma_f32_16x16x32_bf16 a[164:167],v[120:123],a[228:231],a[164:167]
v_mfma_f32_16x16x32_bf16 a[164:167],v[128:131],a[208:211],a[164:167]
buffer_load_dwordx4 v[64:67],v252,s[20:23],s52 offen sc1
v_mfma_f32_16x16x32_bf16 a[168:171],v[144:147],a[208:211],a[168:171]
v_mfma_f32_16x16x32_bf16 a[168:171],v[148:151],a[228:231],a[168:171]
v_mfma_f32_16x16x32_bf16 a[172:175],v[40:43],a[228:231],a[172:175]
v_mfma_f32_16x16x32_bf16 a[172:175],a[196:199],a[208:211],a[172:175]
buffer_load_dwordx4 v[72:75],v18,s[20:23],s52 offen offset:1024 sc1
v_mfma_f32_16x16x32_bf16 a[176:179],v[132:135],a[208:211],a[176:179]
v_mfma_f32_16x16x32_bf16 a[176:179],v[160:163],a[228:231],a[176:179]
s_waitcnt vmcnt(30)
v_mfma_f32_16x16x32_bf16 a[0:3],v[140:143],v[248:251],a[0:3]
buffer_load_dwordx4 v[152:155],v252,s[20:23],s52 offen offset:1024 sc1
s_waitcnt vmcnt(30)
v_mfma_f32_16x16x32_bf16 a[0:3],v[224:227],a[236:239],a[0:3]
v_mfma_f32_16x16x32_bf16 a[4:7],v[232:235],a[236:239],a[4:7]
v_mfma_f32_16x16x32_bf16 a[4:7],v[28:31],v[248:251],a[4:7]
v_mfma_f32_16x16x32_bf16 a[8:11],a[252:255],v[248:251],a[8:11]
buffer_load_dwordx4 v[52:55],v18,s[20:23],s53 offen sc1
v_mfma_f32_16x16x32_bf16 a[8:11],v[244:247],a[236:239],a[8:11]
v_mfma_f32_16x16x32_bf16 a[12:15],v[236:239],a[236:239],a[12:15]
v_mfma_f32_16x16x32_bf16 a[12:15],v[228:231],v[248:251],a[12:15]
v_mfma_f32_16x16x32_bf16 a[16:19],v[220:223],v[248:251],a[16:19]
buffer_load_dwordx4 v[56:59],v252,s[20:23],s53 offen sc1
v_mfma_f32_16x16x32_bf16 a[16:19],v[240:243],a[236:239],a[16:19]
s_waitcnt vmcnt(30)
v_mfma_f32_16x16x32_bf16 a[36:39],v[240:243],a[220:223],a[36:39]
v_mfma_f32_16x16x32_bf16 a[36:39],v[220:223],v[176:179],a[36:39]
v_mfma_f32_16x16x32_bf16 a[32:35],v[228:231],v[176:179],a[32:35]
buffer_load_dwordx4 v[24:27],v18,s[20:23],s53 offen offset:1024 sc1
v_mfma_f32_16x16x32_bf16 a[32:35],v[236:239],a[220:223],a[32:35]
v_mfma_f32_16x16x32_bf16 a[28:31],v[244:247],a[220:223],a[28:31]
v_mfma_f32_16x16x32_bf16 a[28:31],a[252:255],v[176:179],a[28:31]
buffer_load_dwordx4 a[244:247],v252,s[20:23],s53 offen offset:1024 sc1
v_mfma_f32_16x16x32_bf16 a[24:27],v[28:31],v[176:179],a[24:27]
v_mfma_f32_16x16x32_bf16 a[24:27],v[232:235],a[220:223],a[24:27]
v_mfma_f32_16x16x32_bf16 a[20:23],v[224:227],a[220:223],a[20:23]
v_mfma_f32_16x16x32_bf16 a[20:23],v[140:143],v[176:179],a[20:23]
buffer_load_dwordx4 v[68:71],v18,s[20:23],s54 offen sc1
s_waitcnt vmcnt(32)
v_mfma_f32_16x16x32_bf16 a[40:43],v[140:143],a[232:235],a[40:43]
s_waitcnt vmcnt(31)
v_mfma_f32_16x16x32_bf16 a[40:43],v[224:227],v[112:115],a[40:43]
v_mfma_f32_16x16x32_bf16 a[44:47],v[232:235],v[112:115],a[44:47]
v_mfma_f32_16x16x32_bf16 a[44:47],v[28:31],a[232:235],a[44:47]
buffer_load_dwordx4 v[80:83],v252,s[20:23],s54 offen sc1
v_mfma_f32_16x16x32_bf16 a[48:51],a[252:255],a[232:235],a[48:51]
v_mfma_f32_16x16x32_bf16 a[48:51],v[244:247],v[112:115],a[48:51]
v_mfma_f32_16x16x32_bf16 a[52:55],v[236:239],v[112:115],a[52:55]
buffer_load_dwordx4 a[192:195],v18,s[20:23],s54 offen offset:1024 sc1
v_mfma_f32_16x16x32_bf16 a[52:55],v[228:231],a[232:235],a[52:55]
v_mfma_f32_16x16x32_bf16 a[56:59],v[220:223],a[232:235],a[56:59]
v_mfma_f32_16x16x32_bf16 a[56:59],v[240:243],v[112:115],a[56:59]
s_waitcnt vmcnt(31)
v_mfma_f32_16x16x32_bf16 a[76:79],v[240:243],v[60:63],a[76:79]
buffer_load_dwordx4 v[76:79],v252,s[20:23],s54 offen offset:1024 sc1
v_mfma_f32_16x16x32_bf16 a[76:79],v[220:223],a[240:243],a[76:79]
v_mfma_f32_16x16x32_bf16 a[72:75],v[228:231],a[240:243],a[72:75]
v_mfma_f32_16x16x32_bf16 a[72:75],v[236:239],v[60:63],a[72:75]
v_mfma_f32_16x16x32_bf16 a[68:71],v[244:247],v[60:63],a[68:71]
buffer_load_dwordx4 v[124:127],v18,s[20:23],s55 offen sc1
v_mfma_f32_16x16x32_bf16 a[68:71],a[252:255],a[240:243],a[68:71]
v_mfma_f32_16x16x32_bf16 a[64:67],v[28:31],a[240:243],a[64:67]
v_mfma_f32_16x16x32_bf16 a[64:67],v[232:235],v[60:63],a[64:67]
v_mfma_f32_16x16x32_bf16 a[60:63],v[224:227],v[60:63],a[60:63]
buffer_load_dwordx4 a[180:183],v252,s[20:23],s55 offen sc1
v_mfma_f32_16x16x32_bf16 a[60:63],v[140:143],a[240:243],a[60:63]
s_waitcnt vmcnt(33)
v_mfma_f32_16x16x32_bf16 a[80:83],v[140:143],a[200:203],a[80:83]
s_waitcnt vmcnt(32)
v_mfma_f32_16x16x32_bf16 a[80:83],v[224:227],a[184:187],a[80:83]
buffer_load_dwordx4 v[92:95],v18,s[20:23],s55 offen offset:1024 sc1
v_mfma_f32_16x16x32_bf16 a[84:87],v[232:235],a[184:187],a[84:87]
v_mfma_f32_16x16x32_bf16 a[84:87],v[28:31],a[200:203],a[84:87]
v_mfma_f32_16x16x32_bf16 a[88:91],a[252:255],a[200:203],a[88:91]
v_mfma_f32_16x16x32_bf16 a[88:91],v[244:247],a[184:187],a[88:91]
buffer_load_dwordx4 a[204:207],v252,s[20:23],s55 offen offset:1024 sc1
v_mfma_f32_16x16x32_bf16 a[92:95],v[236:239],a[184:187],a[92:95]
v_mfma_f32_16x16x32_bf16 a[92:95],v[228:231],a[200:203],a[92:95]
v_mfma_f32_16x16x32_bf16 a[96:99],v[220:223],a[200:203],a[96:99]
v_mfma_f32_16x16x32_bf16 a[96:99],v[240:243],a[184:187],a[96:99]
buffer_load_dwordx4 v[36:39],v18,s[20:23],s69 offen sc1
s_waitcnt vmcnt(33)
v_mfma_f32_16x16x32_bf16 a[116:119],v[240:243],v[84:87],a[116:119]
v_mfma_f32_16x16x32_bf16 a[116:119],v[220:223],v[96:99],a[116:119]
v_mfma_f32_16x16x32_bf16 a[112:115],v[228:231],v[96:99],a[112:115]
v_mfma_f32_16x16x32_bf16 a[112:115],v[236:239],v[84:87],a[112:115]
buffer_load_dwordx4 v[156:159],v252,s[20:23],s69 offen sc1
v_mfma_f32_16x16x32_bf16 a[108:111],v[244:247],v[84:87],a[108:111]
v_mfma_f32_16x16x32_bf16 a[108:111],a[252:255],v[96:99],a[108:111]
v_mfma_f32_16x16x32_bf16 a[104:107],v[28:31],v[96:99],a[104:107]
s_cmp_le_u32 s51,2
s_cselect_b32 s59,8,0
s_add_u32 s59,s59,s48
s_add_u32 s59,s59,80
s_mul_i32 s57,s59,9216
v_add_u32 v16,s57,v10
s_mul_i32 s57,s59,5120
v_add_u32 v17,s57,v10
buffer_load_dwordx4 v[116:119],v17,s[24:27],0 offen sc1
v_mfma_f32_16x16x32_bf16 a[104:107],v[232:235],v[84:87],a[104:107]
v_mfma_f32_16x16x32_bf16 a[100:103],v[224:227],v[84:87],a[100:103]
v_mfma_f32_16x16x32_bf16 a[100:103],v[140:143],v[96:99],a[100:103]
s_waitcnt vmcnt(34)
v_mfma_f32_16x16x32_bf16 a[120:123],v[140:143],v[88:91],a[120:123]
buffer_load_dwordx4 v[120:123],v17,s[24:27],0 offen offset:1024 sc1
s_waitcnt vmcnt(34)
v_mfma_f32_16x16x32_bf16 a[120:123],v[224:227],v[100:103],a[120:123]
v_mfma_f32_16x16x32_bf16 a[124:127],v[232:235],v[100:103],a[124:127]
v_mfma_f32_16x16x32_bf16 a[124:127],v[28:31],v[88:91],a[124:127]
v_mfma_f32_16x16x32_bf16 a[128:131],a[252:255],v[88:91],a[128:131]
buffer_load_dwordx4 v[128:131],v17,s[24:27],0 offen offset:2048 sc1
v_mfma_f32_16x16x32_bf16 a[128:131],v[244:247],v[100:103],a[128:131]
v_mfma_f32_16x16x32_bf16 a[132:135],v[236:239],v[100:103],a[132:135]
v_mfma_f32_16x16x32_bf16 a[132:135],v[228:231],v[88:91],a[132:135]
v_mfma_f32_16x16x32_bf16 a[136:139],v[220:223],v[88:91],a[136:139]
buffer_load_dwordx4 v[144:147],v17,s[24:27],0 offen offset:3072 sc1
v_mfma_f32_16x16x32_bf16 a[136:139],v[240:243],v[100:103],a[136:139]
s_waitcnt vmcnt(34)
v_mfma_f32_16x16x32_bf16 a[156:159],v[240:243],v[108:111],a[156:159]
v_mfma_f32_16x16x32_bf16 a[156:159],v[220:223],v[104:107],a[156:159]
buffer_load_dwordx4 v[148:151],v17,s[24:27],s68 offen sc1
v_mfma_f32_16x16x32_bf16 a[152:155],v[228:231],v[104:107],a[152:155]
v_mfma_f32_16x16x32_bf16 a[152:155],v[236:239],v[108:111],a[152:155]
v_mfma_f32_16x16x32_bf16 a[148:151],v[244:247],v[108:111],a[148:151]
v_mfma_f32_16x16x32_bf16 a[148:151],a[252:255],v[104:107],a[148:151]
s_cmp_le_u32 s51,2
s_cselect_b32 s59,8,0
s_add_u32 s59,s59,s48
s_add_u32 s59,s59,84
s_mul_i32 s57,s59,9216
v_add_u32 v18,s57,v10
s_mul_i32 s57,s59,5120
v_add_u32 v15,s57,v10
buffer_load_dwordx4 v[40:43],v15,s[24:27],0 offen sc1
v_mfma_f32_16x16x32_bf16 a[144:147],v[28:31],v[104:107],a[144:147]
v_mfma_f32_16x16x32_bf16 a[144:147],v[232:235],v[108:111],a[144:147]
v_mfma_f32_16x16x32_bf16 a[140:143],v[224:227],v[108:111],a[140:143]
v_mfma_f32_16x16x32_bf16 a[140:143],v[140:143],v[104:107],a[140:143]
buffer_load_dwordx4 a[196:199],v15,s[24:27],0 offen offset:1024 sc1
s_waitcnt vmcnt(36)
v_mfma_f32_16x16x32_bf16 a[160:163],v[140:143],v[32:35],a[160:163]
s_waitcnt vmcnt(35)
v_mfma_f32_16x16x32_bf16 a[160:163],v[224:227],v[44:47],a[160:163]
v_mfma_f32_16x16x32_bf16 a[164:167],v[232:235],v[44:47],a[164:167]
v_mfma_f32_16x16x32_bf16 a[164:167],v[28:31],v[32:35],a[164:167]
buffer_load_dwordx4 v[132:135],v15,s[24:27],0 offen offset:2048 sc1
v_mfma_f32_16x16x32_bf16 a[168:171],a[252:255],v[32:35],a[168:171]
v_mfma_f32_16x16x32_bf16 a[168:171],v[244:247],v[44:47],a[168:171]
v_mfma_f32_16x16x32_bf16 a[172:175],v[236:239],v[44:47],a[172:175]
buffer_load_dwordx4 a[208:211],v15,s[24:27],0 offen offset:3072 sc1
v_mfma_f32_16x16x32_bf16 a[172:175],v[228:231],v[32:35],a[172:175]
v_mfma_f32_16x16x32_bf16 a[176:179],v[220:223],v[32:35],a[176:179]
v_mfma_f32_16x16x32_bf16 a[176:179],v[240:243],v[44:47],a[176:179]
s_waitcnt vmcnt(26)
v_mfma_f32_16x16x32_bf16 a[0:3],a[216:219],v[136:139],a[0:3]
buffer_load_dwordx4 v[160:163],v15,s[24:27],s68 offen sc1
s_waitcnt vmcnt(26)
v_mfma_f32_16x16x32_bf16 a[0:3],a[248:251],v[64:67],a[0:3]
v_mfma_f32_16x16x32_bf16 a[4:7],a[188:191],v[64:67],a[4:7]
v_mfma_f32_16x16x32_bf16 a[4:7],v[164:167],v[136:139],a[4:7]
v_mfma_f32_16x16x32_bf16 a[8:11],a[224:227],v[136:139],a[8:11]
buffer_load_dwordx4 a[228:231],v16,s[20:23],s52 offen sc1
v_mfma_f32_16x16x32_bf16 a[8:11],a[212:215],v[64:67],a[8:11]
v_mfma_f32_16x16x32_bf16 a[12:15],v[20:23],v[64:67],a[12:15]
v_mfma_f32_16x16x32_bf16 a[12:15],v[48:51],v[136:139],a[12:15]
buffer_load_dwordx4 v[248:251],v18,s[20:23],s52 offen sc1
v_mfma_f32_16x16x32_bf16 a[16:19],v[172:175],v[136:139],a[16:19]
v_mfma_f32_16x16x32_bf16 a[16:19],v[168:171],v[64:67],a[16:19]
s_waitcnt vmcnt(26)
v_mfma_f32_16x16x32_bf16 a[36:39],v[168:171],v[152:155],a[36:39]
v_mfma_f32_16x16x32_bf16 a[36:39],v[172:175],v[72:75],a[36:39]
buffer_load_dwordx4 a[236:239],v16,s[20:23],s52 offen offset:1024 sc1
v_mfma_f32_16x16x32_bf16 a[32:35],v[48:51],v[72:75],a[32:35]
v_mfma_f32_16x16x32_bf16 a[32:35],v[20:23],v[152:155],a[32:35]
v_mfma_f32_16x16x32_bf16 a[28:31],a[212:215],v[152:155],a[28:31]
v_mfma_f32_16x16x32_bf16 a[28:31],a[224:227],v[72:75],a[28:31]
buffer_load_dwordx4 a[220:223],v18,s[20:23],s52 offen offset:1024 sc1
v_mfma_f32_16x16x32_bf16 a[24:27],v[164:167],v[72:75],a[24:27]
v_mfma_f32_16x16x32_bf16 a[24:27],a[188:191],v[152:155],a[24:27]
v_mfma_f32_16x16x32_bf16 a[20:23],a[248:251],v[152:155],a[20:23]
v_mfma_f32_16x16x32_bf16 a[20:23],a[216:219],v[72:75],a[20:23]
buffer_load_dwordx4 v[176:179],v16,s[20:23],s53 offen sc1
s_waitcnt vmcnt(28)
v_mfma_f32_16x16x32_bf16 a[40:43],a[216:219],v[52:55],a[40:43]
s_waitcnt vmcnt(27)
v_mfma_f32_16x16x32_bf16 a[40:43],a[248:251],v[56:59],a[40:43]
v_mfma_f32_16x16x32_bf16 a[44:47],a[188:191],v[56:59],a[44:47]
buffer_load_dwordx4 a[232:235],v18,s[20:23],s53 offen sc1
v_mfma_f32_16x16x32_bf16 a[44:47],v[164:167],v[52:55],a[44:47]
v_mfma_f32_16x16x32_bf16 a[48:51],a[224:227],v[52:55],a[48:51]
v_mfma_f32_16x16x32_bf16 a[48:51],a[212:215],v[56:59],a[48:51]
v_mfma_f32_16x16x32_bf16 a[52:55],v[20:23],v[56:59],a[52:55]
buffer_load_dwordx4 v[112:115],v16,s[20:23],s53 offen offset:1024 sc1
v_mfma_f32_16x16x32_bf16 a[52:55],v[48:51],v[52:55],a[52:55]
v_mfma_f32_16x16x32_bf16 a[56:59],v[172:175],v[52:55],a[56:59]
v_mfma_f32_16x16x32_bf16 a[56:59],v[168:171],v[56:59],a[56:59]
s_waitcnt vmcnt(27)
v_mfma_f32_16x16x32_bf16 a[76:79],v[168:171],a[244:247],a[76:79]
buffer_load_dwordx4 v[60:63],v18,s[20:23],s53 offen offset:1024 sc1
v_mfma_f32_16x16x32_bf16 a[76:79],v[172:175],v[24:27],a[76:79]
v_mfma_f32_16x16x32_bf16 a[72:75],v[48:51],v[24:27],a[72:75]
v_mfma_f32_16x16x32_bf16 a[72:75],v[20:23],a[244:247],a[72:75]
v_mfma_f32_16x16x32_bf16 a[68:71],a[212:215],a[244:247],a[68:71]
buffer_load_dwordx4 a[240:243],v16,s[20:23],s54 offen sc1
v_mfma_f32_16x16x32_bf16 a[68:71],a[224:227],v[24:27],a[68:71]
v_mfma_f32_16x16x32_bf16 a[64:67],v[164:167],v[24:27],a[64:67]
v_mfma_f32_16x16x32_bf16 a[64:67],a[188:191],a[244:247],a[64:67]
buffer_load_dwordx4 a[200:203],v18,s[20:23],s54 offen sc1
v_mfma_f32_16x16x32_bf16 a[60:63],a[248:251],a[244:247],a[60:63]
v_mfma_f32_16x16x32_bf16 a[60:63],a[216:219],v[24:27],a[60:63]
s_waitcnt vmcnt(29)
v_mfma_f32_16x16x32_bf16 a[80:83],a[216:219],v[68:71],a[80:83]
s_waitcnt vmcnt(28)
v_mfma_f32_16x16x32_bf16 a[80:83],a[248:251],v[80:83],a[80:83]
buffer_load_dwordx4 a[184:187],v16,s[20:23],s54 offen offset:1024 sc1
v_mfma_f32_16x16x32_bf16 a[84:87],a[188:191],v[80:83],a[84:87]
v_mfma_f32_16x16x32_bf16 a[84:87],v[164:167],v[68:71],a[84:87]
v_mfma_f32_16x16x32_bf16 a[88:91],a[224:227],v[68:71],a[88:91]
v_mfma_f32_16x16x32_bf16 a[88:91],a[212:215],v[80:83],a[88:91]
buffer_load_dwordx4 v[84:87],v18,s[20:23],s54 offen offset:1024 sc1
v_mfma_f32_16x16x32_bf16 a[92:95],v[20:23],v[80:83],a[92:95]
v_mfma_f32_16x16x32_bf16 a[92:95],v[48:51],v[68:71],a[92:95]
v_mfma_f32_16x16x32_bf16 a[96:99],v[172:175],v[68:71],a[96:99]
v_mfma_f32_16x16x32_bf16 a[96:99],v[168:171],v[80:83],a[96:99]
buffer_load_dwordx4 v[96:99],v16,s[20:23],s55 offen sc1
s_waitcnt vmcnt(29)
v_mfma_f32_16x16x32_bf16 a[116:119],v[168:171],v[76:79],a[116:119]
v_mfma_f32_16x16x32_bf16 a[116:119],v[172:175],a[192:195],a[116:119]
v_mfma_f32_16x16x32_bf16 a[112:115],v[48:51],a[192:195],a[112:115]
buffer_load_dwordx4 v[88:91],v18,s[20:23],s55 offen sc1
v_mfma_f32_16x16x32_bf16 a[112:115],v[20:23],v[76:79],a[112:115]
v_mfma_f32_16x16x32_bf16 a[108:111],a[212:215],v[76:79],a[108:111]
v_mfma_f32_16x16x32_bf16 a[108:111],a[224:227],a[192:195],a[108:111]
v_mfma_f32_16x16x32_bf16 a[104:107],v[164:167],a[192:195],a[104:107]
buffer_load_dwordx4 v[100:103],v16,s[20:23],s55 offen offset:1024 sc1
v_mfma_f32_16x16x32_bf16 a[104:107],a[188:191],v[76:79],a[104:107]
v_mfma_f32_16x16x32_bf16 a[100:103],a[248:251],v[76:79],a[100:103]
v_mfma_f32_16x16x32_bf16 a[100:103],a[216:219],a[192:195],a[100:103]
s_waitcnt vmcnt(30)
v_mfma_f32_16x16x32_bf16 a[120:123],a[216:219],v[124:127],a[120:123]
buffer_load_dwordx4 v[108:111],v18,s[20:23],s55 offen offset:1024 sc1
s_waitcnt vmcnt(30)
v_mfma_f32_16x16x32_bf16 a[120:123],a[248:251],a[180:183],a[120:123]
v_mfma_f32_16x16x32_bf16 a[124:127],a[188:191],a[180:183],a[124:127]
v_mfma_f32_16x16x32_bf16 a[124:127],v[164:167],v[124:127],a[124:127]
v_mfma_f32_16x16x32_bf16 a[128:131],a[224:227],v[124:127],a[128:131]
buffer_load_dwordx4 v[104:107],v16,s[20:23],s69 offen sc1
v_mfma_f32_16x16x32_bf16 a[128:131],a[212:215],a[180:183],a[128:131]
v_mfma_f32_16x16x32_bf16 a[132:135],v[20:23],a[180:183],a[132:135]
v_mfma_f32_16x16x32_bf16 a[132:135],v[48:51],v[124:127],a[132:135]
buffer_load_dwordx4 v[140:143],v18,s[20:23],s69 offen sc1
v_mfma_f32_16x16x32_bf16 a[136:139],v[172:175],v[124:127],a[136:139]
v_mfma_f32_16x16x32_bf16 a[136:139],v[168:171],a[180:183],a[136:139]
s_waitcnt vmcnt(30)
v_mfma_f32_16x16x32_bf16 a[156:159],v[168:171],a[204:207],a[156:159]
v_mfma_f32_16x16x32_bf16 a[156:159],v[172:175],v[92:95],a[156:159]
s_cmp_le_u32 s51,3
s_cselect_b32 s59,8,0
s_add_u32 s59,s59,s48
s_add_u32 s59,s59,88
s_mul_i32 s57,s59,9216
v_add_u32 v252,s57,v10
s_mul_i32 s57,s59,5120
v_add_u32 v253,s57,v10
buffer_load_dwordx4 v[224:227],v253,s[24:27],0 offen sc1
v_mfma_f32_16x16x32_bf16 a[152:155],v[48:51],v[92:95],a[152:155]
v_mfma_f32_16x16x32_bf16 a[152:155],v[20:23],a[204:207],a[152:155]
v_mfma_f32_16x16x32_bf16 a[148:151],a[212:215],a[204:207],a[148:151]
v_mfma_f32_16x16x32_bf16 a[148:151],a[224:227],v[92:95],a[148:151]
buffer_load_dwordx4 v[232:235],v253,s[24:27],0 offen offset:1024 sc1
v_mfma_f32_16x16x32_bf16 a[144:147],v[164:167],v[92:95],a[144:147]
v_mfma_f32_16x16x32_bf16 a[144:147],a[188:191],a[204:207],a[144:147]
v_mfma_f32_16x16x32_bf16 a[140:143],a[248:251],a[204:207],a[140:143]
buffer_load_dwordx4 v[28:31],v253,s[24:27],0 offen offset:2048 sc1
v_mfma_f32_16x16x32_bf16 a[140:143],a[216:219],v[92:95],a[140:143]
s_waitcnt vmcnt(32)
v_mfma_f32_16x16x32_bf16 a[160:163],a[216:219],v[36:39],a[160:163]
s_waitcnt vmcnt(31)
v_mfma_f32_16x16x32_bf16 a[160:163],a[248:251],v[156:159],a[160:163]
v_mfma_f32_16x16x32_bf16 a[164:167],a[188:191],v[156:159],a[164:167]
buffer_load_dwordx4 a[252:255],v253,s[24:27],0 offen offset:3072 sc1
v_mfma_f32_16x16x32_bf16 a[164:167],v[164:167],v[36:39],a[164:167]
v_mfma_f32_16x16x32_bf16 a[168:171],a[224:227],v[36:39],a[168:171]
v_mfma_f32_16x16x32_bf16 a[168:171],a[212:215],v[156:159],a[168:171]
v_mfma_f32_16x16x32_bf16 a[172:175],v[20:23],v[156:159],a[172:175]
buffer_load_dwordx4 v[244:247],v253,s[24:27],s68 offen sc1
v_mfma_f32_16x16x32_bf16 a[172:175],v[48:51],v[36:39],a[172:175]
v_mfma_f32_16x16x32_bf16 a[176:179],v[172:175],v[36:39],a[176:179]
v_mfma_f32_16x16x32_bf16 a[176:179],v[168:171],v[156:159],a[176:179]
s_barrier
s_waitcnt vmcnt(22)
v_mfma_f32_16x16x32_bf16 a[0:3],v[116:119],a[228:231],a[0:3]
s_cmp_le_u32 s51,3
s_cselect_b32 s59,8,0
s_add_u32 s59,s59,s48
s_add_u32 s59,s59,92
s_mul_i32 s57,s59,9216
v_add_u32 v16,s57,v10
s_mul_i32 s57,s59,5120
v_add_u32 v17,s57,v10
buffer_load_dwordx4 v[236:239],v17,s[24:27],0 offen sc1
s_waitcnt vmcnt(22)
v_mfma_f32_16x16x32_bf16 a[0:3],v[40:43],v[248:251],a[0:3]
v_mfma_f32_16x16x32_bf16 a[4:7],a[196:199],v[248:251],a[4:7]
v_mfma_f32_16x16x32_bf16 a[4:7],v[120:123],a[228:231],a[4:7]
buffer_load_dwordx4 v[228:231],v17,s[24:27],0 offen offset:1024 sc1
v_mfma_f32_16x16x32_bf16 a[8:11],v[128:131],a[228:231],a[8:11]
v_mfma_f32_16x16x32_bf16 a[8:11],v[132:135],v[248:251],a[8:11]
v_mfma_f32_16x16x32_bf16 a[12:15],a[208:211],v[248:251],a[12:15]
v_mfma_f32_16x16x32_bf16 a[12:15],v[144:147],a[228:231],a[12:15]
buffer_load_dwordx4 v[220:223],v17,s[24:27],0 offen offset:2048 sc1
v_mfma_f32_16x16x32_bf16 a[16:19],v[148:151],a[228:231],a[16:19]
v_mfma_f32_16x16x32_bf16 a[16:19],v[160:163],v[248:251],a[16:19]
s_waitcnt vmcnt(22)
v_mfma_f32_16x16x32_bf16 a[36:39],v[160:163],a[220:223],a[36:39]
v_mfma_f32_16x16x32_bf16 a[36:39],v[148:151],a[236:239],a[36:39]
buffer_load_dwordx4 v[32:35],v17,s[24:27],0 offen offset:3072 sc1
v_mfma_f32_16x16x32_bf16 a[32:35],v[144:147],a[236:239],a[32:35]
v_mfma_f32_16x16x32_bf16 a[32:35],a[208:211],a[220:223],a[32:35]
v_mfma_f32_16x16x32_bf16 a[28:31],v[132:135],a[220:223],a[28:31]
v_mfma_f32_16x16x32_bf16 a[28:31],v[128:131],a[236:239],a[28:31]
buffer_load_dwordx4 v[240:243],v17,s[24:27],s68 offen sc1
v_mfma_f32_16x16x32_bf16 a[24:27],v[120:123],a[236:239],a[24:27]
v_mfma_f32_16x16x32_bf16 a[24:27],a[196:199],a[220:223],a[24:27]
v_mfma_f32_16x16x32_bf16 a[20:23],v[40:43],a[220:223],a[20:23]
buffer_load_dwordx4 v[44:47],v252,s[20:23],s52 offen sc1
v_mfma_f32_16x16x32_bf16 a[20:23],v[116:119],a[236:239],a[20:23]
s_waitcnt vmcnt(24)
v_mfma_f32_16x16x32_bf16 a[40:43],v[116:119],v[176:179],a[40:43]
s_waitcnt vmcnt(23)
v_mfma_f32_16x16x32_bf16 a[40:43],v[40:43],a[232:235],a[40:43]
v_mfma_f32_16x16x32_bf16 a[44:47],a[196:199],a[232:235],a[44:47]
buffer_load_dwordx4 v[136:139],v16,s[20:23],s52 offen sc1
v_mfma_f32_16x16x32_bf16 a[44:47],v[120:123],v[176:179],a[44:47]
v_mfma_f32_16x16x32_bf16 a[48:51],v[128:131],v[176:179],a[48:51]
v_mfma_f32_16x16x32_bf16 a[48:51],v[132:135],a[232:235],a[48:51]
v_mfma_f32_16x16x32_bf16 a[52:55],a[208:211],a[232:235],a[52:55]
buffer_load_dwordx4 v[64:67],v252,s[20:23],s52 offen offset:1024 sc1
v_mfma_f32_16x16x32_bf16 a[52:55],v[144:147],v[176:179],a[52:55]
v_mfma_f32_16x16x32_bf16 a[56:59],v[148:151],v[176:179],a[56:59]
v_mfma_f32_16x16x32_bf16 a[56:59],v[160:163],a[232:235],a[56:59]
s_waitcnt vmcnt(23)
v_mfma_f32_16x16x32_bf16 a[76:79],v[160:163],v[60:63],a[76:79]
buffer_load_dwordx4 v[152:155],v16,s[20:23],s52 offen offset:1024 sc1
v_mfma_f32_16x16x32_bf16 a[76:79],v[148:151],v[112:115],a[76:79]
v_mfma_f32_16x16x32_bf16 a[72:75],v[144:147],v[112:115],a[72:75]
v_mfma_f32_16x16x32_bf16 a[72:75],a[208:211],v[60:63],a[72:75]
buffer_load_dwordx4 v[72:75],v252,s[20:23],s53 offen sc1
v_mfma_f32_16x16x32_bf16 a[68:71],v[132:135],v[60:63],a[68:71]
v_mfma_f32_16x16x32_bf16 a[68:71],v[128:131],v[112:115],a[68:71]
v_mfma_f32_16x16x32_bf16 a[64:67],v[120:123],v[112:115],a[64:67]
v_mfma_f32_16x16x32_bf16 a[64:67],a[196:199],v[60:63],a[64:67]
buffer_load_dwordx4 v[52:55],v16,s[20:23],s53 offen sc1
v_mfma_f32_16x16x32_bf16 a[60:63],v[40:43],v[60:63],a[60:63]
v_mfma_f32_16x16x32_bf16 a[60:63],v[116:119],v[112:115],a[60:63]
s_waitcnt vmcnt(25)
v_mfma_f32_16x16x32_bf16 a[80:83],v[116:119],a[240:243],a[80:83]
s_waitcnt vmcnt(24)
v_mfma_f32_16x16x32_bf16 a[80:83],v[40:43],a[200:203],a[80:83]
buffer_load_dwordx4 v[56:59],v252,s[20:23],s53 offen offset:1024 sc1
v_mfma_f32_16x16x32_bf16 a[84:87],a[196:199],a[200:203],a[84:87]
v_mfma_f32_16x16x32_bf16 a[84:87],v[120:123],a[240:243],a[84:87]
v_mfma_f32_16x16x32_bf16 a[88:91],v[128:131],a[240:243],a[88:91]
v_mfma_f32_16x16x32_bf16 a[88:91],v[132:135],a[200:203],a[88:91]
buffer_load_dwordx4 a[244:247],v16,s[20:23],s53 offen offset:1024 sc1
v_mfma_f32_16x16x32_bf16 a[92:95],a[208:211],a[200:203],a[92:95]
v_mfma_f32_16x16x32_bf16 a[92:95],v[144:147],a[240:243],a[92:95]
v_mfma_f32_16x16x32_bf16 a[96:99],v[148:151],a[240:243],a[96:99]
buffer_load_dwordx4 v[24:27],v252,s[20:23],s54 offen sc1
v_mfma_f32_16x16x32_bf16 a[96:99],v[160:163],a[200:203],a[96:99]
s_waitcnt vmcnt(25)
v_mfma_f32_16x16x32_bf16 a[116:119],v[160:163],v[84:87],a[116:119]
v_mfma_f32_16x16x32_bf16 a[116:119],v[148:151],a[184:187],a[116:119]
v_mfma_f32_16x16x32_bf16 a[112:115],v[144:147],a[184:187],a[112:115]
buffer_load_dwordx4 v[68:71],v16,s[20:23],s54 offen sc1
v_mfma_f32_16x16x32_bf16 a[112:115],a[208:211],v[84:87],a[112:115]
v_mfma_f32_16x16x32_bf16 a[108:111],v[132:135],v[84:87],a[108:111]
v_mfma_f32_16x16x32_bf16 a[108:111],v[128:131],a[184:187],a[108:111]
v_mfma_f32_16x16x32_bf16 a[104:107],v[120:123],a[184:187],a[104:107]
buffer_load_dwordx4 v[80:83],v252,s[20:23],s54 offen offset:1024 sc1
v_mfma_f32_16x16x32_bf16 a[104:107],a[196:199],v[84:87],a[104:107]
v_mfma_f32_16x16x32_bf16 a[100:103],v[40:43],v[84:87],a[100:103]
v_mfma_f32_16x16x32_bf16 a[100:103],v[116:119],a[184:187],a[100:103]
buffer_load_dwordx4 v[76:79],v16,s[20:23],s54 offen offset:1024 sc1
s_waitcnt vmcnt(27)
v_mfma_f32_16x16x32_bf16 a[120:123],v[116:119],v[96:99],a[120:123]
s_waitcnt vmcnt(26)
v_mfma_f32_16x16x32_bf16 a[120:123],v[40:43],v[88:91],a[120:123]
v_mfma_f32_16x16x32_bf16 a[124:127],a[196:199],v[88:91],a[124:127]
v_mfma_f32_16x16x32_bf16 a[124:127],v[120:123],v[96:99],a[124:127]
buffer_load_dwordx4 a[192:195],v252,s[20:23],s55 offen sc1
v_mfma_f32_16x16x32_bf16 a[128:131],v[128:131],v[96:99],a[128:131]
v_mfma_f32_16x16x32_bf16 a[128:131],v[132:135],v[88:91],a[128:131]
v_mfma_f32_16x16x32_bf16 a[132:135],a[208:211],v[88:91],a[132:135]
v_mfma_f32_16x16x32_bf16 a[132:135],v[144:147],v[96:99],a[132:135]
buffer_load_dwordx4 v[124:127],v16,s[20:23],s55 offen sc1
v_mfma_f32_16x16x32_bf16 a[136:139],v[148:151],v[96:99],a[136:139]
v_mfma_f32_16x16x32_bf16 a[136:139],v[160:163],v[88:91],a[136:139]
s_waitcnt vmcnt(26)
v_mfma_f32_16x16x32_bf16 a[156:159],v[160:163],v[108:111],a[156:159]
v_mfma_f32_16x16x32_bf16 a[156:159],v[148:151],v[100:103],a[156:159]
buffer_load_dwordx4 a[180:183],v252,s[20:23],s55 offen offset:1024 sc1
v_mfma_f32_16x16x32_bf16 a[152:155],v[144:147],v[100:103],a[152:155]
v_mfma_f32_16x16x32_bf16 a[152:155],a[208:211],v[108:111],a[152:155]
v_mfma_f32_16x16x32_bf16 a[148:151],v[132:135],v[108:111],a[148:151]
buffer_load_dwordx4 a[204:207],v16,s[20:23],s55 offen offset:1024 sc1
v_mfma_f32_16x16x32_bf16 a[148:151],v[128:131],v[100:103],a[148:151]
v_mfma_f32_16x16x32_bf16 a[144:147],v[120:123],v[100:103],a[144:147]
v_mfma_f32_16x16x32_bf16 a[144:147],a[196:199],v[108:111],a[144:147]
v_mfma_f32_16x16x32_bf16 a[140:143],v[40:43],v[108:111],a[140:143]
buffer_load_dwordx4 v[92:95],v252,s[20:23],s69 offen sc1
v_mfma_f32_16x16x32_bf16 a[140:143],v[116:119],v[100:103],a[140:143]
s_waitcnt vmcnt(28)
v_mfma_f32_16x16x32_bf16 a[160:163],v[116:119],v[104:107],a[160:163]
s_waitcnt vmcnt(27)
v_mfma_f32_16x16x32_bf16 a[160:163],v[40:43],v[140:143],a[160:163]
v_mfma_f32_16x16x32_bf16 a[164:167],a[196:199],v[140:143],a[164:167]
buffer_load_dwordx4 a[216:219],v16,s[20:23],s69 offen sc1
v_mfma_f32_16x16x32_bf16 a[164:167],v[120:123],v[104:107],a[164:167]
v_mfma_f32_16x16x32_bf16 a[168:171],v[128:131],v[104:107],a[168:171]
v_mfma_f32_16x16x32_bf16 a[168:171],v[132:135],v[140:143],a[168:171]
v_mfma_f32_16x16x32_bf16 a[172:175],a[208:211],v[140:143],a[172:175]
s_cmp_le_u32 s51,4
s_cselect_b32 s59,8,0
s_add_u32 s59,s59,s48
s_add_u32 s59,s59,96
s_mul_i32 s57,s59,9216
v_add_u32 v18,s57,v10
s_mul_i32 s57,s59,5120
v_add_u32 v15,s57,v10
buffer_load_dwordx4 a[248:251],v15,s[24:27],0 offen sc1
v_mfma_f32_16x16x32_bf16 a[172:175],v[144:147],v[104:107],a[172:175]
v_mfma_f32_16x16x32_bf16 a[176:179],v[148:151],v[104:107],a[176:179]
v_mfma_f32_16x16x32_bf16 a[176:179],v[160:163],v[140:143],a[176:179]
buffer_load_dwordx4 a[188:191],v15,s[24:27],0 offen offset:1024 sc1
s_waitcnt vmcnt(19)
v_mfma_f32_16x16x32_bf16 a[0:3],v[224:227],v[44:47],a[0:3]
s_waitcnt vmcnt(18)
v_mfma_f32_16x16x32_bf16 a[0:3],v[236:239],v[136:139],a[0:3]
v_mfma_f32_16x16x32_bf16 a[4:7],v[228:231],v[136:139],a[4:7]
v_mfma_f32_16x16x32_bf16 a[4:7],v[232:235],v[44:47],a[4:7]
buffer_load_dwordx4 v[164:167],v15,s[24:27],0 offen offset:2048 sc1
v_mfma_f32_16x16x32_bf16 a[8:11],v[28:31],v[44:47],a[8:11]
v_mfma_f32_16x16x32_bf16 a[8:11],v[220:223],v[136:139],a[8:11]
v_mfma_f32_16x16x32_bf16 a[12:15],v[32:35],v[136:139],a[12:15]
v_mfma_f32_16x16x32_bf16 a[12:15],a[252:255],v[44:47],a[12:15]
buffer_load_dwordx4 a[224:227],v15,s[24:27],0 offen offset:3072 sc1
v_mfma_f32_16x16x32_bf16 a[16:19],v[244:247],v[44:47],a[16:19]
v_mfma_f32_16x16x32_bf16 a[16:19],v[240:243],v[136:139],a[16:19]
s_waitcnt vmcnt(18)
v_mfma_f32_16x16x32_bf16 a[36:39],v[240:243],v[152:155],a[36:39]
v_mfma_f32_16x16x32_bf16 a[36:39],v[244:247],v[64:67],a[36:39]
buffer_load_dwordx4 a[212:215],v15,s[24:27],s68 offen sc1
v_mfma_f32_16x16x32_bf16 a[32:35],a[252:255],v[64:67],a[32:35]
v_mfma_f32_16x16x32_bf16 a[32:35],v[32:35],v[152:155],a[32:35]
v_mfma_f32_16x16x32_bf16 a[28:31],v[220:223],v[152:155],a[28:31]
s_cmp_le_u32 s51,4
s_cselect_b32 s59,8,0
s_add_u32 s59,s59,s48
s_add_u32 s59,s59,100
s_mul_i32 s57,s59,9216
v_add_u32 v252,s57,v10
s_mul_i32 s57,s59,5120
v_add_u32 v253,s57,v10
buffer_load_dwordx4 v[20:23],v253,s[24:27],0 offen sc1
v_mfma_f32_16x16x32_bf16 a[28:31],v[28:31],v[64:67],a[28:31]
v_mfma_f32_16x16x32_bf16 a[24:27],v[232:235],v[64:67],a[24:27]
v_mfma_f32_16x16x32_bf16 a[24:27],v[228:231],v[152:155],a[24:27]
v_mfma_f32_16x16x32_bf16 a[20:23],v[236:239],v[152:155],a[20:23]
buffer_load_dwordx4 v[48:51],v253,s[24:27],0 offen offset:1024 sc1
v_mfma_f32_16x16x32_bf16 a[20:23],v[224:227],v[64:67],a[20:23]
s_waitcnt vmcnt(20)
v_mfma_f32_16x16x32_bf16 a[40:43],v[224:227],v[72:75],a[40:43]
s_waitcnt vmcnt(19)
v_mfma_f32_16x16x32_bf16 a[40:43],v[236:239],v[52:55],a[40:43]
v_mfma_f32_16x16x32_bf16 a[44:47],v[228:231],v[52:55],a[44:47]
buffer_load_dwordx4 v[172:175],v253,s[24:27],0 offen offset:2048 sc1
v_mfma_f32_16x16x32_bf16 a[44:47],v[232:235],v[72:75],a[44:47]
v_mfma_f32_16x16x32_bf16 a[48:51],v[28:31],v[72:75],a[48:51]
v_mfma_f32_16x16x32_bf16 a[48:51],v[220:223],v[52:55],a[48:51]
v_mfma_f32_16x16x32_bf16 a[52:55],v[32:35],v[52:55],a[52:55]
buffer_load_dwordx4 v[36:39],v253,s[24:27],0 offen offset:3072 sc1
v_mfma_f32_16x16x32_bf16 a[52:55],a[252:255],v[72:75],a[52:55]
v_mfma_f32_16x16x32_bf16 a[56:59],v[244:247],v[72:75],a[56:59]
v_mfma_f32_16x16x32_bf16 a[56:59],v[240:243],v[52:55],a[56:59]
buffer_load_dwordx4 v[168:171],v253,s[24:27],s68 offen sc1
s_waitcnt vmcnt(20)
v_mfma_f32_16x16x32_bf16 a[76:79],v[240:243],a[244:247],a[76:79]
v_mfma_f32_16x16x32_bf16 a[76:79],v[244:247],v[56:59],a[76:79]
v_mfma_f32_16x16x32_bf16 a[72:75],a[252:255],v[56:59],a[72:75]
v_mfma_f32_16x16x32_bf16 a[72:75],v[32:35],a[244:247],a[72:75]
buffer_load_dwordx4 v[156:159],v18,s[20:23],s52 offen sc1
v_mfma_f32_16x16x32_bf16 a[68:71],v[220:223],a[244:247],a[68:71]
v_mfma_f32_16x16x32_bf16 a[68:71],v[28:31],v[56:59],a[68:71]
v_mfma_f32_16x16x32_bf16 a[64:67],v[232:235],v[56:59],a[64:67]
v_mfma_f32_16x16x32_bf16 a[64:67],v[228:231],a[244:247],a[64:67]
buffer_load_dwordx4 a[228:231],v252,s[20:23],s52 offen sc1
v_mfma_f32_16x16x32_bf16 a[60:63],v[236:239],a[244:247],a[60:63]
v_mfma_f32_16x16x32_bf16 a[60:63],v[224:227],v[56:59],a[60:63]
s_waitcnt vmcnt(21)
v_mfma_f32_16x16x32_bf16 a[80:83],v[224:227],v[24:27],a[80:83]
buffer_load_dwordx4 v[248:251],v18,s[20:23],s52 offen offset:1024 sc1
s_waitcnt vmcnt(21)
v_mfma_f32_16x16x32_bf16 a[80:83],v[236:239],v[68:71],a[80:83]
v_mfma_f32_16x16x32_bf16 a[84:87],v[228:231],v[68:71],a[84:87]
v_mfma_f32_16x16x32_bf16 a[84:87],v[232:235],v[24:27],a[84:87]
v_mfma_f32_16x16x32_bf16 a[88:91],v[28:31],v[24:27],a[88:91]
buffer_load_dwordx4 a[220:223],v252,s[20:23],s52 offen offset:1024 sc1
v_mfma_f32_16x16x32_bf16 a[88:91],v[220:223],v[68:71],a[88:91]
v_mfma_f32_16x16x32_bf16 a[92:95],v[32:35],v[68:71],a[92:95]
v_mfma_f32_16x16x32_bf16 a[92:95],a[252:255],v[24:27],a[92:95]
v_mfma_f32_16x16x32_bf16 a[96:99],v[244:247],v[24:27],a[96:99]
buffer_load_dwordx4 a[236:239],v18,s[20:23],s53 offen sc1
v_mfma_f32_16x16x32_bf16 a[96:99],v[240:243],v[68:71],a[96:99]
s_waitcnt vmcnt(21)
v_mfma_f32_16x16x32_bf16 a[116:119],v[240:243],v[76:79],a[116:119]
v_mfma_f32_16x16x32_bf16 a[116:119],v[244:247],v[80:83],a[116:119]
v_mfma_f32_16x16x32_bf16 a[112:115],a[252:255],v[80:83],a[112:115]
buffer_load_dwordx4 v[176:179],v252,s[20:23],s53 offen sc1
v_mfma_f32_16x16x32_bf16 a[112:115],v[32:35],v[76:79],a[112:115]
v_mfma_f32_16x16x32_bf16 a[108:111],v[220:223],v[76:79],a[108:111]
v_mfma_f32_16x16x32_bf16 a[108:111],v[28:31],v[80:83],a[108:111]
buffer_load_dwordx4 a[232:235],v18,s[20:23],s53 offen offset:1024 sc1
v_mfma_f32_16x16x32_bf16 a[104:107],v[232:235],v[80:83],a[104:107]
v_mfma_f32_16x16x32_bf16 a[104:107],v[228:231],v[76:79],a[104:107]
v_mfma_f32_16x16x32_bf16 a[100:103],v[236:239],v[76:79],a[100:103]
v_mfma_f32_16x16x32_bf16 a[100:103],v[224:227],v[80:83],a[100:103]
buffer_load_dwordx4 v[60:63],v252,s[20:23],s53 offen offset:1024 sc1
s_waitcnt vmcnt(23)
v_mfma_f32_16x16x32_bf16 a[120:123],v[224:227],a[192:195],a[120:123]
s_waitcnt vmcnt(22)
v_mfma_f32_16x16x32_bf16 a[120:123],v[236:239],v[124:127],a[120:123]
v_mfma_f32_16x16x32_bf16 a[124:127],v[228:231],v[124:127],a[124:127]
v_mfma_f32_16x16x32_bf16 a[124:127],v[232:235],a[192:195],a[124:127]
buffer_load_dwordx4 v[112:115],v18,s[20:23],s54 offen sc1
v_mfma_f32_16x16x32_bf16 a[128:131],v[28:31],a[192:195],a[128:131]
v_mfma_f32_16x16x32_bf16 a[128:131],v[220:223],v[124:127],a[128:131]
v_mfma_f32_16x16x32_bf16 a[132:135],v[32:35],v[124:127],a[132:135]
v_mfma_f32_16x16x32_bf16 a[132:135],a[252:255],a[192:195],a[132:135]
buffer_load_dwordx4 a[240:243],v252,s[20:23],s54 offen sc1
v_mfma_f32_16x16x32_bf16 a[136:139],v[244:247],a[192:195],a[136:139]
v_mfma_f32_16x16x32_bf16 a[136:139],v[240:243],v[124:127],a[136:139]
s_waitcnt vmcnt(22)
v_mfma_f32_16x16x32_bf16 a[156:159],v[240:243],a[204:207],a[156:159]
buffer_load_dwordx4 a[200:203],v18,s[20:23],s54 offen offset:1024 sc1
v_mfma_f32_16x16x32_bf16 a[156:159],v[244:247],a[180:183],a[156:159]
v_mfma_f32_16x16x32_bf16 a[152:155],a[252:255],a[180:183],a[152:155]
v_mfma_f32_16x16x32_bf16 a[152:155],v[32:35],a[204:207],a[152:155]
v_mfma_f32_16x16x32_bf16 a[148:151],v[220:223],a[204:207],a[148:151]
buffer_load_dwordx4 v[84:87],v252,s[20:23],s54 offen offset:1024 sc1
v_mfma_f32_16x16x32_bf16 a[148:151],v[28:31],a[180:183],a[148:151]
v_mfma_f32_16x16x32_bf16 a[144:147],v[232:235],a[180:183],a[144:147]
v_mfma_f32_16x16x32_bf16 a[144:147],v[228:231],a[204:207],a[144:147]
v_mfma_f32_16x16x32_bf16 a[140:143],v[236:239],a[204:207],a[140:143]
buffer_load_dwordx4 a[184:187],v18,s[20:23],s55 offen sc1
v_mfma_f32_16x16x32_bf16 a[140:143],v[224:227],a[180:183],a[140:143]
s_waitcnt vmcnt(24)
v_mfma_f32_16x16x32_bf16 a[160:163],v[224:227],v[92:95],a[160:163]
s_waitcnt vmcnt(23)
v_mfma_f32_16x16x32_bf16 a[160:163],v[236:239],a[216:219],a[160:163]
v_mfma_f32_16x16x32_bf16 a[164:167],v[228:231],a[216:219],a[164:167]
buffer_load_dwordx4 v[96:99],v252,s[20:23],s55 offen sc1
v_mfma_f32_16x16x32_bf16 a[164:167],v[232:235],v[92:95],a[164:167]
v_mfma_f32_16x16x32_bf16 a[168:171],v[28:31],v[92:95],a[168:171]
v_mfma_f32_16x16x32_bf16 a[168:171],v[220:223],a[216:219],a[168:171]
buffer_load_dwordx4 v[88:91],v18,s[20:23],s55 offen offset:1024 sc1
v_mfma_f32_16x16x32_bf16 a[172:175],v[32:35],a[216:219],a[172:175]
v_mfma_f32_16x16x32_bf16 a[172:175],a[252:255],v[92:95],a[172:175]
v_mfma_f32_16x16x32_bf16 a[176:179],v[244:247],v[92:95],a[176:179]
v_mfma_f32_16x16x32_bf16 a[176:179],v[240:243],a[216:219],a[176:179]
buffer_load_dwordx4 v[108:111],v252,s[20:23],s55 offen offset:1024 sc1
s_waitcnt vmcnt(15)
v_mfma_f32_16x16x32_bf16 a[0:3],a[248:251],v[156:159],a[0:3]
s_waitcnt vmcnt(14)
v_mfma_f32_16x16x32_bf16 a[0:3],v[20:23],a[228:231],a[0:3]
v_mfma_f32_16x16x32_bf16 a[4:7],v[48:51],a[228:231],a[4:7]
v_mfma_f32_16x16x32_bf16 a[4:7],a[188:191],v[156:159],a[4:7]
buffer_load_dwordx4 v[100:103],v18,s[20:23],s69 offen sc1
v_mfma_f32_16x16x32_bf16 a[8:11],v[164:167],v[156:159],a[8:11]
v_mfma_f32_16x16x32_bf16 a[8:11],v[172:175],a[228:231],a[8:11]
v_mfma_f32_16x16x32_bf16 a[12:15],v[36:39],a[228:231],a[12:15]
v_mfma_f32_16x16x32_bf16 a[12:15],a[224:227],v[156:159],a[12:15]
buffer_load_dwordx4 v[116:119],v252,s[20:23],s69 offen sc1
v_mfma_f32_16x16x32_bf16 a[16:19],a[212:215],v[156:159],a[16:19]
v_mfma_f32_16x16x32_bf16 a[16:19],v[168:171],a[228:231],a[16:19]
s_waitcnt vmcnt(14)
v_mfma_f32_16x16x32_bf16 a[36:39],v[168:171],a[220:223],a[36:39]
s_cmp_le_u32 s51,5
s_cselect_b32 s59,8,0
s_add_u32 s59,s59,s48
s_add_u32 s59,s59,104
s_mul_i32 s57,s59,9216
v_add_u32 v16,s57,v10
s_mul_i32 s57,s59,5120
v_add_u32 v17,s57,v10
buffer_load_dwordx4 v[40:43],v17,s[24:27],0 offen sc1
v_mfma_f32_16x16x32_bf16 a[36:39],a[212:215],v[248:251],a[36:39]
v_mfma_f32_16x16x32_bf16 a[32:35],a[224:227],v[248:251],a[32:35]
v_mfma_f32_16x16x32_bf16 a[32:35],v[36:39],a[220:223],a[32:35]
v_mfma_f32_16x16x32_bf16 a[28:31],v[172:175],a[220:223],a[28:31]
buffer_load_dwordx4 a[196:199],v17,s[24:27],0 offen offset:1024 sc1
v_mfma_f32_16x16x32_bf16 a[28:31],v[164:167],v[248:251],a[28:31]
v_mfma_f32_16x16x32_bf16 a[24:27],a[188:191],v[248:251],a[24:27]
v_mfma_f32_16x16x32_bf16 a[24:27],v[48:51],a[220:223],a[24:27]
v_mfma_f32_16x16x32_bf16 a[20:23],v[20:23],a[220:223],a[20:23]
buffer_load_dwordx4 v[120:123],v17,s[24:27],0 offen offset:2048 sc1
v_mfma_f32_16x16x32_bf16 a[20:23],a[248:251],v[248:251],a[20:23]
s_waitcnt vmcnt(16)
v_mfma_f32_16x16x32_bf16 a[40:43],a[248:251],a[236:239],a[40:43]
s_waitcnt vmcnt(15)
v_mfma_f32_16x16x32_bf16 a[40:43],v[20:23],v[176:179],a[40:43]
buffer_load_dwordx4 v[128:131],v17,s[24:27],0 offen offset:3072 sc1
v_mfma_f32_16x16x32_bf16 a[44:47],v[48:51],v[176:179],a[44:47]
v_mfma_f32_16x16x32_bf16 a[44:47],a[188:191],a[236:239],a[44:47]
v_mfma_f32_16x16x32_bf16 a[48:51],v[164:167],a[236:239],a[48:51]
v_mfma_f32_16x16x32_bf16 a[48:51],v[172:175],v[176:179],a[48:51]
buffer_load_dwordx4 v[132:135],v17,s[24:27],s68 offen sc1
v_mfma_f32_16x16x32_bf16 a[52:55],v[36:39],v[176:179],a[52:55]
v_mfma_f32_16x16x32_bf16 a[52:55],a[224:227],a[236:239],a[52:55]
v_mfma_f32_16x16x32_bf16 a[56:59],a[212:215],a[236:239],a[56:59]
v_mfma_f32_16x16x32_bf16 a[56:59],v[168:171],v[176:179],a[56:59]
s_cmp_le_u32 s51,5
s_cselect_b32 s59,8,0
s_add_u32 s59,s59,s48
s_add_u32 s59,s59,108
s_mul_i32 s57,s59,9216
v_add_u32 v18,s57,v10
s_mul_i32 s57,s59,5120
v_add_u32 v15,s57,v10
buffer_load_dwordx4 a[208:211],v15,s[24:27],0 offen sc1
s_waitcnt vmcnt(16)
v_mfma_f32_16x16x32_bf16 a[76:79],v[168:171],v[60:63],a[76:79]
v_mfma_f32_16x16x32_bf16 a[76:79],a[212:215],a[232:235],a[76:79]
v_mfma_f32_16x16x32_bf16 a[72:75],a[224:227],a[232:235],a[72:75]
v_mfma_f32_16x16x32_bf16 a[72:75],v[36:39],v[60:63],a[72:75]
buffer_load_dwordx4 v[144:147],v15,s[24:27],0 offen offset:1024 sc1
v_mfma_f32_16x16x32_bf16 a[68:71],v[172:175],v[60:63],a[68:71]
v_mfma_f32_16x16x32_bf16 a[68:71],v[164:167],a[232:235],a[68:71]
v_mfma_f32_16x16x32_bf16 a[64:67],a[188:191],a[232:235],a[64:67]
buffer_load_dwordx4 v[148:151],v15,s[24:27],0 offen offset:2048 sc1
v_mfma_f32_16x16x32_bf16 a[64:67],v[48:51],v[60:63],a[64:67]
v_mfma_f32_16x16x32_bf16 a[60:63],v[20:23],v[60:63],a[60:63]
v_mfma_f32_16x16x32_bf16 a[60:63],a[248:251],a[232:235],a[60:63]
s_waitcnt vmcnt(17)
v_mfma_f32_16x16x32_bf16 a[80:83],a[248:251],v[112:115],a[80:83]
buffer_load_dwordx4 v[104:107],v15,s[24:27],0 offen offset:3072 sc1
s_waitcnt vmcnt(17)
v_mfma_f32_16x16x32_bf16 a[80:83],v[20:23],a[240:243],a[80:83]
v_mfma_f32_16x16x32_bf16 a[84:87],v[48:51],a[240:243],a[84:87]
v_mfma_f32_16x16x32_bf16 a[84:87],a[188:191],v[112:115],a[84:87]
v_mfma_f32_16x16x32_bf16 a[88:91],v[164:167],v[112:115],a[88:91]
buffer_load_dwordx4 v[160:163],v15,s[24:27],s68 offen sc1
v_mfma_f32_16x16x32_bf16 a[88:91],v[172:175],a[240:243],a[88:91]
v_mfma_f32_16x16x32_bf16 a[92:95],v[36:39],a[240:243],a[92:95]
v_mfma_f32_16x16x32_bf16 a[92:95],a[224:227],v[112:115],a[92:95]
v_mfma_f32_16x16x32_bf16 a[96:99],a[212:215],v[112:115],a[96:99]
buffer_load_dwordx4 v[140:143],v16,s[20:23],s52 offen sc1
v_mfma_f32_16x16x32_bf16 a[96:99],v[168:171],a[240:243],a[96:99]
s_waitcnt vmcnt(17)
v_mfma_f32_16x16x32_bf16 a[116:119],v[168:171],v[84:87],a[116:119]
v_mfma_f32_16x16x32_bf16 a[116:119],a[212:215],a[200:203],a[116:119]
buffer_load_dwordx4 v[44:47],v18,s[20:23],s52 offen sc1
v_mfma_f32_16x16x32_bf16 a[112:115],a[224:227],a[200:203],a[112:115]
v_mfma_f32_16x16x32_bf16 a[112:115],v[36:39],v[84:87],a[112:115]
v_mfma_f32_16x16x32_bf16 a[108:111],v[172:175],v[84:87],a[108:111]
v_mfma_f32_16x16x32_bf16 a[108:111],v[164:167],a[200:203],a[108:111]
buffer_load_dwordx4 v[136:139],v16,s[20:23],s52 offen offset:1024 sc1
v_mfma_f32_16x16x32_bf16 a[104:107],a[188:191],a[200:203],a[104:107]
v_mfma_f32_16x16x32_bf16 a[104:107],v[48:51],v[84:87],a[104:107]
v_mfma_f32_16x16x32_bf16 a[100:103],v[20:23],v[84:87],a[100:103]
v_mfma_f32_16x16x32_bf16 a[100:103],a[248:251],a[200:203],a[100:103]
buffer_load_dwordx4 v[152:155],v18,s[20:23],s52 offen offset:1024 sc1
s_waitcnt vmcnt(19)
v_mfma_f32_16x16x32_bf16 a[120:123],a[248:251],a[184:187],a[120:123]
s_waitcnt vmcnt(18)
v_mfma_f32_16x16x32_bf16 a[120:123],v[20:23],v[96:99],a[120:123]
v_mfma_f32_16x16x32_bf16 a[124:127],v[48:51],v[96:99],a[124:127]
v_mfma_f32_16x16x32_bf16 a[124:127],a[188:191],a[184:187],a[124:127]
buffer_load_dwordx4 v[64:67],v16,s[20:23],s53 offen sc1
v_mfma_f32_16x16x32_bf16 a[128:131],v[164:167],a[184:187],a[128:131]
v_mfma_f32_16x16x32_bf16 a[128:131],v[172:175],v[96:99],a[128:131]
v_mfma_f32_16x16x32_bf16 a[132:135],v[36:39],v[96:99],a[132:135]
buffer_load_dwordx4 v[72:75],v18,s[20:23],s53 offen sc1
v_mfma_f32_16x16x32_bf16 a[132:135],a[224:227],a[184:187],a[132:135]
v_mfma_f32_16x16x32_bf16 a[136:139],a[212:215],a[184:187],a[136:139]
v_mfma_f32_16x16x32_bf16 a[136:139],v[168:171],v[96:99],a[136:139]
s_waitcnt vmcnt(18)
v_mfma_f32_16x16x32_bf16 a[156:159],v[168:171],v[108:111],a[156:159]
buffer_load_dwordx4 v[52:55],v16,s[20:23],s53 offen offset:1024 sc1
v_mfma_f32_16x16x32_bf16 a[156:159],a[212:215],v[88:91],a[156:159]
v_mfma_f32_16x16x32_bf16 a[152:155],a[224:227],v[88:91],a[152:155]
v_mfma_f32_16x16x32_bf16 a[152:155],v[36:39],v[108:111],a[152:155]
v_mfma_f32_16x16x32_bf16 a[148:151],v[172:175],v[108:111],a[148:151]
buffer_load_dwordx4 a[244:247],v18,s[20:23],s53 offen offset:1024 sc1
v_mfma_f32_16x16x32_bf16 a[148:151],v[164:167],v[88:91],a[148:151]
v_mfma_f32_16x16x32_bf16 a[144:147],a[188:191],v[88:91],a[144:147]
v_mfma_f32_16x16x32_bf16 a[144:147],v[48:51],v[108:111],a[144:147]
v_mfma_f32_16x16x32_bf16 a[140:143],v[20:23],v[108:111],a[140:143]
buffer_load_dwordx4 v[56:59],v16,s[20:23],s54 offen sc1
v_mfma_f32_16x16x32_bf16 a[140:143],a[248:251],v[88:91],a[140:143]
s_waitcnt vmcnt(20)
v_mfma_f32_16x16x32_bf16 a[160:163],a[248:251],v[100:103],a[160:163]
s_waitcnt vmcnt(19)
v_mfma_f32_16x16x32_bf16 a[160:163],v[20:23],v[116:119],a[160:163]
buffer_load_dwordx4 v[24:27],v18,s[20:23],s54 offen sc1
v_mfma_f32_16x16x32_bf16 a[164:167],v[48:51],v[116:119],a[164:167]
v_mfma_f32_16x16x32_bf16 a[164:167],a[188:191],v[100:103],a[164:167]
v_mfma_f32_16x16x32_bf16 a[168:171],v[164:167],v[100:103],a[168:171]
v_mfma_f32_16x16x32_bf16 a[168:171],v[172:175],v[116:119],a[168:171]
buffer_load_dwordx4 v[68:71],v16,s[20:23],s54 offen offset:1024 sc1
v_mfma_f32_16x16x32_bf16 a[172:175],v[36:39],v[116:119],a[172:175]
v_mfma_f32_16x16x32_bf16 a[172:175],a[224:227],v[100:103],a[172:175]
v_mfma_f32_16x16x32_bf16 a[176:179],a[212:215],v[100:103],a[176:179]
v_mfma_f32_16x16x32_bf16 a[176:179],v[168:171],v[116:119],a[176:179]
buffer_load_dwordx4 v[76:79],v18,s[20:23],s54 offen offset:1024 sc1
s_waitcnt vmcnt(11)
v_mfma_f32_16x16x32_bf16 a[0:3],v[40:43],v[140:143],a[0:3]
s_waitcnt vmcnt(10)
v_mfma_f32_16x16x32_bf16 a[0:3],a[208:211],v[44:47],a[0:3]
v_mfma_f32_16x16x32_bf16 a[4:7],v[144:147],v[44:47],a[4:7]
buffer_load_dwordx4 v[80:83],v16,s[20:23],s55 offen sc1
v_mfma_f32_16x16x32_bf16 a[4:7],a[196:199],v[140:143],a[4:7]
v_mfma_f32_16x16x32_bf16 a[8:11],v[120:123],v[140:143],a[8:11]
v_mfma_f32_16x16x32_bf16 a[8:11],v[148:151],v[44:47],a[8:11]
v_mfma_f32_16x16x32_bf16 a[12:15],v[104:107],v[44:47],a[12:15]
buffer_load_dwordx4 a[192:195],v18,s[20:23],s55 offen sc1
v_mfma_f32_16x16x32_bf16 a[12:15],v[128:131],v[140:143],a[12:15]
v_mfma_f32_16x16x32_bf16 a[16:19],v[132:135],v[140:143],a[16:19]
v_mfma_f32_16x16x32_bf16 a[16:19],v[160:163],v[44:47],a[16:19]
s_waitcnt vmcnt(10)
v_mfma_f32_16x16x32_bf16 a[36:39],v[160:163],v[152:155],a[36:39]
buffer_load_dwordx4 v[124:127],v16,s[20:23],s55 offen offset:1024 sc1
v_mfma_f32_16x16x32_bf16 a[36:39],v[132:135],v[136:139],a[36:39]
v_mfma_f32_16x16x32_bf16 a[32:35],v[128:131],v[136:139],a[32:35]
v_mfma_f32_16x16x32_bf16 a[32:35],v[104:107],v[152:155],a[32:35]
v_mfma_f32_16x16x32_bf16 a[28:31],v[148:151],v[152:155],a[28:31]
buffer_load_dwordx4 a[204:207],v18,s[20:23],s55 offen offset:1024 sc1
v_mfma_f32_16x16x32_bf16 a[28:31],v[120:123],v[136:139],a[28:31]
v_mfma_f32_16x16x32_bf16 a[24:27],a[196:199],v[136:139],a[24:27]
v_mfma_f32_16x16x32_bf16 a[24:27],v[144:147],v[152:155],a[24:27]
buffer_load_dwordx4 a[180:183],v16,s[20:23],s69 offen sc1
v_mfma_f32_16x16x32_bf16 a[20:23],a[208:211],v[152:155],a[20:23]
v_mfma_f32_16x16x32_bf16 a[20:23],v[40:43],v[136:139],a[20:23]
s_waitcnt vmcnt(12)
v_mfma_f32_16x16x32_bf16 a[40:43],v[40:43],v[64:67],a[40:43]
s_waitcnt vmcnt(11)
v_mfma_f32_16x16x32_bf16 a[40:43],a[208:211],v[72:75],a[40:43]
buffer_load_dwordx4 v[224:227],v18,s[20:23],s69 offen sc1
v_mfma_f32_16x16x32_bf16 a[44:47],v[144:147],v[72:75],a[44:47]
v_mfma_f32_16x16x32_bf16 a[44:47],a[196:199],v[64:67],a[44:47]
v_mfma_f32_16x16x32_bf16 a[48:51],v[120:123],v[64:67],a[48:51]
v_mfma_f32_16x16x32_bf16 a[48:51],v[148:151],v[72:75],a[48:51]
s_cmp_le_u32 s51,6
s_cselect_b32 s59,8,0
s_add_u32 s59,s59,s48
s_add_u32 s59,s59,112
s_mul_i32 s57,s59,9216
v_add_u32 v252,s57,v10
s_mul_i32 s57,s59,5120
v_add_u32 v253,s57,v10
buffer_load_dwordx4 v[236:239],v253,s[24:27],0 offen sc1
v_mfma_f32_16x16x32_bf16 a[52:55],v[104:107],v[72:75],a[52:55]
v_mfma_f32_16x16x32_bf16 a[52:55],v[128:131],v[64:67],a[52:55]
v_mfma_f32_16x16x32_bf16 a[56:59],v[132:135],v[64:67],a[56:59]
v_mfma_f32_16x16x32_bf16 a[56:59],v[160:163],v[72:75],a[56:59]
buffer_load_dwordx4 v[228:231],v253,s[24:27],0 offen offset:1024 sc1
s_waitcnt vmcnt(12)
v_mfma_f32_16x16x32_bf16 a[76:79],v[160:163],a[244:247],a[76:79]
v_mfma_f32_16x16x32_bf16 a[76:79],v[132:135],v[52:55],a[76:79]
v_mfma_f32_16x16x32_bf16 a[72:75],v[128:131],v[52:55],a[72:75]
buffer_load_dwordx4 v[232:235],v253,s[24:27],0 offen offset:2048 sc1
v_mfma_f32_16x16x32_bf16 a[72:75],v[104:107],a[244:247],a[72:75]
v_mfma_f32_16x16x32_bf16 a[68:71],v[148:151],a[244:247],a[68:71]
v_mfma_f32_16x16x32_bf16 a[68:71],v[120:123],v[52:55],a[68:71]
v_mfma_f32_16x16x32_bf16 a[64:67],a[196:199],v[52:55],a[64:67]
buffer_load_dwordx4 v[28:31],v253,s[24:27],0 offen offset:3072 sc1
v_mfma_f32_16x16x32_bf16 a[64:67],v[144:147],a[244:247],a[64:67]
v_mfma_f32_16x16x32_bf16 a[60:63],a[208:211],a[244:247],a[60:63]
v_mfma_f32_16x16x32_bf16 a[60:63],v[40:43],v[52:55],a[60:63]
s_waitcnt vmcnt(13)
v_mfma_f32_16x16x32_bf16 a[80:83],v[40:43],v[56:59],a[80:83]
buffer_load_dwordx4 v[220:223],v253,s[24:27],s68 offen sc1
s_waitcnt vmcnt(13)
v_mfma_f32_16x16x32_bf16 a[80:83],a[208:211],v[24:27],a[80:83]
v_mfma_f32_16x16x32_bf16 a[84:87],v[144:147],v[24:27],a[84:87]
v_mfma_f32_16x16x32_bf16 a[84:87],a[196:199],v[56:59],a[84:87]
v_mfma_f32_16x16x32_bf16 a[88:91],v[120:123],v[56:59],a[88:91]
s_cmp_le_u32 s51,6
s_cselect_b32 s59,8,0
s_add_u32 s59,s59,s48
s_add_u32 s59,s59,116
s_mul_i32 s57,s59,9216
v_add_u32 v16,s57,v10
s_mul_i32 s57,s59,5120
v_add_u32 v17,s57,v10
buffer_load_dwordx4 v[32:35],v17,s[24:27],0 offen sc1
s_xor_b32 s59,s48,1
s_mul_i32 s59,s59,30720
s_add_u32 s59,s59,0
v_add_u32 v1,s59,v10
s_xor_b32 s59,s48,2
s_mul_i32 s59,s59,30720
s_add_u32 s59,s59,10240
v_add_u32 v4,s59,v10
s_xor_b32 s59,s48,3
s_mul_i32 s59,s59,30720
s_add_u32 s59,s59,20480
v_add_u32 v5,s59,v10
s_mul_i32 s59,s48,5120
s_add_u32 s59,s59,122880
v_add_u32 v6,s59,v10
s_mul_i32 s59,s48,30720
v_add_u32 v2,s59,v10
v_and_b32 v3,15,v0
v_mul_u32_u24 v3,1280,v3
v_bfe_u32 v9,v0,4,1
v_lshl_add_u32 v9,v9,5,v3
v_bfe_u32 v7,v0,5,1
v_lshl_add_u32 v9,v7,4,v9
v_bfe_u32 v7,v0,4,2
v_lshl_add_u32 v3,v7,3,v3
s_mul_i32 s90,s51,160
s_mul_i32 s59,s48,40960
s_add_u32 s70,s90,s59
s_add_u32 s71,s70,20480
s_lshl_b32 s59,s48,10
s_add_u32 s59,s59,122880
v_add_u32 v8,s59,v10
s_lshl_b32 s59,s48,5
s_add_u32 s90,s90,s59
s_add_u32 s90,s90,163840
v_mfma_f32_16x16x32_bf16 a[88:91],v[148:151],v[24:27],a[88:91]
v_mfma_f32_16x16x32_bf16 a[92:95],v[104:107],v[24:27],a[92:95]
v_mfma_f32_16x16x32_bf16 a[92:95],v[128:131],v[56:59],a[92:95]
buffer_load_dwordx4 a[252:255],v17,s[24:27],0 offen offset:1024 sc1
v_mfma_f32_16x16x32_bf16 a[96:99],v[132:135],v[56:59],a[96:99]
v_mfma_f32_16x16x32_bf16 a[96:99],v[160:163],v[24:27],a[96:99]
s_waitcnt vmcnt(13)
v_mfma_f32_16x16x32_bf16 a[116:119],v[160:163],v[76:79],a[116:119]
v_mfma_f32_16x16x32_bf16 a[116:119],v[132:135],v[68:71],a[116:119]
buffer_load_dwordx4 v[244:247],v17,s[24:27],0 offen offset:2048 sc1
v_mfma_f32_16x16x32_bf16 a[112:115],v[128:131],v[68:71],a[112:115]
v_mfma_f32_16x16x32_bf16 a[112:115],v[104:107],v[76:79],a[112:115]
v_mfma_f32_16x16x32_bf16 a[108:111],v[148:151],v[76:79],a[108:111]
v_mfma_f32_16x16x32_bf16 a[108:111],v[120:123],v[68:71],a[108:111]
buffer_load_dwordx4 v[92:95],v17,s[24:27],0 offen offset:3072 sc1
v_mfma_f32_16x16x32_bf16 a[104:107],a[196:199],v[68:71],a[104:107]
v_mfma_f32_16x16x32_bf16 a[104:107],v[144:147],v[76:79],a[104:107]
v_mfma_f32_16x16x32_bf16 a[100:103],a[208:211],v[76:79],a[100:103]
v_mfma_f32_16x16x32_bf16 a[100:103],v[40:43],v[68:71],a[100:103]
buffer_load_dwordx4 v[240:243],v17,s[24:27],s68 offen sc1
s_waitcnt vmcnt(15)
v_mfma_f32_16x16x32_bf16 a[120:123],v[40:43],v[80:83],a[120:123]
s_waitcnt vmcnt(14)
v_mfma_f32_16x16x32_bf16 a[120:123],a[208:211],a[192:195],a[120:123]
v_mfma_f32_16x16x32_bf16 a[124:127],v[144:147],a[192:195],a[124:127]
buffer_load_dwordx4 a[216:219],v252,s[20:23],s53 offen sc1
v_mfma_f32_16x16x32_bf16 a[124:127],a[196:199],v[80:83],a[124:127]
v_mfma_f32_16x16x32_bf16 a[128:131],v[120:123],v[80:83],a[128:131]
v_mfma_f32_16x16x32_bf16 a[128:131],v[148:151],a[192:195],a[128:131]
v_mfma_f32_16x16x32_bf16 a[132:135],v[104:107],a[192:195],a[132:135]
buffer_load_dwordx4 v[156:159],v16,s[20:23],s53 offen sc1
v_mfma_f32_16x16x32_bf16 a[132:135],v[128:131],v[80:83],a[132:135]
v_mfma_f32_16x16x32_bf16 a[136:139],v[132:135],v[80:83],a[136:139]
v_mfma_f32_16x16x32_bf16 a[136:139],v[160:163],a[192:195],a[136:139]
s_waitcnt vmcnt(14)
v_mfma_f32_16x16x32_bf16 a[156:159],v[160:163],a[204:207],a[156:159]
buffer_load_dwordx4 a[228:231],v252,s[20:23],s53 offen offset:1024 sc1
v_mfma_f32_16x16x32_bf16 a[156:159],v[132:135],v[124:127],a[156:159]
v_mfma_f32_16x16x32_bf16 a[152:155],v[128:131],v[124:127],a[152:155]
v_mfma_f32_16x16x32_bf16 a[152:155],v[104:107],a[204:207],a[152:155]
buffer_load_dwordx4 a[220:223],v16,s[20:23],s53 offen offset:1024 sc1
v_mfma_f32_16x16x32_bf16 a[148:151],v[148:151],a[204:207],a[148:151]
v_mfma_f32_16x16x32_bf16 a[148:151],v[120:123],v[124:127],a[148:151]
v_mfma_f32_16x16x32_bf16 a[144:147],a[196:199],v[124:127],a[144:147]
v_mfma_f32_16x16x32_bf16 a[144:147],v[144:147],a[204:207],a[144:147]
buffer_load_dwordx4 v[248:251],v252,s[20:23],s54 offen sc1
v_mfma_f32_16x16x32_bf16 a[140:143],a[208:211],a[204:207],a[140:143]
v_mfma_f32_16x16x32_bf16 a[140:143],v[40:43],v[124:127],a[140:143]
s_waitcnt vmcnt(16)
v_mfma_f32_16x16x32_bf16 a[160:163],v[40:43],a[180:183],a[160:163]
s_waitcnt vmcnt(15)
v_mfma_f32_16x16x32_bf16 a[160:163],a[208:211],v[224:227],a[160:163]
buffer_load_dwordx4 a[236:239],v16,s[20:23],s54 offen sc1
v_mfma_f32_16x16x32_bf16 a[164:167],v[144:147],v[224:227],a[164:167]
v_mfma_f32_16x16x32_bf16 a[164:167],a[196:199],a[180:183],a[164:167]
v_mfma_f32_16x16x32_bf16 a[168:171],v[120:123],a[180:183],a[168:171]
v_mfma_f32_16x16x32_bf16 a[168:171],v[148:151],v[224:227],a[168:171]
buffer_load_dwordx4 v[176:179],v252,s[20:23],s54 offen offset:1024 sc1
v_mfma_f32_16x16x32_bf16 a[172:175],v[104:107],v[224:227],a[172:175]
v_mfma_f32_16x16x32_bf16 a[172:175],v[128:131],a[180:183],a[172:175]
v_mfma_f32_16x16x32_bf16 a[176:179],v[132:135],a[180:183],a[176:179]
buffer_load_dwordx4 v[60:63],v16,s[20:23],s54 offen offset:1024 sc1
v_mfma_f32_16x16x32_bf16 a[176:179],v[160:163],v[224:227],a[176:179]
s_waitcnt vmcnt(7)
v_mfma_f32_16x16x32_bf16 a[40:43],v[236:239],a[216:219],a[40:43]
v_accvgpr_read_b32 v180,a0
s_waitcnt vmcnt(6)
v_mfma_f32_16x16x32_bf16 a[40:43],v[32:35],v[156:159],a[40:43]
v_accvgpr_read_b32 v181,a1
v_mfma_f32_16x16x32_bf16 a[44:47],a[252:255],v[156:159],a[44:47]
buffer_load_dwordx4 a[232:235],v252,s[20:23],s55 offen sc1
v_mfma_f32_16x16x32_bf16 a[44:47],v[228:231],a[216:219],a[44:47]
v_accvgpr_read_b32 v182,a2
v_mfma_f32_16x16x32_bf16 a[48:51],v[232:235],a[216:219],a[48:51]
v_accvgpr_read_b32 v183,a3
v_mfma_f32_16x16x32_bf16 a[48:51],v[244:247],v[156:159],a[48:51]
v_accvgpr_read_b32 v184,a4
v_mfma_f32_16x16x32_bf16 a[52:55],v[92:95],v[156:159],a[52:55]
buffer_load_dwordx4 v[112:115],v16,s[20:23],s55 offen sc1
ds_write_b128 v1,a[40:43] offset:0
v_mfma_f32_16x16x32_bf16 a[52:55],v[28:31],a[216:219],a[52:55]
v_accvgpr_read_b32 v185,a5
v_mfma_f32_16x16x32_bf16 a[56:59],v[220:223],a[216:219],a[56:59]
v_accvgpr_read_b32 v186,a6
ds_write_b128 v1,a[44:47] offset:1024
v_mfma_f32_16x16x32_bf16 a[56:59],v[240:243],v[156:159],a[56:59]
v_accvgpr_read_b32 v187,a7
s_waitcnt vmcnt(6)
v_mfma_f32_16x16x32_bf16 a[76:79],v[240:243],a[220:223],a[76:79]
buffer_load_dwordx4 a[240:243],v252,s[20:23],s55 offen offset:1024 sc1
ds_write_b128 v1,a[48:51] offset:2048
v_mfma_f32_16x16x32_bf16 a[76:79],v[220:223],a[228:231],a[76:79]
v_accvgpr_read_b32 v188,a8
v_mfma_f32_16x16x32_bf16 a[72:75],v[28:31],a[228:231],a[72:75]
v_accvgpr_read_b32 v189,a9
ds_write_b128 v1,a[52:55] offset:3072
v_mfma_f32_16x16x32_bf16 a[72:75],v[92:95],a[220:223],a[72:75]
buffer_load_dwordx4 v[84:87],v16,s[20:23],s55 offen offset:1024 sc1
v_mfma_f32_16x16x32_bf16 a[68:71],v[244:247],a[220:223],a[68:71]
v_accvgpr_read_b32 v190,a10
ds_write_b128 v1,a[56:59] offset:4096
v_mfma_f32_16x16x32_bf16 a[68:71],v[232:235],a[228:231],a[68:71]
v_accvgpr_read_b32 v191,a11
v_mfma_f32_16x16x32_bf16 a[64:67],v[228:231],a[228:231],a[64:67]
v_accvgpr_read_b32 v192,a12
ds_write_b128 v1,a[76:79] offset:9216
v_mfma_f32_16x16x32_bf16 a[64:67],a[252:255],a[220:223],a[64:67]
buffer_load_dwordx4 a[200:203],v252,s[20:23],s69 offen sc1
v_mfma_f32_16x16x32_bf16 a[60:63],v[32:35],a[220:223],a[60:63]
v_accvgpr_read_b32 v193,a13
ds_write_b128 v1,a[72:75] offset:8192
v_mfma_f32_16x16x32_bf16 a[60:63],v[236:239],a[228:231],a[60:63]
v_accvgpr_read_b32 v194,a14
s_waitcnt vmcnt(8)
v_mfma_f32_16x16x32_bf16 a[80:83],v[236:239],v[248:251],a[80:83]
v_accvgpr_read_b32 v195,a15
ds_write_b128 v1,a[68:71] offset:7168
s_waitcnt vmcnt(7)
v_mfma_f32_16x16x32_bf16 a[80:83],v[32:35],a[236:239],a[80:83]
buffer_load_dwordx4 a[184:187],v16,s[20:23],s69 offen sc1
v_mfma_f32_16x16x32_bf16 a[84:87],a[252:255],a[236:239],a[84:87]
v_accvgpr_read_b32 v196,a16
ds_write_b128 v1,a[64:67] offset:6144
v_mfma_f32_16x16x32_bf16 a[84:87],v[228:231],v[248:251],a[84:87]
v_accvgpr_read_b32 v197,a17
v_mfma_f32_16x16x32_bf16 a[88:91],v[232:235],v[248:251],a[88:91]
v_accvgpr_read_b32 v198,a18
ds_write_b128 v1,a[60:63] offset:5120
v_mfma_f32_16x16x32_bf16 a[88:91],v[244:247],a[236:239],a[88:91]
buffer_load_dwordx4 v[96:99],v252,s[20:23],s52 offen sc1
v_mfma_f32_16x16x32_bf16 a[92:95],v[92:95],a[236:239],a[92:95]
v_accvgpr_read_b32 v199,a19
ds_write_b128 v4,a[80:83] offset:0
v_mfma_f32_16x16x32_bf16 a[92:95],v[28:31],v[248:251],a[92:95]
v_accvgpr_read_b32 v200,a20
v_mfma_f32_16x16x32_bf16 a[96:99],v[220:223],v[248:251],a[96:99]
buffer_load_dwordx4 v[108:111],v16,s[20:23],s52 offen sc1
ds_write_b128 v4,a[84:87] offset:1024
v_mfma_f32_16x16x32_bf16 a[96:99],v[240:243],a[236:239],a[96:99]
v_accvgpr_read_b32 v201,a21
s_waitcnt vmcnt(8)
v_mfma_f32_16x16x32_bf16 a[116:119],v[240:243],v[60:63],a[116:119]
v_accvgpr_read_b32 v202,a22
ds_write_b128 v4,a[88:91] offset:2048
v_mfma_f32_16x16x32_bf16 a[116:119],v[220:223],v[176:179],a[116:119]
v_accvgpr_read_b32 v203,a23
v_mfma_f32_16x16x32_bf16 a[112:115],v[28:31],v[176:179],a[112:115]
buffer_load_dwordx4 v[88:91],v252,s[20:23],s52 offen offset:1024 sc1
ds_write_b128 v4,a[92:95] offset:3072
v_mfma_f32_16x16x32_bf16 a[112:115],v[92:95],v[60:63],a[112:115]
v_accvgpr_read_b32 v204,a24
v_mfma_f32_16x16x32_bf16 a[108:111],v[244:247],v[60:63],a[108:111]
v_accvgpr_read_b32 v205,a25
ds_write_b128 v4,a[96:99] offset:4096
v_mfma_f32_16x16x32_bf16 a[108:111],v[232:235],v[176:179],a[108:111]
v_accvgpr_read_b32 v206,a26
v_mfma_f32_16x16x32_bf16 a[104:107],v[228:231],v[176:179],a[104:107]
buffer_load_dwordx4 a[248:251],v16,s[20:23],s52 offen offset:1024 sc1
s_waitcnt lgkmcnt(14)
ds_write_b128 v4,a[116:119] offset:9216
v_mfma_f32_16x16x32_bf16 a[104:107],a[252:255],v[60:63],a[104:107]
v_accvgpr_read_b32 v207,a27
v_mfma_f32_16x16x32_bf16 a[100:103],v[32:35],v[60:63],a[100:103]
v_accvgpr_read_b32 v208,a28
s_waitcnt lgkmcnt(14)
ds_write_b128 v4,a[112:115] offset:8192
v_mfma_f32_16x16x32_bf16 a[100:103],v[236:239],v[176:179],a[100:103]
v_accvgpr_read_b32 v209,a29
s_waitcnt vmcnt(9)
v_mfma_f32_16x16x32_bf16 a[120:123],v[236:239],a[232:235],a[120:123]
v_accvgpr_read_b32 v210,a30
s_waitcnt lgkmcnt(14)
ds_write_b128 v4,a[108:111] offset:7168
s_waitcnt vmcnt(8)
v_mfma_f32_16x16x32_bf16 a[120:123],v[32:35],v[112:115],a[120:123]
v_accvgpr_read_b32 v211,a31
v_mfma_f32_16x16x32_bf16 a[124:127],a[252:255],v[112:115],a[124:127]
v_accvgpr_read_b32 v212,a32
s_waitcnt lgkmcnt(14)
ds_write_b128 v4,a[104:107] offset:6144
v_mfma_f32_16x16x32_bf16 a[124:127],v[228:231],a[232:235],a[124:127]
v_accvgpr_read_b32 v213,a33
v_mfma_f32_16x16x32_bf16 a[128:131],v[232:235],a[232:235],a[128:131]
v_accvgpr_read_b32 v214,a34
s_waitcnt lgkmcnt(14)
ds_write_b128 v4,a[100:103] offset:5120
v_mfma_f32_16x16x32_bf16 a[128:131],v[244:247],v[112:115],a[128:131]
v_accvgpr_read_b32 v215,a35
v_mfma_f32_16x16x32_bf16 a[132:135],v[92:95],v[112:115],a[132:135]
v_accvgpr_read_b32 v216,a36
s_waitcnt lgkmcnt(14)
ds_write_b128 v5,a[120:123] offset:0
v_mfma_f32_16x16x32_bf16 a[132:135],v[28:31],a[232:235],a[132:135]
v_accvgpr_read_b32 v217,a37
v_mfma_f32_16x16x32_bf16 a[136:139],v[220:223],a[232:235],a[136:139]
v_accvgpr_read_b32 v218,a38
s_waitcnt lgkmcnt(14)
ds_write_b128 v5,a[124:127] offset:1024
v_mfma_f32_16x16x32_bf16 a[136:139],v[240:243],v[112:115],a[136:139]
v_accvgpr_read_b32 v219,a39
s_waitcnt vmcnt(6)
v_mfma_f32_16x16x32_bf16 a[156:159],v[240:243],v[84:87],a[156:159]
s_waitcnt lgkmcnt(14)
ds_write_b128 v5,a[128:131] offset:2048
v_mfma_f32_16x16x32_bf16 a[156:159],v[220:223],a[240:243],a[156:159]
v_mfma_f32_16x16x32_bf16 a[152:155],v[28:31],a[240:243],a[152:155]
s_waitcnt lgkmcnt(14)
ds_write_b128 v5,a[132:135] offset:3072
v_mfma_f32_16x16x32_bf16 a[152:155],v[92:95],v[84:87],a[152:155]
v_mfma_f32_16x16x32_bf16 a[148:151],v[244:247],v[84:87],a[148:151]
s_waitcnt lgkmcnt(14)
ds_write_b128 v5,a[136:139] offset:4096
v_mfma_f32_16x16x32_bf16 a[148:151],v[232:235],a[240:243],a[148:151]
v_mfma_f32_16x16x32_bf16 a[144:147],v[228:231],a[240:243],a[144:147]
s_waitcnt lgkmcnt(14)
ds_write_b128 v5,a[156:159] offset:9216
v_mfma_f32_16x16x32_bf16 a[144:147],a[252:255],v[84:87],a[144:147]
v_mfma_f32_16x16x32_bf16 a[140:143],v[32:35],v[84:87],a[140:143]
s_waitcnt lgkmcnt(14)
ds_write_b128 v5,a[152:155] offset:8192
v_mfma_f32_16x16x32_bf16 a[140:143],v[236:239],a[240:243],a[140:143]
s_waitcnt vmcnt(5)
v_mfma_f32_16x16x32_bf16 a[160:163],v[236:239],a[200:203],a[160:163]
s_waitcnt lgkmcnt(14)
ds_write_b128 v5,a[148:151] offset:7168
s_waitcnt vmcnt(4)
v_mfma_f32_16x16x32_bf16 a[160:163],v[32:35],a[184:187],a[160:163]
v_mfma_f32_16x16x32_bf16 a[164:167],a[252:255],a[184:187],a[164:167]
s_waitcnt lgkmcnt(14)
ds_write_b128 v5,a[144:147] offset:6144
v_mfma_f32_16x16x32_bf16 a[164:167],v[228:231],a[200:203],a[164:167]
v_mfma_f32_16x16x32_bf16 a[168:171],v[232:235],a[200:203],a[168:171]
s_waitcnt lgkmcnt(14)
ds_write_b128 v5,a[140:143] offset:5120
v_mfma_f32_16x16x32_bf16 a[168:171],v[244:247],a[184:187],a[168:171]
v_mfma_f32_16x16x32_bf16 a[172:175],v[92:95],a[184:187],a[172:175]
s_waitcnt lgkmcnt(14)
ds_write_b128 v6,a[160:163] offset:0
v_mfma_f32_16x16x32_bf16 a[172:175],v[28:31],a[200:203],a[172:175]
v_mfma_f32_16x16x32_bf16 a[176:179],v[220:223],a[200:203],a[176:179]
s_waitcnt lgkmcnt(14)
ds_write_b128 v6,a[164:167] offset:1024
v_mfma_f32_16x16x32_bf16 a[176:179],v[240:243],a[184:187],a[176:179]
s_waitcnt vmcnt(2)
v_mfma_f32_16x16x32_bf16 v[196:199],v[240:243],v[108:111],v[196:199]
s_waitcnt lgkmcnt(14)
ds_write_b128 v6,a[168:171] offset:2048
v_mfma_f32_16x16x32_bf16 v[196:199],v[220:223],v[96:99],v[196:199]
s_waitcnt lgkmcnt(14)
ds_write_b128 v6,a[172:175] offset:3072
v_mfma_f32_16x16x32_bf16 v[192:195],v[28:31],v[96:99],v[192:195]
s_waitcnt lgkmcnt(14)
ds_write_b128 v6,a[176:179] offset:4096
v_mfma_f32_16x16x32_bf16 v[192:195],v[92:95],v[108:111],v[192:195]
v_mfma_f32_16x16x32_bf16 v[188:191],v[244:247],v[108:111],v[188:191]
s_waitcnt lgkmcnt(0)
s_barrier
ds_read_b128 v[20:23],v2 offset:0
ds_read_b128 v[48:51],v2 offset:10240
v_mfma_f32_16x16x32_bf16 v[188:191],v[232:235],v[96:99],v[188:191]
ds_read_b128 v[164:167],v2 offset:20480
ds_read_b128 v[172:175],v2 offset:1024
v_mfma_f32_16x16x32_bf16 v[184:187],v[228:231],v[96:99],v[184:187]
ds_read_b128 v[36:39],v2 offset:11264
ds_read_b128 v[100:103],v2 offset:21504
v_mfma_f32_16x16x32_bf16 v[184:187],a[252:255],v[108:111],v[184:187]
ds_read_b128 v[168:171],v2 offset:2048
ds_read_b128 v[116:119],v2 offset:12288
v_mfma_f32_16x16x32_bf16 v[180:183],v[32:35],v[108:111],v[180:183]
ds_read_b128 v[140:143],v2 offset:22528
ds_read_b128 v[44:47],v2 offset:3072
v_mfma_f32_16x16x32_bf16 v[180:183],v[236:239],v[96:99],v[180:183]
ds_read_b128 v[152:155],v2 offset:13312
ds_read_b128 v[136:139],v2 offset:23552
s_waitcnt vmcnt(1)
v_mfma_f32_16x16x32_bf16 v[200:203],v[236:239],v[88:91],v[200:203]
ds_read_b128 v[64:67],v2 offset:4096
ds_read_b128 v[72:75],v2 offset:14336
s_waitcnt vmcnt(0)
v_mfma_f32_16x16x32_bf16 v[200:203],v[32:35],a[248:251],v[200:203]
ds_read_b128 v[52:55],v2 offset:24576
s_waitcnt lgkmcnt(14)
ds_read_b128 v[56:59],v2 offset:5120
v_mfma_f32_16x16x32_bf16 v[204:207],a[252:255],a[248:251],v[204:207]
s_waitcnt lgkmcnt(14)
ds_read_b128 v[24:27],v2 offset:15360
s_waitcnt lgkmcnt(14)
ds_read_b128 v[76:79],v2 offset:25600
v_mfma_f32_16x16x32_bf16 v[204:207],v[228:231],v[88:91],v[204:207]
s_waitcnt lgkmcnt(14)
ds_read_b128 v[68:71],v2 offset:6144
s_waitcnt lgkmcnt(14)
ds_read_b128 v[80:83],v2 offset:16384
v_mfma_f32_16x16x32_bf16 v[208:211],v[232:235],v[88:91],v[208:211]
s_waitcnt lgkmcnt(14)
ds_read_b128 v[124:127],v2 offset:26624
s_waitcnt lgkmcnt(14)
ds_read_b128 v[40:43],v2 offset:7168
v_mfma_f32_16x16x32_bf16 v[208:211],v[244:247],a[248:251],v[208:211]
s_waitcnt lgkmcnt(14)
ds_read_b128 v[144:147],v2 offset:17408
s_waitcnt lgkmcnt(14)
ds_read_b128 v[120:123],v2 offset:27648
v_mfma_f32_16x16x32_bf16 v[212:215],v[92:95],a[248:251],v[212:215]
s_waitcnt lgkmcnt(14)
ds_read_b128 v[148:151],v2 offset:8192
s_waitcnt lgkmcnt(14)
ds_read_b128 v[104:107],v2 offset:18432
v_mfma_f32_16x16x32_bf16 v[212:215],v[28:31],v[88:91],v[212:215]
s_waitcnt lgkmcnt(14)
ds_read_b128 v[128:131],v2 offset:28672
s_waitcnt lgkmcnt(14)
ds_read_b128 v[132:135],v2 offset:9216
v_mfma_f32_16x16x32_bf16 v[216:219],v[220:223],v[88:91],v[216:219]
s_waitcnt lgkmcnt(14)
ds_read_b128 v[160:163],v2 offset:19456
s_waitcnt lgkmcnt(14)
ds_read_b128 v[224:227],v2 offset:29696
v_mfma_f32_16x16x32_bf16 v[216:219],v[240:243],a[248:251],v[216:219]
v_pk_add_f32 v[20:21],v[20:21],v[48:49]
v_pk_add_f32 v[22:23],v[22:23],v[50:51]
v_pk_add_f32 v[180:181],v[180:181],v[164:165]
v_pk_add_f32 v[182:183],v[182:183],v[166:167]
v_pk_add_f32 v[180:181],v[180:181],v[20:21]
v_pk_add_f32 v[182:183],v[182:183],v[22:23]
v_cvt_pk_bf16_f32 v48,v180,v181
v_cvt_pk_bf16_f32 v49,v182,v183
v_pk_add_f32 v[172:173],v[172:173],v[36:37]
v_pk_add_f32 v[174:175],v[174:175],v[38:39]
v_pk_add_f32 v[184:185],v[184:185],v[100:101]
v_pk_add_f32 v[186:187],v[186:187],v[102:103]
v_pk_add_f32 v[184:185],v[184:185],v[172:173]
v_pk_add_f32 v[186:187],v[186:187],v[174:175]
v_cvt_pk_bf16_f32 v50,v184,v185
v_cvt_pk_bf16_f32 v51,v186,v187
s_nop 0
v_permlane16_swap_b32 v48,v50
v_permlane16_swap_b32 v49,v51
buffer_store_dwordx4 v[48:51],v9,s[28:31],s70 offen offset:0
v_pk_add_f32 v[168:169],v[168:169],v[116:117]
v_pk_add_f32 v[170:171],v[170:171],v[118:119]
v_pk_add_f32 v[188:189],v[188:189],v[140:141]
v_pk_add_f32 v[190:191],v[190:191],v[142:143]
v_pk_add_f32 v[188:189],v[188:189],v[168:169]
v_pk_add_f32 v[190:191],v[190:191],v[170:171]
v_cvt_pk_bf16_f32 v116,v188,v189
v_cvt_pk_bf16_f32 v117,v190,v191
v_pk_add_f32 v[44:45],v[44:45],v[152:153]
v_pk_add_f32 v[46:47],v[46:47],v[154:155]
v_pk_add_f32 v[192:193],v[192:193],v[136:137]
v_pk_add_f32 v[194:195],v[194:195],v[138:139]
v_pk_add_f32 v[192:193],v[192:193],v[44:45]
v_pk_add_f32 v[194:195],v[194:195],v[46:47]
v_cvt_pk_bf16_f32 v118,v192,v193
v_cvt_pk_bf16_f32 v119,v194,v195
s_nop 0
v_permlane16_swap_b32 v116,v118
v_permlane16_swap_b32 v117,v119
buffer_store_dwordx4 v[116:119],v9,s[28:31],s70 offen offset:64
v_pk_add_f32 v[64:65],v[64:65],v[72:73]
v_pk_add_f32 v[66:67],v[66:67],v[74:75]
v_pk_add_f32 v[196:197],v[196:197],v[52:53]
v_pk_add_f32 v[198:199],v[198:199],v[54:55]
v_pk_add_f32 v[196:197],v[196:197],v[64:65]
v_pk_add_f32 v[198:199],v[198:199],v[66:67]
v_cvt_pk_bf16_f32 v72,v196,v197
v_cvt_pk_bf16_f32 v73,v198,v199
buffer_store_dwordx2 v[72:73],v3,s[28:31],s70 offen offset:128
s_waitcnt lgkmcnt(14)
ds_read_b128 v[20:23],v8 offset:0
s_waitcnt lgkmcnt(14)
ds_read_b128 v[164:167],v8 offset:5120
s_waitcnt lgkmcnt(14)
ds_read_b128 v[172:175],v8 offset:10240
v_pk_add_f32 v[56:57],v[56:57],v[24:25]
v_pk_add_f32 v[58:59],v[58:59],v[26:27]
v_pk_add_f32 v[200:201],v[200:201],v[76:77]
v_pk_add_f32 v[202:203],v[202:203],v[78:79]
v_pk_add_f32 v[200:201],v[200:201],v[56:57]
v_pk_add_f32 v[202:203],v[202:203],v[58:59]
v_cvt_pk_bf16_f32 v24,v200,v201
v_cvt_pk_bf16_f32 v25,v202,v203
s_waitcnt lgkmcnt(14)
ds_read_b128 v[100:103],v8 offset:15360
s_waitcnt lgkmcnt(14)
ds_read_b128 v[168:171],v8 offset:1024
s_waitcnt lgkmcnt(14)
ds_read_b128 v[140:143],v8 offset:6144
v_pk_add_f32 v[68:69],v[68:69],v[80:81]
v_pk_add_f32 v[70:71],v[70:71],v[82:83]
v_pk_add_f32 v[204:205],v[204:205],v[124:125]
v_pk_add_f32 v[206:207],v[206:207],v[126:127]
v_pk_add_f32 v[204:205],v[204:205],v[68:69]
v_pk_add_f32 v[206:207],v[206:207],v[70:71]
v_cvt_pk_bf16_f32 v26,v204,v205
v_cvt_pk_bf16_f32 v27,v206,v207
s_nop 0
v_permlane16_swap_b32 v24,v26
v_permlane16_swap_b32 v25,v27
buffer_store_dwordx4 v[24:27],v9,s[28:31],s71 offen offset:0
s_waitcnt lgkmcnt(14)
ds_read_b128 v[44:47],v8 offset:11264
s_waitcnt lgkmcnt(14)
ds_read_b128 v[136:139],v8 offset:16384
v_pk_add_f32 v[40:41],v[40:41],v[144:145]
v_pk_add_f32 v[42:43],v[42:43],v[146:147]
s_waitcnt lgkmcnt(14)
v_pk_add_f32 v[208:209],v[208:209],v[120:121]
v_pk_add_f32 v[210:211],v[210:211],v[122:123]
v_pk_add_f32 v[208:209],v[208:209],v[40:41]
v_pk_add_f32 v[210:211],v[210:211],v[42:43]
v_cvt_pk_bf16_f32 v144,v208,v209
v_cvt_pk_bf16_f32 v145,v210,v211
s_waitcnt lgkmcnt(12)
v_pk_add_f32 v[148:149],v[148:149],v[104:105]
v_pk_add_f32 v[150:151],v[150:151],v[106:107]
s_waitcnt lgkmcnt(11)
v_pk_add_f32 v[212:213],v[212:213],v[128:129]
v_pk_add_f32 v[214:215],v[214:215],v[130:131]
v_pk_add_f32 v[212:213],v[212:213],v[148:149]
v_pk_add_f32 v[214:215],v[214:215],v[150:151]
v_cvt_pk_bf16_f32 v146,v212,v213
v_cvt_pk_bf16_f32 v147,v214,v215
s_nop 0
v_permlane16_swap_b32 v144,v146
v_permlane16_swap_b32 v145,v147
buffer_store_dwordx4 v[144:147],v9,s[28:31],s71 offen offset:64
s_waitcnt lgkmcnt(9)
v_pk_add_f32 v[132:133],v[132:133],v[160:161]
v_pk_add_f32 v[134:135],v[134:135],v[162:163]
s_waitcnt lgkmcnt(8)
v_pk_add_f32 v[216:217],v[216:217],v[224:225]
v_pk_add_f32 v[218:219],v[218:219],v[226:227]
v_pk_add_f32 v[216:217],v[216:217],v[132:133]
v_pk_add_f32 v[218:219],v[218:219],v[134:135]
v_cvt_pk_bf16_f32 v160,v216,v217
v_cvt_pk_bf16_f32 v161,v218,v219
buffer_store_dwordx2 v[160:161],v3,s[28:31],s71 offen offset:128
s_waitcnt lgkmcnt(6)
v_pk_add_f32 v[20:21],v[20:21],v[164:165]
v_pk_add_f32 v[22:23],v[22:23],v[166:167]
s_waitcnt lgkmcnt(4)
v_pk_add_f32 v[172:173],v[172:173],v[100:101]
v_pk_add_f32 v[174:175],v[174:175],v[102:103]
v_pk_add_f32 v[20:21],v[20:21],v[172:173]
v_pk_add_f32 v[22:23],v[22:23],v[174:175]
v_cvt_pk_bf16_f32 v164,v20,v21
v_cvt_pk_bf16_f32 v165,v22,v23
buffer_store_dwordx2 v[164:165],v3,s[28:31],s90 offen offset:0
s_cmp_lg_u32 s48,3
s_cbranch_scc1 L_end
s_waitcnt lgkmcnt(2)
v_pk_add_f32 v[168:169],v[168:169],v[140:141]
v_pk_add_f32 v[170:171],v[170:171],v[142:143]
s_waitcnt lgkmcnt(0)
v_pk_add_f32 v[44:45],v[44:45],v[136:137]
v_pk_add_f32 v[46:47],v[46:47],v[138:139]
v_pk_add_f32 v[168:169],v[168:169],v[44:45]
v_pk_add_f32 v[170:171],v[170:171],v[46:47]
v_cvt_pk_bf16_f32 v140,v168,v169
v_cvt_pk_bf16_f32 v141,v170,v171
buffer_store_dwordx2 v[140:141],v3,s[28:31],s90 offen offset:32
L_end:
s_endpgm
L_rsA0:
s_nop 15
v_max3_f32 v1,v48,v49,v50
v_max3_f32 v1,v1,v51,v52
v_max3_f32 v1,v1,v53,v54
v_max_f32 v1,v1,v55
v_mov_b32 v4,v1
s_nop 1
v_permlane32_swap_b32 v1,v4
v_max_f32 v1,v1,v4
v_mov_b32 v4,v1
s_nop 1
v_permlane16_swap_b32 v1,v4
v_max_f32 v1,v1,v4
v_max_f32 v1,0,v1
v_sub_f32 v48,v48,v1
v_sub_f32 v49,v49,v1
v_sub_f32 v50,v50,v1
v_sub_f32 v51,v51,v1
v_sub_f32 v52,v52,v1
v_sub_f32 v53,v53,v1
v_sub_f32 v54,v54,v1
v_sub_f32 v55,v55,v1
v_sub_f32 v112,v112,v1
v_sub_f32 v113,v113,v1
v_sub_f32 v114,v114,v1
v_sub_f32 v115,v115,v1
v_exp_f32_e64 v20,-v1
v_max3_f32 v1,v56,v57,v58
v_max3_f32 v1,v1,v59,v60
v_max3_f32 v1,v1,v61,v62
v_max_f32 v1,v1,v63
v_mov_b32 v4,v1
s_nop 1
v_permlane32_swap_b32 v1,v4
v_max_f32 v1,v1,v4
v_mov_b32 v4,v1
s_nop 1
v_permlane16_swap_b32 v1,v4
v_max_f32 v1,v1,v4
v_max_f32 v1,0,v1
v_sub_f32 v56,v56,v1
v_sub_f32 v57,v57,v1
v_sub_f32 v58,v58,v1
v_sub_f32 v59,v59,v1
v_sub_f32 v60,v60,v1
v_sub_f32 v61,v61,v1
v_sub_f32 v62,v62,v1
v_sub_f32 v63,v63,v1
v_sub_f32 v116,v116,v1
v_sub_f32 v117,v117,v1
v_sub_f32 v118,v118,v1
v_sub_f32 v119,v119,v1
v_exp_f32_e64 v21,-v1
v_max3_f32 v1,v64,v65,v66
v_max3_f32 v1,v1,v67,v68
v_max3_f32 v1,v1,v69,v70
v_max_f32 v1,v1,v71
v_mov_b32 v4,v1
s_nop 1
v_permlane32_swap_b32 v1,v4
v_max_f32 v1,v1,v4
v_mov_b32 v4,v1
s_nop 1
v_permlane16_swap_b32 v1,v4
v_max_f32 v1,v1,v4
v_max_f32 v1,0,v1
v_sub_f32 v64,v64,v1
v_sub_f32 v65,v65,v1
v_sub_f32 v66,v66,v1
v_sub_f32 v67,v67,v1
v_sub_f32 v68,v68,v1
v_sub_f32 v69,v69,v1
v_sub_f32 v70,v70,v1
v_sub_f32 v71,v71,v1
v_sub_f32 v120,v120,v1
v_sub_f32 v121,v121,v1
v_sub_f32 v122,v122,v1
v_sub_f32 v123,v123,v1
v_exp_f32_e64 v22,-v1
v_max3_f32 v1,v72,v73,v74
v_max3_f32 v1,v1,v75,v76
v_max3_f32 v1,v1,v77,v78
v_max_f32 v1,v1,v79
v_mov_b32 v4,v1
s_nop 1
v_permlane32_swap_b32 v1,v4
v_max_f32 v1,v1,v4
v_mov_b32 v4,v1
s_nop 1
v_permlane16_swap_b32 v1,v4
v_max_f32 v1,v1,v4
v_max_f32 v1,0,v1
v_sub_f32 v72,v72,v1
v_sub_f32 v73,v73,v1
v_sub_f32 v74,v74,v1
v_sub_f32 v75,v75,v1
v_sub_f32 v76,v76,v1
v_sub_f32 v77,v77,v1
v_sub_f32 v78,v78,v1
v_sub_f32 v79,v79,v1
v_sub_f32 v124,v124,v1
v_sub_f32 v125,v125,v1
v_sub_f32 v126,v126,v1
v_sub_f32 v127,v127,v1
v_exp_f32_e64 v23,-v1
s_mov_b32 s93,1
s_nop 3
s_setpc_b64 s[62:63]
L_rsA1:
s_nop 15
v_max3_f32 v1,v80,v81,v82
v_max3_f32 v1,v1,v83,v84
v_max3_f32 v1,v1,v85,v86
v_max_f32 v1,v1,v87
v_mov_b32 v4,v1
s_nop 1
v_permlane32_swap_b32 v1,v4
v_max_f32 v1,v1,v4
v_mov_b32 v4,v1
s_nop 1
v_permlane16_swap_b32 v1,v4
v_max_f32 v1,v1,v4
v_max_f32 v1,0,v1
v_sub_f32 v80,v80,v1
v_sub_f32 v81,v81,v1
v_sub_f32 v82,v82,v1
v_sub_f32 v83,v83,v1
v_sub_f32 v84,v84,v1
v_sub_f32 v85,v85,v1
v_sub_f32 v86,v86,v1
v_sub_f32 v87,v87,v1
v_sub_f32 v112,v112,v1
v_sub_f32 v113,v113,v1
v_sub_f32 v114,v114,v1
v_sub_f32 v115,v115,v1
v_exp_f32_e64 v20,-v1
v_max3_f32 v1,v88,v89,v90
v_max3_f32 v1,v1,v91,v92
v_max3_f32 v1,v1,v93,v94
v_max_f32 v1,v1,v95
v_mov_b32 v4,v1
s_nop 1
v_permlane32_swap_b32 v1,v4
v_max_f32 v1,v1,v4
v_mov_b32 v4,v1
s_nop 1
v_permlane16_swap_b32 v1,v4
v_max_f32 v1,v1,v4
v_max_f32 v1,0,v1
v_sub_f32 v88,v88,v1
v_sub_f32 v89,v89,v1
v_sub_f32 v90,v90,v1
v_sub_f32 v91,v91,v1
v_sub_f32 v92,v92,v1
v_sub_f32 v93,v93,v1
v_sub_f32 v94,v94,v1
v_sub_f32 v95,v95,v1
v_sub_f32 v116,v116,v1
v_sub_f32 v117,v117,v1
v_sub_f32 v118,v118,v1
v_sub_f32 v119,v119,v1
v_exp_f32_e64 v21,-v1
v_max3_f32 v1,v96,v97,v98
v_max3_f32 v1,v1,v99,v100
v_max3_f32 v1,v1,v101,v102
v_max_f32 v1,v1,v103
v_mov_b32 v4,v1
s_nop 1
v_permlane32_swap_b32 v1,v4
v_max_f32 v1,v1,v4
v_mov_b32 v4,v1
s_nop 1
v_permlane16_swap_b32 v1,v4
v_max_f32 v1,v1,v4
v_max_f32 v1,0,v1
v_sub_f32 v96,v96,v1
v_sub_f32 v97,v97,v1
v_sub_f32 v98,v98,v1
v_sub_f32 v99,v99,v1
v_sub_f32 v100,v100,v1
v_sub_f32 v101,v101,v1
v_sub_f32 v102,v102,v1
v_sub_f32 v103,v103,v1
v_sub_f32 v120,v120,v1
v_sub_f32 v121,v121,v1
v_sub_f32 v122,v122,v1
v_sub_f32 v123,v123,v1
v_exp_f32_e64 v22,-v1
v_max3_f32 v1,v104,v105,v106
v_max3_f32 v1,v1,v107,v108
v_max3_f32 v1,v1,v109,v110
v_max_f32 v1,v1,v111
v_mov_b32 v4,v1
s_nop 1
v_permlane32_swap_b32 v1,v4
v_max_f32 v1,v1,v4
v_mov_b32 v4,v1
s_nop 1
v_permlane16_swap_b32 v1,v4
v_max_f32 v1,v1,v4
v_max_f32 v1,0,v1
v_sub_f32 v104,v104,v1
v_sub_f32 v105,v105,v1
v_sub_f32 v106,v106,v1
v_sub_f32 v107,v107,v1
v_sub_f32 v108,v108,v1
v_sub_f32 v109,v109,v1
v_sub_f32 v110,v110,v1
v_sub_f32 v111,v111,v1
v_sub_f32 v124,v124,v1
v_sub_f32 v125,v125,v1
v_sub_f32 v126,v126,v1
v_sub_f32 v127,v127,v1
v_exp_f32_e64 v23,-v1
s_mov_b32 s93,1
s_nop 3
s_setpc_b64 s[62:63]
L_rsP2:
s_nop 15
v_mul_f32 v156,v156,v20
v_accvgpr_read_b32 v4,a0
v_accvgpr_read_b32 v5,a1
v_mul_f32 v4,v4,v20
v_mul_f32 v5,v5,v20
v_accvgpr_write_b32 a0,v4
v_accvgpr_write_b32 a1,v5
v_accvgpr_read_b32 v4,a2
v_accvgpr_read_b32 v5,a3
v_mul_f32 v4,v4,v20
v_mul_f32 v5,v5,v20
v_accvgpr_write_b32 a2,v4
v_accvgpr_write_b32 a3,v5
v_accvgpr_read_b32 v4,a16
v_accvgpr_read_b32 v5,a17
v_mul_f32 v4,v4,v20
v_mul_f32 v5,v5,v20
v_accvgpr_write_b32 a16,v4
v_accvgpr_write_b32 a17,v5
v_accvgpr_read_b32 v4,a18
v_accvgpr_read_b32 v5,a19
v_mul_f32 v4,v4,v20
v_mul_f32 v5,v5,v20
v_accvgpr_write_b32 a18,v4
v_accvgpr_write_b32 a19,v5
v_accvgpr_read_b32 v4,a32
v_accvgpr_read_b32 v5,a33
v_mul_f32 v4,v4,v20
v_mul_f32 v5,v5,v20
v_accvgpr_write_b32 a32,v4
v_accvgpr_write_b32 a33,v5
v_accvgpr_read_b32 v4,a34
v_accvgpr_read_b32 v5,a35
v_mul_f32 v4,v4,v20
v_mul_f32 v5,v5,v20
v_accvgpr_write_b32 a34,v4
v_accvgpr_write_b32 a35,v5
v_accvgpr_read_b32 v4,a48
v_accvgpr_read_b32 v5,a49
v_mul_f32 v4,v4,v20
v_mul_f32 v5,v5,v20
v_accvgpr_write_b32 a48,v4
v_accvgpr_write_b32 a49,v5
v_accvgpr_read_b32 v4,a50
v_accvgpr_read_b32 v5,a51
v_mul_f32 v4,v4,v20
v_mul_f32 v5,v5,v20
v_accvgpr_write_b32 a50,v4
v_accvgpr_write_b32 a51,v5
v_accvgpr_read_b32 v4,a64
v_accvgpr_read_b32 v5,a65
v_mul_f32 v4,v4,v20
v_mul_f32 v5,v5,v20
v_accvgpr_write_b32 a64,v4
v_accvgpr_write_b32 a65,v5
v_accvgpr_read_b32 v4,a66
v_accvgpr_read_b32 v5,a67
v_mul_f32 v4,v4,v20
v_mul_f32 v5,v5,v20
v_accvgpr_write_b32 a66,v4
v_accvgpr_write_b32 a67,v5
v_accvgpr_read_b32 v4,a80
v_accvgpr_read_b32 v5,a81
v_mul_f32 v4,v4,v20
v_mul_f32 v5,v5,v20
v_accvgpr_write_b32 a80,v4
v_accvgpr_write_b32 a81,v5
v_accvgpr_read_b32 v4,a82
v_accvgpr_read_b32 v5,a83
v_mul_f32 v4,v4,v20
v_mul_f32 v5,v5,v20
v_accvgpr_write_b32 a82,v4
v_accvgpr_write_b32 a83,v5
v_accvgpr_read_b32 v4,a96
v_accvgpr_read_b32 v5,a97
v_mul_f32 v4,v4,v20
v_mul_f32 v5,v5,v20
v_accvgpr_write_b32 a96,v4
v_accvgpr_write_b32 a97,v5
v_accvgpr_read_b32 v4,a98
v_accvgpr_read_b32 v5,a99
v_mul_f32 v4,v4,v20
v_mul_f32 v5,v5,v20
v_accvgpr_write_b32 a98,v4
v_accvgpr_write_b32 a99,v5
v_accvgpr_read_b32 v4,a112
v_accvgpr_read_b32 v5,a113
v_mul_f32 v4,v4,v20
v_mul_f32 v5,v5,v20
v_accvgpr_write_b32 a112,v4
v_accvgpr_write_b32 a113,v5
v_accvgpr_read_b32 v4,a114
v_accvgpr_read_b32 v5,a115
v_mul_f32 v4,v4,v20
v_mul_f32 v5,v5,v20
v_accvgpr_write_b32 a114,v4
v_accvgpr_write_b32 a115,v5
v_mul_f32 v160,v160,v21
v_accvgpr_read_b32 v4,a4
v_accvgpr_read_b32 v5,a5
v_mul_f32 v4,v4,v21
v_mul_f32 v5,v5,v21
v_accvgpr_write_b32 a4,v4
v_accvgpr_write_b32 a5,v5
v_accvgpr_read_b32 v4,a6
v_accvgpr_read_b32 v5,a7
v_mul_f32 v4,v4,v21
v_mul_f32 v5,v5,v21
v_accvgpr_write_b32 a6,v4
v_accvgpr_write_b32 a7,v5
v_accvgpr_read_b32 v4,a20
v_accvgpr_read_b32 v5,a21
v_mul_f32 v4,v4,v21
v_mul_f32 v5,v5,v21
v_accvgpr_write_b32 a20,v4
v_accvgpr_write_b32 a21,v5
v_accvgpr_read_b32 v4,a22
v_accvgpr_read_b32 v5,a23
v_mul_f32 v4,v4,v21
v_mul_f32 v5,v5,v21
v_accvgpr_write_b32 a22,v4
v_accvgpr_write_b32 a23,v5
v_accvgpr_read_b32 v4,a36
v_accvgpr_read_b32 v5,a37
v_mul_f32 v4,v4,v21
v_mul_f32 v5,v5,v21
v_accvgpr_write_b32 a36,v4
v_accvgpr_write_b32 a37,v5
v_accvgpr_read_b32 v4,a38
v_accvgpr_read_b32 v5,a39
v_mul_f32 v4,v4,v21
v_mul_f32 v5,v5,v21
v_accvgpr_write_b32 a38,v4
v_accvgpr_write_b32 a39,v5
v_accvgpr_read_b32 v4,a52
v_accvgpr_read_b32 v5,a53
v_mul_f32 v4,v4,v21
v_mul_f32 v5,v5,v21
v_accvgpr_write_b32 a52,v4
v_accvgpr_write_b32 a53,v5
v_accvgpr_read_b32 v4,a54
v_accvgpr_read_b32 v5,a55
v_mul_f32 v4,v4,v21
v_mul_f32 v5,v5,v21
v_accvgpr_write_b32 a54,v4
v_accvgpr_write_b32 a55,v5
v_accvgpr_read_b32 v4,a68
v_accvgpr_read_b32 v5,a69
v_mul_f32 v4,v4,v21
v_mul_f32 v5,v5,v21
v_accvgpr_write_b32 a68,v4
v_accvgpr_write_b32 a69,v5
v_accvgpr_read_b32 v4,a70
v_accvgpr_read_b32 v5,a71
v_mul_f32 v4,v4,v21
v_mul_f32 v5,v5,v21
v_accvgpr_write_b32 a70,v4
v_accvgpr_write_b32 a71,v5
v_accvgpr_read_b32 v4,a84
v_accvgpr_read_b32 v5,a85
v_mul_f32 v4,v4,v21
v_mul_f32 v5,v5,v21
v_accvgpr_write_b32 a84,v4
v_accvgpr_write_b32 a85,v5
v_accvgpr_read_b32 v4,a86
v_accvgpr_read_b32 v5,a87
v_mul_f32 v4,v4,v21
v_mul_f32 v5,v5,v21
v_accvgpr_write_b32 a86,v4
v_accvgpr_write_b32 a87,v5
v_accvgpr_read_b32 v4,a100
v_accvgpr_read_b32 v5,a101
v_mul_f32 v4,v4,v21
v_mul_f32 v5,v5,v21
v_accvgpr_write_b32 a100,v4
v_accvgpr_write_b32 a101,v5
v_accvgpr_read_b32 v4,a102
v_accvgpr_read_b32 v5,a103
v_mul_f32 v4,v4,v21
v_mul_f32 v5,v5,v21
v_accvgpr_write_b32 a102,v4
v_accvgpr_write_b32 a103,v5
v_accvgpr_read_b32 v4,a116
v_accvgpr_read_b32 v5,a117
v_mul_f32 v4,v4,v21
v_mul_f32 v5,v5,v21
v_accvgpr_write_b32 a116,v4
v_accvgpr_write_b32 a117,v5
v_accvgpr_read_b32 v4,a118
v_accvgpr_read_b32 v5,a119
v_mul_f32 v4,v4,v21
v_mul_f32 v5,v5,v21
v_accvgpr_write_b32 a118,v4
v_accvgpr_write_b32 a119,v5
v_mul_f32 v164,v164,v22
v_accvgpr_read_b32 v4,a8
v_accvgpr_read_b32 v5,a9
v_mul_f32 v4,v4,v22
v_mul_f32 v5,v5,v22
v_accvgpr_write_b32 a8,v4
v_accvgpr_write_b32 a9,v5
v_accvgpr_read_b32 v4,a10
v_accvgpr_read_b32 v5,a11
v_mul_f32 v4,v4,v22
v_mul_f32 v5,v5,v22
v_accvgpr_write_b32 a10,v4
v_accvgpr_write_b32 a11,v5
v_accvgpr_read_b32 v4,a24
v_accvgpr_read_b32 v5,a25
v_mul_f32 v4,v4,v22
v_mul_f32 v5,v5,v22
v_accvgpr_write_b32 a24,v4
v_accvgpr_write_b32 a25,v5
v_accvgpr_read_b32 v4,a26
v_accvgpr_read_b32 v5,a27
v_mul_f32 v4,v4,v22
v_mul_f32 v5,v5,v22
v_accvgpr_write_b32 a26,v4
v_accvgpr_write_b32 a27,v5
v_accvgpr_read_b32 v4,a40
v_accvgpr_read_b32 v5,a41
v_mul_f32 v4,v4,v22
v_mul_f32 v5,v5,v22
v_accvgpr_write_b32 a40,v4
v_accvgpr_write_b32 a41,v5
v_accvgpr_read_b32 v4,a42
v_accvgpr_read_b32 v5,a43
v_mul_f32 v4,v4,v22
v_mul_f32 v5,v5,v22
v_accvgpr_write_b32 a42,v4
v_accvgpr_write_b32 a43,v5
v_accvgpr_read_b32 v4,a56
v_accvgpr_read_b32 v5,a57
v_mul_f32 v4,v4,v22
v_mul_f32 v5,v5,v22
v_accvgpr_write_b32 a56,v4
v_accvgpr_write_b32 a57,v5
v_accvgpr_read_b32 v4,a58
v_accvgpr_read_b32 v5,a59
v_mul_f32 v4,v4,v22
v_mul_f32 v5,v5,v22
v_accvgpr_write_b32 a58,v4
v_accvgpr_write_b32 a59,v5
v_accvgpr_read_b32 v4,a72
v_accvgpr_read_b32 v5,a73
v_mul_f32 v4,v4,v22
v_mul_f32 v5,v5,v22
v_accvgpr_write_b32 a72,v4
v_accvgpr_write_b32 a73,v5
v_accvgpr_read_b32 v4,a74
v_accvgpr_read_b32 v5,a75
v_mul_f32 v4,v4,v22
v_mul_f32 v5,v5,v22
v_accvgpr_write_b32 a74,v4
v_accvgpr_write_b32 a75,v5
v_accvgpr_read_b32 v4,a88
v_accvgpr_read_b32 v5,a89
v_mul_f32 v4,v4,v22
v_mul_f32 v5,v5,v22
v_accvgpr_write_b32 a88,v4
v_accvgpr_write_b32 a89,v5
v_accvgpr_read_b32 v4,a90
v_accvgpr_read_b32 v5,a91
v_mul_f32 v4,v4,v22
v_mul_f32 v5,v5,v22
v_accvgpr_write_b32 a90,v4
v_accvgpr_write_b32 a91,v5
v_accvgpr_read_b32 v4,a104
v_accvgpr_read_b32 v5,a105
v_mul_f32 v4,v4,v22
v_mul_f32 v5,v5,v22
v_accvgpr_write_b32 a104,v4
v_accvgpr_write_b32 a105,v5
v_accvgpr_read_b32 v4,a106
v_accvgpr_read_b32 v5,a107
v_mul_f32 v4,v4,v22
v_mul_f32 v5,v5,v22
v_accvgpr_write_b32 a106,v4
v_accvgpr_write_b32 a107,v5
v_accvgpr_read_b32 v4,a120
v_accvgpr_read_b32 v5,a121
v_mul_f32 v4,v4,v22
v_mul_f32 v5,v5,v22
v_accvgpr_write_b32 a120,v4
v_accvgpr_write_b32 a121,v5
v_accvgpr_read_b32 v4,a122
v_accvgpr_read_b32 v5,a123
v_mul_f32 v4,v4,v22
v_mul_f32 v5,v5,v22
v_accvgpr_write_b32 a122,v4
v_accvgpr_write_b32 a123,v5
v_mul_f32 v168,v168,v23
v_accvgpr_read_b32 v4,a12
v_accvgpr_read_b32 v5,a13
v_mul_f32 v4,v4,v23
v_mul_f32 v5,v5,v23
v_accvgpr_write_b32 a12,v4
v_accvgpr_write_b32 a13,v5
v_accvgpr_read_b32 v4,a14
v_accvgpr_read_b32 v5,a15
v_mul_f32 v4,v4,v23
v_mul_f32 v5,v5,v23
v_accvgpr_write_b32 a14,v4
v_accvgpr_write_b32 a15,v5
v_accvgpr_read_b32 v4,a28
v_accvgpr_read_b32 v5,a29
v_mul_f32 v4,v4,v23
v_mul_f32 v5,v5,v23
v_accvgpr_write_b32 a28,v4
v_accvgpr_write_b32 a29,v5
v_accvgpr_read_b32 v4,a30
v_accvgpr_read_b32 v5,a31
v_mul_f32 v4,v4,v23
v_mul_f32 v5,v5,v23
v_accvgpr_write_b32 a30,v4
v_accvgpr_write_b32 a31,v5
v_accvgpr_read_b32 v4,a44
v_accvgpr_read_b32 v5,a45
v_mul_f32 v4,v4,v23
v_mul_f32 v5,v5,v23
v_accvgpr_write_b32 a44,v4
v_accvgpr_write_b32 a45,v5
v_accvgpr_read_b32 v4,a46
v_accvgpr_read_b32 v5,a47
v_mul_f32 v4,v4,v23
v_mul_f32 v5,v5,v23
v_accvgpr_write_b32 a46,v4
v_accvgpr_write_b32 a47,v5
v_accvgpr_read_b32 v4,a60
v_accvgpr_read_b32 v5,a61
v_mul_f32 v4,v4,v23
v_mul_f32 v5,v5,v23
v_accvgpr_write_b32 a60,v4
v_accvgpr_write_b32 a61,v5
v_accvgpr_read_b32 v4,a62
v_accvgpr_read_b32 v5,a63
v_mul_f32 v4,v4,v23
v_mul_f32 v5,v5,v23
v_accvgpr_write_b32 a62,v4
v_accvgpr_write_b32 a63,v5
v_accvgpr_read_b32 v4,a76
v_accvgpr_read_b32 v5,a77
v_mul_f32 v4,v4,v23
v_mul_f32 v5,v5,v23
v_accvgpr_write_b32 a76,v4
v_accvgpr_write_b32 a77,v5
v_accvgpr_read_b32 v4,a78
v_accvgpr_read_b32 v5,a79
v_mul_f32 v4,v4,v23
v_mul_f32 v5,v5,v23
v_accvgpr_write_b32 a78,v4
v_accvgpr_write_b32 a79,v5
v_accvgpr_read_b32 v4,a92
v_accvgpr_read_b32 v5,a93
v_mul_f32 v4,v4,v23
v_mul_f32 v5,v5,v23
v_accvgpr_write_b32 a92,v4
v_accvgpr_write_b32 a93,v5
v_accvgpr_read_b32 v4,a94
v_accvgpr_read_b32 v5,a95
v_mul_f32 v4,v4,v23
v_mul_f32 v5,v5,v23
v_accvgpr_write_b32 a94,v4
v_accvgpr_write_b32 a95,v5
v_accvgpr_read_b32 v4,a108
v_accvgpr_read_b32 v5,a109
v_mul_f32 v4,v4,v23
v_mul_f32 v5,v5,v23
v_accvgpr_write_b32 a108,v4
v_accvgpr_write_b32 a109,v5
v_accvgpr_read_b32 v4,a110
v_accvgpr_read_b32 v5,a111
v_mul_f32 v4,v4,v23
v_mul_f32 v5,v5,v23
v_accvgpr_write_b32 a110,v4
v_accvgpr_write_b32 a111,v5
v_accvgpr_read_b32 v4,a124
v_accvgpr_read_b32 v5,a125
v_mul_f32 v4,v4,v23
v_mul_f32 v5,v5,v23
v_accvgpr_write_b32 a124,v4
v_accvgpr_write_b32 a125,v5
v_accvgpr_read_b32 v4,a126
v_accvgpr_read_b32 v5,a127
v_mul_f32 v4,v4,v23
v_mul_f32 v5,v5,v23
v_accvgpr_write_b32 a126,v4
v_accvgpr_write_b32 a127,v5
s_mov_b32 s93,0
s_nop 3
s_setpc_b64 s[62:63]
L_rs9:
s_nop 15
v_max3_f32 v3,v144,v145,v146
v_max3_f32 v3,v3,v147,v148
v_max3_f32 v3,v3,v149,v150
v_max_f32 v3,v3,v151
v_mov_b32 v4,v3
s_nop 1
v_permlane32_swap_b32 v3,v4
v_max_f32 v3,v3,v4
v_mov_b32 v4,v3
s_nop 1
v_permlane16_swap_b32 v3,v4
v_max_f32 v3,v3,v4
v_max_f32 v3,0,v3
v_sub_f32 v144,v144,v3
v_sub_f32 v145,v145,v3
v_sub_f32 v146,v146,v3
v_sub_f32 v147,v147,v3
v_sub_f32 v148,v148,v3
v_sub_f32 v149,v149,v3
v_sub_f32 v150,v150,v3
v_sub_f32 v151,v151,v3
v_sub_f32 v152,v152,v3
v_sub_f32 v153,v153,v3
v_sub_f32 v154,v154,v3
v_sub_f32 v155,v155,v3
v_exp_f32_e64 v3,-v3
s_nop 0
v_mul_f32 v172,v172,v3
v_accvgpr_read_b32 v4,a128
v_accvgpr_read_b32 v5,a129
v_mul_f32 v4,v4,v3
v_mul_f32 v5,v5,v3
v_accvgpr_write_b32 a128,v4
v_accvgpr_write_b32 a129,v5
v_accvgpr_read_b32 v4,a130
v_accvgpr_read_b32 v5,a131
v_mul_f32 v4,v4,v3
v_mul_f32 v5,v5,v3
v_accvgpr_write_b32 a130,v4
v_accvgpr_write_b32 a131,v5
v_accvgpr_read_b32 v4,a132
v_accvgpr_read_b32 v5,a133
v_mul_f32 v4,v4,v3
v_mul_f32 v5,v5,v3
v_accvgpr_write_b32 a132,v4
v_accvgpr_write_b32 a133,v5
v_accvgpr_read_b32 v4,a134
v_accvgpr_read_b32 v5,a135
v_mul_f32 v4,v4,v3
v_mul_f32 v5,v5,v3
v_accvgpr_write_b32 a134,v4
v_accvgpr_write_b32 a135,v5
v_accvgpr_read_b32 v4,a136
v_accvgpr_read_b32 v5,a137
v_mul_f32 v4,v4,v3
v_mul_f32 v5,v5,v3
v_accvgpr_write_b32 a136,v4
v_accvgpr_write_b32 a137,v5
v_accvgpr_read_b32 v4,a138
v_accvgpr_read_b32 v5,a139
v_mul_f32 v4,v4,v3
v_mul_f32 v5,v5,v3
v_accvgpr_write_b32 a138,v4
v_accvgpr_write_b32 a139,v5
v_accvgpr_read_b32 v4,a140
v_accvgpr_read_b32 v5,a141
v_mul_f32 v4,v4,v3
v_mul_f32 v5,v5,v3
v_accvgpr_write_b32 a140,v4
v_accvgpr_write_b32 a141,v5
v_accvgpr_read_b32 v4,a142
v_accvgpr_read_b32 v5,a143
v_mul_f32 v4,v4,v3
v_mul_f32 v5,v5,v3
v_accvgpr_write_b32 a142,v4
v_accvgpr_write_b32 a143,v5
v_accvgpr_read_b32 v4,a144
v_accvgpr_read_b32 v5,a145
v_mul_f32 v4,v4,v3
v_mul_f32 v5,v5,v3
v_accvgpr_write_b32 a144,v4
v_accvgpr_write_b32 a145,v5
v_accvgpr_read_b32 v4,a146
v_accvgpr_read_b32 v5,a147
v_mul_f32 v4,v4,v3
v_mul_f32 v5,v5,v3
v_accvgpr_write_b32 a146,v4
v_accvgpr_write_b32 a147,v5
v_accvgpr_read_b32 v4,a148
v_accvgpr_read_b32 v5,a149
v_mul_f32 v4,v4,v3
v_mul_f32 v5,v5,v3
v_accvgpr_write_b32 a148,v4
v_accvgpr_write_b32 a149,v5
v_accvgpr_read_b32 v4,a150
v_accvgpr_read_b32 v5,a151
v_mul_f32 v4,v4,v3
v_mul_f32 v5,v5,v3
v_accvgpr_write_b32 a150,v4
v_accvgpr_write_b32 a151,v5
v_accvgpr_read_b32 v4,a152
v_accvgpr_read_b32 v5,a153
v_mul_f32 v4,v4,v3
v_mul_f32 v5,v5,v3
v_accvgpr_write_b32 a152,v4
v_accvgpr_write_b32 a153,v5
v_accvgpr_read_b32 v4,a154
v_accvgpr_read_b32 v5,a155
v_mul_f32 v4,v4,v3
v_mul_f32 v5,v5,v3
v_accvgpr_write_b32 a154,v4
v_accvgpr_write_b32 a155,v5
v_accvgpr_read_b32 v4,a156
v_accvgpr_read_b32 v5,a157
v_mul_f32 v4,v4,v3
v_mul_f32 v5,v5,v3
v_accvgpr_write_b32 a156,v4
v_accvgpr_write_b32 a157,v5
v_accvgpr_read_b32 v4,a158
v_accvgpr_read_b32 v5,a159
v_mul_f32 v4,v4,v3
v_mul_f32 v5,v5,v3
v_accvgpr_write_b32 a158,v4
v_accvgpr_write_b32 a159,v5
s_nop 3
s_setpc_b64 s[62:63]
L_noA1_0_o:
s_swappc_b64 s[62:63],s[64:65]
s_branch L_noA1_0
L_noP1_0_o:
s_swappc_b64 s[62:63],s[80:81]
s_branch L_noP1_0
L_noA2_0_o:
s_swappc_b64 s[62:63],s[60:61]
s_branch L_noA2_0
L_noP2_0_o:
s_swappc_b64 s[62:63],s[80:81]
s_branch L_noP2_0
L_noA3_0_o:
s_swappc_b64 s[62:63],s[64:65]
s_swappc_b64 s[62:63],s[66:67]
s_branch L_noA3_0
L_noP3_0_o:
s_swappc_b64 s[62:63],s[80:81]
s_branch L_noP3_0
L_noA4_0_o:
s_swappc_b64 s[62:63],s[60:61]
s_branch L_noA4_0
L_noP4_0_o:
s_swappc_b64 s[62:63],s[80:81]
s_branch L_noP4_0
L_noA5_0_o:
s_swappc_b64 s[62:63],s[64:65]
s_swappc_b64 s[62:63],s[66:67]
s_branch L_noA5_0
L_noP5_0_o:
s_swappc_b64 s[62:63],s[80:81]
s_branch L_noP5_0
L_noA6_0_o:
s_swappc_b64 s[62:63],s[60:61]
s_branch L_noA6_0
L_noP6_0_o:
s_swappc_b64 s[62:63],s[80:81]
s_branch L_noP6_0
L_noA7_0_o:
s_swappc_b64 s[62:63],s[64:65]
s_swappc_b64 s[62:63],s[66:67]
s_branch L_noA7_0
L_noP7_0_o:
s_swappc_b64 s[62:63],s[80:81]
s_branch L_noP7_0
L_noA8_0_o:
s_swappc_b64 s[62:63],s[60:61]
s_branch L_noA8_0
L_noP8_0_o:
s_swappc_b64 s[62:63],s[80:81]
s_branch L_noP8_0
L_noA9_0_o:
s_swappc_b64 s[62:63],s[64:65]
s_swappc_b64 s[62:63],s[66:67]
s_branch L_noA9_0
L_noP9_0_o:
s_swappc_b64 s[62:63],s[80:81]
s_branch L_noP9_0
L_noA10_0_o:
s_swappc_b64 s[62:63],s[60:61]
s_branch L_noA10_0
L_noP10_0_o:
s_swappc_b64 s[62:63],s[80:81]
s_branch L_noP10_0
L_noA11_0_o:
s_swappc_b64 s[62:63],s[64:65]
s_swappc_b64 s[62:63],s[66:67]
s_branch L_noA11_0
L_noP11_0_o:
s_swappc_b64 s[62:63],s[80:81]
s_branch L_noP11_0
L_noA12_0_o:
s_swappc_b64 s[62:63],s[60:61]
s_branch L_noA12_0
L_noP12_0_o:
s_swappc_b64 s[62:63],s[80:81]
s_branch L_noP12_0
L_noA13_0_o:
s_swappc_b64 s[62:63],s[64:65]
s_swappc_b64 s[62:63],s[66:67]
s_branch L_noA13_0
L_noP13_0_o:
s_swappc_b64 s[62:63],s[80:81]
s_branch L_noP13_0
L_noA14_0_o:
s_swappc_b64 s[62:63],s[60:61]
s_branch L_noA14_0
L_noP14_0_o:
s_swappc_b64 s[62:63],s[80:81]
s_branch L_noP14_0
L_noA15_0_o:
s_swappc_b64 s[62:63],s[64:65]
s_swappc_b64 s[62:63],s[66:67]
s_branch L_noA15_0
L_noP15_0_o:
s_swappc_b64 s[62:63],s[80:81]
s_branch L_noP15_0
L_arr0_o:
s_nop 1
v_mov_b32 v9,s53
s_mov_b64 exec,1
buffer_store_byte v9,off,s[96:99],s55 sc1
s_mov_b64 exec,-1
s_nop 1
s_branch L_arr0
L_arr1_o:
s_nop 1
v_mov_b32 v9,s53
s_mov_b64 exec,1
buffer_store_byte v9,off,s[96:99],s55 sc1
s_mov_b64 exec,-1
s_nop 1
s_branch L_arr1
L_arr2_o:
s_nop 1
v_mov_b32 v9,s53
s_mov_b64 exec,1
buffer_store_byte v9,off,s[96:99],s55 sc1
s_mov_b64 exec,-1
s_nop 1
s_branch L_arr2
L_arr3_o:
s_nop 1
v_mov_b32 v9,s53
s_mov_b64 exec,1
buffer_store_byte v9,off,s[96:99],s55 sc1
s_mov_b64 exec,-1
s_nop 1
s_branch L_arr3
L_arr4_o:
s_nop 1
v_mov_b32 v9,s53
s_mov_b64 exec,1
buffer_store_byte v9,off,s[96:99],s55 sc1
s_mov_b64 exec,-1
s_nop 1
s_branch L_arr4
L_arr5_o:
s_nop 1
v_mov_b32 v9,s53
s_mov_b64 exec,1
buffer_store_byte v9,off,s[96:99],s55 sc1
s_mov_b64 exec,-1
s_nop 1
s_branch L_arr5
L_arr6_o:
s_nop 1
v_mov_b32 v9,s53
s_mov_b64 exec,1
buffer_store_byte v9,off,s[96:99],s55 sc1
s_mov_b64 exec,-1
s_nop 1
s_branch L_arr6
L_noA1_1_o:
s_swappc_b64 s[62:63],s[64:65]
s_branch L_noA1_1
L_noP1_1_o:
s_swappc_b64 s[62:63],s[80:81]
s_branch L_noP1_1
L_noA2_1_o:
s_swappc_b64 s[62:63],s[60:61]
s_branch L_noA2_1
L_noP2_1_o:
s_swappc_b64 s[62:63],s[80:81]
s_branch L_noP2_1
L_noA3_1_o:
s_swappc_b64 s[62:63],s[64:65]
s_swappc_b64 s[62:63],s[66:67]
s_branch L_noA3_1
L_noP3_1_o:
s_swappc_b64 s[62:63],s[80:81]
s_branch L_noP3_1
L_noA4_1_o:
s_swappc_b64 s[62:63],s[60:61]
s_branch L_noA4_1
L_noP4_1_o:
s_swappc_b64 s[62:63],s[80:81]
s_branch L_noP4_1
L_noA5_1_o:
s_swappc_b64 s[62:63],s[64:65]
s_swappc_b64 s[62:63],s[66:67]
s_branch L_noA5_1
L_noP5_1_o:
s_swappc_b64 s[62:63],s[80:81]
s_branch L_noP5_1
L_noA6_1_o:
s_swappc_b64 s[62:63],s[60:61]
s_branch L_noA6_1
L_noP6_1_o:
s_swappc_b64 s[62:63],s[80:81]
s_branch L_noP6_1
L_noA7_1_o:
s_swappc_b64 s[62:63],s[64:65]
s_swappc_b64 s[62:63],s[66:67]
s_branch L_noA7_1
L_noP7_1_o:
s_swappc_b64 s[62:63],s[80:81]
s_branch L_noP7_1
L_noA8_1_o:
s_swappc_b64 s[62:63],s[60:61]
s_branch L_noA8_1
L_noP8_1_o:
s_swappc_b64 s[62:63],s[80:81]
s_branch L_noP8_1
L_noA9_1_o:
s_swappc_b64 s[62:63],s[64:65]
s_swappc_b64 s[62:63],s[66:67]
s_branch L_noA9_1
L_noP9_1_o:
s_swappc_b64 s[62:63],s[80:81]
s_branch L_noP9_1
L_noA10_1_o:
s_swappc_b64 s[62:63],s[60:61]
s_branch L_noA10_1
L_noP10_1_o:
s_swappc_b64 s[62:63],s[80:81]
s_branch L_noP10_1
L_noA11_1_o:
s_swappc_b64 s[62:63],s[64:65]
s_swappc_b64 s[62:63],s[66:67]
s_branch L_noA11_1
L_noP11_1_o:
s_swappc_b64 s[62:63],s[80:81]
s_branch L_noP11_1
L_noA12_1_o:
s_swappc_b64 s[62:63],s[60:61]
s_branch L_noA12_1
L_noP12_1_o:
s_swappc_b64 s[62:63],s[80:81]
s_branch L_noP12_1
L_noA13_1_o:
s_swappc_b64 s[62:63],s[64:65]
s_swappc_b64 s[62:63],s[66:67]
s_branch L_noA13_1
L_noP13_1_o:
s_swappc_b64 s[62:63],s[80:81]
s_branch L_noP13_1
L_noA14_1_o:
s_swappc_b64 s[62:63],s[60:61]
s_branch L_noA14_1
L_noP14_1_o:
s_swappc_b64 s[62:63],s[80:81]
s_branch L_noP14_1
L_noA15_1_o:
s_swappc_b64 s[62:63],s[64:65]
s_swappc_b64 s[62:63],s[66:67]
s_branch L_noA15_1
L_noP15_1_o:
s_swappc_b64 s[62:63],s[80:81]
s_branch L_noP15_1
L_code_end:
.section .rodata,"a"
.p2align 6
.amdhsa_kernel standalone__gqa_block_cached__near_ridge_kernel
  .amdhsa_next_free_vgpr 512
  .amdhsa_next_free_sgpr 102
  .amdhsa_accum_offset 256
  .amdhsa_group_segment_fixed_size 0
  .amdhsa_kernarg_size 64
  .amdhsa_user_sgpr_count 2
  .amdhsa_user_sgpr_kernarg_segment_ptr 1
  .amdhsa_system_sgpr_workgroup_id_x 1
.end_amdhsa_kernel
```
